```python
import torch

def _softmax(x, axis=-1):
    return torch.softmax(x, dim=axis)

def _gelu(x):
    return torch.nn.functional.gelu(x, approximate='tanh')

def _silu(x):
    return torch.nn.functional.silu(x)

def _sigmoid(x):
    return torch.sigmoid(x)

def _layernorm(x, axis=-1, eps=1e-05):
    m = x.mean(dim=axis, keepdim=True)
    v = x.var(dim=axis, keepdim=True, unbiased=False)
    return (x - m) / torch.sqrt(v + eps)

def _scatter_add(tgt, idx, src, axis=0):
    return tgt.clone().index_add_(axis, idx, src)

def _segment_sum(src, seg, n):
    out = torch.zeros((n,) + src.shape[1:], dtype=src.dtype)
    return out.index_add_(0, seg, src)

def _pad(x, pw):
    flat = tuple((v for pair in reversed(pw) for v in pair))
    return torch.nn.functional.pad(x, flat)
kernel_name = 'sequential_preLN__memory_aug_recurrent_mem_tr__dense_activation_silu__prompt'

def setup_inputs():

    _w = lambda a: (lambda t: t.to(torch.bfloat16) if t.is_floating_point() else t)(torch.as_tensor(a))

    def _A_setup():
        B, S, Dm = (1, 2048, 1024)
        H, Dh = (32, 128)
        M, seg = (8, 32)
        seg = min(seg, S)
        S = S // seg * seg
        return {'x': _w((lambda *s: torch.randn(*s, dtype=torch.bfloat16) * 0.05)(B, S, Dm)), 'mem0': _w((lambda *s: torch.randn(*s, dtype=torch.bfloat16) * 0.2)(B, M, Dm)), 'Wq': _w((lambda *s: torch.randn(*s, dtype=torch.bfloat16) * 1.6)(Dm, H, Dh) * Dm ** (-0.5)), 'Wk': _w((lambda *s: torch.randn(*s, dtype=torch.bfloat16) * 1.6)(Dm, H, Dh) * Dm ** (-0.5)), 'Wv': _w((lambda *s: torch.randn(*s, dtype=torch.bfloat16) * 0.2)(Dm, H, Dh) * Dm ** (-0.5)), 'Wo': _w((lambda *s: torch.randn(*s, dtype=torch.bfloat16) * 0.2)(H, Dh, Dm) * (H * Dh) ** (-0.5)), 'seg_len': seg}
    _A_in = _A_setup()

    def _B_setup():
        B, S, D, F = (1, 2048, 1024, 3584)
        return {'x': _w((lambda *s: torch.randn(*s, dtype=torch.bfloat16) * 0.05)(B, S, D)), 'w1': _w((lambda *s: torch.randn(*s, dtype=torch.bfloat16) * 0.8)(D, F) * D ** (-0.5)), 'w2': _w((lambda *s: torch.randn(*s, dtype=torch.bfloat16) * 0.1)(F, D) * F ** (-0.5))}
    _B_in = _B_setup()
    return {'A_x': _A_in['x'], 'A_mem0': _A_in['mem0'], 'A_Wq': _A_in['Wq'], 'A_Wk': _A_in['Wk'], 'A_Wv': _A_in['Wv'], 'A_Wo': _A_in['Wo'], 'A_seg_len': _A_in['seg_len'], 'B_x': _B_in['x'], 'B_w1': _B_in['w1'], 'B_w2': _B_in['w2']}

def reference(A_x, A_mem0, A_Wq, A_Wk, A_Wv, A_Wo, A_seg_len, B_x, B_w1, B_w2):

    def _A_ref(x, mem0, Wq, Wk, Wv, Wo, seg_len):
        B, S, Dm = x.shape
        H, Dh = (Wq.shape[1], Wq.shape[2])
        M = mem0.shape[1]
        scale = Dh ** (-0.5)
        n_seg = S // seg_len
        L = M + seg_len
        idx = torch.arange(L)
        mask = (idx[:, None] < M) | (idx[:, None] >= idx[None, :])
        mem = mem0
        outs = []
        for s in range(n_seg):
            xs = x[:, s * seg_len:(s + 1) * seg_len, :].clone()
            h = torch.concatenate([mem, xs], axis=1)
            q = torch.einsum('btd,dhe->bhte', h, Wq)
            k = torch.einsum('btd,dhe->bhte', h, Wk)
            v = torch.einsum('btd,dhe->bhte', h, Wv)
            scores = torch.einsum('bhqe,bhke->bhqk', q, k) * scale
            scores = torch.where(mask[None, None], scores, -1000000000.0)
            p = _softmax(scores, axis=-1)
            o = torch.einsum('bhqk,bhke->bhqe', p, v)
            o = torch.einsum('bhte,hed->btd', o, Wo)
            mem = o[:, :M, :].clone()
            outs.append(o[:, M:, :])
        return torch.concatenate(outs, axis=1)

    def _B_ref(x, w1, w2):
        h = torch.einsum('bsd,df->bsf', x, w1)
        h = _silu(h)
        out = torch.einsum('bsf,fd->bsd', h, w2)
        return out
    x = A_x
    h = x + _A_ref(_layernorm(x, axis=-1), A_mem0, A_Wq, A_Wk, A_Wv, A_Wo, A_seg_len)
    h2 = h + _B_ref(_layernorm(h, axis=-1), B_w1, B_w2)
    return h2
```

```asm
; @launch kernel=mega_kernel grid=(256,1,1) block=(256,1,1) lds=163840
.amdgcn_target "amdgcn-amd-amdhsa--gfx950"
.text
.globl mega_kernel
.p2align 8
.type mega_kernel,@function
mega_kernel:
 s_cmp_ge_u32 s2, 256
 s_cbranch_scc1 chain_exit
 s_load_dwordx2 s[28:29], s[0:1], 8
 s_load_dwordx4 s[40:43], s[0:1], 16
 s_load_dwordx4 s[44:47], s[0:1], 32
 s_load_dwordx2 s[30:31], s[0:1], 96
 v_and_b32 v1, 63, v0
 v_lshrrev_b32 v2, 6, v0
 s_nop 0
 v_readfirstlane_b32 s32, v2
 s_getreg_b32 s48, hwreg(HW_REG_XCC_ID)
 s_and_b32 s48, s48, 15
 s_mov_b32 s38, 0x400000

 s_waitcnt lgkmcnt(0)
 s_mov_b32 s4, s30
 s_and_b32 s5, s31, 0xffff
 s_mov_b32 s6, 0x10000000
 s_mov_b32 s7, 0x00020000
 s_mov_b32 s8, s40
 s_and_b32 s9, s41, 0xffff
 s_mov_b32 s10, 0x800000
 s_mov_b32 s11, 0x00020000
 s_mov_b32 s12, s42
 s_and_b32 s13, s43, 0xffff
 s_mov_b32 s14, 0x800000
 s_mov_b32 s15, 0x00020000
 s_mov_b32 s16, s44
 s_and_b32 s17, s45, 0xffff
 s_mov_b32 s18, 0x800000
 s_mov_b32 s19, 0x00020000
 s_mov_b32 s20, s46
 s_and_b32 s21, s47, 0xffff
 s_mov_b32 s22, 0x800000
 s_mov_b32 s23, 0x00020000
 s_mov_b32 s24, s28
 s_and_b32 s25, s29, 0xffff
 s_mov_b32 s26, 0x4000
 s_mov_b32 s27, 0x00020000
 s_load_dwordx2 s[92:93], s[0:1], 0
 s_load_dwordx2 s[96:97], s[0:1], 88
 v_lshrrev_b32 v2, 6, v0
 s_lshl_b32 s3, s2, 3
 v_lshl_add_u32 v2, v2, 1, s3
 v_lshlrev_b32 v2, 11, v2
 v_lshl_add_u32 v2, v1, 4, v2
 v_mov_b32 v52, 0
 s_waitcnt lgkmcnt(0)
 s_and_b32 s93, s93, 0xffff
 s_mov_b32 s94, 4194304
 s_mov_b32 s95, 0x00020000
 s_and_b32 s97, s97, 0xffff
 s_mov_b32 s98, 256
 s_mov_b32 s99, 0x00020000

 buffer_load_dwordx4 v[32:35], v2, s[92:95], 0 offen offset:0
 buffer_load_dwordx4 v[36:39], v2, s[92:95], 0 offen offset:1024
 buffer_load_dwordx4 v[40:43], v2, s[92:95], 0 offen offset:2048
 buffer_load_dwordx4 v[44:47], v2, s[92:95], 0 offen offset:3072
 s_or_b32 s36, s2, s32
 s_cbranch_scc1 mega_i1
 v_and_b32 v3, 31, v1
 v_lshlrev_b32 v3, 12, v3
 s_mov_b32 s36, 159383552
 buffer_store_dword v52, v3, s[4:7], s36 offen sc1
 v_lshlrev_b32 v3, 6, v1
 s_mov_b32 s36, 159514624
 buffer_store_dword v52, v3, s[4:7], s36 offen sc1
 s_waitcnt vmcnt(0)
 v_mov_b32 v3, 1
 s_mov_b64 exec, 1
 buffer_store_dword v3, v52, s[96:99], 0 offen sc1
 s_mov_b64 exec, -1

mega_i1:
 v_mov_b32 v48, -1
 v_mov_b32 v49, -1
 v_mov_b32 v50, -1
 v_mov_b32 v51, -1
 v_lshlrev_b32 v3, 4, v0
 s_lshl_b32 s38, s2, 14

 s_add_u32 s36, s38, 117440512
 buffer_store_dwordx4 v[48:51], v3, s[4:7], s36 offen sc1
 s_add_u32 s36, s38, 125829120
 buffer_store_dwordx4 v[48:51], v3, s[4:7], s36 offen sc1
 s_add_u32 s36, s38, 117444608
 buffer_store_dwordx4 v[48:51], v3, s[4:7], s36 offen sc1
 s_add_u32 s36, s38, 125833216
 buffer_store_dwordx4 v[48:51], v3, s[4:7], s36 offen sc1
 s_add_u32 s36, s38, 117448704
 buffer_store_dwordx4 v[48:51], v3, s[4:7], s36 offen sc1
 s_add_u32 s36, s38, 125837312
 buffer_store_dwordx4 v[48:51], v3, s[4:7], s36 offen sc1
 s_add_u32 s36, s38, 117452800
 buffer_store_dwordx4 v[48:51], v3, s[4:7], s36 offen sc1
 s_add_u32 s36, s38, 125841408
 buffer_store_dwordx4 v[48:51], v3, s[4:7], s36 offen sc1
 v_and_b32 v53, 15, v0
 v_lshlrev_b32 v53, 7, v53
 s_lshl_b32 s36, s2, 11
 s_add_u32 s36, s36, 161480704
 buffer_store_dword v52, v53, s[4:7], s36 offen sc1

 v_lshrrev_b32 v27, 6, v0
 v_mul_u32_u24 v24, 4128, v27
 v_lshl_add_u32 v24, v1, 4, v24
 v_and_b32 v28, 7, v1
 v_lshrrev_b32 v29, 3, v1
 v_lshl_add_u32 v29, v27, 5, v29
 v_mul_u32_u24 v25, 2064, v28
 v_lshl_add_u32 v25, v29, 4, v25
 v_lshlrev_b32 v26, 9, v29
 v_lshl_add_u32 v26, v28, 4, v26
 s_lshr_b32 s36, s3, 5
 s_lshl_b32 s36, s36, 16
 s_and_b32 s37, s3, 31
 s_lshl_b32 s37, s37, 4
 s_add_u32 s36, s36, s37
 v_add_u32 v26, s36, v26

 s_waitcnt vmcnt(9)
 v_lshlrev_b32 v8, 16, v32
 v_and_b32 v9, 0xffff0000, v32
 v_lshlrev_b32 v10, 16, v33
 v_and_b32 v11, 0xffff0000, v33
 v_lshlrev_b32 v12, 16, v34
 v_and_b32 v13, 0xffff0000, v34
 v_lshlrev_b32 v14, 16, v35
 v_and_b32 v15, 0xffff0000, v35
 v_lshlrev_b32 v16, 16, v36
 v_and_b32 v17, 0xffff0000, v36
 v_lshlrev_b32 v18, 16, v37
 v_and_b32 v19, 0xffff0000, v37
 v_lshlrev_b32 v20, 16, v38
 v_and_b32 v21, 0xffff0000, v38
 v_lshlrev_b32 v22, 16, v39
 v_and_b32 v23, 0xffff0000, v39
 v_add_f32 v4, v8, v9
 v_add_f32 v4, v4, v10
 v_add_f32 v4, v4, v11
 v_add_f32 v4, v4, v12
 v_add_f32 v4, v4, v13
 v_add_f32 v4, v4, v14
 v_add_f32 v4, v4, v15
 v_add_f32 v4, v4, v16
 v_add_f32 v4, v4, v17
 v_add_f32 v4, v4, v18
 v_add_f32 v4, v4, v19
 v_add_f32 v4, v4, v20
 v_add_f32 v4, v4, v21
 v_add_f32 v4, v4, v22
 v_add_f32 v4, v4, v23
 s_nop 1
 v_add_f32_dpp v4, v4, v4 row_ror:8 row_mask:0xf bank_mask:0xf
 s_nop 1
 v_add_f32_dpp v4, v4, v4 row_ror:4 row_mask:0xf bank_mask:0xf
 s_nop 1
 v_add_f32_dpp v4, v4, v4 row_ror:2 row_mask:0xf bank_mask:0xf
 s_nop 1
 v_add_f32_dpp v4, v4, v4 row_ror:1 row_mask:0xf bank_mask:0xf
 v_mov_b32 v5, v4
 s_nop 1
 v_permlane16_swap_b32 v4, v5
 v_add_f32 v4, v4, v5
 v_mov_b32 v5, v4
 s_nop 1
 v_permlane32_swap_b32 v4, v5
 v_add_f32 v4, v4, v5
 v_mul_f32 v6, 0x3a800000, v4
 v_mov_b32 v7, 0
 v_sub_f32 v5, v8, v6
 v_fmac_f32 v7, v5, v5
 v_sub_f32 v5, v9, v6
 v_fmac_f32 v7, v5, v5
 v_sub_f32 v5, v10, v6
 v_fmac_f32 v7, v5, v5
 v_sub_f32 v5, v11, v6
 v_fmac_f32 v7, v5, v5
 v_sub_f32 v5, v12, v6
 v_fmac_f32 v7, v5, v5
 v_sub_f32 v5, v13, v6
 v_fmac_f32 v7, v5, v5
 v_sub_f32 v5, v14, v6
 v_fmac_f32 v7, v5, v5
 v_sub_f32 v5, v15, v6
 v_fmac_f32 v7, v5, v5
 v_sub_f32 v5, v16, v6
 v_fmac_f32 v7, v5, v5
 v_sub_f32 v5, v17, v6
 v_fmac_f32 v7, v5, v5
 v_sub_f32 v5, v18, v6
 v_fmac_f32 v7, v5, v5
 v_sub_f32 v5, v19, v6
 v_fmac_f32 v7, v5, v5
 v_sub_f32 v5, v20, v6
 v_fmac_f32 v7, v5, v5
 v_sub_f32 v5, v21, v6
 v_fmac_f32 v7, v5, v5
 v_sub_f32 v5, v22, v6
 v_fmac_f32 v7, v5, v5
 v_sub_f32 v5, v23, v6
 v_fmac_f32 v7, v5, v5
 s_nop 1
 v_add_f32_dpp v7, v7, v7 row_ror:8 row_mask:0xf bank_mask:0xf
 s_nop 1
 v_add_f32_dpp v7, v7, v7 row_ror:4 row_mask:0xf bank_mask:0xf
 s_nop 1
 v_add_f32_dpp v7, v7, v7 row_ror:2 row_mask:0xf bank_mask:0xf
 s_nop 1
 v_add_f32_dpp v7, v7, v7 row_ror:1 row_mask:0xf bank_mask:0xf
 v_mov_b32 v5, v7
 s_nop 1
 v_permlane16_swap_b32 v7, v5
 v_add_f32 v7, v7, v5
 v_mov_b32 v5, v7
 s_nop 1
 v_permlane32_swap_b32 v7, v5
 v_add_f32 v7, v7, v5
 v_mul_f32 v7, 0x3a800000, v7
 v_cvt_pk_bf16_f32 v7, v7, v7
 v_lshlrev_b32 v7, 16, v7
 v_add_f32 v7, 0x3727c5ac, v7
 v_cvt_pk_bf16_f32 v7, v7, v7
 v_lshlrev_b32 v7, 16, v7
 v_sqrt_f32 v7, v7
 s_nop 0
 v_cvt_pk_bf16_f32 v7, v7, v7
 v_lshlrev_b32 v7, 16, v7
 v_rcp_f32 v7, v7
 v_cvt_pk_bf16_f32 v6, v6, v6
 v_lshlrev_b32 v6, 16, v6
 v_sub_f32 v8, v8, v6
 v_sub_f32 v9, v9, v6
 v_cvt_pk_bf16_f32 v5, v8, v9
 v_lshlrev_b32 v8, 16, v5
 v_and_b32 v9, 0xffff0000, v5
 v_mul_f32 v8, v8, v7
 v_mul_f32 v9, v9, v7
 v_cvt_pk_bf16_f32 v32, v8, v9
 v_sub_f32 v10, v10, v6
 v_sub_f32 v11, v11, v6
 v_cvt_pk_bf16_f32 v5, v10, v11
 v_lshlrev_b32 v10, 16, v5
 v_and_b32 v11, 0xffff0000, v5
 v_mul_f32 v10, v10, v7
 v_mul_f32 v11, v11, v7
 v_cvt_pk_bf16_f32 v33, v10, v11
 v_sub_f32 v12, v12, v6
 v_sub_f32 v13, v13, v6
 v_cvt_pk_bf16_f32 v5, v12, v13
 v_lshlrev_b32 v12, 16, v5
 v_and_b32 v13, 0xffff0000, v5
 v_mul_f32 v12, v12, v7
 v_mul_f32 v13, v13, v7
 v_cvt_pk_bf16_f32 v34, v12, v13
 v_sub_f32 v14, v14, v6
 v_sub_f32 v15, v15, v6
 v_cvt_pk_bf16_f32 v5, v14, v15
 v_lshlrev_b32 v14, 16, v5
 v_and_b32 v15, 0xffff0000, v5
 v_mul_f32 v14, v14, v7
 v_mul_f32 v15, v15, v7
 v_cvt_pk_bf16_f32 v35, v14, v15
 v_sub_f32 v16, v16, v6
 v_sub_f32 v17, v17, v6
 v_cvt_pk_bf16_f32 v5, v16, v17
 v_lshlrev_b32 v16, 16, v5
 v_and_b32 v17, 0xffff0000, v5
 v_mul_f32 v16, v16, v7
 v_mul_f32 v17, v17, v7
 v_cvt_pk_bf16_f32 v36, v16, v17
 v_sub_f32 v18, v18, v6
 v_sub_f32 v19, v19, v6
 v_cvt_pk_bf16_f32 v5, v18, v19
 v_lshlrev_b32 v18, 16, v5
 v_and_b32 v19, 0xffff0000, v5
 v_mul_f32 v18, v18, v7
 v_mul_f32 v19, v19, v7
 v_cvt_pk_bf16_f32 v37, v18, v19
 v_sub_f32 v20, v20, v6
 v_sub_f32 v21, v21, v6
 v_cvt_pk_bf16_f32 v5, v20, v21
 v_lshlrev_b32 v20, 16, v5
 v_and_b32 v21, 0xffff0000, v5
 v_mul_f32 v20, v20, v7
 v_mul_f32 v21, v21, v7
 v_cvt_pk_bf16_f32 v38, v20, v21
 v_sub_f32 v22, v22, v6
 v_sub_f32 v23, v23, v6
 v_cvt_pk_bf16_f32 v5, v22, v23
 v_lshlrev_b32 v22, 16, v5
 v_and_b32 v23, 0xffff0000, v5
 v_mul_f32 v22, v22, v7
 v_mul_f32 v23, v23, v7
 v_cvt_pk_bf16_f32 v39, v22, v23
 v_lshlrev_b32 v8, 16, v40
 v_and_b32 v9, 0xffff0000, v40
 v_lshlrev_b32 v10, 16, v41
 v_and_b32 v11, 0xffff0000, v41
 v_lshlrev_b32 v12, 16, v42
 v_and_b32 v13, 0xffff0000, v42
 v_lshlrev_b32 v14, 16, v43
 v_and_b32 v15, 0xffff0000, v43
 v_lshlrev_b32 v16, 16, v44
 v_and_b32 v17, 0xffff0000, v44
 v_lshlrev_b32 v18, 16, v45
 v_and_b32 v19, 0xffff0000, v45
 v_lshlrev_b32 v20, 16, v46
 v_and_b32 v21, 0xffff0000, v46
 v_lshlrev_b32 v22, 16, v47
 v_and_b32 v23, 0xffff0000, v47
 v_add_f32 v4, v8, v9
 v_add_f32 v4, v4, v10
 v_add_f32 v4, v4, v11
 v_add_f32 v4, v4, v12
 v_add_f32 v4, v4, v13
 v_add_f32 v4, v4, v14
 v_add_f32 v4, v4, v15
 v_add_f32 v4, v4, v16
 v_add_f32 v4, v4, v17
 v_add_f32 v4, v4, v18
 v_add_f32 v4, v4, v19
 v_add_f32 v4, v4, v20
 v_add_f32 v4, v4, v21
 v_add_f32 v4, v4, v22
 v_add_f32 v4, v4, v23
 s_nop 1
 v_add_f32_dpp v4, v4, v4 row_ror:8 row_mask:0xf bank_mask:0xf
 s_nop 1
 v_add_f32_dpp v4, v4, v4 row_ror:4 row_mask:0xf bank_mask:0xf
 s_nop 1
 v_add_f32_dpp v4, v4, v4 row_ror:2 row_mask:0xf bank_mask:0xf
 s_nop 1
 v_add_f32_dpp v4, v4, v4 row_ror:1 row_mask:0xf bank_mask:0xf
 v_mov_b32 v5, v4
 s_nop 1
 v_permlane16_swap_b32 v4, v5
 v_add_f32 v4, v4, v5
 v_mov_b32 v5, v4
 s_nop 1
 v_permlane32_swap_b32 v4, v5
 v_add_f32 v4, v4, v5
 v_mul_f32 v6, 0x3a800000, v4
 v_mov_b32 v7, 0
 v_sub_f32 v5, v8, v6
 v_fmac_f32 v7, v5, v5
 v_sub_f32 v5, v9, v6
 v_fmac_f32 v7, v5, v5
 v_sub_f32 v5, v10, v6
 v_fmac_f32 v7, v5, v5
 v_sub_f32 v5, v11, v6
 v_fmac_f32 v7, v5, v5
 v_sub_f32 v5, v12, v6
 v_fmac_f32 v7, v5, v5
 v_sub_f32 v5, v13, v6
 v_fmac_f32 v7, v5, v5
 v_sub_f32 v5, v14, v6
 v_fmac_f32 v7, v5, v5
 v_sub_f32 v5, v15, v6
 v_fmac_f32 v7, v5, v5
 v_sub_f32 v5, v16, v6
 v_fmac_f32 v7, v5, v5
 v_sub_f32 v5, v17, v6
 v_fmac_f32 v7, v5, v5
 v_sub_f32 v5, v18, v6
 v_fmac_f32 v7, v5, v5
 v_sub_f32 v5, v19, v6
 v_fmac_f32 v7, v5, v5
 v_sub_f32 v5, v20, v6
 v_fmac_f32 v7, v5, v5
 v_sub_f32 v5, v21, v6
 v_fmac_f32 v7, v5, v5
 v_sub_f32 v5, v22, v6
 v_fmac_f32 v7, v5, v5
 v_sub_f32 v5, v23, v6
 v_fmac_f32 v7, v5, v5
 s_nop 1
 v_add_f32_dpp v7, v7, v7 row_ror:8 row_mask:0xf bank_mask:0xf
 s_nop 1
 v_add_f32_dpp v7, v7, v7 row_ror:4 row_mask:0xf bank_mask:0xf
 s_nop 1
 v_add_f32_dpp v7, v7, v7 row_ror:2 row_mask:0xf bank_mask:0xf
 s_nop 1
 v_add_f32_dpp v7, v7, v7 row_ror:1 row_mask:0xf bank_mask:0xf
 v_mov_b32 v5, v7
 s_nop 1
 v_permlane16_swap_b32 v7, v5
 v_add_f32 v7, v7, v5
 v_mov_b32 v5, v7
 s_nop 1
 v_permlane32_swap_b32 v7, v5
 v_add_f32 v7, v7, v5
 v_mul_f32 v7, 0x3a800000, v7
 v_cvt_pk_bf16_f32 v7, v7, v7
 v_lshlrev_b32 v7, 16, v7
 v_add_f32 v7, 0x3727c5ac, v7
 v_cvt_pk_bf16_f32 v7, v7, v7
 v_lshlrev_b32 v7, 16, v7
 v_sqrt_f32 v7, v7
 s_nop 0
 v_cvt_pk_bf16_f32 v7, v7, v7
 v_lshlrev_b32 v7, 16, v7
 v_rcp_f32 v7, v7
 v_cvt_pk_bf16_f32 v6, v6, v6
 v_lshlrev_b32 v6, 16, v6
 v_sub_f32 v8, v8, v6
 v_sub_f32 v9, v9, v6
 v_cvt_pk_bf16_f32 v5, v8, v9
 v_lshlrev_b32 v8, 16, v5
 v_and_b32 v9, 0xffff0000, v5
 v_mul_f32 v8, v8, v7
 v_mul_f32 v9, v9, v7
 v_cvt_pk_bf16_f32 v40, v8, v9
 v_sub_f32 v10, v10, v6
 v_sub_f32 v11, v11, v6
 v_cvt_pk_bf16_f32 v5, v10, v11
 v_lshlrev_b32 v10, 16, v5
 v_and_b32 v11, 0xffff0000, v5
 v_mul_f32 v10, v10, v7
 v_mul_f32 v11, v11, v7
 v_cvt_pk_bf16_f32 v41, v10, v11
 v_sub_f32 v12, v12, v6
 v_sub_f32 v13, v13, v6
 v_cvt_pk_bf16_f32 v5, v12, v13
 v_lshlrev_b32 v12, 16, v5
 v_and_b32 v13, 0xffff0000, v5
 v_mul_f32 v12, v12, v7
 v_mul_f32 v13, v13, v7
 v_cvt_pk_bf16_f32 v42, v12, v13
 v_sub_f32 v14, v14, v6
 v_sub_f32 v15, v15, v6
 v_cvt_pk_bf16_f32 v5, v14, v15
 v_lshlrev_b32 v14, 16, v5
 v_and_b32 v15, 0xffff0000, v5
 v_mul_f32 v14, v14, v7
 v_mul_f32 v15, v15, v7
 v_cvt_pk_bf16_f32 v43, v14, v15
 v_sub_f32 v16, v16, v6
 v_sub_f32 v17, v17, v6
 v_cvt_pk_bf16_f32 v5, v16, v17
 v_lshlrev_b32 v16, 16, v5
 v_and_b32 v17, 0xffff0000, v5
 v_mul_f32 v16, v16, v7
 v_mul_f32 v17, v17, v7
 v_cvt_pk_bf16_f32 v44, v16, v17
 v_sub_f32 v18, v18, v6
 v_sub_f32 v19, v19, v6
 v_cvt_pk_bf16_f32 v5, v18, v19
 v_lshlrev_b32 v18, 16, v5
 v_and_b32 v19, 0xffff0000, v5
 v_mul_f32 v18, v18, v7
 v_mul_f32 v19, v19, v7
 v_cvt_pk_bf16_f32 v45, v18, v19
 v_sub_f32 v20, v20, v6
 v_sub_f32 v21, v21, v6
 v_cvt_pk_bf16_f32 v5, v20, v21
 v_lshlrev_b32 v20, 16, v5
 v_and_b32 v21, 0xffff0000, v5
 v_mul_f32 v20, v20, v7
 v_mul_f32 v21, v21, v7
 v_cvt_pk_bf16_f32 v46, v20, v21
 v_sub_f32 v22, v22, v6
 v_sub_f32 v23, v23, v6
 v_cvt_pk_bf16_f32 v5, v22, v23
 v_lshlrev_b32 v22, 16, v5
 v_and_b32 v23, 0xffff0000, v5
 v_mul_f32 v22, v22, v7
 v_mul_f32 v23, v23, v7
 v_cvt_pk_bf16_f32 v47, v22, v23
 ds_write_b128 v24, v[32:35] offset:0
 ds_write_b128 v24, v[36:39] offset:1024
 ds_write_b128 v24, v[40:43] offset:2064
 ds_write_b128 v24, v[44:47] offset:3088
 s_waitcnt lgkmcnt(0)
 s_barrier
 ds_read_b128 v[32:35], v25 offset:0
 ds_read_b128 v[36:39], v25 offset:128
 ds_read_b128 v[40:43], v25 offset:256
 ds_read_b128 v[44:47], v25 offset:384
 s_mov_b32 s36, 0
 s_waitcnt lgkmcnt(3)
 buffer_store_dwordx4 v[32:35], v26, s[4:7], s36 offen sc1
 s_mov_b32 s36, 4096
 s_waitcnt lgkmcnt(2)
 buffer_store_dwordx4 v[36:39], v26, s[4:7], s36 offen sc1
 s_mov_b32 s36, 8192
 s_waitcnt lgkmcnt(1)
 buffer_store_dwordx4 v[40:43], v26, s[4:7], s36 offen sc1
 s_mov_b32 s36, 12288
 s_waitcnt lgkmcnt(0)
 buffer_store_dwordx4 v[44:47], v26, s[4:7], s36 offen sc1
 s_mov_b32 s38, 0x400000
 s_waitcnt vmcnt(0)
 s_barrier
 s_cmp_lg_u32 s32, 0
 s_cbranch_scc1 mega_i3

mega_i2:
 buffer_load_dword v3, v52, s[96:99], 0 offen sc1
 s_sub_u32 s38, s38, 1
 s_cbranch_scc1 chain_exit
 s_waitcnt vmcnt(0)
 v_cmp_eq_u32 vcc, 0, v3
 s_cbranch_vccnz mega_i2
 s_and_b32 s36, s2, 7
 s_lshl_b32 s36, s36, 12
 s_add_u32 s36, s36, 159453184
 v_mov_b32 v3, 1
 s_mov_b64 exec, 1
 buffer_atomic_add v3, v52, s[4:7], s36 offen
 s_mov_b64 exec, -1

mega_i3:
 s_cmp_lg_u32 s32, 0
 s_cbranch_scc1 chain_role_wait
 s_and_b32 s33, s48, 7
 s_cmp_ge_u32 s48, 8
 s_cselect_b32 s49, 0x10001, 1
 s_lshl_b32 s50, s33, 12
 s_add_u32 s50, s50, 159383552
 v_mov_b32 v2, s49
 v_mov_b32 v3, 0
 s_mov_b64 exec, 1
 buffer_atomic_add v2, v3, s[4:7], s50 offen sc0
 s_waitcnt vmcnt(0)
 s_mov_b64 exec, -1
 v_readfirstlane_b32 s34, v2
 s_and_b32 s34, s34, 0xffff
 s_cmp_ge_u32 s33, 4
 s_cbranch_scc1 chain_free
 s_cmp_lt_u32 s34, 32
 s_cbranch_scc1 chain_role_ok

chain_free:
 v_lshlrev_b32 v3, 12, v1
 v_and_b32 v3, 0x7fff, v3
 s_mov_b32 s50, 159383552

chain_ovf_poll:
 s_sub_u32 s38, s38, 1
 s_cbranch_scc1 chain_exit
 buffer_load_dword v2, v3, s[4:7], s50 offen sc1
 s_waitcnt vmcnt(0)
 v_and_b32 v2, 0xffff, v2
 s_mov_b32 s49, 0

 v_readlane_b32 s58, v2, 0
 v_readlane_b32 s59, v2, 1
 v_readlane_b32 s60, v2, 2
 v_readlane_b32 s61, v2, 3
 v_readlane_b32 s62, v2, 4
 v_readlane_b32 s63, v2, 5
 v_readlane_b32 s64, v2, 6
 v_readlane_b32 s65, v2, 7
 s_nop 1
 s_add_u32 s49, s49, s58
 s_add_u32 s49, s49, s59
 s_add_u32 s49, s49, s60
 s_add_u32 s49, s49, s61
 s_add_u32 s49, s49, s62
 s_add_u32 s49, s49, s63
 s_add_u32 s49, s49, s64
 s_add_u32 s49, s49, s65
 s_cmp_lg_u32 s49, 256
 s_cbranch_scc1 chain_ovf_poll
 v_mov_b32 v2, 1
 v_mov_b32 v3, 0
 s_mov_b32 s50, 159449088
 s_mov_b64 exec, 1
 buffer_atomic_add v2, v3, s[4:7], s50 offen sc0
 s_waitcnt vmcnt(0)
 s_mov_b64 exec, -1
 v_readfirstlane_b32 s49, v2

 s_min_u32 s50, s58, 32
 s_sub_u32 s51, 32, s50
 s_cmp_lt_u32 s49, s51
 s_cbranch_scc0 chain_vac_1
 s_mov_b32 s33, 0
 s_add_u32 s34, s50, s49
 s_branch chain_role_ok

chain_vac_1:
 s_sub_u32 s49, s49, s51
 s_min_u32 s50, s59, 32
 s_sub_u32 s51, 32, s50
 s_cmp_lt_u32 s49, s51
 s_cbranch_scc0 chain_vac_2
 s_mov_b32 s33, 1
 s_add_u32 s34, s50, s49
 s_branch chain_role_ok

chain_vac_2:
 s_sub_u32 s49, s49, s51
 s_min_u32 s50, s60, 32
 s_sub_u32 s51, 32, s50
 s_cmp_lt_u32 s49, s51
 s_cbranch_scc0 chain_vac_3
 s_mov_b32 s33, 2
 s_add_u32 s34, s50, s49
 s_branch chain_role_ok

chain_vac_3:
 s_sub_u32 s49, s49, s51
 s_min_u32 s50, s61, 32
 s_sub_u32 s51, 32, s50
 s_cmp_lt_u32 s49, s51
 s_cbranch_scc0 chain_vac_4
 s_mov_b32 s33, 3
 s_add_u32 s34, s50, s49
 s_branch chain_role_ok

chain_vac_4:
 s_sub_u32 s49, s49, s51
 s_mov_b32 s33, 4
 s_mov_b32 s34, s49

chain_role_ok:
 s_lshl_b32 s49, s33, 5
 s_add_u32 s49, s49, s34
 v_mov_b32 v2, s49
 v_mov_b32 v3, 20480
 ds_write_b32 v3, v2
 s_waitcnt lgkmcnt(0)

chain_role_wait:
 s_barrier
 v_mov_b32 v3, 20480
 ds_read_b32 v2, v3
 s_waitcnt lgkmcnt(0)
 v_readfirstlane_b32 s49, v2
 s_cmp_ge_u32 s49, 128
 s_cbranch_scc1 mega_worker
 s_lshr_b32 s33, s49, 5
 s_and_b32 s34, s49, 31
 s_lshr_b32 s50, s34, 2
 s_mul_i32 s35, s33, 8
 s_add_u32 s35, s35, s50
 s_and_b32 s36, s34, 3

 v_and_b32 v80, 15, v1
 v_lshrrev_b32 v81, 4, v1
 v_and_b32 v82, 7, v1
 v_lshrrev_b32 v83, 3, v80
 v_and_b32 v84, 1, v81
 v_lshrrev_b32 v85, 1, v81

 s_mov_b32 s48, 0
 s_mul_i32 s49, s33, 16384
 s_add_u32 s48, s48, s49
 s_mul_i32 s49, s32, 4096
 s_add_u32 s48, s48, s49
 v_mov_b32 v2, s48
 v_mul_u32_u24 v86, 2048, v83
 v_add_u32 v2, v2, v86
 v_mul_u32_u24 v86, 64, v82
 v_add_u32 v2, v2, v86
 v_mul_u32_u24 v86, 16, v81
 v_add_u32 v2, v2, v86
 s_mov_b32 s48, 0
 s_mul_i32 s49, s33, 16384
 s_add_u32 s48, s48, s49
 s_mul_i32 s49, s34, 512
 s_add_u32 s48, s48, s49
 v_mov_b32 v3, s48
 v_mul_u32_u24 v86, 64, v82
 v_add_u32 v3, v3, v86
 v_mul_u32_u24 v86, 32, v83
 v_add_u32 v3, v3, v86
 v_mul_u32_u24 v86, 8, v81
 v_add_u32 v3, v3, v86
 s_mov_b32 s48, 0
 s_mul_i32 s49, s35, 4096
 s_add_u32 s48, s48, s49
 s_mul_i32 s49, s36, 1024
 s_add_u32 s48, s48, s49
 v_mov_b32 v4, s48
 v_mul_u32_u24 v86, 32, v80
 v_add_u32 v4, v4, v86
 v_mul_u32_u24 v86, 8, v81
 v_add_u32 v4, v4, v86
 s_mov_b32 s48, 0
 s_mul_i32 s49, s35, 4096
 s_add_u32 s48, s48, s49
 v_mov_b32 v5, s48
 v_mul_u32_u24 v86, 2048, v83
 v_add_u32 v5, v5, v86
 v_mul_u32_u24 v86, 512, v85
 v_add_u32 v5, v5, v86
 v_mul_u32_u24 v86, 32, v82
 v_add_u32 v5, v5, v86
 v_mul_u32_u24 v86, 16, v84
 v_add_u32 v5, v5, v86
 s_mov_b32 s48, 256
 s_mul_i32 s49, s35, 4096
 s_add_u32 s48, s48, s49
 v_mov_b32 v6, s48
 v_mul_u32_u24 v86, 512, v85
 v_add_u32 v6, v6, v86
 v_mul_u32_u24 v86, 32, v82
 v_add_u32 v6, v6, v86
 v_mul_u32_u24 v86, 16, v84
 v_add_u32 v6, v6, v86
 s_mov_b32 s48, 0
 s_mul_i32 s49, s33, 16384
 s_add_u32 s48, s48, s49
 s_mul_i32 s49, s34, 512
 s_add_u32 s48, s48, s49
 v_mov_b32 v7, s48
 v_mul_u32_u24 v86, 32, v82
 v_add_u32 v7, v7, v86
 v_mul_u32_u24 v86, 8, v81
 v_add_u32 v7, v7, v86
 s_mov_b32 s48, 0
 s_mul_i32 s49, s33, 16384
 s_add_u32 s48, s48, s49
 s_mul_i32 s49, s32, 4096
 s_add_u32 s48, s48, s49
 v_mov_b32 v8, s48
 v_mul_u32_u24 v86, 1024, v83
 v_add_u32 v8, v8, v86
 v_mul_u32_u24 v86, 256, v85
 v_add_u32 v8, v8, v86
 v_mul_u32_u24 v86, 32, v82
 v_add_u32 v8, v8, v86
 v_mul_u32_u24 v86, 16, v84
 v_add_u32 v8, v8, v86
 s_mov_b32 s48, 0
 s_mul_i32 s49, s33, 32768
 s_add_u32 s48, s48, s49
 s_mul_i32 s49, s34, 1024
 s_add_u32 s48, s48, s49
 v_mov_b32 v9, s48
 v_mul_u32_u24 v86, 16, v1
 v_add_u32 v9, v9, v86
 s_mov_b32 s48, 0
 s_mul_i32 s49, s34, 1024
 s_add_u32 s48, s48, s49
 v_mov_b32 v10, s48
 v_mul_u32_u24 v86, 16, v1
 v_add_u32 v10, v10, v86
 s_mov_b32 s48, 0
 s_mul_i32 s49, s35, 2048
 s_add_u32 s48, s48, s49
 s_mul_i32 s49, s36, 512
 s_add_u32 s48, s48, s49
 v_mov_b32 v11, s48
 v_mul_u32_u24 v86, 16, v80
 v_add_u32 v11, v11, v86
 v_mul_u32_u24 v86, 8, v84
 v_add_u32 v11, v11, v86
 s_mov_b32 s48, 0
 s_mul_i32 s49, s35, 8192
 s_add_u32 s48, s48, s49
 v_mov_b32 v12, s48
 v_mul_u32_u24 v86, 16, v80
 v_add_u32 v12, v12, v86
 v_mul_u32_u24 v86, 512, v84
 v_add_u32 v12, v12, v86
 v_mul_u32_u24 v86, 1024, v85
 v_add_u32 v12, v12, v86
 s_mov_b32 s48, 0
 s_mul_i32 s49, s35, 8192
 s_add_u32 s48, s48, s49
 s_mul_i32 s49, s36, 2048
 s_add_u32 s48, s48, s49
 v_mov_b32 v13, s48
 v_mul_u32_u24 v86, 16, v80
 v_add_u32 v13, v13, v86
 v_mul_u32_u24 v86, 512, v85
 v_add_u32 v13, v13, v86
 v_mul_u32_u24 v86, 8, v84
 v_add_u32 v13, v13, v86
 s_mov_b32 s48, 0
 s_mul_i32 s49, s32, 1024
 s_add_u32 s48, s48, s49
 v_mov_b32 v14, s48
 v_mul_u32_u24 v86, 16, v1
 v_add_u32 v14, v14, v86
 s_mov_b32 s48, 8192
 v_mov_b32 v15, s48
 v_mul_u32_u24 v86, 256, v84
 v_add_u32 v15, v15, v86
 v_mul_u32_u24 v86, 16, v80
 v_add_u32 v15, v15, v86
 s_mov_b32 s48, 0
 s_mul_i32 s49, s35, 2048
 s_add_u32 s48, s48, s49
 s_mul_i32 s49, s36, 512
 s_add_u32 s48, s48, s49
 v_mov_b32 v16, s48
 v_mul_u32_u24 v86, 32, v82
 v_add_u32 v16, v16, v86
 v_mul_u32_u24 v86, 8, v81
 v_add_u32 v16, v16, v86
 s_mov_b32 s48, 21504
 v_mov_b32 v17, s48
 v_mul_u32_u24 v86, 8, v1
 v_add_u32 v17, v17, v86
 s_mov_b32 s48, 0
 v_mov_b32 v20, s48
 v_mul_u32_u24 v86, 16, v1
 v_add_u32 v20, v20, v86
 v_mov_b32 v18, 0
 v_mov_b32 v19, 1
 ds_write_b32 v18, v18 offset:20544
 ds_write_b32 v18, v18 offset:20608
 ds_write_b32 v18, v18 offset:20612
 s_mov_b32 s80, 0xff00ff00
 s_mov_b32 s81, 0xff00ff00
 s_mov_b32 s52, 0
 s_mov_b32 s53, -1
 s_mov_b32 s54, 0x00ff00ff
 s_mov_b32 s55, 0x00ff00ff
 s_mov_b32 s56, -1
 s_mov_b32 s57, 0
 s_mov_b32 s66, 0x3e0293ee

 v_mov_b32 v184, -1
 v_mov_b32 v220, 0x3f803f80
 v_mov_b32 v185, -1
 v_mov_b32 v221, 0x3f803f80
 v_mov_b32 v186, -1
 v_mov_b32 v222, 0x3f803f80
 v_mov_b32 v187, -1
 v_mov_b32 v223, 0x3f803f80
 v_mov_b32 v188, 0xff800000
 v_mov_b32 v189, 0xff800000
 v_mov_b32 v190, 0xff800000
 v_mov_b32 v191, 0xff800000
 v_mov_b32 v192, 0xff800000
 v_mov_b32 v193, 0xff800000
 v_mov_b32 v194, 0xff800000
 v_mov_b32 v195, 0xff800000
 s_cmp_eq_u32 s32, 0
 s_cbranch_scc0 chain_init_w1
 s_mov_b64 exec, s[54:55]

 s_mov_b32 s48, 132120576
 buffer_store_dwordx2 v[184:185], v7, s[4:7], s48 offen offset:0 sc1
 buffer_store_dwordx2 v[184:185], v7, s[4:7], s48 offen offset:256 sc1
 s_mov_b32 s48, 132186112
 buffer_store_dwordx2 v[184:185], v7, s[4:7], s48 offen offset:0 sc1
 buffer_store_dwordx2 v[184:185], v7, s[4:7], s48 offen offset:256 sc1
 s_mov_b64 exec, -1
 s_branch chain_init_done

chain_init_w1:
 s_cmp_eq_u32 s32, 1
 s_cbranch_scc0 chain_init_done
 v_lshlrev_b32 v92, 11, v82
 v_lshlrev_b32 v86, 5, v83
 v_add_u32 v92, v92, v86
 v_lshlrev_b32 v86, 3, v81
 v_add_u32 v92, v92, v86
 s_lshl_b32 s48, s34, 6
 buffer_load_dwordx2 v[94:95], v92, s[24:27], s48 offen

 s_mov_b32 s49, 209715200
 buffer_store_dwordx4 v[184:187], v9, s[4:7], s49 offen offset:0 sc1
 s_mov_b32 s49, 210239488
 buffer_store_dwordx4 v[184:187], v9, s[4:7], s49 offen offset:0 sc1
 s_mov_b32 s49, 100794368
 buffer_store_dwordx2 v[184:185], v3, s[4:7], s49 offen offset:0 sc1
 s_mov_b32 s49, 100925440
 buffer_store_dwordx2 v[184:185], v3, s[4:7], s49 offen offset:0 sc1
 s_mov_b32 s49, 113246208
 buffer_store_dwordx2 v[184:185], v4, s[4:7], s49 offen offset:0 sc1
 s_mov_b32 s49, 113246208
 buffer_store_dwordx2 v[184:185], v4, s[4:7], s49 offen offset:512 sc1
 s_mov_b32 s49, 113377280
 buffer_store_dwordx2 v[184:185], v4, s[4:7], s49 offen offset:0 sc1
 s_mov_b32 s49, 113377280
 buffer_store_dwordx2 v[184:185], v4, s[4:7], s49 offen offset:512 sc1
 s_waitcnt vmcnt(8)
 v_min_u32 v94, -2, v94
 v_min_u32 v95, -2, v95
 s_mov_b32 s49, 100663296
 buffer_store_dwordx2 v[94:95], v3, s[4:7], s49 offen sc1

chain_init_done:
 s_waitcnt vmcnt(0) lgkmcnt(0)
 s_barrier
 s_cmp_eq_u32 s32, 0
 s_cbranch_scc0 chain_ready_done
 s_lshl_b32 s50, s33, 12
 s_add_u32 s50, s50, 159416320
 v_mov_b32 v86, 1
 s_mov_b64 exec, 1
 buffer_atomic_add v86, v18, s[4:7], s50 offen
 s_mov_b64 exec, -1

chain_ready_done:
 v_lshrrev_b32 v86, 2, v1
 v_lshlrev_b32 v88, 13, v86
 v_and_b32 v86, 3, v1
 v_lshlrev_b32 v86, 4, v86
 v_add_u32 v88, v88, v86
 s_lshl_b32 s48, s32, 21
 s_lshl_b32 s49, s35, 8
 s_add_u32 s48, s48, s49
 s_mul_i32 s49, s36, 64
 s_add_u32 s48, s48, s49
 v_add_u32 v88, s48, v88
 v_lshrrev_b32 v86, 2, v1
 v_lshlrev_b32 v89, 11, v86
 v_and_b32 v86, 3, v1
 v_lshlrev_b32 v86, 4, v86
 v_add_u32 v89, v89, v86
 s_lshl_b32 s48, s33, 2
 s_add_u32 s48, s48, s32
 s_mul_i32 s48, s48, 524288
 s_lshl_b32 s49, s34, 6
 s_add_u32 s48, s48, s49
 v_add_u32 v89, s48, v89
 s_lshl_b32 s48, s32, 15
 s_add_u32 s48, s48, 24576
 v_add_u32 v90, s48, v20
 v_lshrrev_b32 v86, 2, v80
 v_lshl_add_u32 v86, v81, 3, v86
 v_and_b32 v94, 3, v80
 v_lshlrev_b32 v94, 3, v94
 v_mul_u32_u24 v93, 64, v86
 v_add_u32 v93, v93, v94
 v_lshl_add_u32 v94, v86, 6, v94
 v_add_u32 v93, s48, v93
 v_add_u32 v94, s48, v94

 s_mov_b32 s48, 0
 buffer_load_dwordx4 v[112:115], v88, s[8:11], s48 offen
 s_mov_b32 s48, 131072
 buffer_load_dwordx4 v[116:119], v88, s[8:11], s48 offen
 s_mov_b32 s48, 262144
 buffer_load_dwordx4 v[120:123], v88, s[8:11], s48 offen
 s_mov_b32 s48, 393216
 buffer_load_dwordx4 v[124:127], v88, s[8:11], s48 offen
 s_mov_b32 s48, 524288
 buffer_load_dwordx4 v[128:131], v88, s[8:11], s48 offen
 s_mov_b32 s48, 655360
 buffer_load_dwordx4 v[132:135], v88, s[8:11], s48 offen
 s_mov_b32 s48, 786432
 buffer_load_dwordx4 v[136:139], v88, s[8:11], s48 offen
 s_mov_b32 s48, 917504
 buffer_load_dwordx4 v[140:143], v88, s[8:11], s48 offen
 s_mov_b32 s48, 1048576
 buffer_load_dwordx4 v[144:147], v88, s[8:11], s48 offen
 s_mov_b32 s48, 1179648
 buffer_load_dwordx4 v[148:151], v88, s[8:11], s48 offen
 s_mov_b32 s48, 1310720
 buffer_load_dwordx4 v[152:155], v88, s[8:11], s48 offen
 s_mov_b32 s48, 1441792
 buffer_load_dwordx4 v[156:159], v88, s[8:11], s48 offen
 s_mov_b32 s48, 1572864
 buffer_load_dwordx4 v[160:163], v88, s[8:11], s48 offen
 s_mov_b32 s48, 1703936
 buffer_load_dwordx4 v[164:167], v88, s[8:11], s48 offen
 s_mov_b32 s48, 1835008
 buffer_load_dwordx4 v[168:171], v88, s[8:11], s48 offen
 s_mov_b32 s48, 1966080
 buffer_load_dwordx4 v[172:175], v88, s[8:11], s48 offen
 s_waitcnt vmcnt(15)
 ds_write_b128 v90, v[112:115] offset:0
 s_waitcnt vmcnt(14)
 ds_write_b128 v90, v[116:119] offset:1024
 s_waitcnt vmcnt(13)
 ds_write_b128 v90, v[120:123] offset:2048
 s_waitcnt vmcnt(12)
 ds_write_b128 v90, v[124:127] offset:3072
 s_waitcnt vmcnt(11)
 ds_write_b128 v90, v[128:131] offset:4096
 s_waitcnt vmcnt(10)
 ds_write_b128 v90, v[132:135] offset:5120
 s_waitcnt vmcnt(9)
 ds_write_b128 v90, v[136:139] offset:6144
 s_waitcnt vmcnt(8)
 ds_write_b128 v90, v[140:143] offset:7168
 s_waitcnt vmcnt(7)
 ds_write_b128 v90, v[144:147] offset:8192
 s_waitcnt vmcnt(6)
 ds_write_b128 v90, v[148:151] offset:9216
 s_waitcnt vmcnt(5)
 ds_write_b128 v90, v[152:155] offset:10240
 s_waitcnt vmcnt(4)
 ds_write_b128 v90, v[156:159] offset:11264
 s_waitcnt vmcnt(3)
 ds_write_b128 v90, v[160:163] offset:12288
 s_waitcnt vmcnt(2)
 ds_write_b128 v90, v[164:167] offset:13312
 s_waitcnt vmcnt(1)
 ds_write_b128 v90, v[168:171] offset:14336
 s_waitcnt vmcnt(0)
 ds_write_b128 v90, v[172:175] offset:15360
 s_waitcnt lgkmcnt(0)
 s_mov_b32 s48, 0
 buffer_load_dwordx4 v[112:115], v88, s[12:15], s48 offen
 s_mov_b32 s48, 131072
 buffer_load_dwordx4 v[116:119], v88, s[12:15], s48 offen
 s_mov_b32 s48, 262144
 buffer_load_dwordx4 v[120:123], v88, s[12:15], s48 offen
 s_mov_b32 s48, 393216
 buffer_load_dwordx4 v[124:127], v88, s[12:15], s48 offen
 s_mov_b32 s48, 524288
 buffer_load_dwordx4 v[128:131], v88, s[12:15], s48 offen
 s_mov_b32 s48, 655360
 buffer_load_dwordx4 v[132:135], v88, s[12:15], s48 offen
 s_mov_b32 s48, 786432
 buffer_load_dwordx4 v[136:139], v88, s[12:15], s48 offen
 s_mov_b32 s48, 917504
 buffer_load_dwordx4 v[140:143], v88, s[12:15], s48 offen
 s_mov_b32 s48, 1048576
 buffer_load_dwordx4 v[144:147], v88, s[12:15], s48 offen
 s_mov_b32 s48, 1179648
 buffer_load_dwordx4 v[148:151], v88, s[12:15], s48 offen
 s_mov_b32 s48, 1310720
 buffer_load_dwordx4 v[152:155], v88, s[12:15], s48 offen
 s_mov_b32 s48, 1441792
 buffer_load_dwordx4 v[156:159], v88, s[12:15], s48 offen
 s_mov_b32 s48, 1572864
 buffer_load_dwordx4 v[160:163], v88, s[12:15], s48 offen
 s_mov_b32 s48, 1703936
 buffer_load_dwordx4 v[164:167], v88, s[12:15], s48 offen
 s_mov_b32 s48, 1835008
 buffer_load_dwordx4 v[168:171], v88, s[12:15], s48 offen
 s_mov_b32 s48, 1966080
 buffer_load_dwordx4 v[172:175], v88, s[12:15], s48 offen
 s_waitcnt vmcnt(15)
 ds_write_b128 v90, v[112:115] offset:16384
 s_waitcnt vmcnt(14)
 ds_write_b128 v90, v[116:119] offset:17408
 s_waitcnt vmcnt(13)
 ds_write_b128 v90, v[120:123] offset:18432
 s_waitcnt vmcnt(12)
 ds_write_b128 v90, v[124:127] offset:19456
 s_waitcnt vmcnt(11)
 ds_write_b128 v90, v[128:131] offset:20480
 s_waitcnt vmcnt(10)
 ds_write_b128 v90, v[132:135] offset:21504
 s_waitcnt vmcnt(9)
 ds_write_b128 v90, v[136:139] offset:22528
 s_waitcnt vmcnt(8)
 ds_write_b128 v90, v[140:143] offset:23552
 s_waitcnt vmcnt(7)
 ds_write_b128 v90, v[144:147] offset:24576
 s_waitcnt vmcnt(6)
 ds_write_b128 v90, v[148:151] offset:25600
 s_waitcnt vmcnt(5)
 ds_write_b128 v90, v[152:155] offset:26624
 s_waitcnt vmcnt(4)
 ds_write_b128 v90, v[156:159] offset:27648
 s_waitcnt vmcnt(3)
 ds_write_b128 v90, v[160:163] offset:28672
 s_waitcnt vmcnt(2)
 ds_write_b128 v90, v[164:167] offset:29696
 s_waitcnt vmcnt(1)
 ds_write_b128 v90, v[168:171] offset:30720
 s_waitcnt vmcnt(0)
 ds_write_b128 v90, v[172:175] offset:31744
 s_waitcnt lgkmcnt(0)
 ds_read_b64_tr_b16 a[0:1], v93 offset:0
 ds_read_b64_tr_b16 a[2:3], v93 offset:256
 ds_read_b64_tr_b16 a[4:5], v93 offset:2048
 ds_read_b64_tr_b16 a[6:7], v93 offset:2304
 ds_read_b64_tr_b16 a[8:9], v93 offset:4096
 ds_read_b64_tr_b16 a[10:11], v93 offset:4352
 ds_read_b64_tr_b16 a[12:13], v93 offset:6144
 ds_read_b64_tr_b16 a[14:15], v93 offset:6400
 s_waitcnt lgkmcnt(0)
 ds_read_b64_tr_b16 a[16:17], v93 offset:8192
 ds_read_b64_tr_b16 a[18:19], v93 offset:8448
 ds_read_b64_tr_b16 a[20:21], v93 offset:10240
 ds_read_b64_tr_b16 a[22:23], v93 offset:10496
 ds_read_b64_tr_b16 a[24:25], v93 offset:12288
 ds_read_b64_tr_b16 a[26:27], v93 offset:12544
 ds_read_b64_tr_b16 a[28:29], v93 offset:14336
 ds_read_b64_tr_b16 a[30:31], v93 offset:14592
 s_waitcnt lgkmcnt(0)
 ds_read_b64_tr_b16 a[32:33], v93 offset:32
 ds_read_b64_tr_b16 a[34:35], v93 offset:288
 ds_read_b64_tr_b16 a[36:37], v93 offset:2080
 ds_read_b64_tr_b16 a[38:39], v93 offset:2336
 ds_read_b64_tr_b16 a[40:41], v93 offset:4128
 ds_read_b64_tr_b16 a[42:43], v93 offset:4384
 ds_read_b64_tr_b16 a[44:45], v93 offset:6176
 ds_read_b64_tr_b16 a[46:47], v93 offset:6432
 s_waitcnt lgkmcnt(0)
 ds_read_b64_tr_b16 a[48:49], v93 offset:8224
 ds_read_b64_tr_b16 a[50:51], v93 offset:8480
 ds_read_b64_tr_b16 a[52:53], v93 offset:10272
 ds_read_b64_tr_b16 a[54:55], v93 offset:10528
 ds_read_b64_tr_b16 a[56:57], v93 offset:12320
 ds_read_b64_tr_b16 a[58:59], v93 offset:12576
 ds_read_b64_tr_b16 a[60:61], v93 offset:14368
 ds_read_b64_tr_b16 a[62:63], v93 offset:14624
 s_waitcnt lgkmcnt(0)
 ds_read_b64_tr_b16 a[64:65], v93 offset:16384
 ds_read_b64_tr_b16 a[66:67], v93 offset:16640
 ds_read_b64_tr_b16 a[68:69], v93 offset:18432
 ds_read_b64_tr_b16 a[70:71], v93 offset:18688
 ds_read_b64_tr_b16 a[72:73], v93 offset:20480
 ds_read_b64_tr_b16 a[74:75], v93 offset:20736
 ds_read_b64_tr_b16 a[76:77], v93 offset:22528
 ds_read_b64_tr_b16 a[78:79], v93 offset:22784
 s_waitcnt lgkmcnt(0)
 ds_read_b64_tr_b16 a[80:81], v93 offset:24576
 ds_read_b64_tr_b16 a[82:83], v93 offset:24832
 ds_read_b64_tr_b16 a[84:85], v93 offset:26624
 ds_read_b64_tr_b16 a[86:87], v93 offset:26880
 ds_read_b64_tr_b16 a[88:89], v93 offset:28672
 ds_read_b64_tr_b16 a[90:91], v93 offset:28928
 ds_read_b64_tr_b16 a[92:93], v93 offset:30720
 ds_read_b64_tr_b16 a[94:95], v93 offset:30976
 s_waitcnt lgkmcnt(0)
 ds_read_b64_tr_b16 a[96:97], v93 offset:16416
 ds_read_b64_tr_b16 a[98:99], v93 offset:16672
 ds_read_b64_tr_b16 a[100:101], v93 offset:18464
 ds_read_b64_tr_b16 a[102:103], v93 offset:18720
 ds_read_b64_tr_b16 a[104:105], v93 offset:20512
 ds_read_b64_tr_b16 a[106:107], v93 offset:20768
 ds_read_b64_tr_b16 a[108:109], v93 offset:22560
 ds_read_b64_tr_b16 a[110:111], v93 offset:22816
 s_waitcnt lgkmcnt(0)
 ds_read_b64_tr_b16 a[112:113], v93 offset:24608
 ds_read_b64_tr_b16 a[114:115], v93 offset:24864
 ds_read_b64_tr_b16 a[116:117], v93 offset:26656
 ds_read_b64_tr_b16 a[118:119], v93 offset:26912
 ds_read_b64_tr_b16 a[120:121], v93 offset:28704
 ds_read_b64_tr_b16 a[122:123], v93 offset:28960
 ds_read_b64_tr_b16 a[124:125], v93 offset:30752
 ds_read_b64_tr_b16 a[126:127], v93 offset:31008
 s_waitcnt lgkmcnt(0)
 s_waitcnt lgkmcnt(0)
 s_mov_b32 s48, 0
 buffer_load_dwordx4 v[112:115], v88, s[16:19], s48 offen
 s_mov_b32 s48, 131072
 buffer_load_dwordx4 v[116:119], v88, s[16:19], s48 offen
 s_mov_b32 s48, 262144
 buffer_load_dwordx4 v[120:123], v88, s[16:19], s48 offen
 s_mov_b32 s48, 393216
 buffer_load_dwordx4 v[124:127], v88, s[16:19], s48 offen
 s_mov_b32 s48, 524288
 buffer_load_dwordx4 v[128:131], v88, s[16:19], s48 offen
 s_mov_b32 s48, 655360
 buffer_load_dwordx4 v[132:135], v88, s[16:19], s48 offen
 s_mov_b32 s48, 786432
 buffer_load_dwordx4 v[136:139], v88, s[16:19], s48 offen
 s_mov_b32 s48, 917504
 buffer_load_dwordx4 v[140:143], v88, s[16:19], s48 offen
 s_mov_b32 s48, 1048576
 buffer_load_dwordx4 v[144:147], v88, s[16:19], s48 offen
 s_mov_b32 s48, 1179648
 buffer_load_dwordx4 v[148:151], v88, s[16:19], s48 offen
 s_mov_b32 s48, 1310720
 buffer_load_dwordx4 v[152:155], v88, s[16:19], s48 offen
 s_mov_b32 s48, 1441792
 buffer_load_dwordx4 v[156:159], v88, s[16:19], s48 offen
 s_mov_b32 s48, 1572864
 buffer_load_dwordx4 v[160:163], v88, s[16:19], s48 offen
 s_mov_b32 s48, 1703936
 buffer_load_dwordx4 v[164:167], v88, s[16:19], s48 offen
 s_mov_b32 s48, 1835008
 buffer_load_dwordx4 v[168:171], v88, s[16:19], s48 offen
 s_mov_b32 s48, 1966080
 buffer_load_dwordx4 v[172:175], v88, s[16:19], s48 offen
 s_waitcnt vmcnt(15)
 ds_write_b128 v90, v[112:115] offset:0
 s_waitcnt vmcnt(14)
 ds_write_b128 v90, v[116:119] offset:1024
 s_waitcnt vmcnt(13)
 ds_write_b128 v90, v[120:123] offset:2048
 s_waitcnt vmcnt(12)
 ds_write_b128 v90, v[124:127] offset:3072
 s_waitcnt vmcnt(11)
 ds_write_b128 v90, v[128:131] offset:4096
 s_waitcnt vmcnt(10)
 ds_write_b128 v90, v[132:135] offset:5120
 s_waitcnt vmcnt(9)
 ds_write_b128 v90, v[136:139] offset:6144
 s_waitcnt vmcnt(8)
 ds_write_b128 v90, v[140:143] offset:7168
 s_waitcnt vmcnt(7)
 ds_write_b128 v90, v[144:147] offset:8192
 s_waitcnt vmcnt(6)
 ds_write_b128 v90, v[148:151] offset:9216
 s_waitcnt vmcnt(5)
 ds_write_b128 v90, v[152:155] offset:10240
 s_waitcnt vmcnt(4)
 ds_write_b128 v90, v[156:159] offset:11264
 s_waitcnt vmcnt(3)
 ds_write_b128 v90, v[160:163] offset:12288
 s_waitcnt vmcnt(2)
 ds_write_b128 v90, v[164:167] offset:13312
 s_waitcnt vmcnt(1)
 ds_write_b128 v90, v[168:171] offset:14336
 s_waitcnt vmcnt(0)
 ds_write_b128 v90, v[172:175] offset:15360
 s_waitcnt lgkmcnt(0)
 s_mov_b32 s48, 0
 buffer_load_dwordx4 v[112:115], v89, s[20:23], s48 offen
 s_mov_b32 s48, 32768
 buffer_load_dwordx4 v[116:119], v89, s[20:23], s48 offen
 s_mov_b32 s48, 65536
 buffer_load_dwordx4 v[120:123], v89, s[20:23], s48 offen
 s_mov_b32 s48, 98304
 buffer_load_dwordx4 v[124:127], v89, s[20:23], s48 offen
 s_mov_b32 s48, 131072
 buffer_load_dwordx4 v[128:131], v89, s[20:23], s48 offen
 s_mov_b32 s48, 163840
 buffer_load_dwordx4 v[132:135], v89, s[20:23], s48 offen
 s_mov_b32 s48, 196608
 buffer_load_dwordx4 v[136:139], v89, s[20:23], s48 offen
 s_mov_b32 s48, 229376
 buffer_load_dwordx4 v[140:143], v89, s[20:23], s48 offen
 s_mov_b32 s48, 262144
 buffer_load_dwordx4 v[144:147], v89, s[20:23], s48 offen
 s_mov_b32 s48, 294912
 buffer_load_dwordx4 v[148:151], v89, s[20:23], s48 offen
 s_mov_b32 s48, 327680
 buffer_load_dwordx4 v[152:155], v89, s[20:23], s48 offen
 s_mov_b32 s48, 360448
 buffer_load_dwordx4 v[156:159], v89, s[20:23], s48 offen
 s_mov_b32 s48, 393216
 buffer_load_dwordx4 v[160:163], v89, s[20:23], s48 offen
 s_mov_b32 s48, 425984
 buffer_load_dwordx4 v[164:167], v89, s[20:23], s48 offen
 s_mov_b32 s48, 458752
 buffer_load_dwordx4 v[168:171], v89, s[20:23], s48 offen
 s_mov_b32 s48, 491520
 buffer_load_dwordx4 v[172:175], v89, s[20:23], s48 offen
 s_waitcnt vmcnt(15)
 ds_write_b128 v90, v[112:115] offset:16384
 s_waitcnt vmcnt(14)
 ds_write_b128 v90, v[116:119] offset:17408
 s_waitcnt vmcnt(13)
 ds_write_b128 v90, v[120:123] offset:18432
 s_waitcnt vmcnt(12)
 ds_write_b128 v90, v[124:127] offset:19456
 s_waitcnt vmcnt(11)
 ds_write_b128 v90, v[128:131] offset:20480
 s_waitcnt vmcnt(10)
 ds_write_b128 v90, v[132:135] offset:21504
 s_waitcnt vmcnt(9)
 ds_write_b128 v90, v[136:139] offset:22528
 s_waitcnt vmcnt(8)
 ds_write_b128 v90, v[140:143] offset:23552
 s_waitcnt vmcnt(7)
 ds_write_b128 v90, v[144:147] offset:24576
 s_waitcnt vmcnt(6)
 ds_write_b128 v90, v[148:151] offset:25600
 s_waitcnt vmcnt(5)
 ds_write_b128 v90, v[152:155] offset:26624
 s_waitcnt vmcnt(4)
 ds_write_b128 v90, v[156:159] offset:27648
 s_waitcnt vmcnt(3)
 ds_write_b128 v90, v[160:163] offset:28672
 s_waitcnt vmcnt(2)
 ds_write_b128 v90, v[164:167] offset:29696
 s_waitcnt vmcnt(1)
 ds_write_b128 v90, v[168:171] offset:30720
 s_waitcnt vmcnt(0)
 ds_write_b128 v90, v[172:175] offset:31744
 s_waitcnt lgkmcnt(0)
 ds_read_b64_tr_b16 a[128:129], v93 offset:0
 ds_read_b64_tr_b16 a[130:131], v93 offset:256
 ds_read_b64_tr_b16 a[132:133], v93 offset:2048
 ds_read_b64_tr_b16 a[134:135], v93 offset:2304
 ds_read_b64_tr_b16 a[136:137], v93 offset:4096
 ds_read_b64_tr_b16 a[138:139], v93 offset:4352
 ds_read_b64_tr_b16 a[140:141], v93 offset:6144
 ds_read_b64_tr_b16 a[142:143], v93 offset:6400
 s_waitcnt lgkmcnt(0)
 ds_read_b64_tr_b16 a[144:145], v93 offset:8192
 ds_read_b64_tr_b16 a[146:147], v93 offset:8448
 ds_read_b64_tr_b16 a[148:149], v93 offset:10240
 ds_read_b64_tr_b16 a[150:151], v93 offset:10496
 ds_read_b64_tr_b16 a[152:153], v93 offset:12288
 ds_read_b64_tr_b16 a[154:155], v93 offset:12544
 ds_read_b64_tr_b16 a[156:157], v93 offset:14336
 ds_read_b64_tr_b16 a[158:159], v93 offset:14592
 s_waitcnt lgkmcnt(0)
 ds_read_b64_tr_b16 a[160:161], v93 offset:32
 ds_read_b64_tr_b16 a[162:163], v93 offset:288
 ds_read_b64_tr_b16 a[164:165], v93 offset:2080
 ds_read_b64_tr_b16 a[166:167], v93 offset:2336
 ds_read_b64_tr_b16 a[168:169], v93 offset:4128
 ds_read_b64_tr_b16 a[170:171], v93 offset:4384
 ds_read_b64_tr_b16 a[172:173], v93 offset:6176
 ds_read_b64_tr_b16 a[174:175], v93 offset:6432
 s_waitcnt lgkmcnt(0)
 ds_read_b64_tr_b16 a[176:177], v93 offset:8224
 ds_read_b64_tr_b16 a[178:179], v93 offset:8480
 ds_read_b64_tr_b16 a[180:181], v93 offset:10272
 ds_read_b64_tr_b16 a[182:183], v93 offset:10528
 ds_read_b64_tr_b16 a[184:185], v93 offset:12320
 ds_read_b64_tr_b16 a[186:187], v93 offset:12576
 ds_read_b64_tr_b16 a[188:189], v93 offset:14368
 ds_read_b64_tr_b16 a[190:191], v93 offset:14624
 s_waitcnt lgkmcnt(0)
 ds_read_b64_tr_b16 a[192:193], v94 offset:16384
 ds_read_b64_tr_b16 a[194:195], v94 offset:16640
 ds_read_b64_tr_b16 a[196:197], v94 offset:16416
 ds_read_b64_tr_b16 a[198:199], v94 offset:16672
 ds_read_b64_tr_b16 a[200:201], v94 offset:18432
 ds_read_b64_tr_b16 a[202:203], v94 offset:18688
 ds_read_b64_tr_b16 a[204:205], v94 offset:18464
 ds_read_b64_tr_b16 a[206:207], v94 offset:18720
 s_waitcnt lgkmcnt(0)
 ds_read_b64_tr_b16 a[208:209], v94 offset:20480
 ds_read_b64_tr_b16 a[210:211], v94 offset:20736
 ds_read_b64_tr_b16 a[212:213], v94 offset:20512
 ds_read_b64_tr_b16 a[214:215], v94 offset:20768
 ds_read_b64_tr_b16 a[216:217], v94 offset:22528
 ds_read_b64_tr_b16 a[218:219], v94 offset:22784
 ds_read_b64_tr_b16 a[220:221], v94 offset:22560
 ds_read_b64_tr_b16 a[222:223], v94 offset:22816
 s_waitcnt lgkmcnt(0)
 ds_read_b64_tr_b16 a[224:225], v94 offset:24576
 ds_read_b64_tr_b16 a[226:227], v94 offset:24832
 ds_read_b64_tr_b16 a[228:229], v94 offset:24608
 ds_read_b64_tr_b16 a[230:231], v94 offset:24864
 ds_read_b64_tr_b16 a[232:233], v94 offset:26624
 ds_read_b64_tr_b16 a[234:235], v94 offset:26880
 ds_read_b64_tr_b16 a[236:237], v94 offset:26656
 ds_read_b64_tr_b16 a[238:239], v94 offset:26912
 s_waitcnt lgkmcnt(0)
 ds_read_b64_tr_b16 a[240:241], v94 offset:28672
 ds_read_b64_tr_b16 a[242:243], v94 offset:28928
 ds_read_b64_tr_b16 a[244:245], v94 offset:28704
 ds_read_b64_tr_b16 a[246:247], v94 offset:28960
 ds_read_b64_tr_b16 a[248:249], v94 offset:30720
 ds_read_b64_tr_b16 a[250:251], v94 offset:30976
 ds_read_b64_tr_b16 a[252:253], v94 offset:30752
 ds_read_b64_tr_b16 a[254:255], v94 offset:31008
 s_waitcnt lgkmcnt(0)
 s_waitcnt lgkmcnt(0)
 v_mov_b32 v178, 0
 v_mov_b32 v179, 0
 v_mov_b32 v182, 0
 v_mov_b32 v183, 0
 s_mov_b32 s37, 0
 s_mov_b32 s40, 100663296
 s_mov_b32 s41, 113246208
 s_mov_b32 s42, 132120576
 s_mov_b32 s43, 209715200
 s_mov_b32 s82, 210763776
 s_mov_b32 s44, 125829120
 s_mov_b32 s45, 20971520
 s_mov_b32 s46, 20975616
 s_mov_b32 s47, 37748736
 s_mov_b32 s74, 117440512
 s_mov_b32 s75, 100794368
 s_mov_b32 s76, 101056512
 s_mov_b32 s77, 113508352
 s_mov_b32 s78, 132251648
 s_mov_b32 s79, 4

 v_and_b32 v197, 7, v0
 v_lshlrev_b32 v197, 12, v197
 s_mov_b32 s48, 159453184
iw_5:
 buffer_load_dword v196, v197, s[4:7], s48 offen sc1
 s_sub_u32 s38, s38, 1
 s_cbranch_scc1 chain_exit
 s_waitcnt vmcnt(0)
 v_add_u32_dpp v196, v196, v196 quad_perm:[1,0,3,2] row_mask:0xf bank_mask:0xf
 s_nop 1
 v_add_u32_dpp v196, v196, v196 quad_perm:[2,3,0,1] row_mask:0xf bank_mask:0xf
 s_nop 1
 v_add_u32_dpp v196, v196, v196 row_half_mirror row_mask:0xf bank_mask:0xf
 v_cmp_gt_u32 vcc, 0x100, v196
 s_cbranch_vccnz iw_5

 s_cmp_eq_u32 s32, 0
 s_cbranch_scc0 chain_nopf0
 s_mov_b32 s48, 0
 s_lshr_b32 s48, s48, 2
 s_and_b32 s49, s48, 0xfe
 s_cmp_lt_u32 s48, 4
 s_cselect_b32 s48, s48, s49
 s_lshl_b32 s48, s48, 4
 s_lshr_b32 s49, s35, 1
 s_add_u32 s48, s48, s49
 s_lshl_b32 s48, s48, 10
 s_add_u32 s48, s48, 161488896
 v_and_b32 v197, 7, v1
 v_lshlrev_b32 v197, 7, v197

kvpl_7:
 s_sub_u32 s38, s38, 1
 s_cbranch_scc1 chain_exit
 buffer_load_dword v196, v197, s[4:7], s48 offen sc1
 s_waitcnt vmcnt(0)
 v_add_u32_dpp v196, v196, v196 quad_perm:[1,0,3,2] row_mask:0xf bank_mask:0xf
 s_nop 1
 v_add_u32_dpp v196, v196, v196 quad_perm:[2,3,0,1] row_mask:0xf bank_mask:0xf
 s_nop 1
 v_add_u32_dpp v196, v196, v196 row_half_mirror row_mask:0xf bank_mask:0xf
 v_cmp_gt_u32 vcc, 4, v196
 s_cbranch_vccnz kvpl_7

kvsk_6:
 buffer_load_dwordx4 v[136:139], v12, s[4:7], s45 offen offset:0 sc1
 buffer_load_dwordx4 v[140:143], v12, s[4:7], s45 offen offset:2048 sc1
 buffer_load_dwordx4 v[144:147], v12, s[4:7], s46 offen offset:0 sc1
 buffer_load_dwordx4 v[148:151], v12, s[4:7], s46 offen offset:2048 sc1
 buffer_load_dwordx4 v[152:155], v12, s[4:7], s45 offen offset:256 sc1
 buffer_load_dwordx4 v[156:159], v12, s[4:7], s45 offen offset:2304 sc1
 buffer_load_dwordx4 v[160:163], v12, s[4:7], s46 offen offset:256 sc1
 buffer_load_dwordx4 v[164:167], v12, s[4:7], s46 offen offset:2304 sc1
 buffer_load_dwordx2 v[168:169], v13, s[4:7], s47 offen offset:0 sc1
 buffer_load_dwordx2 v[170:171], v13, s[4:7], s47 offen offset:1024 sc1
 buffer_load_dwordx2 v[172:173], v13, s[4:7], s47 offen offset:256 sc1
 buffer_load_dwordx2 v[174:175], v13, s[4:7], s47 offen offset:1280 sc1
chain_nopf0:
 v_lshlrev_b32 v86, 12, v1
 v_and_b32 v86, 0xffff, v86
 s_mov_b32 s50, 159383552

chain_cen_poll:
 s_sub_u32 s38, s38, 1
 s_cbranch_scc1 chain_exit
 buffer_load_dword v92, v86, s[4:7], s50 offen sc1
 s_waitcnt vmcnt(0)
 s_mov_b32 s49, 0
 s_mov_b32 s51, 0

 v_readlane_b32 s58, v92, 8
 v_readlane_b32 s59, v92, 9
 v_readlane_b32 s60, v92, 10
 v_readlane_b32 s61, v92, 11
 s_nop 1
 s_add_u32 s49, s49, s58
 s_add_u32 s49, s49, s59
 s_add_u32 s49, s49, s60
 s_add_u32 s49, s49, s61
 s_cmp_lg_u32 s49, 128
 s_cbranch_scc1 chain_cen_poll

 v_readlane_b32 s58, v92, 0
 v_readlane_b32 s59, v92, 1
 v_readlane_b32 s60, v92, 2
 v_readlane_b32 s61, v92, 3
 s_nop 1
 s_cmp_lt_u32 s58, 32
 s_cselect_b32 s48, 1, 0
 s_or_b32 s51, s51, s48
 s_lshr_b32 s48, s58, 16
 s_or_b32 s51, s51, s48
 s_cmp_lt_u32 s59, 32
 s_cselect_b32 s48, 1, 0
 s_or_b32 s51, s51, s48
 s_lshr_b32 s48, s59, 16
 s_or_b32 s51, s51, s48
 s_cmp_lt_u32 s60, 32
 s_cselect_b32 s48, 1, 0
 s_or_b32 s51, s51, s48
 s_lshr_b32 s48, s60, 16
 s_or_b32 s51, s51, s48
 s_cmp_lt_u32 s61, 32
 s_cselect_b32 s48, 1, 0
 s_or_b32 s51, s51, s48
 s_lshr_b32 s48, s61, 16
 s_or_b32 s51, s51, s48
 s_mov_b32 s83, s51
 s_cmp_eq_u32 s32, 0
 s_cbranch_scc1 chain_loop_fast_0
 s_cmp_eq_u32 s32, 1
 s_cbranch_scc1 chain_loop_fast_1
 s_cmp_eq_u32 s32, 2
 s_cbranch_scc1 chain_loop_fast_2
chain_loop_fast_3:
 buffer_load_dwordx4 v[24:27], v2, s[4:7], s40 offen offset:0 sc1
 buffer_load_dwordx4 v[28:31], v2, s[4:7], s40 offen offset:512 sc1
 buffer_load_dwordx4 v[32:35], v2, s[4:7], s40 offen offset:1024 sc1
 buffer_load_dwordx4 v[36:39], v2, s[4:7], s40 offen offset:1536 sc1
 s_waitcnt vmcnt(3)
pc_8:
 v_max3_u32 v196, v24, v25, v26
 v_max_u32 v197, v196, v27
 v_cmp_eq_u32 vcc, -1, v197
 s_cbranch_vccnz pr_9
 v_mfma_f32_16x16x32_bf16 v[40:43], a[0:3], v[24:27], 0
 v_mfma_f32_16x16x32_bf16 v[44:47], a[16:19], v[24:27], 0
 v_mfma_f32_16x16x32_bf16 v[48:51], a[64:67], v[24:27], 0
 v_mfma_f32_16x16x32_bf16 v[52:55], a[80:83], v[24:27], 0
 v_mfma_f32_16x16x32_bf16 v[56:59], a[32:35], v[24:27], 0
 v_mfma_f32_16x16x32_bf16 v[60:63], a[48:51], v[24:27], 0
 v_mfma_f32_16x16x32_bf16 v[64:67], a[96:99], v[24:27], 0
 v_mfma_f32_16x16x32_bf16 v[68:71], a[112:115], v[24:27], 0
 s_waitcnt vmcnt(2)
pc_10:
 v_max3_u32 v196, v28, v29, v30
 v_max_u32 v197, v196, v31
 v_cmp_eq_u32 vcc, -1, v197
 s_cbranch_vccnz pr_11
 v_mfma_f32_16x16x32_bf16 v[40:43], a[4:7], v[28:31], v[40:43]
 v_mfma_f32_16x16x32_bf16 v[44:47], a[20:23], v[28:31], v[44:47]
 v_mfma_f32_16x16x32_bf16 v[48:51], a[68:71], v[28:31], v[48:51]
 v_mfma_f32_16x16x32_bf16 v[52:55], a[84:87], v[28:31], v[52:55]
 v_mfma_f32_16x16x32_bf16 v[56:59], a[36:39], v[28:31], v[56:59]
 v_mfma_f32_16x16x32_bf16 v[60:63], a[52:55], v[28:31], v[60:63]
 v_mfma_f32_16x16x32_bf16 v[64:67], a[100:103], v[28:31], v[64:67]
 v_mfma_f32_16x16x32_bf16 v[68:71], a[116:119], v[28:31], v[68:71]
 s_waitcnt vmcnt(1)
pc_12:
 v_max3_u32 v196, v32, v33, v34
 v_max_u32 v197, v196, v35
 v_cmp_eq_u32 vcc, -1, v197
 s_cbranch_vccnz pr_13
 v_mfma_f32_16x16x32_bf16 v[40:43], a[8:11], v[32:35], v[40:43]
 v_mfma_f32_16x16x32_bf16 v[44:47], a[24:27], v[32:35], v[44:47]
 v_mfma_f32_16x16x32_bf16 v[48:51], a[72:75], v[32:35], v[48:51]
 v_mfma_f32_16x16x32_bf16 v[52:55], a[88:91], v[32:35], v[52:55]
 v_mfma_f32_16x16x32_bf16 v[56:59], a[40:43], v[32:35], v[56:59]
 v_mfma_f32_16x16x32_bf16 v[60:63], a[56:59], v[32:35], v[60:63]
 v_mfma_f32_16x16x32_bf16 v[64:67], a[104:107], v[32:35], v[64:67]
 v_mfma_f32_16x16x32_bf16 v[68:71], a[120:123], v[32:35], v[68:71]
 s_waitcnt vmcnt(0)
pc_14:
 v_max3_u32 v196, v36, v37, v38
 v_max_u32 v197, v196, v39
 v_cmp_eq_u32 vcc, -1, v197
 s_cbranch_vccnz pr_15
 v_mfma_f32_16x16x32_bf16 v[40:43], a[12:15], v[36:39], v[40:43]
 v_mfma_f32_16x16x32_bf16 v[44:47], a[28:31], v[36:39], v[44:47]
 v_mfma_f32_16x16x32_bf16 v[48:51], a[76:79], v[36:39], v[48:51]
 v_mfma_f32_16x16x32_bf16 v[52:55], a[92:95], v[36:39], v[52:55]
 v_mfma_f32_16x16x32_bf16 v[56:59], a[44:47], v[36:39], v[56:59]
 v_mfma_f32_16x16x32_bf16 v[60:63], a[60:63], v[36:39], v[60:63]
 v_mfma_f32_16x16x32_bf16 v[64:67], a[108:111], v[36:39], v[64:67]
 v_mfma_f32_16x16x32_bf16 v[68:71], a[124:127], v[36:39], v[68:71]
 s_nop 1
 v_add_f32_dpp v72, v44, v40 row_ror:8 row_mask:0xf bank_mask:0x3
 v_add_f32_dpp v73, v45, v41 row_ror:8 row_mask:0xf bank_mask:0x3
 v_add_f32_dpp v74, v46, v42 row_ror:8 row_mask:0xf bank_mask:0x3
 v_add_f32_dpp v75, v47, v43 row_ror:8 row_mask:0xf bank_mask:0x3
 v_add_f32_dpp v72, v48, v52 row_ror:8 row_mask:0xf bank_mask:0xc
 v_add_f32_dpp v73, v49, v53 row_ror:8 row_mask:0xf bank_mask:0xc
 v_add_f32_dpp v74, v50, v54 row_ror:8 row_mask:0xf bank_mask:0xc
 v_add_f32_dpp v75, v51, v55 row_ror:8 row_mask:0xf bank_mask:0xc
 ds_write_b128 v14, v[72:75] offset:0
 v_add_f32_dpp v76, v60, v56 row_ror:8 row_mask:0xf bank_mask:0x3
 v_add_f32_dpp v77, v61, v57 row_ror:8 row_mask:0xf bank_mask:0x3
 v_add_f32_dpp v78, v62, v58 row_ror:8 row_mask:0xf bank_mask:0x3
 v_add_f32_dpp v79, v63, v59 row_ror:8 row_mask:0xf bank_mask:0x3
 v_add_f32_dpp v76, v64, v68 row_ror:8 row_mask:0xf bank_mask:0xc
 v_add_f32_dpp v77, v65, v69 row_ror:8 row_mask:0xf bank_mask:0xc
 v_add_f32_dpp v78, v66, v70 row_ror:8 row_mask:0xf bank_mask:0xc
 v_add_f32_dpp v79, v67, v71 row_ror:8 row_mask:0xf bank_mask:0xc
 ds_write_b128 v14, v[76:79] offset:4096
 s_waitcnt lgkmcnt(0)
 s_barrier
 v_mfma_f32_16x16x32_bf16 v[40:43], v[24:27], a[128:131], 0
 v_mfma_f32_16x16x32_bf16 v[44:47], v[24:27], a[144:147], 0
 v_mfma_f32_16x16x32_bf16 v[48:51], v[24:27], a[160:163], 0
 v_mfma_f32_16x16x32_bf16 v[52:55], v[24:27], a[176:179], 0
 v_mfma_f32_16x16x32_bf16 v[40:43], v[28:31], a[132:135], v[40:43]
 v_mfma_f32_16x16x32_bf16 v[44:47], v[28:31], a[148:151], v[44:47]
 v_mfma_f32_16x16x32_bf16 v[48:51], v[28:31], a[164:167], v[48:51]
 v_mfma_f32_16x16x32_bf16 v[52:55], v[28:31], a[180:183], v[52:55]
 v_mfma_f32_16x16x32_bf16 v[40:43], v[32:35], a[136:139], v[40:43]
 v_mfma_f32_16x16x32_bf16 v[44:47], v[32:35], a[152:155], v[44:47]
 v_mfma_f32_16x16x32_bf16 v[48:51], v[32:35], a[168:171], v[48:51]
 v_mfma_f32_16x16x32_bf16 v[52:55], v[32:35], a[184:187], v[52:55]
 v_mfma_f32_16x16x32_bf16 v[40:43], v[36:39], a[140:143], v[40:43]
 v_mfma_f32_16x16x32_bf16 v[44:47], v[36:39], a[156:159], v[44:47]
 v_mfma_f32_16x16x32_bf16 v[48:51], v[36:39], a[172:175], v[48:51]
 v_mfma_f32_16x16x32_bf16 v[52:55], v[36:39], a[188:191], v[52:55]
 s_nop 7
 v_cndmask_b32 v72, v40, v44, s[52:53]
 v_cndmask_b32 v73, v41, v45, s[52:53]
 v_cndmask_b32 v74, v42, v46, s[52:53]
 v_cndmask_b32 v75, v43, v47, s[52:53]
 ds_write_b128 v14, v[72:75] offset:8192
 v_cndmask_b32 v76, v48, v52, s[52:53]
 v_cndmask_b32 v77, v49, v53, s[52:53]
 v_cndmask_b32 v78, v50, v54, s[52:53]
 v_cndmask_b32 v79, v51, v55, s[52:53]
 ds_write_b128 v14, v[76:79] offset:12288
 s_waitcnt lgkmcnt(0)
 s_mov_b64 exec, 1
 ds_add_u32 v18, v19 offset:20544
 s_mov_b64 exec, -1

vpl_16:
 ds_read_b32 v196, v18 offset:20544
 s_sub_u32 s38, s38, 1
 s_cbranch_scc1 chain_exit
 s_waitcnt lgkmcnt(0)
 v_cmp_gt_u32 vcc, s79, v196
 s_cbranch_vccnz vpl_16

 ds_read_b128 v[80:83], v15 offset:0
 ds_read_b128 v[84:87], v15 offset:512
 ds_read_b128 v[88:91], v15 offset:1024
 ds_read_b128 v[92:95], v15 offset:1536
 ds_read_b128 v[96:99], v15 offset:2048
 ds_read_b128 v[100:103], v15 offset:2560
 ds_read_b128 v[104:107], v15 offset:3072
 ds_read_b128 v[108:111], v15 offset:3584
 s_waitcnt lgkmcnt(6)
 v_pk_add_f32 v[80:81], v[80:81], v[84:85]
 v_pk_add_f32 v[82:83], v[82:83], v[86:87]
 s_waitcnt lgkmcnt(4)
 v_pk_add_f32 v[88:89], v[88:89], v[92:93]
 v_pk_add_f32 v[90:91], v[90:91], v[94:95]
 s_waitcnt lgkmcnt(2)
 v_pk_add_f32 v[96:97], v[96:97], v[100:101]
 v_pk_add_f32 v[98:99], v[98:99], v[102:103]
 s_waitcnt lgkmcnt(0)
 v_pk_add_f32 v[104:105], v[104:105], v[108:109]
 v_pk_add_f32 v[106:107], v[106:107], v[110:111]
 v_pk_add_f32 v[80:81], v[80:81], v[88:89]
 v_pk_add_f32 v[82:83], v[82:83], v[90:91]
 v_pk_add_f32 v[96:97], v[96:97], v[104:105]
 v_pk_add_f32 v[98:99], v[98:99], v[106:107]
 v_pk_add_f32 v[80:81], v[80:81], v[96:97]
 v_pk_add_f32 v[82:83], v[82:83], v[98:99]
 v_cvt_pk_bf16_f32 v176, v80, v81
 v_cvt_pk_bf16_f32 v177, v82, v83
 v_min_u32 v176, -2, v176
 v_min_u32 v177, -2, v177
 ds_write_b64 v17, v[176:177] offset:0
 ds_read_b128 v[80:83], v15 offset:4096
 ds_read_b128 v[84:87], v15 offset:4608
 ds_read_b128 v[88:91], v15 offset:5120
 ds_read_b128 v[92:95], v15 offset:5632
 ds_read_b128 v[96:99], v15 offset:6144
 ds_read_b128 v[100:103], v15 offset:6656
 ds_read_b128 v[104:107], v15 offset:7168
 ds_read_b128 v[108:111], v15 offset:7680
 s_waitcnt lgkmcnt(6)
 v_pk_add_f32 v[80:81], v[80:81], v[84:85]
 v_pk_add_f32 v[82:83], v[82:83], v[86:87]
 s_waitcnt lgkmcnt(4)
 v_pk_add_f32 v[88:89], v[88:89], v[92:93]
 v_pk_add_f32 v[90:91], v[90:91], v[94:95]
 s_waitcnt lgkmcnt(2)
 v_pk_add_f32 v[96:97], v[96:97], v[100:101]
 v_pk_add_f32 v[98:99], v[98:99], v[102:103]
 s_waitcnt lgkmcnt(0)
 v_pk_add_f32 v[104:105], v[104:105], v[108:109]
 v_pk_add_f32 v[106:107], v[106:107], v[110:111]
 v_pk_add_f32 v[80:81], v[80:81], v[88:89]
 v_pk_add_f32 v[82:83], v[82:83], v[90:91]
 v_pk_add_f32 v[96:97], v[96:97], v[104:105]
 v_pk_add_f32 v[98:99], v[98:99], v[106:107]
 v_pk_add_f32 v[80:81], v[80:81], v[96:97]
 v_pk_add_f32 v[82:83], v[82:83], v[98:99]
 v_cvt_pk_bf16_f32 v180, v80, v81
 v_cvt_pk_bf16_f32 v181, v82, v83
 v_min_u32 v180, -2, v180
 v_min_u32 v181, -2, v181
 ds_write_b64 v17, v[180:181] offset:512
 v_mov_b32 v196, s79
 s_waitcnt lgkmcnt(0)
 ds_write_b32 v18, v196 offset:20608
 s_mov_b64 exec, s[56:57]

 buffer_store_dwordx2 v[176:177], v11, s[4:7], s44 offen offset:0 sc1
 buffer_store_dwordx2 v[180:181], v11, s[4:7], s44 offen offset:256 sc1
 s_mov_b64 exec, -1
 s_cmp_eq_u32 s37, 63
 s_cbranch_scc1 mega_join
 s_add_u32 s48, s37, 1
 s_and_b32 s48, s48, 3
 s_mul_i32 s48, s48, 131072
 s_add_u32 s84, s48, 100663296
 s_add_u32 s48, s37, 2
 s_and_b32 s48, s48, 3
 s_mul_i32 s48, s48, 131072
 s_add_u32 s85, s48, 100663296
 s_add_u32 s48, s37, 4
 s_and_b32 s48, s48, 3
 s_mul_i32 s48, s48, 131072
 s_add_u32 s86, s48, 100663296
 s_add_u32 s48, s37, 1
 s_and_b32 s48, s48, 3
 s_mul_i32 s48, s48, 131072
 s_add_u32 s87, s48, 113246208
 s_add_u32 s48, s37, 3
 s_and_b32 s48, s48, 3
 s_mul_i32 s48, s48, 131072
 s_add_u32 s88, s48, 113246208
 s_add_u32 s48, s37, 1
 s_and_b32 s48, s48, 3
 s_mul_i32 s48, s48, 65536
 s_add_u32 s89, s48, 132120576
 s_add_u32 s48, s37, 3
 s_and_b32 s48, s48, 3
 s_mul_i32 s48, s48, 65536
 s_add_u32 s90, s48, 132120576
 s_barrier
 buffer_load_dwordx4 v[204:207], v8, s[4:7], s42 offen offset:0 sc1
 buffer_load_dwordx4 v[208:211], v8, s[4:7], s42 offen offset:512 sc1
 buffer_load_dwordx4 v[212:215], v8, s[4:7], s42 offen offset:2048 sc1
 buffer_load_dwordx4 v[216:219], v8, s[4:7], s42 offen offset:2560 sc1
 s_waitcnt vmcnt(3)
pc_17:
 v_max3_u32 v196, v204, v205, v206
 v_max_u32 v197, v196, v207
 v_cmp_eq_u32 vcc, -1, v197
 s_cbranch_vccnz pr_18
 v_mfma_f32_16x16x32_bf16 v[40:43], a[192:195], v[204:207], 0
 v_mfma_f32_16x16x32_bf16 v[48:51], a[208:211], v[204:207], 0
 v_mfma_f32_16x16x32_bf16 v[44:47], a[196:199], v[204:207], 0
 v_mfma_f32_16x16x32_bf16 v[52:55], a[212:215], v[204:207], 0
 s_waitcnt vmcnt(2)
pc_19:
 v_max3_u32 v196, v208, v209, v210
 v_max_u32 v197, v196, v211
 v_cmp_eq_u32 vcc, -1, v197
 s_cbranch_vccnz pr_20
 v_mfma_f32_16x16x32_bf16 v[40:43], a[200:203], v[208:211], v[40:43]
 v_mfma_f32_16x16x32_bf16 v[48:51], a[216:219], v[208:211], v[48:51]
 v_mfma_f32_16x16x32_bf16 v[44:47], a[204:207], v[208:211], v[44:47]
 v_mfma_f32_16x16x32_bf16 v[52:55], a[220:223], v[208:211], v[52:55]
 s_waitcnt vmcnt(1)
pc_21:
 v_max3_u32 v196, v212, v213, v214
 v_max_u32 v197, v196, v215
 v_cmp_eq_u32 vcc, -1, v197
 s_cbranch_vccnz pr_22
 v_mfma_f32_16x16x32_bf16 v[40:43], a[224:227], v[212:215], v[40:43]
 v_mfma_f32_16x16x32_bf16 v[48:51], a[240:243], v[212:215], v[48:51]
 v_mfma_f32_16x16x32_bf16 v[44:47], a[228:231], v[212:215], v[44:47]
 v_mfma_f32_16x16x32_bf16 v[52:55], a[244:247], v[212:215], v[52:55]
 s_waitcnt vmcnt(0)
pc_23:
 v_max3_u32 v196, v216, v217, v218
 v_max_u32 v197, v196, v219
 v_cmp_eq_u32 vcc, -1, v197
 s_cbranch_vccnz pr_24
 v_mfma_f32_16x16x32_bf16 v[40:43], a[232:235], v[216:219], v[40:43]
 v_mfma_f32_16x16x32_bf16 v[48:51], a[248:251], v[216:219], v[48:51]
 v_mfma_f32_16x16x32_bf16 v[44:47], a[236:239], v[216:219], v[44:47]
 v_mfma_f32_16x16x32_bf16 v[52:55], a[252:255], v[216:219], v[52:55]
 s_nop 5
 v_add_f32_dpp v72, v48, v40 row_ror:8 row_mask:0xf bank_mask:0x3
 v_add_f32_dpp v73, v49, v41 row_ror:8 row_mask:0xf bank_mask:0x3
 v_add_f32_dpp v74, v50, v42 row_ror:8 row_mask:0xf bank_mask:0x3
 v_add_f32_dpp v75, v51, v43 row_ror:8 row_mask:0xf bank_mask:0x3
 v_add_f32_dpp v72, v44, v52 row_ror:8 row_mask:0xf bank_mask:0xc
 v_add_f32_dpp v73, v45, v53 row_ror:8 row_mask:0xf bank_mask:0xc
 v_add_f32_dpp v74, v46, v54 row_ror:8 row_mask:0xf bank_mask:0xc
 v_add_f32_dpp v75, v47, v55 row_ror:8 row_mask:0xf bank_mask:0xc
 ds_write_b128 v14, v[72:75] offset:16384
 s_waitcnt lgkmcnt(0)
 s_barrier
 s_add_u32 s44, s44, 65536
 s_add_u32 s74, s74, 65536
 s_add_u32 s79, s79, 4
 s_add_u32 s43, s43, 524288

 s_mov_b32 s40, s84
 s_mov_b32 s76, s86
 s_mov_b32 s41, s87
 s_mov_b32 s77, s88
 s_mov_b32 s42, s89
 s_mov_b32 s78, s90
 s_add_u32 s37, s37, 1
 s_barrier
 s_branch chain_loop_fast_3
pr_9:
 s_sub_u32 s38, s38, 1
 s_cbranch_scc1 chain_exit
 s_mov_b64 exec, vcc
 buffer_load_dwordx4 v[24:27], v2, s[4:7], s40 offen offset:0 sc1
 s_mov_b64 exec, -1
 s_waitcnt vmcnt(1)
 v_max3_u32 v196, v28, v29, v30
 v_max_u32 v196, v196, v31
 v_cmp_eq_u32 vcc, -1, v196
 s_cbranch_vccz ps_25
 s_mov_b64 exec, vcc
 buffer_load_dwordx4 v[28:31], v2, s[4:7], s40 offen offset:512 sc1
 s_mov_b64 exec, -1
ps_25:
 v_max3_u32 v196, v32, v33, v34
 v_max_u32 v196, v196, v35
 v_cmp_eq_u32 vcc, -1, v196
 s_cbranch_vccz ps_26
 s_mov_b64 exec, vcc
 buffer_load_dwordx4 v[32:35], v2, s[4:7], s40 offen offset:1024 sc1
 s_mov_b64 exec, -1
ps_26:
 v_max3_u32 v196, v36, v37, v38
 v_max_u32 v196, v196, v39
 v_cmp_eq_u32 vcc, -1, v196
 s_cbranch_vccz ps_27
 s_mov_b64 exec, vcc
 buffer_load_dwordx4 v[36:39], v2, s[4:7], s40 offen offset:1536 sc1
 s_mov_b64 exec, -1
ps_27:
 s_waitcnt vmcnt(0)
 s_branch pc_8
pr_11:
 s_sub_u32 s38, s38, 1
 s_cbranch_scc1 chain_exit
 s_mov_b64 exec, vcc
 buffer_load_dwordx4 v[28:31], v2, s[4:7], s40 offen offset:512 sc1
 s_mov_b64 exec, -1
 s_waitcnt vmcnt(1)
 v_max3_u32 v196, v32, v33, v34
 v_max_u32 v196, v196, v35
 v_cmp_eq_u32 vcc, -1, v196
 s_cbranch_vccz ps_28
 s_mov_b64 exec, vcc
 buffer_load_dwordx4 v[32:35], v2, s[4:7], s40 offen offset:1024 sc1
 s_mov_b64 exec, -1
ps_28:
 v_max3_u32 v196, v36, v37, v38
 v_max_u32 v196, v196, v39
 v_cmp_eq_u32 vcc, -1, v196
 s_cbranch_vccz ps_29
 s_mov_b64 exec, vcc
 buffer_load_dwordx4 v[36:39], v2, s[4:7], s40 offen offset:1536 sc1
 s_mov_b64 exec, -1
ps_29:
 s_waitcnt vmcnt(0)
 s_branch pc_10
pr_13:
 s_sub_u32 s38, s38, 1
 s_cbranch_scc1 chain_exit
 s_mov_b64 exec, vcc
 buffer_load_dwordx4 v[32:35], v2, s[4:7], s40 offen offset:1024 sc1
 s_mov_b64 exec, -1
 s_waitcnt vmcnt(1)
 v_max3_u32 v196, v36, v37, v38
 v_max_u32 v196, v196, v39
 v_cmp_eq_u32 vcc, -1, v196
 s_cbranch_vccz ps_30
 s_mov_b64 exec, vcc
 buffer_load_dwordx4 v[36:39], v2, s[4:7], s40 offen offset:1536 sc1
 s_mov_b64 exec, -1
ps_30:
 s_waitcnt vmcnt(0)
 s_branch pc_12
pr_15:
 s_sub_u32 s38, s38, 1
 s_cbranch_scc1 chain_exit
 s_mov_b64 exec, vcc
 buffer_load_dwordx4 v[36:39], v2, s[4:7], s40 offen offset:1536 sc1
 s_mov_b64 exec, -1
 s_waitcnt vmcnt(0)
 s_branch pc_14
pr_18:
 s_sub_u32 s38, s38, 1
 s_cbranch_scc1 chain_exit
 s_mov_b64 exec, vcc
 buffer_load_dwordx4 v[204:207], v8, s[4:7], s42 offen offset:0 sc1
 s_mov_b64 exec, -1
 s_waitcnt vmcnt(1)
 v_max3_u32 v196, v208, v209, v210
 v_max_u32 v196, v196, v211
 v_cmp_eq_u32 vcc, -1, v196
 s_cbranch_vccz ps_31
 s_mov_b64 exec, vcc
 buffer_load_dwordx4 v[208:211], v8, s[4:7], s42 offen offset:512 sc1
 s_mov_b64 exec, -1
ps_31:
 v_max3_u32 v196, v212, v213, v214
 v_max_u32 v196, v196, v215
 v_cmp_eq_u32 vcc, -1, v196
 s_cbranch_vccz ps_32
 s_mov_b64 exec, vcc
 buffer_load_dwordx4 v[212:215], v8, s[4:7], s42 offen offset:2048 sc1
 s_mov_b64 exec, -1
ps_32:
 v_max3_u32 v196, v216, v217, v218
 v_max_u32 v196, v196, v219
 v_cmp_eq_u32 vcc, -1, v196
 s_cbranch_vccz ps_33
 s_mov_b64 exec, vcc
 buffer_load_dwordx4 v[216:219], v8, s[4:7], s42 offen offset:2560 sc1
 s_mov_b64 exec, -1
ps_33:
 s_waitcnt vmcnt(0)
 s_branch pc_17
pr_20:
 s_sub_u32 s38, s38, 1
 s_cbranch_scc1 chain_exit
 s_mov_b64 exec, vcc
 buffer_load_dwordx4 v[208:211], v8, s[4:7], s42 offen offset:512 sc1
 s_mov_b64 exec, -1
 s_waitcnt vmcnt(1)
 v_max3_u32 v196, v212, v213, v214
 v_max_u32 v196, v196, v215
 v_cmp_eq_u32 vcc, -1, v196
 s_cbranch_vccz ps_34
 s_mov_b64 exec, vcc
 buffer_load_dwordx4 v[212:215], v8, s[4:7], s42 offen offset:2048 sc1
 s_mov_b64 exec, -1
ps_34:
 v_max3_u32 v196, v216, v217, v218
 v_max_u32 v196, v196, v219
 v_cmp_eq_u32 vcc, -1, v196
 s_cbranch_vccz ps_35
 s_mov_b64 exec, vcc
 buffer_load_dwordx4 v[216:219], v8, s[4:7], s42 offen offset:2560 sc1
 s_mov_b64 exec, -1
ps_35:
 s_waitcnt vmcnt(0)
 s_branch pc_19
pr_22:
 s_sub_u32 s38, s38, 1
 s_cbranch_scc1 chain_exit
 s_mov_b64 exec, vcc
 buffer_load_dwordx4 v[212:215], v8, s[4:7], s42 offen offset:2048 sc1
 s_mov_b64 exec, -1
 s_waitcnt vmcnt(1)
 v_max3_u32 v196, v216, v217, v218
 v_max_u32 v196, v196, v219
 v_cmp_eq_u32 vcc, -1, v196
 s_cbranch_vccz ps_36
 s_mov_b64 exec, vcc
 buffer_load_dwordx4 v[216:219], v8, s[4:7], s42 offen offset:2560 sc1
 s_mov_b64 exec, -1
ps_36:
 s_waitcnt vmcnt(0)
 s_branch pc_21
pr_24:
 s_sub_u32 s38, s38, 1
 s_cbranch_scc1 chain_exit
 s_mov_b64 exec, vcc
 buffer_load_dwordx4 v[216:219], v8, s[4:7], s42 offen offset:2560 sc1
 s_mov_b64 exec, -1
 s_waitcnt vmcnt(0)
 s_branch pc_23
chain_loop_fast_0:
 buffer_load_dwordx4 v[24:27], v2, s[4:7], s40 offen offset:0 sc1
 buffer_load_dwordx4 v[28:31], v2, s[4:7], s40 offen offset:512 sc1
 buffer_load_dwordx4 v[32:35], v2, s[4:7], s40 offen offset:1024 sc1
 buffer_load_dwordx4 v[36:39], v2, s[4:7], s40 offen offset:1536 sc1
 s_waitcnt vmcnt(3)
pc_37:
 v_max3_u32 v196, v24, v25, v26
 v_max_u32 v197, v196, v27
 v_cmp_eq_u32 vcc, -1, v197
 s_cbranch_vccnz pr_38
 v_mfma_f32_16x16x32_bf16 v[40:43], a[0:3], v[24:27], 0
 v_mfma_f32_16x16x32_bf16 v[44:47], a[16:19], v[24:27], 0
 v_mfma_f32_16x16x32_bf16 v[48:51], a[64:67], v[24:27], 0
 v_mfma_f32_16x16x32_bf16 v[52:55], a[80:83], v[24:27], 0
 v_mfma_f32_16x16x32_bf16 v[56:59], a[32:35], v[24:27], 0
 v_mfma_f32_16x16x32_bf16 v[60:63], a[48:51], v[24:27], 0
 v_mfma_f32_16x16x32_bf16 v[64:67], a[96:99], v[24:27], 0
 v_mfma_f32_16x16x32_bf16 v[68:71], a[112:115], v[24:27], 0
 s_waitcnt vmcnt(2)
pc_39:
 v_max3_u32 v196, v28, v29, v30
 v_max_u32 v197, v196, v31
 v_cmp_eq_u32 vcc, -1, v197
 s_cbranch_vccnz pr_40
 v_mfma_f32_16x16x32_bf16 v[40:43], a[4:7], v[28:31], v[40:43]
 v_mfma_f32_16x16x32_bf16 v[44:47], a[20:23], v[28:31], v[44:47]
 v_mfma_f32_16x16x32_bf16 v[48:51], a[68:71], v[28:31], v[48:51]
 v_mfma_f32_16x16x32_bf16 v[52:55], a[84:87], v[28:31], v[52:55]
 v_mfma_f32_16x16x32_bf16 v[56:59], a[36:39], v[28:31], v[56:59]
 v_mfma_f32_16x16x32_bf16 v[60:63], a[52:55], v[28:31], v[60:63]
 v_mfma_f32_16x16x32_bf16 v[64:67], a[100:103], v[28:31], v[64:67]
 v_mfma_f32_16x16x32_bf16 v[68:71], a[116:119], v[28:31], v[68:71]
 s_waitcnt vmcnt(1)
pc_41:
 v_max3_u32 v196, v32, v33, v34
 v_max_u32 v197, v196, v35
 v_cmp_eq_u32 vcc, -1, v197
 s_cbranch_vccnz pr_42
 v_mfma_f32_16x16x32_bf16 v[40:43], a[8:11], v[32:35], v[40:43]
 v_mfma_f32_16x16x32_bf16 v[44:47], a[24:27], v[32:35], v[44:47]
 v_mfma_f32_16x16x32_bf16 v[48:51], a[72:75], v[32:35], v[48:51]
 v_mfma_f32_16x16x32_bf16 v[52:55], a[88:91], v[32:35], v[52:55]
 v_mfma_f32_16x16x32_bf16 v[56:59], a[40:43], v[32:35], v[56:59]
 v_mfma_f32_16x16x32_bf16 v[60:63], a[56:59], v[32:35], v[60:63]
 v_mfma_f32_16x16x32_bf16 v[64:67], a[104:107], v[32:35], v[64:67]
 v_mfma_f32_16x16x32_bf16 v[68:71], a[120:123], v[32:35], v[68:71]
 s_waitcnt vmcnt(0)
pc_43:
 v_max3_u32 v196, v36, v37, v38
 v_max_u32 v197, v196, v39
 v_cmp_eq_u32 vcc, -1, v197
 s_cbranch_vccnz pr_44
 v_mfma_f32_16x16x32_bf16 v[40:43], a[12:15], v[36:39], v[40:43]
 v_mfma_f32_16x16x32_bf16 v[44:47], a[28:31], v[36:39], v[44:47]
 v_mfma_f32_16x16x32_bf16 v[48:51], a[76:79], v[36:39], v[48:51]
 v_mfma_f32_16x16x32_bf16 v[52:55], a[92:95], v[36:39], v[52:55]
 v_mfma_f32_16x16x32_bf16 v[56:59], a[44:47], v[36:39], v[56:59]
 v_mfma_f32_16x16x32_bf16 v[60:63], a[60:63], v[36:39], v[60:63]
 v_mfma_f32_16x16x32_bf16 v[64:67], a[108:111], v[36:39], v[64:67]
 v_mfma_f32_16x16x32_bf16 v[68:71], a[124:127], v[36:39], v[68:71]
 s_nop 1
 v_add_f32_dpp v72, v44, v40 row_ror:8 row_mask:0xf bank_mask:0x3
 v_add_f32_dpp v73, v45, v41 row_ror:8 row_mask:0xf bank_mask:0x3
 v_add_f32_dpp v74, v46, v42 row_ror:8 row_mask:0xf bank_mask:0x3
 v_add_f32_dpp v75, v47, v43 row_ror:8 row_mask:0xf bank_mask:0x3
 v_add_f32_dpp v72, v48, v52 row_ror:8 row_mask:0xf bank_mask:0xc
 v_add_f32_dpp v73, v49, v53 row_ror:8 row_mask:0xf bank_mask:0xc
 v_add_f32_dpp v74, v50, v54 row_ror:8 row_mask:0xf bank_mask:0xc
 v_add_f32_dpp v75, v51, v55 row_ror:8 row_mask:0xf bank_mask:0xc
 ds_write_b128 v14, v[72:75] offset:0
 v_add_f32_dpp v76, v60, v56 row_ror:8 row_mask:0xf bank_mask:0x3
 v_add_f32_dpp v77, v61, v57 row_ror:8 row_mask:0xf bank_mask:0x3
 v_add_f32_dpp v78, v62, v58 row_ror:8 row_mask:0xf bank_mask:0x3
 v_add_f32_dpp v79, v63, v59 row_ror:8 row_mask:0xf bank_mask:0x3
 v_add_f32_dpp v76, v64, v68 row_ror:8 row_mask:0xf bank_mask:0xc
 v_add_f32_dpp v77, v65, v69 row_ror:8 row_mask:0xf bank_mask:0xc
 v_add_f32_dpp v78, v66, v70 row_ror:8 row_mask:0xf bank_mask:0xc
 v_add_f32_dpp v79, v67, v71 row_ror:8 row_mask:0xf bank_mask:0xc
 ds_write_b128 v14, v[76:79] offset:4096
 s_waitcnt lgkmcnt(0)
 s_barrier
 v_mfma_f32_16x16x32_bf16 v[40:43], v[24:27], a[128:131], 0
 v_mfma_f32_16x16x32_bf16 v[44:47], v[24:27], a[144:147], 0
 v_mfma_f32_16x16x32_bf16 v[48:51], v[24:27], a[160:163], 0
 v_mfma_f32_16x16x32_bf16 v[52:55], v[24:27], a[176:179], 0
 v_mfma_f32_16x16x32_bf16 v[40:43], v[28:31], a[132:135], v[40:43]
 v_mfma_f32_16x16x32_bf16 v[44:47], v[28:31], a[148:151], v[44:47]
 v_mfma_f32_16x16x32_bf16 v[48:51], v[28:31], a[164:167], v[48:51]
 v_mfma_f32_16x16x32_bf16 v[52:55], v[28:31], a[180:183], v[52:55]
 v_mfma_f32_16x16x32_bf16 v[40:43], v[32:35], a[136:139], v[40:43]
 v_mfma_f32_16x16x32_bf16 v[44:47], v[32:35], a[152:155], v[44:47]
 v_mfma_f32_16x16x32_bf16 v[48:51], v[32:35], a[168:171], v[48:51]
 v_mfma_f32_16x16x32_bf16 v[52:55], v[32:35], a[184:187], v[52:55]
 v_mfma_f32_16x16x32_bf16 v[40:43], v[36:39], a[140:143], v[40:43]
 v_mfma_f32_16x16x32_bf16 v[44:47], v[36:39], a[156:159], v[44:47]
 v_mfma_f32_16x16x32_bf16 v[48:51], v[36:39], a[172:175], v[48:51]
 v_mfma_f32_16x16x32_bf16 v[52:55], v[36:39], a[188:191], v[52:55]
 s_nop 7
 v_cndmask_b32 v72, v40, v44, s[52:53]
 v_cndmask_b32 v73, v41, v45, s[52:53]
 v_cndmask_b32 v74, v42, v46, s[52:53]
 v_cndmask_b32 v75, v43, v47, s[52:53]
 ds_write_b128 v14, v[72:75] offset:8192
 v_cndmask_b32 v76, v48, v52, s[52:53]
 v_cndmask_b32 v77, v49, v53, s[52:53]
 v_cndmask_b32 v78, v50, v54, s[52:53]
 v_cndmask_b32 v79, v51, v55, s[52:53]
 ds_write_b128 v14, v[76:79] offset:12288
 s_waitcnt lgkmcnt(0)
 s_mov_b64 exec, 1
 ds_add_u32 v18, v19 offset:20544
 s_mov_b64 exec, -1

 s_cmp_eq_u32 s37, 63
 s_cbranch_scc1 mega_join
 buffer_load_dwordx4 v[112:115], v5, s[4:7], s41 offen offset:0 sc1
 buffer_load_dwordx4 v[116:119], v5, s[4:7], s41 offen offset:1024 sc1
 buffer_load_dwordx4 v[120:123], v6, s[4:7], s41 offen offset:0 sc1
 buffer_load_dwordx4 v[124:127], v6, s[4:7], s41 offen offset:1024 sc1
 buffer_load_dwordx4 v[128:131], v6, s[4:7], s41 offen offset:2048 sc1
 buffer_load_dwordx4 v[132:135], v6, s[4:7], s41 offen offset:3072 sc1
pw_45:
 s_waitcnt vmcnt(4)
 v_max3_u32 v196, v112, v113, v114
 v_max3_u32 v197, v115, v116, v117
 v_max_u32 v198, v118, v119
 v_max3_u32 v199, v196, v197, v198
 v_cmp_eq_u32 vcc, -1, v199
 s_cbranch_vccnz pr_46
 v_mfma_f32_16x16x32_bf16 v[40:43], v[136:139], v[112:115], 0
 v_mfma_f32_16x16x32_bf16 v[40:43], v[140:143], v[116:119], v[40:43]
 v_mfma_f32_16x16x32_bf16 v[44:47], v[144:147], v[112:115], 0
 v_mfma_f32_16x16x32_bf16 v[44:47], v[148:151], v[116:119], v[44:47]
 v_mfma_f32_16x16x32_bf16 v[48:51], v[152:155], v[112:115], 0
 v_mfma_f32_16x16x32_bf16 v[48:51], v[156:159], v[116:119], v[48:51]
 v_mfma_f32_16x16x32_bf16 v[52:55], v[160:163], v[112:115], 0
 v_mfma_f32_16x16x32_bf16 v[52:55], v[164:167], v[116:119], v[52:55]
pw_47:
 s_waitcnt vmcnt(0)
 v_max3_u32 v196, v120, v121, v122
 v_max3_u32 v197, v123, v124, v125
 v_max3_u32 v198, v126, v127, v128
 v_max3_u32 v199, v196, v197, v198
 v_max3_u32 v200, v129, v130, v131
 v_max3_u32 v201, v132, v133, v134
 v_max3_u32 v196, v199, v200, v201
 v_max_u32 v197, v196, v135
 v_cmp_eq_u32 vcc, -1, v197
 s_cbranch_vccnz pr_48
 v_mfma_f32_16x16x32_bf16 v[56:59], v[120:123], v[112:115], 0
 v_add_f32_dpp v188, v44, v40 row_ror:8 row_mask:0xf bank_mask:0x3
 v_add_f32_dpp v189, v45, v41 row_ror:8 row_mask:0xf bank_mask:0x3
 v_mfma_f32_16x16x32_bf16 v[56:59], v[124:127], v[116:119], v[56:59]
 v_add_f32_dpp v190, v46, v42 row_ror:8 row_mask:0xf bank_mask:0x3
 v_add_f32_dpp v191, v47, v43 row_ror:8 row_mask:0xf bank_mask:0x3
 v_mfma_f32_16x16x32_bf16 v[60:63], v[128:131], v[112:115], 0
 v_add_f32_dpp v192, v52, v48 row_ror:8 row_mask:0xf bank_mask:0x3
 v_add_f32_dpp v193, v53, v49 row_ror:8 row_mask:0xf bank_mask:0x3
 v_mfma_f32_16x16x32_bf16 v[60:63], v[132:135], v[116:119], v[60:63]
 v_add_f32_dpp v194, v54, v50 row_ror:8 row_mask:0xf bank_mask:0x3
 v_add_f32_dpp v195, v55, v51 row_ror:8 row_mask:0xf bank_mask:0x3
 v_max3_f32 v100, v192, v193, v194
 v_max_f32 v100, v100, v195
 ds_read_b32 v200, v18 offset:20608
 ds_read_b64 v[176:177], v17 offset:0
 ds_read_b64 v[180:181], v17 offset:512
 s_nop 1
 v_add_f32_dpp v188, v56, v60 row_ror:8 row_mask:0x3 bank_mask:0xc
 v_add_f32_dpp v189, v57, v61 row_ror:8 row_mask:0x3 bank_mask:0xc
 v_add_f32_dpp v190, v58, v62 row_ror:8 row_mask:0x3 bank_mask:0xc
 v_add_f32_dpp v191, v59, v63 row_ror:8 row_mask:0x3 bank_mask:0xc
 v_max3_f32 v196, v100, v188, v189
 v_max3_f32 v196, v196, v190, v191
 s_nop 1
 v_max_f32_dpp v196, v196, v196 row_ror:8 row_mask:0xf bank_mask:0xf
 v_mov_b32 v197, v196
 s_nop 1
 v_permlane16_swap_b32 v196, v197
 v_max_f32 v196, v196, v197
 v_mov_b32 v197, v196
 s_nop 1
 v_permlane32_swap_b32 v196, v197
 v_max_f32 v196, v196, v197
 v_mul_f32 v198, s66, v196

 v_fma_f32 v80, v188, s66, -v198
 v_fma_f32 v81, v189, s66, -v198
 v_fma_f32 v82, v190, s66, -v198
 v_fma_f32 v83, v191, s66, -v198
 v_fma_f32 v84, v192, s66, -v198
 v_fma_f32 v85, v193, s66, -v198
 v_fma_f32 v86, v194, s66, -v198
 v_fma_f32 v87, v195, s66, -v198
 v_exp_f32 v80, v80
 v_exp_f32 v81, v81
 v_exp_f32 v82, v82
 v_exp_f32 v83, v83
 v_exp_f32 v84, v84
 v_exp_f32 v85, v85
 v_exp_f32 v86, v86
 v_exp_f32 v87, v87
 s_nop 0
 v_cvt_pk_bf16_f32 v88, v80, v81
 v_cvt_pk_bf16_f32 v89, v82, v83
 v_cvt_pk_bf16_f32 v90, v84, v85
 v_cvt_pk_bf16_f32 v91, v86, v87
fw_49:
 s_waitcnt lgkmcnt(0)
 v_cmp_gt_u32 vcc, s79, v200
 s_cbranch_vccnz fr_50
 v_mfma_f32_16x16x32_bf16 v[40:43], v[220:223], v[88:91], 0
 v_mfma_f32_16x16x32_bf16 v[44:47], v[168:171], v[88:91], 0
 v_mfma_f32_16x16x32_bf16 v[48:51], v[176:179], v[88:91], 0
 v_mfma_f32_16x16x32_bf16 v[52:55], v[172:175], v[88:91], 0
 v_mfma_f32_16x16x32_bf16 v[56:59], v[180:183], v[88:91], 0
 s_nop 3
 v_add_f32_dpp v199, v40, v40 row_ror:8 row_mask:0xf bank_mask:0xf
 v_rcp_f32 v199, v199
 v_add_f32_dpp v80, v48, v44 row_ror:8 row_mask:0xf bank_mask:0xf
 v_add_f32_dpp v81, v49, v45 row_ror:8 row_mask:0xf bank_mask:0xf
 v_add_f32_dpp v82, v50, v46 row_ror:8 row_mask:0xf bank_mask:0xf
 v_add_f32_dpp v83, v51, v47 row_ror:8 row_mask:0xf bank_mask:0xf
 s_nop 0
 v_add_f32_dpp v84, v56, v52 row_ror:8 row_mask:0xf bank_mask:0xf
 v_add_f32_dpp v85, v57, v53 row_ror:8 row_mask:0xf bank_mask:0xf
 v_add_f32_dpp v86, v58, v54 row_ror:8 row_mask:0xf bank_mask:0xf
 v_add_f32_dpp v87, v59, v55 row_ror:8 row_mask:0xf bank_mask:0xf
 s_mov_b64 exec, s[54:55]
 v_mul_f32 v80, v80, v199
 v_mul_f32 v81, v81, v199
 v_mul_f32 v82, v82, v199
 v_mul_f32 v83, v83, v199
 v_cvt_pk_bf16_f32 v88, v80, v81
 v_cvt_pk_bf16_f32 v89, v82, v83
 v_min_u32 v88, -2, v88
 v_min_u32 v89, -2, v89

 buffer_store_dwordx2 v[88:89], v7, s[4:7], s42 offen offset:0
 v_mul_f32 v84, v84, v199
 v_mul_f32 v85, v85, v199
 v_mul_f32 v86, v86, v199
 v_mul_f32 v87, v87, v199
 v_cvt_pk_bf16_f32 v90, v84, v85
 v_cvt_pk_bf16_f32 v91, v86, v87
 v_min_u32 v90, -2, v90
 v_min_u32 v91, -2, v91

 buffer_store_dwordx2 v[90:91], v7, s[4:7], s42 offen offset:256
 s_cmp_lg_u32 s83, 0
 s_cbranch_scc1 sl_51
bk_52:
 s_cbranch_scc1 sl_53
bk_54:
 s_mov_b64 exec, -1
 s_barrier
 buffer_load_dwordx4 v[204:207], v8, s[4:7], s42 offen offset:0 sc1
 buffer_load_dwordx4 v[208:211], v8, s[4:7], s42 offen offset:512 sc1
 buffer_load_dwordx4 v[212:215], v8, s[4:7], s42 offen offset:2048 sc1
 buffer_load_dwordx4 v[216:219], v8, s[4:7], s42 offen offset:2560 sc1
 s_waitcnt vmcnt(3)
pc_55:
 v_max3_u32 v196, v204, v205, v206
 v_max_u32 v197, v196, v207
 v_cmp_eq_u32 vcc, -1, v197
 s_cbranch_vccnz pr_56
 v_mfma_f32_16x16x32_bf16 v[40:43], a[192:195], v[204:207], 0
 v_mfma_f32_16x16x32_bf16 v[48:51], a[208:211], v[204:207], 0
 v_mfma_f32_16x16x32_bf16 v[44:47], a[196:199], v[204:207], 0
 v_mfma_f32_16x16x32_bf16 v[52:55], a[212:215], v[204:207], 0
 s_waitcnt vmcnt(2)
pc_57:
 v_max3_u32 v196, v208, v209, v210
 v_max_u32 v197, v196, v211
 v_cmp_eq_u32 vcc, -1, v197
 s_cbranch_vccnz pr_58
 v_mfma_f32_16x16x32_bf16 v[40:43], a[200:203], v[208:211], v[40:43]
 v_mfma_f32_16x16x32_bf16 v[48:51], a[216:219], v[208:211], v[48:51]
 v_mfma_f32_16x16x32_bf16 v[44:47], a[204:207], v[208:211], v[44:47]
 v_mfma_f32_16x16x32_bf16 v[52:55], a[220:223], v[208:211], v[52:55]
 s_waitcnt vmcnt(1)
pc_59:
 v_max3_u32 v196, v212, v213, v214
 v_max_u32 v197, v196, v215
 v_cmp_eq_u32 vcc, -1, v197
 s_cbranch_vccnz pr_60
 v_mfma_f32_16x16x32_bf16 v[40:43], a[224:227], v[212:215], v[40:43]
 v_mfma_f32_16x16x32_bf16 v[48:51], a[240:243], v[212:215], v[48:51]
 v_mfma_f32_16x16x32_bf16 v[44:47], a[228:231], v[212:215], v[44:47]
 v_mfma_f32_16x16x32_bf16 v[52:55], a[244:247], v[212:215], v[52:55]
 s_waitcnt vmcnt(0)
pc_61:
 v_max3_u32 v196, v216, v217, v218
 v_max_u32 v197, v196, v219
 v_cmp_eq_u32 vcc, -1, v197
 s_cbranch_vccnz pr_62
 v_mfma_f32_16x16x32_bf16 v[40:43], a[232:235], v[216:219], v[40:43]
 v_mfma_f32_16x16x32_bf16 v[48:51], a[248:251], v[216:219], v[48:51]
 v_mfma_f32_16x16x32_bf16 v[44:47], a[236:239], v[216:219], v[44:47]
 v_mfma_f32_16x16x32_bf16 v[52:55], a[252:255], v[216:219], v[52:55]
 s_nop 5
 v_add_f32_dpp v72, v48, v40 row_ror:8 row_mask:0xf bank_mask:0x3
 v_add_f32_dpp v73, v49, v41 row_ror:8 row_mask:0xf bank_mask:0x3
 v_add_f32_dpp v74, v50, v42 row_ror:8 row_mask:0xf bank_mask:0x3
 v_add_f32_dpp v75, v51, v43 row_ror:8 row_mask:0xf bank_mask:0x3
 v_add_f32_dpp v72, v44, v52 row_ror:8 row_mask:0xf bank_mask:0xc
 v_add_f32_dpp v73, v45, v53 row_ror:8 row_mask:0xf bank_mask:0xc
 v_add_f32_dpp v74, v46, v54 row_ror:8 row_mask:0xf bank_mask:0xc
 v_add_f32_dpp v75, v47, v55 row_ror:8 row_mask:0xf bank_mask:0xc
 ds_write_b128 v14, v[72:75] offset:16384
 s_waitcnt lgkmcnt(0)
 s_barrier
 s_add_u32 s48, s37, 1
 s_and_b32 s48, s48, 3
 s_mul_i32 s48, s48, 131072
 s_add_u32 s84, s48, 100663296
 s_add_u32 s48, s37, 2
 s_and_b32 s48, s48, 3
 s_mul_i32 s48, s48, 131072
 s_add_u32 s85, s48, 100663296
 s_add_u32 s48, s37, 4
 s_and_b32 s48, s48, 3
 s_mul_i32 s48, s48, 131072
 s_add_u32 s86, s48, 100663296
 s_add_u32 s48, s37, 1
 s_and_b32 s48, s48, 3
 s_mul_i32 s48, s48, 131072
 s_add_u32 s87, s48, 113246208
 s_add_u32 s48, s37, 3
 s_and_b32 s48, s48, 3
 s_mul_i32 s48, s48, 131072
 s_add_u32 s88, s48, 113246208
 s_add_u32 s48, s37, 1
 s_and_b32 s48, s48, 3
 s_mul_i32 s48, s48, 65536
 s_add_u32 s89, s48, 132120576
 s_add_u32 s48, s37, 3
 s_and_b32 s48, s48, 3
 s_mul_i32 s48, s48, 65536
 s_add_u32 s90, s48, 132120576
 s_mov_b64 exec, s[54:55]
 buffer_store_dwordx2 v[184:185], v7, s[4:7], s78 offen offset:0
 buffer_store_dwordx2 v[184:185], v7, s[4:7], s78 offen offset:256
 s_cmp_lg_u32 s83, 0
 s_cbranch_scc1 sl_63
bk_64:
 s_mov_b64 exec, -1
 buffer_store_dwordx2 v[184:185], v3, s[4:7], s76 offen
 s_cmp_lg_u32 s83, 0
 s_cbranch_scc1 sl_65
bk_66:
 buffer_store_dwordx4 v[184:187], v9, s[4:7], s82 offen sc1
 s_add_u32 s82, s82, 524288
 s_add_u32 s45, s45, 262144
 s_add_u32 s46, s46, 262144
 s_add_u32 s47, s47, 262144

 s_add_u32 s48, s37, 1
 s_and_b32 s49, s48, 3
 s_cbranch_scc1 kvsk_67
 s_lshr_b32 s48, s48, 2
 s_and_b32 s49, s48, 0xfe
 s_cmp_lt_u32 s48, 4
 s_cselect_b32 s48, s48, s49
 s_lshl_b32 s48, s48, 4
 s_lshr_b32 s49, s35, 1
 s_add_u32 s48, s48, s49
 s_lshl_b32 s48, s48, 10
 s_add_u32 s48, s48, 161488896
 v_and_b32 v197, 7, v1
 v_lshlrev_b32 v197, 7, v197

kvpl_68:
 s_sub_u32 s38, s38, 1
 s_cbranch_scc1 chain_exit
 buffer_load_dword v196, v197, s[4:7], s48 offen sc1
 s_waitcnt vmcnt(0)
 v_add_u32_dpp v196, v196, v196 quad_perm:[1,0,3,2] row_mask:0xf bank_mask:0xf
 s_nop 1
 v_add_u32_dpp v196, v196, v196 quad_perm:[2,3,0,1] row_mask:0xf bank_mask:0xf
 s_nop 1
 v_add_u32_dpp v196, v196, v196 row_half_mirror row_mask:0xf bank_mask:0xf
 v_cmp_gt_u32 vcc, 4, v196
 s_cbranch_vccnz kvpl_68

kvsk_67:
 buffer_load_dwordx4 v[136:139], v12, s[4:7], s45 offen offset:0 sc1
 buffer_load_dwordx4 v[140:143], v12, s[4:7], s45 offen offset:2048 sc1
 buffer_load_dwordx4 v[144:147], v12, s[4:7], s46 offen offset:0 sc1
 buffer_load_dwordx4 v[148:151], v12, s[4:7], s46 offen offset:2048 sc1
 buffer_load_dwordx4 v[152:155], v12, s[4:7], s45 offen offset:256 sc1
 buffer_load_dwordx4 v[156:159], v12, s[4:7], s45 offen offset:2304 sc1
 buffer_load_dwordx4 v[160:163], v12, s[4:7], s46 offen offset:256 sc1
 buffer_load_dwordx4 v[164:167], v12, s[4:7], s46 offen offset:2304 sc1
 buffer_load_dwordx2 v[168:169], v13, s[4:7], s47 offen offset:0 sc1
 buffer_load_dwordx2 v[170:171], v13, s[4:7], s47 offen offset:1024 sc1
 buffer_load_dwordx2 v[172:173], v13, s[4:7], s47 offen offset:256 sc1
 buffer_load_dwordx2 v[174:175], v13, s[4:7], s47 offen offset:1280 sc1
 s_add_u32 s44, s44, 65536
 s_add_u32 s74, s74, 65536
 s_add_u32 s79, s79, 4
 s_add_u32 s43, s43, 524288

 s_mov_b32 s40, s84
 s_mov_b32 s76, s86
 s_mov_b32 s41, s87
 s_mov_b32 s77, s88
 s_mov_b32 s42, s89
 s_mov_b32 s78, s90
 s_waitcnt vmcnt(12)
 s_add_u32 s37, s37, 1
 s_barrier
 s_branch chain_loop_fast_0
pr_38:
 s_sub_u32 s38, s38, 1
 s_cbranch_scc1 chain_exit
 s_mov_b64 exec, vcc
 buffer_load_dwordx4 v[24:27], v2, s[4:7], s40 offen offset:0 sc1
 s_mov_b64 exec, -1
 s_waitcnt vmcnt(1)
 v_max3_u32 v196, v28, v29, v30
 v_max_u32 v196, v196, v31
 v_cmp_eq_u32 vcc, -1, v196
 s_cbranch_vccz ps_69
 s_mov_b64 exec, vcc
 buffer_load_dwordx4 v[28:31], v2, s[4:7], s40 offen offset:512 sc1
 s_mov_b64 exec, -1
ps_69:
 v_max3_u32 v196, v32, v33, v34
 v_max_u32 v196, v196, v35
 v_cmp_eq_u32 vcc, -1, v196
 s_cbranch_vccz ps_70
 s_mov_b64 exec, vcc
 buffer_load_dwordx4 v[32:35], v2, s[4:7], s40 offen offset:1024 sc1
 s_mov_b64 exec, -1
ps_70:
 v_max3_u32 v196, v36, v37, v38
 v_max_u32 v196, v196, v39
 v_cmp_eq_u32 vcc, -1, v196
 s_cbranch_vccz ps_71
 s_mov_b64 exec, vcc
 buffer_load_dwordx4 v[36:39], v2, s[4:7], s40 offen offset:1536 sc1
 s_mov_b64 exec, -1
ps_71:
 s_waitcnt vmcnt(0)
 s_branch pc_37
pr_40:
 s_sub_u32 s38, s38, 1
 s_cbranch_scc1 chain_exit
 s_mov_b64 exec, vcc
 buffer_load_dwordx4 v[28:31], v2, s[4:7], s40 offen offset:512 sc1
 s_mov_b64 exec, -1
 s_waitcnt vmcnt(1)
 v_max3_u32 v196, v32, v33, v34
 v_max_u32 v196, v196, v35
 v_cmp_eq_u32 vcc, -1, v196
 s_cbranch_vccz ps_72
 s_mov_b64 exec, vcc
 buffer_load_dwordx4 v[32:35], v2, s[4:7], s40 offen offset:1024 sc1
 s_mov_b64 exec, -1
ps_72:
 v_max3_u32 v196, v36, v37, v38
 v_max_u32 v196, v196, v39
 v_cmp_eq_u32 vcc, -1, v196
 s_cbranch_vccz ps_73
 s_mov_b64 exec, vcc
 buffer_load_dwordx4 v[36:39], v2, s[4:7], s40 offen offset:1536 sc1
 s_mov_b64 exec, -1
ps_73:
 s_waitcnt vmcnt(0)
 s_branch pc_39
pr_42:
 s_sub_u32 s38, s38, 1
 s_cbranch_scc1 chain_exit
 s_mov_b64 exec, vcc
 buffer_load_dwordx4 v[32:35], v2, s[4:7], s40 offen offset:1024 sc1
 s_mov_b64 exec, -1
 s_waitcnt vmcnt(1)
 v_max3_u32 v196, v36, v37, v38
 v_max_u32 v196, v196, v39
 v_cmp_eq_u32 vcc, -1, v196
 s_cbranch_vccz ps_74
 s_mov_b64 exec, vcc
 buffer_load_dwordx4 v[36:39], v2, s[4:7], s40 offen offset:1536 sc1
 s_mov_b64 exec, -1
ps_74:
 s_waitcnt vmcnt(0)
 s_branch pc_41
pr_44:
 s_sub_u32 s38, s38, 1
 s_cbranch_scc1 chain_exit
 s_mov_b64 exec, vcc
 buffer_load_dwordx4 v[36:39], v2, s[4:7], s40 offen offset:1536 sc1
 s_mov_b64 exec, -1
 s_waitcnt vmcnt(0)
 s_branch pc_43
pr_46:
 s_sub_u32 s38, s38, 1
 s_cbranch_scc1 chain_exit
 buffer_load_dwordx4 v[112:115], v5, s[4:7], s41 offen offset:0 sc1
 buffer_load_dwordx4 v[116:119], v5, s[4:7], s41 offen offset:1024 sc1
 buffer_load_dwordx4 v[120:123], v6, s[4:7], s41 offen offset:0 sc1
 buffer_load_dwordx4 v[124:127], v6, s[4:7], s41 offen offset:1024 sc1
 buffer_load_dwordx4 v[128:131], v6, s[4:7], s41 offen offset:2048 sc1
 buffer_load_dwordx4 v[132:135], v6, s[4:7], s41 offen offset:3072 sc1
 s_branch pw_45
pr_48:
 s_sub_u32 s38, s38, 1
 s_cbranch_scc1 chain_exit
 buffer_load_dwordx4 v[112:115], v5, s[4:7], s41 offen offset:0 sc1
 buffer_load_dwordx4 v[116:119], v5, s[4:7], s41 offen offset:1024 sc1
 buffer_load_dwordx4 v[120:123], v6, s[4:7], s41 offen offset:0 sc1
 buffer_load_dwordx4 v[124:127], v6, s[4:7], s41 offen offset:1024 sc1
 buffer_load_dwordx4 v[128:131], v6, s[4:7], s41 offen offset:2048 sc1
 buffer_load_dwordx4 v[132:135], v6, s[4:7], s41 offen offset:3072 sc1
 s_branch pw_47
fr_50:
 s_sub_u32 s38, s38, 1
 s_cbranch_scc1 chain_exit
 ds_read_b32 v200, v18 offset:20608
 ds_read_b64 v[176:177], v17 offset:0
 ds_read_b64 v[180:181], v17 offset:512
 s_branch fw_49
sl_51:
 buffer_store_dwordx2 v[90:91], v7, s[4:7], s42 offen offset:256 sc1
 s_branch bk_52
sl_53:
 buffer_store_dwordx2 v[88:89], v7, s[4:7], s42 offen sc1
 s_branch bk_54
pr_56:
 s_sub_u32 s38, s38, 1
 s_cbranch_scc1 chain_exit
 s_mov_b64 exec, vcc
 buffer_load_dwordx4 v[204:207], v8, s[4:7], s42 offen offset:0 sc1
 s_mov_b64 exec, -1
 s_waitcnt vmcnt(1)
 v_max3_u32 v196, v208, v209, v210
 v_max_u32 v196, v196, v211
 v_cmp_eq_u32 vcc, -1, v196
 s_cbranch_vccz ps_75
 s_mov_b64 exec, vcc
 buffer_load_dwordx4 v[208:211], v8, s[4:7], s42 offen offset:512 sc1
 s_mov_b64 exec, -1
ps_75:
 v_max3_u32 v196, v212, v213, v214
 v_max_u32 v196, v196, v215
 v_cmp_eq_u32 vcc, -1, v196
 s_cbranch_vccz ps_76
 s_mov_b64 exec, vcc
 buffer_load_dwordx4 v[212:215], v8, s[4:7], s42 offen offset:2048 sc1
 s_mov_b64 exec, -1
ps_76:
 v_max3_u32 v196, v216, v217, v218
 v_max_u32 v196, v196, v219
 v_cmp_eq_u32 vcc, -1, v196
 s_cbranch_vccz ps_77
 s_mov_b64 exec, vcc
 buffer_load_dwordx4 v[216:219], v8, s[4:7], s42 offen offset:2560 sc1
 s_mov_b64 exec, -1
ps_77:
 s_waitcnt vmcnt(0)
 s_branch pc_55
pr_58:
 s_sub_u32 s38, s38, 1
 s_cbranch_scc1 chain_exit
 s_mov_b64 exec, vcc
 buffer_load_dwordx4 v[208:211], v8, s[4:7], s42 offen offset:512 sc1
 s_mov_b64 exec, -1
 s_waitcnt vmcnt(1)
 v_max3_u32 v196, v212, v213, v214
 v_max_u32 v196, v196, v215
 v_cmp_eq_u32 vcc, -1, v196
 s_cbranch_vccz ps_78
 s_mov_b64 exec, vcc
 buffer_load_dwordx4 v[212:215], v8, s[4:7], s42 offen offset:2048 sc1
 s_mov_b64 exec, -1
ps_78:
 v_max3_u32 v196, v216, v217, v218
 v_max_u32 v196, v196, v219
 v_cmp_eq_u32 vcc, -1, v196
 s_cbranch_vccz ps_79
 s_mov_b64 exec, vcc
 buffer_load_dwordx4 v[216:219], v8, s[4:7], s42 offen offset:2560 sc1
 s_mov_b64 exec, -1
ps_79:
 s_waitcnt vmcnt(0)
 s_branch pc_57
pr_60:
 s_sub_u32 s38, s38, 1
 s_cbranch_scc1 chain_exit
 s_mov_b64 exec, vcc
 buffer_load_dwordx4 v[212:215], v8, s[4:7], s42 offen offset:2048 sc1
 s_mov_b64 exec, -1
 s_waitcnt vmcnt(1)
 v_max3_u32 v196, v216, v217, v218
 v_max_u32 v196, v196, v219
 v_cmp_eq_u32 vcc, -1, v196
 s_cbranch_vccz ps_80
 s_mov_b64 exec, vcc
 buffer_load_dwordx4 v[216:219], v8, s[4:7], s42 offen offset:2560 sc1
 s_mov_b64 exec, -1
ps_80:
 s_waitcnt vmcnt(0)
 s_branch pc_59
pr_62:
 s_sub_u32 s38, s38, 1
 s_cbranch_scc1 chain_exit
 s_mov_b64 exec, vcc
 buffer_load_dwordx4 v[216:219], v8, s[4:7], s42 offen offset:2560 sc1
 s_mov_b64 exec, -1
 s_waitcnt vmcnt(0)
 s_branch pc_61
sl_63:
 buffer_store_dwordx2 v[184:185], v7, s[4:7], s78 offen offset:0 sc1
 buffer_store_dwordx2 v[184:185], v7, s[4:7], s78 offen offset:256 sc1
 s_branch bk_64
sl_65:
 buffer_store_dwordx2 v[184:185], v3, s[4:7], s76 offen sc1
 s_branch bk_66
chain_loop_fast_1:
 buffer_load_dwordx4 v[24:27], v2, s[4:7], s40 offen offset:0 sc1
 buffer_load_dwordx4 v[28:31], v2, s[4:7], s40 offen offset:512 sc1
 buffer_load_dwordx4 v[32:35], v2, s[4:7], s40 offen offset:1024 sc1
 buffer_load_dwordx4 v[36:39], v2, s[4:7], s40 offen offset:1536 sc1
 s_waitcnt vmcnt(3)
pc_81:
 v_max3_u32 v196, v24, v25, v26
 v_max_u32 v197, v196, v27
 v_cmp_eq_u32 vcc, -1, v197
 s_cbranch_vccnz pr_82
 v_mfma_f32_16x16x32_bf16 v[40:43], a[0:3], v[24:27], 0
 v_mfma_f32_16x16x32_bf16 v[44:47], a[16:19], v[24:27], 0
 v_mfma_f32_16x16x32_bf16 v[48:51], a[64:67], v[24:27], 0
 v_mfma_f32_16x16x32_bf16 v[52:55], a[80:83], v[24:27], 0
 v_mfma_f32_16x16x32_bf16 v[56:59], a[32:35], v[24:27], 0
 v_mfma_f32_16x16x32_bf16 v[60:63], a[48:51], v[24:27], 0
 v_mfma_f32_16x16x32_bf16 v[64:67], a[96:99], v[24:27], 0
 v_mfma_f32_16x16x32_bf16 v[68:71], a[112:115], v[24:27], 0
 s_waitcnt vmcnt(2)
pc_83:
 v_max3_u32 v196, v28, v29, v30
 v_max_u32 v197, v196, v31
 v_cmp_eq_u32 vcc, -1, v197
 s_cbranch_vccnz pr_84
 v_mfma_f32_16x16x32_bf16 v[40:43], a[4:7], v[28:31], v[40:43]
 v_mfma_f32_16x16x32_bf16 v[44:47], a[20:23], v[28:31], v[44:47]
 v_mfma_f32_16x16x32_bf16 v[48:51], a[68:71], v[28:31], v[48:51]
 v_mfma_f32_16x16x32_bf16 v[52:55], a[84:87], v[28:31], v[52:55]
 v_mfma_f32_16x16x32_bf16 v[56:59], a[36:39], v[28:31], v[56:59]
 v_mfma_f32_16x16x32_bf16 v[60:63], a[52:55], v[28:31], v[60:63]
 v_mfma_f32_16x16x32_bf16 v[64:67], a[100:103], v[28:31], v[64:67]
 v_mfma_f32_16x16x32_bf16 v[68:71], a[116:119], v[28:31], v[68:71]
 s_waitcnt vmcnt(1)
pc_85:
 v_max3_u32 v196, v32, v33, v34
 v_max_u32 v197, v196, v35
 v_cmp_eq_u32 vcc, -1, v197
 s_cbranch_vccnz pr_86
 v_mfma_f32_16x16x32_bf16 v[40:43], a[8:11], v[32:35], v[40:43]
 v_mfma_f32_16x16x32_bf16 v[44:47], a[24:27], v[32:35], v[44:47]
 v_mfma_f32_16x16x32_bf16 v[48:51], a[72:75], v[32:35], v[48:51]
 v_mfma_f32_16x16x32_bf16 v[52:55], a[88:91], v[32:35], v[52:55]
 v_mfma_f32_16x16x32_bf16 v[56:59], a[40:43], v[32:35], v[56:59]
 v_mfma_f32_16x16x32_bf16 v[60:63], a[56:59], v[32:35], v[60:63]
 v_mfma_f32_16x16x32_bf16 v[64:67], a[104:107], v[32:35], v[64:67]
 v_mfma_f32_16x16x32_bf16 v[68:71], a[120:123], v[32:35], v[68:71]
 s_waitcnt vmcnt(0)
pc_87:
 v_max3_u32 v196, v36, v37, v38
 v_max_u32 v197, v196, v39
 v_cmp_eq_u32 vcc, -1, v197
 s_cbranch_vccnz pr_88
 v_mfma_f32_16x16x32_bf16 v[40:43], a[12:15], v[36:39], v[40:43]
 v_mfma_f32_16x16x32_bf16 v[44:47], a[28:31], v[36:39], v[44:47]
 v_mfma_f32_16x16x32_bf16 v[48:51], a[76:79], v[36:39], v[48:51]
 v_mfma_f32_16x16x32_bf16 v[52:55], a[92:95], v[36:39], v[52:55]
 v_mfma_f32_16x16x32_bf16 v[56:59], a[44:47], v[36:39], v[56:59]
 v_mfma_f32_16x16x32_bf16 v[60:63], a[60:63], v[36:39], v[60:63]
 v_mfma_f32_16x16x32_bf16 v[64:67], a[108:111], v[36:39], v[64:67]
 v_mfma_f32_16x16x32_bf16 v[68:71], a[124:127], v[36:39], v[68:71]
 s_nop 1
 v_add_f32_dpp v72, v44, v40 row_ror:8 row_mask:0xf bank_mask:0x3
 v_add_f32_dpp v73, v45, v41 row_ror:8 row_mask:0xf bank_mask:0x3
 v_add_f32_dpp v74, v46, v42 row_ror:8 row_mask:0xf bank_mask:0x3
 v_add_f32_dpp v75, v47, v43 row_ror:8 row_mask:0xf bank_mask:0x3
 v_add_f32_dpp v72, v48, v52 row_ror:8 row_mask:0xf bank_mask:0xc
 v_add_f32_dpp v73, v49, v53 row_ror:8 row_mask:0xf bank_mask:0xc
 v_add_f32_dpp v74, v50, v54 row_ror:8 row_mask:0xf bank_mask:0xc
 v_add_f32_dpp v75, v51, v55 row_ror:8 row_mask:0xf bank_mask:0xc
 v_add_f32_dpp v76, v60, v56 row_ror:8 row_mask:0xf bank_mask:0x3
 v_add_f32_dpp v77, v61, v57 row_ror:8 row_mask:0xf bank_mask:0x3
 v_add_f32_dpp v78, v62, v58 row_ror:8 row_mask:0xf bank_mask:0x3
 v_add_f32_dpp v79, v63, v59 row_ror:8 row_mask:0xf bank_mask:0x3
 v_add_f32_dpp v76, v64, v68 row_ror:8 row_mask:0xf bank_mask:0xc
 v_add_f32_dpp v77, v65, v69 row_ror:8 row_mask:0xf bank_mask:0xc
 v_add_f32_dpp v78, v66, v70 row_ror:8 row_mask:0xf bank_mask:0xc
 v_add_f32_dpp v79, v67, v71 row_ror:8 row_mask:0xf bank_mask:0xc
 ds_write_b128 v14, v[76:79] offset:4096
 s_waitcnt lgkmcnt(0)
 s_barrier
 ds_read_b128 v[80:83], v20 offset:0
 ds_read_b128 v[84:87], v20 offset:2048
 ds_read_b128 v[88:91], v20 offset:3072
 s_waitcnt lgkmcnt(2)
 v_pk_add_f32 v[72:73], v[72:73], v[80:81]
 v_pk_add_f32 v[74:75], v[74:75], v[82:83]
 s_waitcnt lgkmcnt(0)
 v_pk_add_f32 v[84:85], v[84:85], v[88:89]
 v_pk_add_f32 v[86:87], v[86:87], v[90:91]
 v_pk_add_f32 v[72:73], v[72:73], v[84:85]
 v_pk_add_f32 v[74:75], v[74:75], v[86:87]
 v_cvt_pk_bf16_f32 v80, v72, v73
 v_cvt_pk_bf16_f32 v81, v74, v75
 v_min_u32 v80, -2, v80
 v_min_u32 v81, -2, v81

 buffer_store_dwordx2 v[80:81], v4, s[4:7], s41 offen offset:0
 buffer_store_dwordx2 v[184:185], v4, s[4:7], s77 offen offset:0
 s_cmp_lg_u32 s83, 0
 s_cbranch_scc1 sl_89
bk_90:
 s_mov_b64 exec, s[80:81]
 buffer_store_dwordx2 v[80:81], v16, s[4:7], s74 offen offset:0 sc1
 s_mov_b64 exec, -1

 v_mfma_f32_16x16x32_bf16 v[40:43], v[24:27], a[128:131], 0
 v_mfma_f32_16x16x32_bf16 v[44:47], v[24:27], a[144:147], 0
 v_mfma_f32_16x16x32_bf16 v[48:51], v[24:27], a[160:163], 0
 v_mfma_f32_16x16x32_bf16 v[52:55], v[24:27], a[176:179], 0
 v_mfma_f32_16x16x32_bf16 v[40:43], v[28:31], a[132:135], v[40:43]
 v_mfma_f32_16x16x32_bf16 v[44:47], v[28:31], a[148:151], v[44:47]
 v_mfma_f32_16x16x32_bf16 v[48:51], v[28:31], a[164:167], v[48:51]
 v_mfma_f32_16x16x32_bf16 v[52:55], v[28:31], a[180:183], v[52:55]
 v_mfma_f32_16x16x32_bf16 v[40:43], v[32:35], a[136:139], v[40:43]
 v_mfma_f32_16x16x32_bf16 v[44:47], v[32:35], a[152:155], v[44:47]
 v_mfma_f32_16x16x32_bf16 v[48:51], v[32:35], a[168:171], v[48:51]
 v_mfma_f32_16x16x32_bf16 v[52:55], v[32:35], a[184:187], v[52:55]
 v_mfma_f32_16x16x32_bf16 v[40:43], v[36:39], a[140:143], v[40:43]
 v_mfma_f32_16x16x32_bf16 v[44:47], v[36:39], a[156:159], v[44:47]
 v_mfma_f32_16x16x32_bf16 v[48:51], v[36:39], a[172:175], v[48:51]
 v_mfma_f32_16x16x32_bf16 v[52:55], v[36:39], a[188:191], v[52:55]
 s_nop 7
 v_cndmask_b32 v72, v40, v44, s[52:53]
 v_cndmask_b32 v73, v41, v45, s[52:53]
 v_cndmask_b32 v74, v42, v46, s[52:53]
 v_cndmask_b32 v75, v43, v47, s[52:53]
 ds_write_b128 v14, v[72:75] offset:8192
 v_cndmask_b32 v76, v48, v52, s[52:53]
 v_cndmask_b32 v77, v49, v53, s[52:53]
 v_cndmask_b32 v78, v50, v54, s[52:53]
 v_cndmask_b32 v79, v51, v55, s[52:53]
 ds_write_b128 v14, v[76:79] offset:12288
 s_waitcnt lgkmcnt(0)
 s_mov_b64 exec, 1
 ds_add_u32 v18, v19 offset:20544
 s_mov_b64 exec, -1

 s_cmp_eq_u32 s37, 63
 s_cbranch_scc1 mega_join
 s_add_u32 s48, s37, 1
 s_and_b32 s48, s48, 3
 s_mul_i32 s48, s48, 131072
 s_add_u32 s84, s48, 100663296
 s_add_u32 s48, s37, 2
 s_and_b32 s48, s48, 3
 s_mul_i32 s48, s48, 131072
 s_add_u32 s85, s48, 100663296
 s_add_u32 s48, s37, 4
 s_and_b32 s48, s48, 3
 s_mul_i32 s48, s48, 131072
 s_add_u32 s86, s48, 100663296
 s_add_u32 s48, s37, 1
 s_and_b32 s48, s48, 3
 s_mul_i32 s48, s48, 131072
 s_add_u32 s87, s48, 113246208
 s_add_u32 s48, s37, 3
 s_and_b32 s48, s48, 3
 s_mul_i32 s48, s48, 131072
 s_add_u32 s88, s48, 113246208
 s_add_u32 s48, s37, 1
 s_and_b32 s48, s48, 3
 s_mul_i32 s48, s48, 65536
 s_add_u32 s89, s48, 132120576
 s_add_u32 s48, s37, 3
 s_and_b32 s48, s48, 3
 s_mul_i32 s48, s48, 65536
 s_add_u32 s90, s48, 132120576
 s_barrier
 buffer_load_dwordx4 v[204:207], v8, s[4:7], s42 offen offset:0 sc1
 buffer_load_dwordx4 v[208:211], v8, s[4:7], s42 offen offset:512 sc1
 buffer_load_dwordx4 v[212:215], v8, s[4:7], s42 offen offset:2048 sc1
 buffer_load_dwordx4 v[216:219], v8, s[4:7], s42 offen offset:2560 sc1
 s_waitcnt vmcnt(3)
pc_91:
 v_max3_u32 v196, v204, v205, v206
 v_max_u32 v197, v196, v207
 v_cmp_eq_u32 vcc, -1, v197
 s_cbranch_vccnz pr_92
 v_mfma_f32_16x16x32_bf16 v[40:43], a[192:195], v[204:207], 0
 v_mfma_f32_16x16x32_bf16 v[48:51], a[208:211], v[204:207], 0
 v_mfma_f32_16x16x32_bf16 v[44:47], a[196:199], v[204:207], 0
 v_mfma_f32_16x16x32_bf16 v[52:55], a[212:215], v[204:207], 0
 s_waitcnt vmcnt(2)
pc_93:
 v_max3_u32 v196, v208, v209, v210
 v_max_u32 v197, v196, v211
 v_cmp_eq_u32 vcc, -1, v197
 s_cbranch_vccnz pr_94
 v_mfma_f32_16x16x32_bf16 v[40:43], a[200:203], v[208:211], v[40:43]
 v_mfma_f32_16x16x32_bf16 v[48:51], a[216:219], v[208:211], v[48:51]
 v_mfma_f32_16x16x32_bf16 v[44:47], a[204:207], v[208:211], v[44:47]
 v_mfma_f32_16x16x32_bf16 v[52:55], a[220:223], v[208:211], v[52:55]
 s_waitcnt vmcnt(1)
pc_95:
 v_max3_u32 v196, v212, v213, v214
 v_max_u32 v197, v196, v215
 v_cmp_eq_u32 vcc, -1, v197
 s_cbranch_vccnz pr_96
 v_mfma_f32_16x16x32_bf16 v[40:43], a[224:227], v[212:215], v[40:43]
 v_mfma_f32_16x16x32_bf16 v[48:51], a[240:243], v[212:215], v[48:51]
 v_mfma_f32_16x16x32_bf16 v[44:47], a[228:231], v[212:215], v[44:47]
 v_mfma_f32_16x16x32_bf16 v[52:55], a[244:247], v[212:215], v[52:55]
 s_waitcnt vmcnt(0)
pc_97:
 v_max3_u32 v196, v216, v217, v218
 v_max_u32 v197, v196, v219
 v_cmp_eq_u32 vcc, -1, v197
 s_cbranch_vccnz pr_98
 v_mfma_f32_16x16x32_bf16 v[40:43], a[232:235], v[216:219], v[40:43]
 v_mfma_f32_16x16x32_bf16 v[48:51], a[248:251], v[216:219], v[48:51]
 v_mfma_f32_16x16x32_bf16 v[44:47], a[236:239], v[216:219], v[44:47]
 v_mfma_f32_16x16x32_bf16 v[52:55], a[252:255], v[216:219], v[52:55]
 s_nop 5
 v_add_f32_dpp v72, v48, v40 row_ror:8 row_mask:0xf bank_mask:0x3
 v_add_f32_dpp v73, v49, v41 row_ror:8 row_mask:0xf bank_mask:0x3
 v_add_f32_dpp v74, v50, v42 row_ror:8 row_mask:0xf bank_mask:0x3
 v_add_f32_dpp v75, v51, v43 row_ror:8 row_mask:0xf bank_mask:0x3
 v_add_f32_dpp v72, v44, v52 row_ror:8 row_mask:0xf bank_mask:0xc
 v_add_f32_dpp v73, v45, v53 row_ror:8 row_mask:0xf bank_mask:0xc
 v_add_f32_dpp v74, v46, v54 row_ror:8 row_mask:0xf bank_mask:0xc
 v_add_f32_dpp v75, v47, v55 row_ror:8 row_mask:0xf bank_mask:0xc
 s_barrier
 ds_read_b128 v[80:83], v20 offset:16384
 ds_read_b128 v[84:87], v20 offset:18432
 ds_read_b128 v[88:91], v20 offset:19456
 s_waitcnt lgkmcnt(2)
 v_pk_add_f32 v[72:73], v[72:73], v[80:81]
 v_pk_add_f32 v[74:75], v[74:75], v[82:83]
 s_waitcnt lgkmcnt(0)
 v_pk_add_f32 v[84:85], v[84:85], v[88:89]
 v_pk_add_f32 v[86:87], v[86:87], v[90:91]
 v_pk_add_f32 v[72:73], v[72:73], v[84:85]
 v_pk_add_f32 v[74:75], v[74:75], v[86:87]
 v_min_u32 v72, -2, v72
 v_min_u32 v73, -2, v73
 v_min_u32 v74, -2, v74
 v_min_u32 v75, -2, v75
 buffer_store_dwordx4 v[72:75], v9, s[4:7], s43 offen sc1
 s_add_u32 s48, s33, 1
 s_and_b32 s48, s48, 3
 s_lshl_b32 s48, s48, 15
 s_add_u32 s59, s43, s48
 s_add_u32 s48, s33, 2
 s_and_b32 s48, s48, 3
 s_lshl_b32 s48, s48, 15
 s_add_u32 s60, s43, s48
 s_add_u32 s48, s33, 3
 s_and_b32 s48, s48, 3
 s_lshl_b32 s48, s48, 15
 s_add_u32 s61, s43, s48
 s_add_u32 s44, s44, 65536
 s_add_u32 s74, s74, 65536
 s_add_u32 s79, s79, 4
 s_add_u32 s43, s43, 524288

 s_mov_b32 s40, s84
 s_mov_b32 s76, s86
 s_mov_b32 s41, s87
 s_mov_b32 s77, s88
 s_mov_b32 s42, s89
 s_mov_b32 s78, s90
 s_sleep 8
 buffer_load_dwordx4 v[80:83], v10, s[4:7], s59 offen sc1
 buffer_load_dwordx4 v[84:87], v10, s[4:7], s60 offen sc1
 buffer_load_dwordx4 v[88:91], v10, s[4:7], s61 offen sc1
rwl_101:
 s_waitcnt vmcnt(0)
 v_max3_u32 v196, v80, v81, v82
 v_max3_u32 v197, v83, v84, v85
 v_max3_u32 v198, v86, v87, v88
 v_max3_u32 v199, v196, v197, v198
 v_max3_u32 v200, v89, v90, v91
 v_max_u32 v201, v199, v200
 v_cmp_eq_u32 vcc, -1, v201
 s_cbranch_vccnz rnx_100
 v_pk_add_f32 v[40:41], v[72:73], v[80:81]
 v_pk_add_f32 v[42:43], v[74:75], v[82:83]
 v_pk_add_f32 v[44:45], v[84:85], v[88:89]
 v_pk_add_f32 v[46:47], v[86:87], v[90:91]
 v_pk_add_f32 v[72:73], v[40:41], v[44:45]
 v_pk_add_f32 v[74:75], v[42:43], v[46:47]
rfin_99:
 v_cvt_pk_bf16_f32 v76, v72, v73
 v_cvt_pk_bf16_f32 v77, v74, v75
 v_min_u32 v76, -2, v76
 v_min_u32 v77, -2, v77

 buffer_store_dwordx2 v[76:77], v3, s[4:7], s75 offen
 s_cmp_lg_u32 s83, 0
 s_cbranch_scc1 sl_102
bk_103:
 s_mov_b32 s75, s85
 s_add_u32 s37, s37, 1
 s_barrier
 s_branch chain_loop_fast_1
pr_82:
 s_sub_u32 s38, s38, 1
 s_cbranch_scc1 chain_exit
 s_mov_b64 exec, vcc
 buffer_load_dwordx4 v[24:27], v2, s[4:7], s40 offen offset:0 sc1
 s_mov_b64 exec, -1
 s_waitcnt vmcnt(1)
 v_max3_u32 v196, v28, v29, v30
 v_max_u32 v196, v196, v31
 v_cmp_eq_u32 vcc, -1, v196
 s_cbranch_vccz ps_104
 s_mov_b64 exec, vcc
 buffer_load_dwordx4 v[28:31], v2, s[4:7], s40 offen offset:512 sc1
 s_mov_b64 exec, -1
ps_104:
 v_max3_u32 v196, v32, v33, v34
 v_max_u32 v196, v196, v35
 v_cmp_eq_u32 vcc, -1, v196
 s_cbranch_vccz ps_105
 s_mov_b64 exec, vcc
 buffer_load_dwordx4 v[32:35], v2, s[4:7], s40 offen offset:1024 sc1
 s_mov_b64 exec, -1
ps_105:
 v_max3_u32 v196, v36, v37, v38
 v_max_u32 v196, v196, v39
 v_cmp_eq_u32 vcc, -1, v196
 s_cbranch_vccz ps_106
 s_mov_b64 exec, vcc
 buffer_load_dwordx4 v[36:39], v2, s[4:7], s40 offen offset:1536 sc1
 s_mov_b64 exec, -1
ps_106:
 s_waitcnt vmcnt(0)
 s_branch pc_81
pr_84:
 s_sub_u32 s38, s38, 1
 s_cbranch_scc1 chain_exit
 s_mov_b64 exec, vcc
 buffer_load_dwordx4 v[28:31], v2, s[4:7], s40 offen offset:512 sc1
 s_mov_b64 exec, -1
 s_waitcnt vmcnt(1)
 v_max3_u32 v196, v32, v33, v34
 v_max_u32 v196, v196, v35
 v_cmp_eq_u32 vcc, -1, v196
 s_cbranch_vccz ps_107
 s_mov_b64 exec, vcc
 buffer_load_dwordx4 v[32:35], v2, s[4:7], s40 offen offset:1024 sc1
 s_mov_b64 exec, -1
ps_107:
 v_max3_u32 v196, v36, v37, v38
 v_max_u32 v196, v196, v39
 v_cmp_eq_u32 vcc, -1, v196
 s_cbranch_vccz ps_108
 s_mov_b64 exec, vcc
 buffer_load_dwordx4 v[36:39], v2, s[4:7], s40 offen offset:1536 sc1
 s_mov_b64 exec, -1
ps_108:
 s_waitcnt vmcnt(0)
 s_branch pc_83
pr_86:
 s_sub_u32 s38, s38, 1
 s_cbranch_scc1 chain_exit
 s_mov_b64 exec, vcc
 buffer_load_dwordx4 v[32:35], v2, s[4:7], s40 offen offset:1024 sc1
 s_mov_b64 exec, -1
 s_waitcnt vmcnt(1)
 v_max3_u32 v196, v36, v37, v38
 v_max_u32 v196, v196, v39
 v_cmp_eq_u32 vcc, -1, v196
 s_cbranch_vccz ps_109
 s_mov_b64 exec, vcc
 buffer_load_dwordx4 v[36:39], v2, s[4:7], s40 offen offset:1536 sc1
 s_mov_b64 exec, -1
ps_109:
 s_waitcnt vmcnt(0)
 s_branch pc_85
pr_88:
 s_sub_u32 s38, s38, 1
 s_cbranch_scc1 chain_exit
 s_mov_b64 exec, vcc
 buffer_load_dwordx4 v[36:39], v2, s[4:7], s40 offen offset:1536 sc1
 s_mov_b64 exec, -1
 s_waitcnt vmcnt(0)
 s_branch pc_87
sl_89:
 buffer_store_dwordx2 v[80:81], v4, s[4:7], s41 offen offset:0 sc1
 buffer_store_dwordx2 v[184:185], v4, s[4:7], s77 offen offset:0 sc1
 s_branch bk_90
pr_92:
 s_sub_u32 s38, s38, 1
 s_cbranch_scc1 chain_exit
 s_mov_b64 exec, vcc
 buffer_load_dwordx4 v[204:207], v8, s[4:7], s42 offen offset:0 sc1
 s_mov_b64 exec, -1
 s_waitcnt vmcnt(1)
 v_max3_u32 v196, v208, v209, v210
 v_max_u32 v196, v196, v211
 v_cmp_eq_u32 vcc, -1, v196
 s_cbranch_vccz ps_110
 s_mov_b64 exec, vcc
 buffer_load_dwordx4 v[208:211], v8, s[4:7], s42 offen offset:512 sc1
 s_mov_b64 exec, -1
ps_110:
 v_max3_u32 v196, v212, v213, v214
 v_max_u32 v196, v196, v215
 v_cmp_eq_u32 vcc, -1, v196
 s_cbranch_vccz ps_111
 s_mov_b64 exec, vcc
 buffer_load_dwordx4 v[212:215], v8, s[4:7], s42 offen offset:2048 sc1
 s_mov_b64 exec, -1
ps_111:
 v_max3_u32 v196, v216, v217, v218
 v_max_u32 v196, v196, v219
 v_cmp_eq_u32 vcc, -1, v196
 s_cbranch_vccz ps_112
 s_mov_b64 exec, vcc
 buffer_load_dwordx4 v[216:219], v8, s[4:7], s42 offen offset:2560 sc1
 s_mov_b64 exec, -1
ps_112:
 s_waitcnt vmcnt(0)
 s_branch pc_91
pr_94:
 s_sub_u32 s38, s38, 1
 s_cbranch_scc1 chain_exit
 s_mov_b64 exec, vcc
 buffer_load_dwordx4 v[208:211], v8, s[4:7], s42 offen offset:512 sc1
 s_mov_b64 exec, -1
 s_waitcnt vmcnt(1)
 v_max3_u32 v196, v212, v213, v214
 v_max_u32 v196, v196, v215
 v_cmp_eq_u32 vcc, -1, v196
 s_cbranch_vccz ps_113
 s_mov_b64 exec, vcc
 buffer_load_dwordx4 v[212:215], v8, s[4:7], s42 offen offset:2048 sc1
 s_mov_b64 exec, -1
ps_113:
 v_max3_u32 v196, v216, v217, v218
 v_max_u32 v196, v196, v219
 v_cmp_eq_u32 vcc, -1, v196
 s_cbranch_vccz ps_114
 s_mov_b64 exec, vcc
 buffer_load_dwordx4 v[216:219], v8, s[4:7], s42 offen offset:2560 sc1
 s_mov_b64 exec, -1
ps_114:
 s_waitcnt vmcnt(0)
 s_branch pc_93
pr_96:
 s_sub_u32 s38, s38, 1
 s_cbranch_scc1 chain_exit
 s_mov_b64 exec, vcc
 buffer_load_dwordx4 v[212:215], v8, s[4:7], s42 offen offset:2048 sc1
 s_mov_b64 exec, -1
 s_waitcnt vmcnt(1)
 v_max3_u32 v196, v216, v217, v218
 v_max_u32 v196, v196, v219
 v_cmp_eq_u32 vcc, -1, v196
 s_cbranch_vccz ps_115
 s_mov_b64 exec, vcc
 buffer_load_dwordx4 v[216:219], v8, s[4:7], s42 offen offset:2560 sc1
 s_mov_b64 exec, -1
ps_115:
 s_waitcnt vmcnt(0)
 s_branch pc_95
pr_98:
 s_sub_u32 s38, s38, 1
 s_cbranch_scc1 chain_exit
 s_mov_b64 exec, vcc
 buffer_load_dwordx4 v[216:219], v8, s[4:7], s42 offen offset:2560 sc1
 s_mov_b64 exec, -1
 s_waitcnt vmcnt(0)
 s_branch pc_97
rnx_100:
 s_sub_u32 s38, s38, 1
 s_cbranch_scc1 chain_exit
 buffer_load_dwordx4 v[80:83], v10, s[4:7], s59 offen sc1
 buffer_load_dwordx4 v[84:87], v10, s[4:7], s60 offen sc1
 buffer_load_dwordx4 v[88:91], v10, s[4:7], s61 offen sc1
 s_branch rwl_101
sl_102:
 buffer_store_dwordx2 v[76:77], v3, s[4:7], s75 offen sc1
 s_branch bk_103
chain_loop_fast_2:
 buffer_load_dwordx4 v[24:27], v2, s[4:7], s40 offen offset:0 sc1
 buffer_load_dwordx4 v[28:31], v2, s[4:7], s40 offen offset:512 sc1
 buffer_load_dwordx4 v[32:35], v2, s[4:7], s40 offen offset:1024 sc1
 buffer_load_dwordx4 v[36:39], v2, s[4:7], s40 offen offset:1536 sc1
 s_waitcnt vmcnt(3)
pc_116:
 v_max3_u32 v196, v24, v25, v26
 v_max_u32 v197, v196, v27
 v_cmp_eq_u32 vcc, -1, v197
 s_cbranch_vccnz pr_117
 v_mfma_f32_16x16x32_bf16 v[40:43], a[0:3], v[24:27], 0
 v_mfma_f32_16x16x32_bf16 v[44:47], a[16:19], v[24:27], 0
 v_mfma_f32_16x16x32_bf16 v[48:51], a[64:67], v[24:27], 0
 v_mfma_f32_16x16x32_bf16 v[52:55], a[80:83], v[24:27], 0
 v_mfma_f32_16x16x32_bf16 v[56:59], a[32:35], v[24:27], 0
 v_mfma_f32_16x16x32_bf16 v[60:63], a[48:51], v[24:27], 0
 v_mfma_f32_16x16x32_bf16 v[64:67], a[96:99], v[24:27], 0
 v_mfma_f32_16x16x32_bf16 v[68:71], a[112:115], v[24:27], 0
 s_waitcnt vmcnt(2)
pc_118:
 v_max3_u32 v196, v28, v29, v30
 v_max_u32 v197, v196, v31
 v_cmp_eq_u32 vcc, -1, v197
 s_cbranch_vccnz pr_119
 v_mfma_f32_16x16x32_bf16 v[40:43], a[4:7], v[28:31], v[40:43]
 v_mfma_f32_16x16x32_bf16 v[44:47], a[20:23], v[28:31], v[44:47]
 v_mfma_f32_16x16x32_bf16 v[48:51], a[68:71], v[28:31], v[48:51]
 v_mfma_f32_16x16x32_bf16 v[52:55], a[84:87], v[28:31], v[52:55]
 v_mfma_f32_16x16x32_bf16 v[56:59], a[36:39], v[28:31], v[56:59]
 v_mfma_f32_16x16x32_bf16 v[60:63], a[52:55], v[28:31], v[60:63]
 v_mfma_f32_16x16x32_bf16 v[64:67], a[100:103], v[28:31], v[64:67]
 v_mfma_f32_16x16x32_bf16 v[68:71], a[116:119], v[28:31], v[68:71]
 s_waitcnt vmcnt(1)
pc_120:
 v_max3_u32 v196, v32, v33, v34
 v_max_u32 v197, v196, v35
 v_cmp_eq_u32 vcc, -1, v197
 s_cbranch_vccnz pr_121
 v_mfma_f32_16x16x32_bf16 v[40:43], a[8:11], v[32:35], v[40:43]
 v_mfma_f32_16x16x32_bf16 v[44:47], a[24:27], v[32:35], v[44:47]
 v_mfma_f32_16x16x32_bf16 v[48:51], a[72:75], v[32:35], v[48:51]
 v_mfma_f32_16x16x32_bf16 v[52:55], a[88:91], v[32:35], v[52:55]
 v_mfma_f32_16x16x32_bf16 v[56:59], a[40:43], v[32:35], v[56:59]
 v_mfma_f32_16x16x32_bf16 v[60:63], a[56:59], v[32:35], v[60:63]
 v_mfma_f32_16x16x32_bf16 v[64:67], a[104:107], v[32:35], v[64:67]
 v_mfma_f32_16x16x32_bf16 v[68:71], a[120:123], v[32:35], v[68:71]
 s_waitcnt vmcnt(0)
pc_122:
 v_max3_u32 v196, v36, v37, v38
 v_max_u32 v197, v196, v39
 v_cmp_eq_u32 vcc, -1, v197
 s_cbranch_vccnz pr_123
 v_mfma_f32_16x16x32_bf16 v[40:43], a[12:15], v[36:39], v[40:43]
 v_mfma_f32_16x16x32_bf16 v[44:47], a[28:31], v[36:39], v[44:47]
 v_mfma_f32_16x16x32_bf16 v[48:51], a[76:79], v[36:39], v[48:51]
 v_mfma_f32_16x16x32_bf16 v[52:55], a[92:95], v[36:39], v[52:55]
 v_mfma_f32_16x16x32_bf16 v[56:59], a[44:47], v[36:39], v[56:59]
 v_mfma_f32_16x16x32_bf16 v[60:63], a[60:63], v[36:39], v[60:63]
 v_mfma_f32_16x16x32_bf16 v[64:67], a[108:111], v[36:39], v[64:67]
 v_mfma_f32_16x16x32_bf16 v[68:71], a[124:127], v[36:39], v[68:71]
 s_nop 1
 v_add_f32_dpp v72, v44, v40 row_ror:8 row_mask:0xf bank_mask:0x3
 v_add_f32_dpp v73, v45, v41 row_ror:8 row_mask:0xf bank_mask:0x3
 v_add_f32_dpp v74, v46, v42 row_ror:8 row_mask:0xf bank_mask:0x3
 v_add_f32_dpp v75, v47, v43 row_ror:8 row_mask:0xf bank_mask:0x3
 v_add_f32_dpp v72, v48, v52 row_ror:8 row_mask:0xf bank_mask:0xc
 v_add_f32_dpp v73, v49, v53 row_ror:8 row_mask:0xf bank_mask:0xc
 v_add_f32_dpp v74, v50, v54 row_ror:8 row_mask:0xf bank_mask:0xc
 v_add_f32_dpp v75, v51, v55 row_ror:8 row_mask:0xf bank_mask:0xc
 ds_write_b128 v14, v[72:75] offset:0
 v_add_f32_dpp v76, v60, v56 row_ror:8 row_mask:0xf bank_mask:0x3
 v_add_f32_dpp v77, v61, v57 row_ror:8 row_mask:0xf bank_mask:0x3
 v_add_f32_dpp v78, v62, v58 row_ror:8 row_mask:0xf bank_mask:0x3
 v_add_f32_dpp v79, v63, v59 row_ror:8 row_mask:0xf bank_mask:0x3
 v_add_f32_dpp v76, v64, v68 row_ror:8 row_mask:0xf bank_mask:0xc
 v_add_f32_dpp v77, v65, v69 row_ror:8 row_mask:0xf bank_mask:0xc
 v_add_f32_dpp v78, v66, v70 row_ror:8 row_mask:0xf bank_mask:0xc
 v_add_f32_dpp v79, v67, v71 row_ror:8 row_mask:0xf bank_mask:0xc
 s_waitcnt lgkmcnt(0)
 s_barrier
 ds_read_b128 v[80:83], v20 offset:4096
 ds_read_b128 v[84:87], v20 offset:5120
 ds_read_b128 v[88:91], v20 offset:7168
 s_waitcnt lgkmcnt(2)
 v_pk_add_f32 v[76:77], v[76:77], v[80:81]
 v_pk_add_f32 v[78:79], v[78:79], v[82:83]
 s_waitcnt lgkmcnt(0)
 v_pk_add_f32 v[84:85], v[84:85], v[88:89]
 v_pk_add_f32 v[86:87], v[86:87], v[90:91]
 v_pk_add_f32 v[76:77], v[76:77], v[84:85]
 v_pk_add_f32 v[78:79], v[78:79], v[86:87]
 v_cvt_pk_bf16_f32 v80, v76, v77
 v_cvt_pk_bf16_f32 v81, v78, v79
 v_min_u32 v80, -2, v80
 v_min_u32 v81, -2, v81

 buffer_store_dwordx2 v[80:81], v4, s[4:7], s41 offen offset:512
 buffer_store_dwordx2 v[184:185], v4, s[4:7], s77 offen offset:512
 s_cmp_lg_u32 s83, 0
 s_cbranch_scc1 sl_124
bk_125:
 s_mov_b64 exec, s[80:81]
 buffer_store_dwordx2 v[80:81], v16, s[4:7], s74 offen offset:256 sc1
 s_mov_b64 exec, -1

 v_mfma_f32_16x16x32_bf16 v[40:43], v[24:27], a[128:131], 0
 v_mfma_f32_16x16x32_bf16 v[44:47], v[24:27], a[144:147], 0
 v_mfma_f32_16x16x32_bf16 v[48:51], v[24:27], a[160:163], 0
 v_mfma_f32_16x16x32_bf16 v[52:55], v[24:27], a[176:179], 0
 v_mfma_f32_16x16x32_bf16 v[40:43], v[28:31], a[132:135], v[40:43]
 v_mfma_f32_16x16x32_bf16 v[44:47], v[28:31], a[148:151], v[44:47]
 v_mfma_f32_16x16x32_bf16 v[48:51], v[28:31], a[164:167], v[48:51]
 v_mfma_f32_16x16x32_bf16 v[52:55], v[28:31], a[180:183], v[52:55]
 v_mfma_f32_16x16x32_bf16 v[40:43], v[32:35], a[136:139], v[40:43]
 v_mfma_f32_16x16x32_bf16 v[44:47], v[32:35], a[152:155], v[44:47]
 v_mfma_f32_16x16x32_bf16 v[48:51], v[32:35], a[168:171], v[48:51]
 v_mfma_f32_16x16x32_bf16 v[52:55], v[32:35], a[184:187], v[52:55]
 v_mfma_f32_16x16x32_bf16 v[40:43], v[36:39], a[140:143], v[40:43]
 v_mfma_f32_16x16x32_bf16 v[44:47], v[36:39], a[156:159], v[44:47]
 v_mfma_f32_16x16x32_bf16 v[48:51], v[36:39], a[172:175], v[48:51]
 v_mfma_f32_16x16x32_bf16 v[52:55], v[36:39], a[188:191], v[52:55]
 s_nop 7
 v_cndmask_b32 v72, v40, v44, s[52:53]
 v_cndmask_b32 v73, v41, v45, s[52:53]
 v_cndmask_b32 v74, v42, v46, s[52:53]
 v_cndmask_b32 v75, v43, v47, s[52:53]
 ds_write_b128 v14, v[72:75] offset:8192
 v_cndmask_b32 v76, v48, v52, s[52:53]
 v_cndmask_b32 v77, v49, v53, s[52:53]
 v_cndmask_b32 v78, v50, v54, s[52:53]
 v_cndmask_b32 v79, v51, v55, s[52:53]
 ds_write_b128 v14, v[76:79] offset:12288
 s_waitcnt lgkmcnt(0)
 s_mov_b64 exec, 1
 ds_add_u32 v18, v19 offset:20544
 s_mov_b64 exec, -1

 s_cmp_eq_u32 s37, 63
 s_cbranch_scc1 mega_join
 s_add_u32 s48, s37, 1
 s_and_b32 s48, s48, 3
 s_mul_i32 s48, s48, 131072
 s_add_u32 s84, s48, 100663296
 s_add_u32 s48, s37, 2
 s_and_b32 s48, s48, 3
 s_mul_i32 s48, s48, 131072
 s_add_u32 s85, s48, 100663296
 s_add_u32 s48, s37, 4
 s_and_b32 s48, s48, 3
 s_mul_i32 s48, s48, 131072
 s_add_u32 s86, s48, 100663296
 s_add_u32 s48, s37, 1
 s_and_b32 s48, s48, 3
 s_mul_i32 s48, s48, 131072
 s_add_u32 s87, s48, 113246208
 s_add_u32 s48, s37, 3
 s_and_b32 s48, s48, 3
 s_mul_i32 s48, s48, 131072
 s_add_u32 s88, s48, 113246208
 s_add_u32 s48, s37, 1
 s_and_b32 s48, s48, 3
 s_mul_i32 s48, s48, 65536
 s_add_u32 s89, s48, 132120576
 s_add_u32 s48, s37, 3
 s_and_b32 s48, s48, 3
 s_mul_i32 s48, s48, 65536
 s_add_u32 s90, s48, 132120576
 s_barrier
 buffer_load_dwordx4 v[204:207], v8, s[4:7], s42 offen offset:0 sc1
 buffer_load_dwordx4 v[208:211], v8, s[4:7], s42 offen offset:512 sc1
 buffer_load_dwordx4 v[212:215], v8, s[4:7], s42 offen offset:2048 sc1
 buffer_load_dwordx4 v[216:219], v8, s[4:7], s42 offen offset:2560 sc1
 s_waitcnt vmcnt(3)
pc_126:
 v_max3_u32 v196, v204, v205, v206
 v_max_u32 v197, v196, v207
 v_cmp_eq_u32 vcc, -1, v197
 s_cbranch_vccnz pr_127
 v_mfma_f32_16x16x32_bf16 v[40:43], a[192:195], v[204:207], 0
 v_mfma_f32_16x16x32_bf16 v[48:51], a[208:211], v[204:207], 0
 v_mfma_f32_16x16x32_bf16 v[44:47], a[196:199], v[204:207], 0
 v_mfma_f32_16x16x32_bf16 v[52:55], a[212:215], v[204:207], 0
 s_waitcnt vmcnt(2)
pc_128:
 v_max3_u32 v196, v208, v209, v210
 v_max_u32 v197, v196, v211
 v_cmp_eq_u32 vcc, -1, v197
 s_cbranch_vccnz pr_129
 v_mfma_f32_16x16x32_bf16 v[40:43], a[200:203], v[208:211], v[40:43]
 v_mfma_f32_16x16x32_bf16 v[48:51], a[216:219], v[208:211], v[48:51]
 v_mfma_f32_16x16x32_bf16 v[44:47], a[204:207], v[208:211], v[44:47]
 v_mfma_f32_16x16x32_bf16 v[52:55], a[220:223], v[208:211], v[52:55]
 s_waitcnt vmcnt(1)
pc_130:
 v_max3_u32 v196, v212, v213, v214
 v_max_u32 v197, v196, v215
 v_cmp_eq_u32 vcc, -1, v197
 s_cbranch_vccnz pr_131
 v_mfma_f32_16x16x32_bf16 v[40:43], a[224:227], v[212:215], v[40:43]
 v_mfma_f32_16x16x32_bf16 v[48:51], a[240:243], v[212:215], v[48:51]
 v_mfma_f32_16x16x32_bf16 v[44:47], a[228:231], v[212:215], v[44:47]
 v_mfma_f32_16x16x32_bf16 v[52:55], a[244:247], v[212:215], v[52:55]
 s_waitcnt vmcnt(0)
pc_132:
 v_max3_u32 v196, v216, v217, v218
 v_max_u32 v197, v196, v219
 v_cmp_eq_u32 vcc, -1, v197
 s_cbranch_vccnz pr_133
 v_mfma_f32_16x16x32_bf16 v[40:43], a[232:235], v[216:219], v[40:43]
 v_mfma_f32_16x16x32_bf16 v[48:51], a[248:251], v[216:219], v[48:51]
 v_mfma_f32_16x16x32_bf16 v[44:47], a[236:239], v[216:219], v[44:47]
 v_mfma_f32_16x16x32_bf16 v[52:55], a[252:255], v[216:219], v[52:55]
 s_nop 5
 v_add_f32_dpp v72, v48, v40 row_ror:8 row_mask:0xf bank_mask:0x3
 v_add_f32_dpp v73, v49, v41 row_ror:8 row_mask:0xf bank_mask:0x3
 v_add_f32_dpp v74, v50, v42 row_ror:8 row_mask:0xf bank_mask:0x3
 v_add_f32_dpp v75, v51, v43 row_ror:8 row_mask:0xf bank_mask:0x3
 v_add_f32_dpp v72, v44, v52 row_ror:8 row_mask:0xf bank_mask:0xc
 v_add_f32_dpp v73, v45, v53 row_ror:8 row_mask:0xf bank_mask:0xc
 v_add_f32_dpp v74, v46, v54 row_ror:8 row_mask:0xf bank_mask:0xc
 v_add_f32_dpp v75, v47, v55 row_ror:8 row_mask:0xf bank_mask:0xc
 ds_write_b128 v14, v[72:75] offset:16384
 s_waitcnt lgkmcnt(0)
 s_barrier
 s_add_u32 s44, s44, 65536
 s_add_u32 s74, s74, 65536
 s_add_u32 s79, s79, 4
 s_add_u32 s43, s43, 524288

 s_mov_b32 s40, s84
 s_mov_b32 s76, s86
 s_mov_b32 s41, s87
 s_mov_b32 s77, s88
 s_mov_b32 s42, s89
 s_mov_b32 s78, s90
 s_add_u32 s37, s37, 1
 s_barrier
 s_branch chain_loop_fast_2
pr_117:
 s_sub_u32 s38, s38, 1
 s_cbranch_scc1 chain_exit
 s_mov_b64 exec, vcc
 buffer_load_dwordx4 v[24:27], v2, s[4:7], s40 offen offset:0 sc1
 s_mov_b64 exec, -1
 s_waitcnt vmcnt(1)
 v_max3_u32 v196, v28, v29, v30
 v_max_u32 v196, v196, v31
 v_cmp_eq_u32 vcc, -1, v196
 s_cbranch_vccz ps_134
 s_mov_b64 exec, vcc
 buffer_load_dwordx4 v[28:31], v2, s[4:7], s40 offen offset:512 sc1
 s_mov_b64 exec, -1
ps_134:
 v_max3_u32 v196, v32, v33, v34
 v_max_u32 v196, v196, v35
 v_cmp_eq_u32 vcc, -1, v196
 s_cbranch_vccz ps_135
 s_mov_b64 exec, vcc
 buffer_load_dwordx4 v[32:35], v2, s[4:7], s40 offen offset:1024 sc1
 s_mov_b64 exec, -1
ps_135:
 v_max3_u32 v196, v36, v37, v38
 v_max_u32 v196, v196, v39
 v_cmp_eq_u32 vcc, -1, v196
 s_cbranch_vccz ps_136
 s_mov_b64 exec, vcc
 buffer_load_dwordx4 v[36:39], v2, s[4:7], s40 offen offset:1536 sc1
 s_mov_b64 exec, -1
ps_136:
 s_waitcnt vmcnt(0)
 s_branch pc_116
pr_119:
 s_sub_u32 s38, s38, 1
 s_cbranch_scc1 chain_exit
 s_mov_b64 exec, vcc
 buffer_load_dwordx4 v[28:31], v2, s[4:7], s40 offen offset:512 sc1
 s_mov_b64 exec, -1
 s_waitcnt vmcnt(1)
 v_max3_u32 v196, v32, v33, v34
 v_max_u32 v196, v196, v35
 v_cmp_eq_u32 vcc, -1, v196
 s_cbranch_vccz ps_137
 s_mov_b64 exec, vcc
 buffer_load_dwordx4 v[32:35], v2, s[4:7], s40 offen offset:1024 sc1
 s_mov_b64 exec, -1
ps_137:
 v_max3_u32 v196, v36, v37, v38
 v_max_u32 v196, v196, v39
 v_cmp_eq_u32 vcc, -1, v196
 s_cbranch_vccz ps_138
 s_mov_b64 exec, vcc
 buffer_load_dwordx4 v[36:39], v2, s[4:7], s40 offen offset:1536 sc1
 s_mov_b64 exec, -1
ps_138:
 s_waitcnt vmcnt(0)
 s_branch pc_118
pr_121:
 s_sub_u32 s38, s38, 1
 s_cbranch_scc1 chain_exit
 s_mov_b64 exec, vcc
 buffer_load_dwordx4 v[32:35], v2, s[4:7], s40 offen offset:1024 sc1
 s_mov_b64 exec, -1
 s_waitcnt vmcnt(1)
 v_max3_u32 v196, v36, v37, v38
 v_max_u32 v196, v196, v39
 v_cmp_eq_u32 vcc, -1, v196
 s_cbranch_vccz ps_139
 s_mov_b64 exec, vcc
 buffer_load_dwordx4 v[36:39], v2, s[4:7], s40 offen offset:1536 sc1
 s_mov_b64 exec, -1
ps_139:
 s_waitcnt vmcnt(0)
 s_branch pc_120
pr_123:
 s_sub_u32 s38, s38, 1
 s_cbranch_scc1 chain_exit
 s_mov_b64 exec, vcc
 buffer_load_dwordx4 v[36:39], v2, s[4:7], s40 offen offset:1536 sc1
 s_mov_b64 exec, -1
 s_waitcnt vmcnt(0)
 s_branch pc_122
sl_124:
 buffer_store_dwordx2 v[80:81], v4, s[4:7], s41 offen offset:512 sc1
 buffer_store_dwordx2 v[184:185], v4, s[4:7], s77 offen offset:512 sc1
 s_branch bk_125
pr_127:
 s_sub_u32 s38, s38, 1
 s_cbranch_scc1 chain_exit
 s_mov_b64 exec, vcc
 buffer_load_dwordx4 v[204:207], v8, s[4:7], s42 offen offset:0 sc1
 s_mov_b64 exec, -1
 s_waitcnt vmcnt(1)
 v_max3_u32 v196, v208, v209, v210
 v_max_u32 v196, v196, v211
 v_cmp_eq_u32 vcc, -1, v196
 s_cbranch_vccz ps_140
 s_mov_b64 exec, vcc
 buffer_load_dwordx4 v[208:211], v8, s[4:7], s42 offen offset:512 sc1
 s_mov_b64 exec, -1
ps_140:
 v_max3_u32 v196, v212, v213, v214
 v_max_u32 v196, v196, v215
 v_cmp_eq_u32 vcc, -1, v196
 s_cbranch_vccz ps_141
 s_mov_b64 exec, vcc
 buffer_load_dwordx4 v[212:215], v8, s[4:7], s42 offen offset:2048 sc1
 s_mov_b64 exec, -1
ps_141:
 v_max3_u32 v196, v216, v217, v218
 v_max_u32 v196, v196, v219
 v_cmp_eq_u32 vcc, -1, v196
 s_cbranch_vccz ps_142
 s_mov_b64 exec, vcc
 buffer_load_dwordx4 v[216:219], v8, s[4:7], s42 offen offset:2560 sc1
 s_mov_b64 exec, -1
ps_142:
 s_waitcnt vmcnt(0)
 s_branch pc_126
pr_129:
 s_sub_u32 s38, s38, 1
 s_cbranch_scc1 chain_exit
 s_mov_b64 exec, vcc
 buffer_load_dwordx4 v[208:211], v8, s[4:7], s42 offen offset:512 sc1
 s_mov_b64 exec, -1
 s_waitcnt vmcnt(1)
 v_max3_u32 v196, v212, v213, v214
 v_max_u32 v196, v196, v215
 v_cmp_eq_u32 vcc, -1, v196
 s_cbranch_vccz ps_143
 s_mov_b64 exec, vcc
 buffer_load_dwordx4 v[212:215], v8, s[4:7], s42 offen offset:2048 sc1
 s_mov_b64 exec, -1
ps_143:
 v_max3_u32 v196, v216, v217, v218
 v_max_u32 v196, v196, v219
 v_cmp_eq_u32 vcc, -1, v196
 s_cbranch_vccz ps_144
 s_mov_b64 exec, vcc
 buffer_load_dwordx4 v[216:219], v8, s[4:7], s42 offen offset:2560 sc1
 s_mov_b64 exec, -1
ps_144:
 s_waitcnt vmcnt(0)
 s_branch pc_128
pr_131:
 s_sub_u32 s38, s38, 1
 s_cbranch_scc1 chain_exit
 s_mov_b64 exec, vcc
 buffer_load_dwordx4 v[212:215], v8, s[4:7], s42 offen offset:2048 sc1
 s_mov_b64 exec, -1
 s_waitcnt vmcnt(1)
 v_max3_u32 v196, v216, v217, v218
 v_max_u32 v196, v196, v219
 v_cmp_eq_u32 vcc, -1, v196
 s_cbranch_vccz ps_145
 s_mov_b64 exec, vcc
 buffer_load_dwordx4 v[216:219], v8, s[4:7], s42 offen offset:2560 sc1
 s_mov_b64 exec, -1
ps_145:
 s_waitcnt vmcnt(0)
 s_branch pc_130
pr_133:
 s_sub_u32 s38, s38, 1
 s_cbranch_scc1 chain_exit
 s_mov_b64 exec, vcc
 buffer_load_dwordx4 v[216:219], v8, s[4:7], s42 offen offset:2560 sc1
 s_mov_b64 exec, -1
 s_waitcnt vmcnt(0)
 s_branch pc_132
chain_exit:
 s_endpgm
mega_join:
 s_mov_b32 s84, 1
 s_branch mega_worker2
mega_worker:
 v_and_b32 v3, 7, v0
 v_lshlrev_b32 v3, 12, v3
 s_mov_b32 s36, 159453184
iw_146:
 buffer_load_dword v2, v3, s[4:7], s36 offen sc1
 s_sub_u32 s38, s38, 1
 s_cbranch_scc1 chain_exit
 s_waitcnt vmcnt(0)
 v_add_u32_dpp v2, v2, v2 quad_perm:[1,0,3,2] row_mask:0xf bank_mask:0xf
 s_nop 1
 v_add_u32_dpp v2, v2, v2 quad_perm:[2,3,0,1] row_mask:0xf bank_mask:0xf
 s_nop 1
 v_add_u32_dpp v2, v2, v2 row_half_mirror row_mask:0xf bank_mask:0xf
 v_cmp_gt_u32 vcc, 0x100, v2
 s_cbranch_vccnz iw_146

 s_mov_b32 s84, 0
mega_worker2:
 s_mov_b32 s80, s4
 s_mov_b32 s81, s5
 s_mov_b32 s82, s6
 s_mov_b32 s83, 0x00020000
 s_mov_b32 s90, s32
 s_mov_b32 s91, 0x2000000
 s_getreg_b32 s100, hwreg(HW_REG_XCC_ID)
 s_and_b32 s100, s100, 3
 s_lshl_b32 s84, s84, 2
 s_or_b32 s100, s100, s84
 s_mov_b32 s97, 8
 s_mov_b32 s101, 57600
 s_waitcnt vmcnt(0) lgkmcnt(0)
 s_getpc_b64 s[98:99]

mega_pc:
 s_add_u32 s98, s98, mega_table-mega_pc
 s_addc_u32 s99, s99, 0
 s_barrier

 s_mov_b32 s87, 0
mega_loop:
 s_cmp_lg_u32 s90, 0
 s_cbranch_scc1 pull_147
 v_accvgpr_write_b32 a255, 1
 v_mov_b32 v255, 0
 s_lshl_b32 s86, s100, 6
 s_add_u32 s86, s86, 159514624
 s_mov_b64 exec, 1
 buffer_atomic_add a255, v255, s[80:83], s86 offen sc0
 s_mov_b64 exec, -1

pull_147:
mega_done:
 s_waitcnt vmcnt(0) lgkmcnt(0)
 s_barrier

 s_cmp_lg_u32 s90, 0
 s_cbranch_scc1 sig_148
 s_cmp_eq_u32 s87, 0
 s_cbranch_scc1 sig_148
 s_lshl_b32 s4, s88, 10
 s_bfe_u32 s5, s101, 0x30004
 s_lshl_b32 s5, s5, 7
 s_add_u32 s4, s4, s5
 s_add_u32 s4, s4, 161480704
 v_mov_b32 v4, s87
 v_mov_b32 v3, 0
 s_mov_b64 exec, 1
 buffer_atomic_add v4, v3, s[80:83], s4 offen
 s_mov_b64 exec, -1

sig_148:
 s_mov_b32 s87, 0
 s_cmp_lg_u32 s90, 0
 s_cbranch_scc1 mega_w1
 v_mov_b32 v3, 0
 s_mov_b64 exec, 1
 ds_write_b32 v3, a255
 v_mov_b32 v3, 163824
 v_mov_b32 v4, -1
 ds_write_b32 v3, v4
 s_mov_b64 exec, -1
 s_waitcnt lgkmcnt(0)

mega_w1:
 s_barrier
 v_mov_b32 v3, 0
 ds_read_b32 v2, v3
 s_waitcnt lgkmcnt(0)
 v_readfirstlane_b32 s4, v2
 s_sub_u32 s91, s91, 0x4000
 s_cbranch_scc1 chain_exit
 s_min_u32 s4, s4, 449
 s_mul_i32 s5, s100, 450
 s_add_u32 s4, s4, s5
 s_lshl_b32 s4, s4, 4
 s_load_dwordx4 s[8:11], s[98:99], s4
 s_mov_b32 s101, s4
 s_waitcnt lgkmcnt(0)
 s_cmp_eq_u32 s8, -1
 s_cbranch_scc0 mega_have
 s_sub_u32 s97, s97, 1
 s_cmp_eq_u32 s97, 0
 s_cbranch_scc1 chain_exit
 s_add_u32 s4, s100, 1
 s_and_b32 s4, s4, 3
 s_and_b32 s100, s100, 4
 s_or_b32 s100, s100, s4
 s_cmp_eq_u32 s97, 4
 s_cselect_b32 s4, 4, 0
 s_xor_b32 s100, s100, s4
 s_mov_b32 s101, 57600
 s_barrier
 s_branch mega_loop

mega_have:
 s_bfe_u32 s92, s8, 0x80008
 s_bfe_u32 s93, s8, 0x80010
 s_lshr_b32 s95, s9, 20
 s_and_b32 s94, s9, 0x3ff
 s_bfe_u32 s88, s9, 0xa000a
 s_and_b32 s6, s8, 0xff
 s_and_b32 s75, s10, 3
 s_bfe_u32 s72, s10, 0x20002
 s_bfe_u32 s76, s10, 0x80008
 s_mov_b32 s77, s11
 s_bfe_u32 s69, s10, 0x80010
 s_lshr_b32 s89, s10, 24
 s_max_u32 s87, s89, 1
 s_mov_b32 s66, 54525952
 s_mov_b32 s64, 262144
 s_mov_b32 s70, 40
 s_mov_b32 s71, 8388608
 s_mov_b32 s65, 2048
 s_mov_b32 s73, 2048
 s_mov_b32 s74, 71303168
 s_cmp_eq_u32 s75, 1
 s_cselect_b32 s66, 75497472, s66
 s_cselect_b32 s64, 65536, s64
 s_cselect_b32 s70, 64, s70
 s_cselect_b32 s71, 7340032, s71
 s_cselect_b32 s65, 7168, s65
 s_cselect_b32 s73, 7168, s73
 s_cselect_b32 s74, 79691776, s74
 s_cmp_eq_u32 s75, 2
 s_cselect_b32 s66, 79691776, s66
 s_cselect_b32 s64, 229376, s64
 s_cselect_b32 s70, 72, s70
 s_cselect_b32 s71, 7340032, s71
 s_cselect_b32 s74, 0, s74
 s_cmp_eq_u32 s72, 2
 s_cselect_b32 s73, 4096, s73
 s_cselect_b32 s74, s11, s74
 s_lshl_b32 s68, s65, 6
 s_lshl_b32 s85, s65, 5
 s_mul_i32 s67, s76, s68
 s_lshl_b32 s5, s76, 12
 s_add_u32 s66, s66, s5

 s_cmp_lg_u32 s90, 0
 s_cbranch_scc1 mega_w2
 s_cmp_eq_u32 s95, 0
 s_cbranch_scc1 mega_w2
 s_lshl_b32 s4, 1, s6
 s_and_b32 s4, s4, 168
 s_cbranch_scc1 mega_w2
 s_lshl_b32 s4, s94, 10
 s_add_u32 s4, s4, 161480704
 v_and_b32 v3, 7, v0
 v_lshlrev_b32 v3, 7, v3

mega_poll:
 buffer_load_dword v2, v3, s[80:83], s4 offen sc1
 s_sub_u32 s91, s91, 16
 s_cbranch_scc1 chain_exit
 s_waitcnt vmcnt(0)
 v_add_u32_dpp v2, v2, v2 quad_perm:[1,0,3,2] row_mask:0xf bank_mask:0xf
 s_nop 1
 v_add_u32_dpp v2, v2, v2 quad_perm:[2,3,0,1] row_mask:0xf bank_mask:0xf
 s_nop 1
 v_add_u32_dpp v2, v2, v2 row_half_mirror row_mask:0xf bank_mask:0xf
 v_cmp_gt_u32 vcc, s95, v2
 s_cbranch_vccz mega_w2
 v_add_u32 v2, 6, v2
 v_cmp_gt_u32 vcc, s95, v2
 s_cbranch_vccz mega_near
 s_sleep 20

mega_near:
 s_sleep 3
 s_branch mega_poll

mega_w2:
 s_barrier
 s_cmp_eq_u32 s6, 0
 s_cbranch_scc1 t_qkv
 s_cmp_eq_u32 s6, 1
 s_cbranch_scc1 t_qkv2
 s_cmp_eq_u32 s6, 2
 s_cbranch_scc1 t_att
 s_cmp_eq_u32 s6, 3
 s_cbranch_scc1 t_g
 s_cmp_eq_u32 s6, 4
 s_cbranch_scc1 t_red
 s_cmp_eq_u32 s6, 5
 s_cbranch_scc1 t_g2
 s_cmp_eq_u32 s6, 6
 s_cbranch_scc1 t_ln
 s_cmp_eq_u32 s6, 7
 s_cbranch_scc1 t_gh
 s_branch chain_exit
t_qkv:
 s_load_dwordx2 s[40:41], s[0:1], 96
 s_load_dwordx2 s[42:43], s[0:1], 16
 s_load_dwordx2 s[44:45], s[0:1], 24
 s_load_dwordx2 s[46:47], s[0:1], 32
 v_and_b32 v1, 63, v0
 v_lshrrev_b32 v8, 6, v0
 s_mov_b32 s25, s92
 v_readfirstlane_b32 s24, v8
 s_mov_b32 s26, s93
 s_and_b32 s27, s24, 3
 s_lshr_b32 s36, s24, 2
 s_and_b32 s28, s36, 0
 s_lshr_b32 s29, s36, 0

 v_lshlrev_b32 v8, 4, v1
 s_mul_i32 s36, s24, 2
 s_add_u32 s36, s36, 0
 s_lshr_b32 s37, s36, 1
 s_and_b32 s36, s36, 1
 s_mul_i32 s38, s25, 4
 s_add_u32 s37, s37, s38
 s_mul_i32 s37, s37, 65536
 s_lshl_b32 s36, s36, 10
 s_add_u32 s36, s36, s37
 v_add_u32 v2, s36, v8

 s_mul_i32 s36, s24, 2
 s_add_u32 s36, s36, 1
 s_lshr_b32 s37, s36, 1
 s_and_b32 s36, s36, 1
 s_mul_i32 s38, s25, 4
 s_add_u32 s37, s37, s38
 s_mul_i32 s37, s37, 65536
 s_lshl_b32 s36, s36, 10
 s_add_u32 s36, s36, s37
 v_add_u32 v3, s36, v8

 s_mul_i32 s36, s24, 64
 v_add_u32 v8, s36, v1

 v_lshrrev_b32 v9, 3, v8
 v_and_b32 v10, 7, v8
 v_bfe_u32 v11, v9, 1, 1
 v_lshlrev_b32 v11, 2, v11
 v_xor_b32 v10, v10, v11

 v_mul_u32_u24 v9, 8192, v9
 v_lshl_add_u32 v4, v10, 4, v9
 s_mov_b32 s30, 0
 s_mul_i32 s63, s26, 128
 s_add_u32 s63, s63, 0
 s_mov_b32 s31, s63
 s_mul_i32 s32, s24, 2048
 s_mul_i32 s51, s24, 1024
 s_mov_b32 s35, 0
 s_mov_b32 s50, 20480
 s_mov_b32 s62, 32
 s_mov_b32 s78, s89
 s_mov_b32 s79, 1
 s_waitcnt lgkmcnt(0)

 s_mov_b32 s4, s40
 s_and_b32 s5, s41, 0xffff
 s_mov_b32 s6, 0x10000000
 s_mov_b32 s7, 0x00020000
 s_mov_b32 s8, s42
 s_and_b32 s9, s43, 0xffff
 s_mov_b32 s10, 0x800000
 s_mov_b32 s11, 0x00020000
 s_mov_b32 s12, s44
 s_and_b32 s13, s45, 0xffff
 s_mov_b32 s14, 0x800000
 s_mov_b32 s15, 0x00020000
 s_mov_b32 s16, s46
 s_and_b32 s17, s47, 0xffff
 s_mov_b32 s18, 0x800000
 s_mov_b32 s19, 0x00020000
 s_add_u32 m0, s32, 0
 s_nop 0
 buffer_load_dwordx4 v2, s[4:7], s30 offen sc1 lds
 s_add_u32 m0, s32, 1024
 s_nop 0
 buffer_load_dwordx4 v3, s[4:7], s30 offen sc1 lds
 s_add_u32 m0, s51, 8192
 s_nop 0
 buffer_load_dwordx4 v4, s[8:11], s31 offen lds
 s_add_u32 m0, s51, 12288
 s_nop 0
 buffer_load_dwordx4 v4, s[12:15], s31 offen lds
 s_add_u32 m0, s51, 16384
 s_nop 0
 buffer_load_dwordx4 v4, s[16:19], s31 offen lds
 s_add_u32 s30, s30, 2048
 s_add_u32 s31, s31, 262144
 s_add_u32 s32, s32, 20480
 s_add_u32 s51, s51, 20480
 s_cmp_ge_u32 s32, 102400
 s_cselect_b32 s38, 102400, 0
 s_sub_u32 s32, s32, s38
 s_sub_u32 s51, s51, s38
 s_sub_u32 s62, s62, 1
 s_cmp_eq_u32 s62, 0
 s_cselect_b32 s38, 128, 0
 s_cselect_b32 s30, 0, s30
 s_cselect_b32 s62, 32, s62
 s_add_u32 s63, s63, s38
 s_cmp_lg_u32 s38, 0
 s_cselect_b32 s31, s63, s31
 s_mul_i32 s36, s27, 2048
 s_mul_i32 s37, s29, 2048
 s_add_u32 s36, s36, s37
 v_lshlrev_b32 v8, 4, v1
 v_add_u32 v5, s36, v8

 v_bfe_u32 v8, v1, 2, 2
 v_lshrrev_b32 v9, 5, v1
 v_lshl_add_u32 v9, v9, 3, v8
 s_mul_i32 s36, s29, 32
 v_add_u32 v9, s36, v9
 v_mul_u32_u24 v9, 128, v9
 v_bfe_u32 v10, v1, 4, 1
 v_lshl_add_u32 v9, v10, 5, v9
 v_and_b32 v10, 3, v1
 v_lshl_add_u32 v9, v10, 3, v9
 v_add_u32 v9, 8192, v9
 v_bfe_u32 v11, v8, 1, 1

 s_mul_i32 s36, s28, 2
 s_add_u32 s36, s36, 0
 v_xor_b32 v10, s36, v11
 v_lshl_add_u32 v6, v10, 6, v9
 s_mul_i32 s36, s28, 2
 s_add_u32 s36, s36, 1
 v_xor_b32 v10, s36, v11
 v_lshl_add_u32 v7, v10, 6, v9
 s_add_u32 m0, s32, 0
 s_nop 0
 buffer_load_dwordx4 v2, s[4:7], s30 offen sc1 lds
 s_add_u32 m0, s32, 1024
 s_nop 0
 buffer_load_dwordx4 v3, s[4:7], s30 offen sc1 lds
 s_add_u32 m0, s51, 8192
 s_nop 0
 buffer_load_dwordx4 v4, s[8:11], s31 offen lds
 s_add_u32 m0, s51, 12288
 s_nop 0
 buffer_load_dwordx4 v4, s[12:15], s31 offen lds
 s_add_u32 m0, s51, 16384
 s_nop 0
 buffer_load_dwordx4 v4, s[16:19], s31 offen lds
 s_add_u32 s30, s30, 2048
 s_add_u32 s31, s31, 262144
 s_add_u32 s32, s32, 20480
 s_add_u32 s51, s51, 20480
 s_cmp_ge_u32 s32, 102400
 s_cselect_b32 s38, 102400, 0
 s_sub_u32 s32, s32, s38
 s_sub_u32 s51, s51, s38
 s_sub_u32 s62, s62, 1
 s_cmp_eq_u32 s62, 0
 s_cselect_b32 s38, 128, 0
 s_cselect_b32 s30, 0, s30
 s_cselect_b32 s62, 32, s62
 s_add_u32 s63, s63, s38
 s_cmp_lg_u32 s38, 0
 s_cselect_b32 s31, s63, s31
 s_add_u32 m0, s32, 0
 s_nop 0
 buffer_load_dwordx4 v2, s[4:7], s30 offen sc1 lds
 s_add_u32 m0, s32, 1024
 s_nop 0
 buffer_load_dwordx4 v3, s[4:7], s30 offen sc1 lds
 s_add_u32 m0, s51, 8192
 s_nop 0
 buffer_load_dwordx4 v4, s[8:11], s31 offen lds
 s_add_u32 m0, s51, 12288
 s_nop 0
 buffer_load_dwordx4 v4, s[12:15], s31 offen lds
 s_add_u32 m0, s51, 16384
 s_nop 0
 buffer_load_dwordx4 v4, s[16:19], s31 offen lds
 s_add_u32 s30, s30, 2048
 s_add_u32 s31, s31, 262144
 s_add_u32 s32, s32, 20480
 s_add_u32 s51, s51, 20480
 s_cmp_ge_u32 s32, 102400
 s_cselect_b32 s38, 102400, 0
 s_sub_u32 s32, s32, s38
 s_sub_u32 s51, s51, s38
 s_sub_u32 s62, s62, 1
 s_cmp_eq_u32 s62, 0
 s_cselect_b32 s38, 128, 0
 s_cselect_b32 s30, 0, s30
 s_cselect_b32 s62, 32, s62
 s_add_u32 s63, s63, s38
 s_cmp_lg_u32 s38, 0
 s_cselect_b32 s31, s63, s31
 s_add_u32 m0, s32, 0
 s_nop 0
 buffer_load_dwordx4 v2, s[4:7], s30 offen sc1 lds
 s_add_u32 m0, s32, 1024
 s_nop 0
 buffer_load_dwordx4 v3, s[4:7], s30 offen sc1 lds
 s_add_u32 m0, s51, 8192
 s_nop 0
 buffer_load_dwordx4 v4, s[8:11], s31 offen lds
 s_add_u32 m0, s51, 12288
 s_nop 0
 buffer_load_dwordx4 v4, s[12:15], s31 offen lds
 s_add_u32 m0, s51, 16384
 s_nop 0
 buffer_load_dwordx4 v4, s[16:19], s31 offen lds
 s_add_u32 s30, s30, 2048
 s_add_u32 s31, s31, 262144
 s_add_u32 s32, s32, 20480
 s_add_u32 s51, s51, 20480
 s_cmp_ge_u32 s32, 102400
 s_cselect_b32 s38, 102400, 0
 s_sub_u32 s32, s32, s38
 s_sub_u32 s51, s51, s38
 s_sub_u32 s62, s62, 1
 s_cmp_eq_u32 s62, 0
 s_cselect_b32 s38, 128, 0
 s_cselect_b32 s30, 0, s30
 s_cselect_b32 s62, 32, s62
 s_add_u32 s63, s63, s38
 s_cmp_lg_u32 s38, 0
 s_cselect_b32 s31, s63, s31
 s_mul_i32 s37, s24, 12288
 s_add_u32 s37, s37, 102400
 v_lshlrev_b32 v73, 4, v1
 v_and_b32 v80, 31, v1
 v_lshrrev_b32 v81, 5, v1
 v_mul_u32_u24 v76, 144, v80
 v_lshl_add_u32 v76, v81, 4, v76
 v_add_u32 v76, s37, v76
 v_mul_u32_u24 v77, 80, v80
 v_lshl_add_u32 v77, v81, 4, v77
 v_add_u32 v77, s37, v77
 v_and_b32 v80, 31, v1
 v_lshrrev_b32 v81, 5, v1
 v_mul_u32_u24 v74, 144, v80
 v_lshl_add_u32 v74, v81, 3, v74
 v_add_u32 v74, s37, v74
 v_mul_u32_u24 v75, 80, v80
 v_lshl_add_u32 v75, v81, 3, v75
 v_add_u32 v75, s37, v75

 s_waitcnt vmcnt(15)
 s_barrier
 ds_read_b128 v[16:19], v5 offset:0
 ds_read_b64_tr_b16 v[20:21], v6 offset:0
 ds_read_b64_tr_b16 v[22:23], v6 offset:512
 ds_read_b64_tr_b16 v[24:25], v7 offset:0
 ds_read_b64_tr_b16 v[26:27], v7 offset:512
 ds_read_b64_tr_b16 v[28:29], v6 offset:4096
 ds_read_b64_tr_b16 v[30:31], v6 offset:4608
 ds_read_b64_tr_b16 v[32:33], v7 offset:4096
 ds_read_b64_tr_b16 v[34:35], v7 offset:4608
 ds_read_b64_tr_b16 v[36:37], v6 offset:8192
 ds_read_b64_tr_b16 v[38:39], v6 offset:8704
 ds_read_b64_tr_b16 v[40:41], v7 offset:8192
 ds_read_b64_tr_b16 v[42:43], v7 offset:8704
t_qkv_tile:
 s_sub_u32 s78, s78, 1
 s_cmp_eq_u32 s78, 0
 s_cselect_b32 s33, 5, 1
 s_sub_u32 s33, 32, s33

 s_waitcnt lgkmcnt(0)
 v_mfma_f32_32x32x16_bf16 a[0:15], v[20:23], v[16:19], 0
 ds_read_b128 v[44:47], v5 offset:1024
 ds_read_b64_tr_b16 v[48:49], v6 offset:2048
 ds_read_b64_tr_b16 v[50:51], v6 offset:2560
 ds_read_b64_tr_b16 v[52:53], v7 offset:2048
 ds_read_b64_tr_b16 v[54:55], v7 offset:2560
 v_mfma_f32_32x32x16_bf16 a[16:31], v[24:27], v[16:19], 0
 ds_read_b64_tr_b16 v[56:57], v6 offset:6144
 ds_read_b64_tr_b16 v[58:59], v6 offset:6656
 ds_read_b64_tr_b16 v[60:61], v7 offset:6144
 ds_read_b64_tr_b16 v[62:63], v7 offset:6656
 s_add_u32 m0, s32, 0
 s_nop 0
 buffer_load_dwordx4 v2, s[4:7], s30 offen sc1 lds
 v_mfma_f32_32x32x16_bf16 a[32:47], v[28:31], v[16:19], 0
 ds_read_b64_tr_b16 v[64:65], v6 offset:10240
 ds_read_b64_tr_b16 v[66:67], v6 offset:10752
 ds_read_b64_tr_b16 v[68:69], v7 offset:10240
 ds_read_b64_tr_b16 v[70:71], v7 offset:10752
 v_mfma_f32_32x32x16_bf16 a[48:63], v[32:35], v[16:19], 0
 s_add_u32 m0, s32, 1024
 s_nop 0
 buffer_load_dwordx4 v3, s[4:7], s30 offen sc1 lds
 v_mfma_f32_32x32x16_bf16 a[64:79], v[16:19], v[36:39], 0
 s_add_u32 m0, s51, 8192
 s_nop 0
 buffer_load_dwordx4 v4, s[8:11], s31 offen lds
 v_mfma_f32_32x32x16_bf16 a[80:95], v[16:19], v[40:43], 0
 s_waitcnt lgkmcnt(0)
 v_mfma_f32_32x32x16_bf16 a[0:15], v[48:51], v[44:47], a[0:15]
 s_add_u32 m0, s51, 12288
 s_nop 0
 buffer_load_dwordx4 v4, s[12:15], s31 offen lds
 v_mfma_f32_32x32x16_bf16 a[16:31], v[52:55], v[44:47], a[16:31]
 s_add_u32 m0, s51, 16384
 s_nop 0
 buffer_load_dwordx4 v4, s[16:19], s31 offen lds
 s_add_u32 s30, s30, 2048
 s_add_u32 s31, s31, 262144
 s_add_u32 s32, s32, 20480
 s_add_u32 s51, s51, 20480
 s_cmp_ge_u32 s32, 102400
 s_cselect_b32 s38, 102400, 0
 s_sub_u32 s32, s32, s38
 s_sub_u32 s51, s51, s38
 s_sub_u32 s62, s62, 1
 s_cmp_eq_u32 s62, 0
 s_cselect_b32 s38, 128, 0
 s_cselect_b32 s30, 0, s30
 s_cselect_b32 s62, 32, s62
 s_add_u32 s63, s63, s38
 s_cmp_lg_u32 s38, 0
 s_cselect_b32 s31, s63, s31
 v_mfma_f32_32x32x16_bf16 a[32:47], v[56:59], v[44:47], a[32:47]
 s_add_u32 s35, s35, 1
 s_cmp_eq_u32 s35, 5
 s_cselect_b32 s34, 0xfffec000, s50
 s_cselect_b32 s35, 0, s35
 v_add_u32 v5, s34, v5
 v_add_u32 v6, s34, v6
 v_add_u32 v7, s34, v7
 s_cmp_eq_u32 s79, 0
 s_cbranch_scc1 fw_149
 s_waitcnt vmcnt(15)
 s_branch fw_150
 fw_149:
 s_waitcnt vmcnt(27)
 fw_150:
 s_barrier
 ds_read_b128 v[16:19], v5 offset:0
 ds_read_b64_tr_b16 v[20:21], v6 offset:0
 ds_read_b64_tr_b16 v[22:23], v6 offset:512
 ds_read_b64_tr_b16 v[24:25], v7 offset:0
 ds_read_b64_tr_b16 v[26:27], v7 offset:512
 ds_read_b64_tr_b16 v[28:29], v6 offset:4096
 ds_read_b64_tr_b16 v[30:31], v6 offset:4608
 ds_read_b64_tr_b16 v[32:33], v7 offset:4096
 ds_read_b64_tr_b16 v[34:35], v7 offset:4608
 v_mfma_f32_32x32x16_bf16 a[48:63], v[60:63], v[44:47], a[48:63]
 ds_read_b64_tr_b16 v[36:37], v6 offset:8192
 ds_read_b64_tr_b16 v[38:39], v6 offset:8704
 ds_read_b64_tr_b16 v[40:41], v7 offset:8192
 ds_read_b64_tr_b16 v[42:43], v7 offset:8704
 v_mfma_f32_32x32x16_bf16 a[64:79], v[44:47], v[64:67], a[64:79]
 v_mfma_f32_32x32x16_bf16 a[80:95], v[44:47], v[68:71], a[80:95]
 s_cmp_eq_u32 s33, 0
 s_cbranch_scc1 t_qkv_lend
t_qkv_loop:
 s_waitcnt lgkmcnt(0)
 v_mfma_f32_32x32x16_bf16 a[0:15], v[20:23], v[16:19], a[0:15]
 ds_read_b128 v[44:47], v5 offset:1024
 ds_read_b64_tr_b16 v[48:49], v6 offset:2048
 ds_read_b64_tr_b16 v[50:51], v6 offset:2560
 ds_read_b64_tr_b16 v[52:53], v7 offset:2048
 ds_read_b64_tr_b16 v[54:55], v7 offset:2560
 v_mfma_f32_32x32x16_bf16 a[16:31], v[24:27], v[16:19], a[16:31]
 ds_read_b64_tr_b16 v[56:57], v6 offset:6144
 ds_read_b64_tr_b16 v[58:59], v6 offset:6656
 ds_read_b64_tr_b16 v[60:61], v7 offset:6144
 ds_read_b64_tr_b16 v[62:63], v7 offset:6656
 s_add_u32 m0, s32, 0
 s_nop 0
 buffer_load_dwordx4 v2, s[4:7], s30 offen sc1 lds
 v_mfma_f32_32x32x16_bf16 a[32:47], v[28:31], v[16:19], a[32:47]
 ds_read_b64_tr_b16 v[64:65], v6 offset:10240
 ds_read_b64_tr_b16 v[66:67], v6 offset:10752
 ds_read_b64_tr_b16 v[68:69], v7 offset:10240
 ds_read_b64_tr_b16 v[70:71], v7 offset:10752
 v_mfma_f32_32x32x16_bf16 a[48:63], v[32:35], v[16:19], a[48:63]
 s_add_u32 m0, s32, 1024
 s_nop 0
 buffer_load_dwordx4 v3, s[4:7], s30 offen sc1 lds
 v_mfma_f32_32x32x16_bf16 a[64:79], v[16:19], v[36:39], a[64:79]
 s_add_u32 m0, s51, 8192
 s_nop 0
 buffer_load_dwordx4 v4, s[8:11], s31 offen lds
 v_mfma_f32_32x32x16_bf16 a[80:95], v[16:19], v[40:43], a[80:95]
 s_waitcnt lgkmcnt(0)
 v_mfma_f32_32x32x16_bf16 a[0:15], v[48:51], v[44:47], a[0:15]
 s_add_u32 m0, s51, 12288
 s_nop 0
 buffer_load_dwordx4 v4, s[12:15], s31 offen lds
 v_mfma_f32_32x32x16_bf16 a[16:31], v[52:55], v[44:47], a[16:31]
 s_add_u32 m0, s51, 16384
 s_nop 0
 buffer_load_dwordx4 v4, s[16:19], s31 offen lds
 s_add_u32 s30, s30, 2048
 s_add_u32 s31, s31, 262144
 s_add_u32 s32, s32, 20480
 s_add_u32 s51, s51, 20480
 s_cmp_ge_u32 s32, 102400
 s_cselect_b32 s38, 102400, 0
 s_sub_u32 s32, s32, s38
 s_sub_u32 s51, s51, s38
 s_sub_u32 s62, s62, 1
 s_cmp_eq_u32 s62, 0
 s_cselect_b32 s38, 128, 0
 s_cselect_b32 s30, 0, s30
 s_cselect_b32 s62, 32, s62
 s_add_u32 s63, s63, s38
 s_cmp_lg_u32 s38, 0
 s_cselect_b32 s31, s63, s31
 v_mfma_f32_32x32x16_bf16 a[32:47], v[56:59], v[44:47], a[32:47]
 s_add_u32 s35, s35, 1
 s_cmp_eq_u32 s35, 5
 s_cselect_b32 s34, 0xfffec000, s50
 s_cselect_b32 s35, 0, s35
 v_add_u32 v5, s34, v5
 v_add_u32 v6, s34, v6
 v_add_u32 v7, s34, v7
 s_waitcnt vmcnt(15)
 s_barrier
 ds_read_b128 v[16:19], v5 offset:0
 ds_read_b64_tr_b16 v[20:21], v6 offset:0
 ds_read_b64_tr_b16 v[22:23], v6 offset:512
 ds_read_b64_tr_b16 v[24:25], v7 offset:0
 ds_read_b64_tr_b16 v[26:27], v7 offset:512
 ds_read_b64_tr_b16 v[28:29], v6 offset:4096
 ds_read_b64_tr_b16 v[30:31], v6 offset:4608
 ds_read_b64_tr_b16 v[32:33], v7 offset:4096
 ds_read_b64_tr_b16 v[34:35], v7 offset:4608
 v_mfma_f32_32x32x16_bf16 a[48:63], v[60:63], v[44:47], a[48:63]
 ds_read_b64_tr_b16 v[36:37], v6 offset:8192
 ds_read_b64_tr_b16 v[38:39], v6 offset:8704
 ds_read_b64_tr_b16 v[40:41], v7 offset:8192
 ds_read_b64_tr_b16 v[42:43], v7 offset:8704
 v_mfma_f32_32x32x16_bf16 a[64:79], v[44:47], v[64:67], a[64:79]
 v_mfma_f32_32x32x16_bf16 a[80:95], v[44:47], v[68:71], a[80:95]
 s_sub_u32 s33, s33, 1
 s_cmp_lg_u32 s33, 0
 s_cbranch_scc1 t_qkv_loop

t_qkv_lend:
 s_cmp_lg_u32 s78, 0
 s_cbranch_scc1 t_qkv_epi
 s_cmp_lg_u32 s90, 0
 s_cbranch_scc1 pull_151
 v_accvgpr_write_b32 a255, 1
 v_mov_b32 v255, 0
 s_lshl_b32 s86, s100, 6
 s_add_u32 s86, s86, 159514624
 s_mov_b64 exec, 1
 buffer_atomic_add a255, v255, s[80:83], s86 offen sc0
 s_mov_b64 exec, -1

pull_151:
 s_waitcnt lgkmcnt(0)
 v_mfma_f32_32x32x16_bf16 a[0:15], v[20:23], v[16:19], a[0:15]
 ds_read_b128 v[44:47], v5 offset:1024
 ds_read_b64_tr_b16 v[48:49], v6 offset:2048
 ds_read_b64_tr_b16 v[50:51], v6 offset:2560
 ds_read_b64_tr_b16 v[52:53], v7 offset:2048
 ds_read_b64_tr_b16 v[54:55], v7 offset:2560
 v_mfma_f32_32x32x16_bf16 a[16:31], v[24:27], v[16:19], a[16:31]
 ds_read_b64_tr_b16 v[56:57], v6 offset:6144
 ds_read_b64_tr_b16 v[58:59], v6 offset:6656
 ds_read_b64_tr_b16 v[60:61], v7 offset:6144
 ds_read_b64_tr_b16 v[62:63], v7 offset:6656
 v_mfma_f32_32x32x16_bf16 a[32:47], v[28:31], v[16:19], a[32:47]
 ds_read_b64_tr_b16 v[64:65], v6 offset:10240
 ds_read_b64_tr_b16 v[66:67], v6 offset:10752
 ds_read_b64_tr_b16 v[68:69], v7 offset:10240
 ds_read_b64_tr_b16 v[70:71], v7 offset:10752
 v_mfma_f32_32x32x16_bf16 a[48:63], v[32:35], v[16:19], a[48:63]
 v_mfma_f32_32x32x16_bf16 a[64:79], v[16:19], v[36:39], a[64:79]
 v_mfma_f32_32x32x16_bf16 a[80:95], v[16:19], v[40:43], a[80:95]
 s_waitcnt lgkmcnt(0)
 v_mfma_f32_32x32x16_bf16 a[0:15], v[48:51], v[44:47], a[0:15]
 v_mfma_f32_32x32x16_bf16 a[16:31], v[52:55], v[44:47], a[16:31]
 v_mfma_f32_32x32x16_bf16 a[32:47], v[56:59], v[44:47], a[32:47]
 s_add_u32 s35, s35, 1
 s_cmp_eq_u32 s35, 5
 s_cselect_b32 s34, 0xfffec000, s50
 s_cselect_b32 s35, 0, s35
 v_add_u32 v5, s34, v5
 v_add_u32 v6, s34, v6
 v_add_u32 v7, s34, v7
 s_waitcnt vmcnt(10)
 s_barrier
 ds_read_b128 v[16:19], v5 offset:0
 ds_read_b64_tr_b16 v[20:21], v6 offset:0
 ds_read_b64_tr_b16 v[22:23], v6 offset:512
 ds_read_b64_tr_b16 v[24:25], v7 offset:0
 ds_read_b64_tr_b16 v[26:27], v7 offset:512
 ds_read_b64_tr_b16 v[28:29], v6 offset:4096
 ds_read_b64_tr_b16 v[30:31], v6 offset:4608
 ds_read_b64_tr_b16 v[32:33], v7 offset:4096
 ds_read_b64_tr_b16 v[34:35], v7 offset:4608
 v_mfma_f32_32x32x16_bf16 a[48:63], v[60:63], v[44:47], a[48:63]
 ds_read_b64_tr_b16 v[36:37], v6 offset:8192
 ds_read_b64_tr_b16 v[38:39], v6 offset:8704
 ds_read_b64_tr_b16 v[40:41], v7 offset:8192
 ds_read_b64_tr_b16 v[42:43], v7 offset:8704
 v_mfma_f32_32x32x16_bf16 a[64:79], v[44:47], v[64:67], a[64:79]
 v_mfma_f32_32x32x16_bf16 a[80:95], v[44:47], v[68:71], a[80:95]
 s_waitcnt lgkmcnt(0)
 v_mfma_f32_32x32x16_bf16 a[0:15], v[20:23], v[16:19], a[0:15]
 ds_read_b128 v[44:47], v5 offset:1024
 ds_read_b64_tr_b16 v[48:49], v6 offset:2048
 ds_read_b64_tr_b16 v[50:51], v6 offset:2560
 ds_read_b64_tr_b16 v[52:53], v7 offset:2048
 ds_read_b64_tr_b16 v[54:55], v7 offset:2560
 v_mfma_f32_32x32x16_bf16 a[16:31], v[24:27], v[16:19], a[16:31]
 ds_read_b64_tr_b16 v[56:57], v6 offset:6144
 ds_read_b64_tr_b16 v[58:59], v6 offset:6656
 ds_read_b64_tr_b16 v[60:61], v7 offset:6144
 ds_read_b64_tr_b16 v[62:63], v7 offset:6656
 v_mfma_f32_32x32x16_bf16 a[32:47], v[28:31], v[16:19], a[32:47]
 ds_read_b64_tr_b16 v[64:65], v6 offset:10240
 ds_read_b64_tr_b16 v[66:67], v6 offset:10752
 ds_read_b64_tr_b16 v[68:69], v7 offset:10240
 ds_read_b64_tr_b16 v[70:71], v7 offset:10752
 v_mfma_f32_32x32x16_bf16 a[48:63], v[32:35], v[16:19], a[48:63]
 v_mfma_f32_32x32x16_bf16 a[64:79], v[16:19], v[36:39], a[64:79]
 v_mfma_f32_32x32x16_bf16 a[80:95], v[16:19], v[40:43], a[80:95]
 s_waitcnt lgkmcnt(0)
 v_mfma_f32_32x32x16_bf16 a[0:15], v[48:51], v[44:47], a[0:15]
 v_mfma_f32_32x32x16_bf16 a[16:31], v[52:55], v[44:47], a[16:31]
 v_mfma_f32_32x32x16_bf16 a[32:47], v[56:59], v[44:47], a[32:47]
 s_add_u32 s35, s35, 1
 s_cmp_eq_u32 s35, 5
 s_cselect_b32 s34, 0xfffec000, s50
 s_cselect_b32 s35, 0, s35
 v_add_u32 v5, s34, v5
 v_add_u32 v6, s34, v6
 v_add_u32 v7, s34, v7
 s_waitcnt vmcnt(5)
 s_barrier
 ds_read_b128 v[16:19], v5 offset:0
 ds_read_b64_tr_b16 v[20:21], v6 offset:0
 ds_read_b64_tr_b16 v[22:23], v6 offset:512
 ds_read_b64_tr_b16 v[24:25], v7 offset:0
 ds_read_b64_tr_b16 v[26:27], v7 offset:512
 ds_read_b64_tr_b16 v[28:29], v6 offset:4096
 ds_read_b64_tr_b16 v[30:31], v6 offset:4608
 ds_read_b64_tr_b16 v[32:33], v7 offset:4096
 ds_read_b64_tr_b16 v[34:35], v7 offset:4608
 v_mfma_f32_32x32x16_bf16 a[48:63], v[60:63], v[44:47], a[48:63]
 ds_read_b64_tr_b16 v[36:37], v6 offset:8192
 ds_read_b64_tr_b16 v[38:39], v6 offset:8704
 ds_read_b64_tr_b16 v[40:41], v7 offset:8192
 ds_read_b64_tr_b16 v[42:43], v7 offset:8704
 v_mfma_f32_32x32x16_bf16 a[64:79], v[44:47], v[64:67], a[64:79]
 v_mfma_f32_32x32x16_bf16 a[80:95], v[44:47], v[68:71], a[80:95]
 s_waitcnt lgkmcnt(0)
 v_mfma_f32_32x32x16_bf16 a[0:15], v[20:23], v[16:19], a[0:15]
 ds_read_b128 v[44:47], v5 offset:1024
 ds_read_b64_tr_b16 v[48:49], v6 offset:2048
 ds_read_b64_tr_b16 v[50:51], v6 offset:2560
 ds_read_b64_tr_b16 v[52:53], v7 offset:2048
 ds_read_b64_tr_b16 v[54:55], v7 offset:2560
 v_mfma_f32_32x32x16_bf16 a[16:31], v[24:27], v[16:19], a[16:31]
 ds_read_b64_tr_b16 v[56:57], v6 offset:6144
 ds_read_b64_tr_b16 v[58:59], v6 offset:6656
 ds_read_b64_tr_b16 v[60:61], v7 offset:6144
 ds_read_b64_tr_b16 v[62:63], v7 offset:6656
 v_mfma_f32_32x32x16_bf16 a[32:47], v[28:31], v[16:19], a[32:47]
 ds_read_b64_tr_b16 v[64:65], v6 offset:10240
 ds_read_b64_tr_b16 v[66:67], v6 offset:10752
 ds_read_b64_tr_b16 v[68:69], v7 offset:10240
 ds_read_b64_tr_b16 v[70:71], v7 offset:10752
 v_mfma_f32_32x32x16_bf16 a[48:63], v[32:35], v[16:19], a[48:63]
 v_mfma_f32_32x32x16_bf16 a[64:79], v[16:19], v[36:39], a[64:79]
 v_mfma_f32_32x32x16_bf16 a[80:95], v[16:19], v[40:43], a[80:95]
 s_waitcnt lgkmcnt(0)
 v_mfma_f32_32x32x16_bf16 a[0:15], v[48:51], v[44:47], a[0:15]
 v_mfma_f32_32x32x16_bf16 a[16:31], v[52:55], v[44:47], a[16:31]
 v_mfma_f32_32x32x16_bf16 a[32:47], v[56:59], v[44:47], a[32:47]
 s_add_u32 s35, s35, 1
 s_cmp_eq_u32 s35, 5
 s_cselect_b32 s34, 0xfffec000, s50
 s_cselect_b32 s35, 0, s35
 v_add_u32 v5, s34, v5
 v_add_u32 v6, s34, v6
 v_add_u32 v7, s34, v7
 s_waitcnt vmcnt(0)
 s_barrier
 ds_read_b128 v[16:19], v5 offset:0
 ds_read_b64_tr_b16 v[20:21], v6 offset:0
 ds_read_b64_tr_b16 v[22:23], v6 offset:512
 ds_read_b64_tr_b16 v[24:25], v7 offset:0
 ds_read_b64_tr_b16 v[26:27], v7 offset:512
 ds_read_b64_tr_b16 v[28:29], v6 offset:4096
 ds_read_b64_tr_b16 v[30:31], v6 offset:4608
 ds_read_b64_tr_b16 v[32:33], v7 offset:4096
 ds_read_b64_tr_b16 v[34:35], v7 offset:4608
 v_mfma_f32_32x32x16_bf16 a[48:63], v[60:63], v[44:47], a[48:63]
 ds_read_b64_tr_b16 v[36:37], v6 offset:8192
 ds_read_b64_tr_b16 v[38:39], v6 offset:8704
 ds_read_b64_tr_b16 v[40:41], v7 offset:8192
 ds_read_b64_tr_b16 v[42:43], v7 offset:8704
 v_mfma_f32_32x32x16_bf16 a[64:79], v[44:47], v[64:67], a[64:79]
 v_mfma_f32_32x32x16_bf16 a[80:95], v[44:47], v[68:71], a[80:95]
 s_waitcnt lgkmcnt(0)
 v_mfma_f32_32x32x16_bf16 a[0:15], v[20:23], v[16:19], a[0:15]
 ds_read_b128 v[44:47], v5 offset:1024
 ds_read_b64_tr_b16 v[48:49], v6 offset:2048
 ds_read_b64_tr_b16 v[50:51], v6 offset:2560
 ds_read_b64_tr_b16 v[52:53], v7 offset:2048
 ds_read_b64_tr_b16 v[54:55], v7 offset:2560
 v_mfma_f32_32x32x16_bf16 a[16:31], v[24:27], v[16:19], a[16:31]
 ds_read_b64_tr_b16 v[56:57], v6 offset:6144
 ds_read_b64_tr_b16 v[58:59], v6 offset:6656
 ds_read_b64_tr_b16 v[60:61], v7 offset:6144
 ds_read_b64_tr_b16 v[62:63], v7 offset:6656
 v_mfma_f32_32x32x16_bf16 a[32:47], v[28:31], v[16:19], a[32:47]
 ds_read_b64_tr_b16 v[64:65], v6 offset:10240
 ds_read_b64_tr_b16 v[66:67], v6 offset:10752
 ds_read_b64_tr_b16 v[68:69], v7 offset:10240
 ds_read_b64_tr_b16 v[70:71], v7 offset:10752
 v_mfma_f32_32x32x16_bf16 a[48:63], v[32:35], v[16:19], a[48:63]
 v_mfma_f32_32x32x16_bf16 a[64:79], v[16:19], v[36:39], a[64:79]
 v_mfma_f32_32x32x16_bf16 a[80:95], v[16:19], v[40:43], a[80:95]
 s_waitcnt lgkmcnt(0)
 v_mfma_f32_32x32x16_bf16 a[0:15], v[48:51], v[44:47], a[0:15]
 v_mfma_f32_32x32x16_bf16 a[16:31], v[52:55], v[44:47], a[16:31]
 v_mfma_f32_32x32x16_bf16 a[32:47], v[56:59], v[44:47], a[32:47]
 v_mfma_f32_32x32x16_bf16 a[48:63], v[60:63], v[44:47], a[48:63]
 v_mfma_f32_32x32x16_bf16 a[64:79], v[44:47], v[64:67], a[64:79]
 v_mfma_f32_32x32x16_bf16 a[80:95], v[44:47], v[68:71], a[80:95]
t_qkv_epi:
 s_nop 7
 s_mul_i32 s52, s25, 4
 s_mul_i32 s37, s24, 1
 s_add_u32 s52, s52, s37
 s_lshl_b32 s52, s52, 5
 s_lshr_b32 s37, s26, 1
 s_add_u32 s52, s52, s37
 s_lshl_b32 s52, s52, 13
 s_and_b32 s37, s26, 1
 s_lshl_b32 s53, s37, 12
 s_add_u32 s53, s53, s52
 s_lshl_b32 s37, s37, 7
 s_add_u32 s52, s52, s37
 s_nop 3

 v_accvgpr_read_b32 v80, a32
 v_accvgpr_read_b32 v81, a33
 v_accvgpr_read_b32 v82, a34
 v_accvgpr_read_b32 v83, a35
 v_accvgpr_read_b32 v84, a36
 v_accvgpr_read_b32 v85, a37
 v_accvgpr_read_b32 v86, a38
 v_accvgpr_read_b32 v87, a39
 v_accvgpr_read_b32 v88, a40
 v_accvgpr_read_b32 v89, a41
 v_accvgpr_read_b32 v90, a42
 v_accvgpr_read_b32 v91, a43
 v_accvgpr_read_b32 v92, a44
 v_accvgpr_read_b32 v93, a45
 v_accvgpr_read_b32 v94, a46
 v_accvgpr_read_b32 v95, a47
 v_cvt_pk_bf16_f32 v96, v80, v81
 v_cvt_pk_bf16_f32 v97, v82, v83
 v_cvt_pk_bf16_f32 v98, v84, v85
 v_cvt_pk_bf16_f32 v99, v86, v87
 v_cvt_pk_bf16_f32 v100, v88, v89
 v_cvt_pk_bf16_f32 v101, v90, v91
 v_cvt_pk_bf16_f32 v102, v92, v93
 v_cvt_pk_bf16_f32 v103, v94, v95
 ds_write_b64 v74, v[96:97] offset:0
 ds_write_b64 v74, v[98:99] offset:16
 ds_write_b64 v74, v[100:101] offset:32
 ds_write_b64 v74, v[102:103] offset:48
 v_accvgpr_read_b32 v104, a48
 v_accvgpr_read_b32 v105, a49
 v_accvgpr_read_b32 v106, a50
 v_accvgpr_read_b32 v107, a51
 v_accvgpr_read_b32 v108, a52
 v_accvgpr_read_b32 v109, a53
 v_accvgpr_read_b32 v110, a54
 v_accvgpr_read_b32 v111, a55
 v_accvgpr_read_b32 v112, a56
 v_accvgpr_read_b32 v113, a57
 v_accvgpr_read_b32 v114, a58
 v_accvgpr_read_b32 v115, a59
 v_accvgpr_read_b32 v116, a60
 v_accvgpr_read_b32 v117, a61
 v_accvgpr_read_b32 v118, a62
 v_accvgpr_read_b32 v119, a63
 v_cvt_pk_bf16_f32 v120, v104, v105
 v_cvt_pk_bf16_f32 v121, v106, v107
 v_cvt_pk_bf16_f32 v122, v108, v109
 v_cvt_pk_bf16_f32 v123, v110, v111
 v_cvt_pk_bf16_f32 v124, v112, v113
 v_cvt_pk_bf16_f32 v125, v114, v115
 v_cvt_pk_bf16_f32 v126, v116, v117
 v_cvt_pk_bf16_f32 v127, v118, v119
 ds_write_b64 v74, v[120:121] offset:64
 ds_write_b64 v74, v[122:123] offset:80
 ds_write_b64 v74, v[124:125] offset:96
 ds_write_b64 v74, v[126:127] offset:112
 s_waitcnt lgkmcnt(0)
 ds_read_b128 v[128:131], v76 offset:0
 ds_read_b128 v[132:135], v76 offset:32
 ds_read_b128 v[136:139], v76 offset:64
 ds_read_b128 v[140:143], v76 offset:96
 v_accvgpr_read_b32 v80, a64
 v_accvgpr_read_b32 v81, a65
 v_accvgpr_read_b32 v82, a66
 v_accvgpr_read_b32 v83, a67
 v_accvgpr_read_b32 v84, a68
 v_accvgpr_read_b32 v85, a69
 v_accvgpr_read_b32 v86, a70
 v_accvgpr_read_b32 v87, a71
 v_accvgpr_read_b32 v88, a72
 v_accvgpr_read_b32 v89, a73
 v_accvgpr_read_b32 v90, a74
 v_accvgpr_read_b32 v91, a75
 v_accvgpr_read_b32 v92, a76
 v_accvgpr_read_b32 v93, a77
 v_accvgpr_read_b32 v94, a78
 v_accvgpr_read_b32 v95, a79
 v_cvt_pk_bf16_f32 v96, v80, v81
 v_cvt_pk_bf16_f32 v97, v82, v83
 v_cvt_pk_bf16_f32 v98, v84, v85
 v_cvt_pk_bf16_f32 v99, v86, v87
 v_cvt_pk_bf16_f32 v100, v88, v89
 v_cvt_pk_bf16_f32 v101, v90, v91
 v_cvt_pk_bf16_f32 v102, v92, v93
 v_cvt_pk_bf16_f32 v103, v94, v95
 ds_write_b64 v75, v[96:97] offset:6144
 ds_write_b64 v75, v[98:99] offset:6160
 ds_write_b64 v75, v[100:101] offset:6176
 ds_write_b64 v75, v[102:103] offset:6192
 v_accvgpr_read_b32 v104, a80
 v_accvgpr_read_b32 v105, a81
 v_accvgpr_read_b32 v106, a82
 v_accvgpr_read_b32 v107, a83
 v_accvgpr_read_b32 v108, a84
 v_accvgpr_read_b32 v109, a85
 v_accvgpr_read_b32 v110, a86
 v_accvgpr_read_b32 v111, a87
 v_accvgpr_read_b32 v112, a88
 v_accvgpr_read_b32 v113, a89
 v_accvgpr_read_b32 v114, a90
 v_accvgpr_read_b32 v115, a91
 v_accvgpr_read_b32 v116, a92
 v_accvgpr_read_b32 v117, a93
 v_accvgpr_read_b32 v118, a94
 v_accvgpr_read_b32 v119, a95
 v_cvt_pk_bf16_f32 v120, v104, v105
 v_cvt_pk_bf16_f32 v121, v106, v107
 v_cvt_pk_bf16_f32 v122, v108, v109
 v_cvt_pk_bf16_f32 v123, v110, v111
 v_cvt_pk_bf16_f32 v124, v112, v113
 v_cvt_pk_bf16_f32 v125, v114, v115
 v_cvt_pk_bf16_f32 v126, v116, v117
 v_cvt_pk_bf16_f32 v127, v118, v119
 ds_write_b64 v75, v[120:121] offset:8704
 ds_write_b64 v75, v[122:123] offset:8720
 ds_write_b64 v75, v[124:125] offset:8736
 ds_write_b64 v75, v[126:127] offset:8752
 s_waitcnt lgkmcnt(8)
 s_add_u32 s36, s53, 20971520
 buffer_store_dwordx4 v[128:131], v73, s[4:7], s36 offen offset:0 sc1
 buffer_store_dwordx4 v[132:135], v73, s[4:7], s36 offen offset:1024 sc1
 buffer_store_dwordx4 v[136:139], v73, s[4:7], s36 offen offset:2048 sc1
 buffer_store_dwordx4 v[140:143], v73, s[4:7], s36 offen offset:3072 sc1
 s_waitcnt lgkmcnt(0)
 ds_read_b128 v[144:147], v77 offset:6144
 ds_read_b128 v[148:151], v77 offset:6176
 ds_read_b128 v[152:155], v77 offset:8704
 ds_read_b128 v[156:159], v77 offset:8736
 v_accvgpr_read_b32 v80, a0
 v_accvgpr_read_b32 v81, a1
 v_accvgpr_read_b32 v82, a2
 v_accvgpr_read_b32 v83, a3
 v_accvgpr_read_b32 v84, a4
 v_accvgpr_read_b32 v85, a5
 v_accvgpr_read_b32 v86, a6
 v_accvgpr_read_b32 v87, a7
 v_accvgpr_read_b32 v88, a8
 v_accvgpr_read_b32 v89, a9
 v_accvgpr_read_b32 v90, a10
 v_accvgpr_read_b32 v91, a11
 v_accvgpr_read_b32 v92, a12
 v_accvgpr_read_b32 v93, a13
 v_accvgpr_read_b32 v94, a14
 v_accvgpr_read_b32 v95, a15
 v_cvt_pk_bf16_f32 v96, v80, v81
 v_cvt_pk_bf16_f32 v97, v82, v83
 v_cvt_pk_bf16_f32 v98, v84, v85
 v_cvt_pk_bf16_f32 v99, v86, v87
 v_cvt_pk_bf16_f32 v100, v88, v89
 v_cvt_pk_bf16_f32 v101, v90, v91
 v_cvt_pk_bf16_f32 v102, v92, v93
 v_cvt_pk_bf16_f32 v103, v94, v95
 ds_write_b64 v74, v[96:97] offset:0
 ds_write_b64 v74, v[98:99] offset:16
 ds_write_b64 v74, v[100:101] offset:32
 ds_write_b64 v74, v[102:103] offset:48
 v_accvgpr_read_b32 v104, a16
 v_accvgpr_read_b32 v105, a17
 v_accvgpr_read_b32 v106, a18
 v_accvgpr_read_b32 v107, a19
 v_accvgpr_read_b32 v108, a20
 v_accvgpr_read_b32 v109, a21
 v_accvgpr_read_b32 v110, a22
 v_accvgpr_read_b32 v111, a23
 v_accvgpr_read_b32 v112, a24
 v_accvgpr_read_b32 v113, a25
 v_accvgpr_read_b32 v114, a26
 v_accvgpr_read_b32 v115, a27
 v_accvgpr_read_b32 v116, a28
 v_accvgpr_read_b32 v117, a29
 v_accvgpr_read_b32 v118, a30
 v_accvgpr_read_b32 v119, a31
 v_cvt_pk_bf16_f32 v120, v104, v105
 v_cvt_pk_bf16_f32 v121, v106, v107
 v_cvt_pk_bf16_f32 v122, v108, v109
 v_cvt_pk_bf16_f32 v123, v110, v111
 v_cvt_pk_bf16_f32 v124, v112, v113
 v_cvt_pk_bf16_f32 v125, v114, v115
 v_cvt_pk_bf16_f32 v126, v116, v117
 v_cvt_pk_bf16_f32 v127, v118, v119
 ds_write_b64 v74, v[120:121] offset:64
 ds_write_b64 v74, v[122:123] offset:80
 ds_write_b64 v74, v[124:125] offset:96
 ds_write_b64 v74, v[126:127] offset:112
 s_waitcnt lgkmcnt(8)
 s_add_u32 s36, s53, 37748736
 buffer_store_dwordx4 v[144:147], v73, s[4:7], s36 offen offset:0 sc1
 buffer_store_dwordx4 v[148:151], v73, s[4:7], s36 offen offset:1024 sc1
 buffer_store_dwordx4 v[152:155], v73, s[4:7], s36 offen offset:2048 sc1
 buffer_store_dwordx4 v[156:159], v73, s[4:7], s36 offen offset:3072 sc1
 s_waitcnt lgkmcnt(0)
 ds_read_b128 v[128:131], v76 offset:0
 ds_read_b128 v[132:135], v76 offset:32
 ds_read_b128 v[136:139], v76 offset:64
 ds_read_b128 v[140:143], v76 offset:96
 s_waitcnt lgkmcnt(0)
 s_add_u32 s36, s53, 4194304
 buffer_store_dwordx4 v[128:131], v73, s[4:7], s36 offen offset:0 sc1
 buffer_store_dwordx4 v[132:135], v73, s[4:7], s36 offen offset:1024 sc1
 buffer_store_dwordx4 v[136:139], v73, s[4:7], s36 offen offset:2048 sc1
 buffer_store_dwordx4 v[140:143], v73, s[4:7], s36 offen offset:3072 sc1
t_qkv_exit:
 s_add_u32 s26, s26, 1
 s_mov_b32 s79, 0
 s_cmp_lg_u32 s78, 0
 s_cbranch_scc1 t_qkv_tile
 s_branch mega_done

t_qkv2:
 s_load_dwordx2 s[40:41], s[0:1], 96
 s_load_dwordx2 s[42:43], s[0:1], 16
 s_load_dwordx2 s[44:45], s[0:1], 24
 s_load_dwordx2 s[46:47], s[0:1], 32
 v_and_b32 v1, 63, v0
 v_lshrrev_b32 v10, 6, v0
 s_mov_b32 s25, s92
 v_readfirstlane_b32 s24, v10
 s_mov_b32 s26, s93
 s_and_b32 s27, s24, 3
 s_lshr_b32 s36, s24, 2
 s_and_b32 s28, s36, 0
 s_lshr_b32 s29, s36, 0

 v_lshlrev_b32 v10, 4, v1
 s_mul_i32 s36, s24, 4
 s_add_u32 s36, s36, 0
 s_lshr_b32 s37, s36, 1
 s_and_b32 s36, s36, 1
 s_mul_i32 s38, s25, 8
 s_add_u32 s37, s37, s38
 s_mul_i32 s37, s37, 65536
 s_lshl_b32 s36, s36, 10
 s_add_u32 s36, s36, s37
 v_add_u32 v2, s36, v10

 s_mul_i32 s36, s24, 4
 s_add_u32 s36, s36, 1
 s_lshr_b32 s37, s36, 1
 s_and_b32 s36, s36, 1
 s_mul_i32 s38, s25, 8
 s_add_u32 s37, s37, s38
 s_mul_i32 s37, s37, 65536
 s_lshl_b32 s36, s36, 10
 s_add_u32 s36, s36, s37
 v_add_u32 v3, s36, v10

 s_mul_i32 s36, s24, 4
 s_add_u32 s36, s36, 2
 s_lshr_b32 s37, s36, 1
 s_and_b32 s36, s36, 1
 s_mul_i32 s38, s25, 8
 s_add_u32 s37, s37, s38
 s_mul_i32 s37, s37, 65536
 s_lshl_b32 s36, s36, 10
 s_add_u32 s36, s36, s37
 v_add_u32 v4, s36, v10

 s_mul_i32 s36, s24, 4
 s_add_u32 s36, s36, 3
 s_lshr_b32 s37, s36, 1
 s_and_b32 s36, s36, 1
 s_mul_i32 s38, s25, 8
 s_add_u32 s37, s37, s38
 s_mul_i32 s37, s37, 65536
 s_lshl_b32 s36, s36, 10
 s_add_u32 s36, s36, s37
 v_add_u32 v5, s36, v10

 s_mul_i32 s36, s24, 64
 v_add_u32 v10, s36, v1

 v_lshrrev_b32 v11, 3, v10
 v_and_b32 v12, 7, v10
 v_bfe_u32 v13, v11, 1, 1
 v_lshlrev_b32 v13, 2, v13
 v_xor_b32 v12, v12, v13

 v_mul_u32_u24 v11, 8192, v11
 v_lshl_add_u32 v6, v12, 4, v11
 s_mov_b32 s30, 0
 s_mul_i32 s63, s26, 128
 s_add_u32 s63, s63, 0
 s_mov_b32 s31, s63
 s_mul_i32 s32, s24, 4096
 s_mul_i32 s51, s24, 1024
 s_mov_b32 s35, 0
 s_mov_b32 s50, 28672
 s_mov_b32 s62, 32
 s_mov_b32 s78, s89
 s_mov_b32 s79, 1
 s_waitcnt lgkmcnt(0)

 s_mov_b32 s4, s40
 s_and_b32 s5, s41, 0xffff
 s_mov_b32 s6, 0x10000000
 s_mov_b32 s7, 0x00020000
 s_mov_b32 s8, s42
 s_and_b32 s9, s43, 0xffff
 s_mov_b32 s10, 0x800000
 s_mov_b32 s11, 0x00020000
 s_mov_b32 s12, s44
 s_and_b32 s13, s45, 0xffff
 s_mov_b32 s14, 0x800000
 s_mov_b32 s15, 0x00020000
 s_mov_b32 s16, s46
 s_and_b32 s17, s47, 0xffff
 s_mov_b32 s18, 0x800000
 s_mov_b32 s19, 0x00020000
 s_add_u32 m0, s32, 0
 s_nop 0
 buffer_load_dwordx4 v2, s[4:7], s30 offen sc1 lds
 s_add_u32 m0, s32, 1024
 s_nop 0
 buffer_load_dwordx4 v3, s[4:7], s30 offen sc1 lds
 s_add_u32 m0, s32, 2048
 s_nop 0
 buffer_load_dwordx4 v4, s[4:7], s30 offen sc1 lds
 s_add_u32 m0, s32, 3072
 s_nop 0
 buffer_load_dwordx4 v5, s[4:7], s30 offen sc1 lds
 s_add_u32 m0, s51, 16384
 s_nop 0
 buffer_load_dwordx4 v6, s[8:11], s31 offen lds
 s_add_u32 m0, s51, 20480
 s_nop 0
 buffer_load_dwordx4 v6, s[12:15], s31 offen lds
 s_add_u32 m0, s51, 24576
 s_nop 0
 buffer_load_dwordx4 v6, s[16:19], s31 offen lds
 s_add_u32 s30, s30, 2048
 s_add_u32 s31, s31, 262144
 s_add_u32 s32, s32, 28672
 s_add_u32 s51, s51, 28672
 s_cmp_ge_u32 s32, 114688
 s_cselect_b32 s38, 114688, 0
 s_sub_u32 s32, s32, s38
 s_sub_u32 s51, s51, s38
 s_sub_u32 s62, s62, 1
 s_cmp_eq_u32 s62, 0
 s_cselect_b32 s38, 128, 0
 s_cselect_b32 s30, 0, s30
 s_cselect_b32 s62, 32, s62
 s_add_u32 s63, s63, s38
 s_cmp_lg_u32 s38, 0
 s_cselect_b32 s31, s63, s31
 s_mul_i32 s36, s27, 4096
 s_mul_i32 s37, s29, 2048
 s_add_u32 s36, s36, s37
 v_lshlrev_b32 v10, 4, v1
 v_add_u32 v7, s36, v10

 v_bfe_u32 v10, v1, 2, 2
 v_lshrrev_b32 v11, 5, v1
 v_lshl_add_u32 v11, v11, 3, v10
 s_mul_i32 s36, s29, 32
 v_add_u32 v11, s36, v11
 v_mul_u32_u24 v11, 128, v11
 v_bfe_u32 v12, v1, 4, 1
 v_lshl_add_u32 v11, v12, 5, v11
 v_and_b32 v12, 3, v1
 v_lshl_add_u32 v11, v12, 3, v11
 v_add_u32 v11, 16384, v11
 v_bfe_u32 v13, v10, 1, 1

 s_mul_i32 s36, s28, 2
 s_add_u32 s36, s36, 0
 v_xor_b32 v12, s36, v13
 v_lshl_add_u32 v8, v12, 6, v11
 s_mul_i32 s36, s28, 2
 s_add_u32 s36, s36, 1
 v_xor_b32 v12, s36, v13
 v_lshl_add_u32 v9, v12, 6, v11
 s_add_u32 m0, s32, 0
 s_nop 0
 buffer_load_dwordx4 v2, s[4:7], s30 offen sc1 lds
 s_add_u32 m0, s32, 1024
 s_nop 0
 buffer_load_dwordx4 v3, s[4:7], s30 offen sc1 lds
 s_add_u32 m0, s32, 2048
 s_nop 0
 buffer_load_dwordx4 v4, s[4:7], s30 offen sc1 lds
 s_add_u32 m0, s32, 3072
 s_nop 0
 buffer_load_dwordx4 v5, s[4:7], s30 offen sc1 lds
 s_add_u32 m0, s51, 16384
 s_nop 0
 buffer_load_dwordx4 v6, s[8:11], s31 offen lds
 s_add_u32 m0, s51, 20480
 s_nop 0
 buffer_load_dwordx4 v6, s[12:15], s31 offen lds
 s_add_u32 m0, s51, 24576
 s_nop 0
 buffer_load_dwordx4 v6, s[16:19], s31 offen lds
 s_add_u32 s30, s30, 2048
 s_add_u32 s31, s31, 262144
 s_add_u32 s32, s32, 28672
 s_add_u32 s51, s51, 28672
 s_cmp_ge_u32 s32, 114688
 s_cselect_b32 s38, 114688, 0
 s_sub_u32 s32, s32, s38
 s_sub_u32 s51, s51, s38
 s_sub_u32 s62, s62, 1
 s_cmp_eq_u32 s62, 0
 s_cselect_b32 s38, 128, 0
 s_cselect_b32 s30, 0, s30
 s_cselect_b32 s62, 32, s62
 s_add_u32 s63, s63, s38
 s_cmp_lg_u32 s38, 0
 s_cselect_b32 s31, s63, s31
 s_add_u32 m0, s32, 0
 s_nop 0
 buffer_load_dwordx4 v2, s[4:7], s30 offen sc1 lds
 s_add_u32 m0, s32, 1024
 s_nop 0
 buffer_load_dwordx4 v3, s[4:7], s30 offen sc1 lds
 s_add_u32 m0, s32, 2048
 s_nop 0
 buffer_load_dwordx4 v4, s[4:7], s30 offen sc1 lds
 s_add_u32 m0, s32, 3072
 s_nop 0
 buffer_load_dwordx4 v5, s[4:7], s30 offen sc1 lds
 s_add_u32 m0, s51, 16384
 s_nop 0
 buffer_load_dwordx4 v6, s[8:11], s31 offen lds
 s_add_u32 m0, s51, 20480
 s_nop 0
 buffer_load_dwordx4 v6, s[12:15], s31 offen lds
 s_add_u32 m0, s51, 24576
 s_nop 0
 buffer_load_dwordx4 v6, s[16:19], s31 offen lds
 s_add_u32 s30, s30, 2048
 s_add_u32 s31, s31, 262144
 s_add_u32 s32, s32, 28672
 s_add_u32 s51, s51, 28672
 s_cmp_ge_u32 s32, 114688
 s_cselect_b32 s38, 114688, 0
 s_sub_u32 s32, s32, s38
 s_sub_u32 s51, s51, s38
 s_sub_u32 s62, s62, 1
 s_cmp_eq_u32 s62, 0
 s_cselect_b32 s38, 128, 0
 s_cselect_b32 s30, 0, s30
 s_cselect_b32 s62, 32, s62
 s_add_u32 s63, s63, s38
 s_cmp_lg_u32 s38, 0
 s_cselect_b32 s31, s63, s31
 s_mul_i32 s37, s24, 12288
 s_add_u32 s37, s37, 114688
 v_lshlrev_b32 v81, 4, v1
 v_and_b32 v88, 31, v1
 v_lshrrev_b32 v89, 5, v1
 v_mul_u32_u24 v84, 144, v88
 v_lshl_add_u32 v84, v89, 4, v84
 v_add_u32 v84, s37, v84
 v_mul_u32_u24 v85, 80, v88
 v_lshl_add_u32 v85, v89, 4, v85
 v_add_u32 v85, s37, v85
 v_and_b32 v88, 31, v1
 v_lshrrev_b32 v89, 5, v1
 v_mul_u32_u24 v82, 144, v88
 v_lshl_add_u32 v82, v89, 3, v82
 v_add_u32 v82, s37, v82
 v_mul_u32_u24 v83, 80, v88
 v_lshl_add_u32 v83, v89, 3, v83
 v_add_u32 v83, s37, v83

 s_waitcnt vmcnt(14)
 s_barrier
 ds_read_b128 v[16:19], v7 offset:0
 ds_read_b128 v[20:23], v7 offset:2048
 ds_read_b64_tr_b16 v[24:25], v8 offset:0
 ds_read_b64_tr_b16 v[26:27], v8 offset:512
 ds_read_b64_tr_b16 v[28:29], v9 offset:0
 ds_read_b64_tr_b16 v[30:31], v9 offset:512
 ds_read_b64_tr_b16 v[32:33], v8 offset:4096
 ds_read_b64_tr_b16 v[34:35], v8 offset:4608
 ds_read_b64_tr_b16 v[36:37], v9 offset:4096
 ds_read_b64_tr_b16 v[38:39], v9 offset:4608
 ds_read_b64_tr_b16 v[40:41], v8 offset:8192
 ds_read_b64_tr_b16 v[42:43], v8 offset:8704
 ds_read_b64_tr_b16 v[44:45], v9 offset:8192
 ds_read_b64_tr_b16 v[46:47], v9 offset:8704
t_qkv2_tile:
 s_sub_u32 s78, s78, 1
 s_cmp_eq_u32 s78, 0
 s_cselect_b32 s33, 4, 1
 s_sub_u32 s33, 32, s33

 s_waitcnt lgkmcnt(0)
 v_mfma_f32_32x32x16_bf16 a[0:15], v[24:27], v[16:19], 0
 ds_read_b128 v[48:51], v7 offset:1024
 ds_read_b128 v[52:55], v7 offset:3072
 ds_read_b64_tr_b16 v[56:57], v8 offset:2048
 v_mfma_f32_32x32x16_bf16 a[16:31], v[24:27], v[20:23], 0
 ds_read_b64_tr_b16 v[58:59], v8 offset:2560
 ds_read_b64_tr_b16 v[60:61], v9 offset:2048
 v_mfma_f32_32x32x16_bf16 a[32:47], v[28:31], v[16:19], 0
 ds_read_b64_tr_b16 v[62:63], v9 offset:2560
 ds_read_b64_tr_b16 v[64:65], v8 offset:6144
 s_add_u32 m0, s32, 0
 s_nop 0
 buffer_load_dwordx4 v2, s[4:7], s30 offen sc1 lds
 v_mfma_f32_32x32x16_bf16 a[48:63], v[28:31], v[20:23], 0
 ds_read_b64_tr_b16 v[66:67], v8 offset:6656
 ds_read_b64_tr_b16 v[68:69], v9 offset:6144
 ds_read_b64_tr_b16 v[70:71], v9 offset:6656
 v_mfma_f32_32x32x16_bf16 a[64:79], v[32:35], v[16:19], 0
 ds_read_b64_tr_b16 v[72:73], v8 offset:10240
 ds_read_b64_tr_b16 v[74:75], v8 offset:10752
 s_add_u32 m0, s32, 1024
 s_nop 0
 buffer_load_dwordx4 v3, s[4:7], s30 offen sc1 lds
 v_mfma_f32_32x32x16_bf16 a[80:95], v[32:35], v[20:23], 0
 ds_read_b64_tr_b16 v[76:77], v9 offset:10240
 ds_read_b64_tr_b16 v[78:79], v9 offset:10752
 v_mfma_f32_32x32x16_bf16 a[96:111], v[36:39], v[16:19], 0
 v_mfma_f32_32x32x16_bf16 a[112:127], v[36:39], v[20:23], 0
 s_add_u32 m0, s32, 2048
 s_nop 0
 buffer_load_dwordx4 v4, s[4:7], s30 offen sc1 lds
 v_mfma_f32_32x32x16_bf16 a[128:143], v[16:19], v[40:43], 0
 v_mfma_f32_32x32x16_bf16 a[144:159], v[20:23], v[40:43], 0
 s_add_u32 m0, s32, 3072
 s_nop 0
 buffer_load_dwordx4 v5, s[4:7], s30 offen sc1 lds
 v_mfma_f32_32x32x16_bf16 a[160:175], v[16:19], v[44:47], 0
 v_mfma_f32_32x32x16_bf16 a[176:191], v[20:23], v[44:47], 0
 s_waitcnt lgkmcnt(0)
 v_mfma_f32_32x32x16_bf16 a[0:15], v[56:59], v[48:51], a[0:15]
 s_add_u32 m0, s51, 16384
 s_nop 0
 buffer_load_dwordx4 v6, s[8:11], s31 offen lds
 v_mfma_f32_32x32x16_bf16 a[16:31], v[56:59], v[52:55], a[16:31]
 v_mfma_f32_32x32x16_bf16 a[32:47], v[60:63], v[48:51], a[32:47]
 s_add_u32 m0, s51, 20480
 s_nop 0
 buffer_load_dwordx4 v6, s[12:15], s31 offen lds
 v_mfma_f32_32x32x16_bf16 a[48:63], v[60:63], v[52:55], a[48:63]
 v_mfma_f32_32x32x16_bf16 a[64:79], v[64:67], v[48:51], a[64:79]
 s_add_u32 m0, s51, 24576
 s_nop 0
 buffer_load_dwordx4 v6, s[16:19], s31 offen lds
 s_add_u32 s30, s30, 2048
 s_add_u32 s31, s31, 262144
 s_add_u32 s32, s32, 28672
 s_add_u32 s51, s51, 28672
 s_cmp_ge_u32 s32, 114688
 s_cselect_b32 s38, 114688, 0
 s_sub_u32 s32, s32, s38
 s_sub_u32 s51, s51, s38
 s_sub_u32 s62, s62, 1
 s_cmp_eq_u32 s62, 0
 s_cselect_b32 s38, 128, 0
 s_cselect_b32 s30, 0, s30
 s_cselect_b32 s62, 32, s62
 s_add_u32 s63, s63, s38
 s_cmp_lg_u32 s38, 0
 s_cselect_b32 s31, s63, s31
 v_mfma_f32_32x32x16_bf16 a[80:95], v[64:67], v[52:55], a[80:95]
 s_add_u32 s35, s35, 1
 s_cmp_eq_u32 s35, 4
 s_cselect_b32 s34, 0xfffeb000, s50
 s_cselect_b32 s35, 0, s35
 v_add_u32 v7, s34, v7
 v_add_u32 v8, s34, v8
 v_add_u32 v9, s34, v9
 s_cmp_eq_u32 s79, 0
 s_cbranch_scc1 fw_152
 s_waitcnt vmcnt(14)
 s_branch fw_153
 fw_152:
 s_waitcnt vmcnt(38)
 fw_153:
 s_barrier
 ds_read_b128 v[16:19], v7 offset:0
 ds_read_b128 v[20:23], v7 offset:2048
 ds_read_b64_tr_b16 v[24:25], v8 offset:0
 ds_read_b64_tr_b16 v[26:27], v8 offset:512
 ds_read_b64_tr_b16 v[28:29], v9 offset:0
 v_mfma_f32_32x32x16_bf16 a[96:111], v[68:71], v[48:51], a[96:111]
 ds_read_b64_tr_b16 v[30:31], v9 offset:512
 ds_read_b64_tr_b16 v[32:33], v8 offset:4096
 ds_read_b64_tr_b16 v[34:35], v8 offset:4608
 ds_read_b64_tr_b16 v[36:37], v9 offset:4096
 ds_read_b64_tr_b16 v[38:39], v9 offset:4608
 v_mfma_f32_32x32x16_bf16 a[112:127], v[68:71], v[52:55], a[112:127]
 ds_read_b64_tr_b16 v[40:41], v8 offset:8192
 ds_read_b64_tr_b16 v[42:43], v8 offset:8704
 ds_read_b64_tr_b16 v[44:45], v9 offset:8192
 ds_read_b64_tr_b16 v[46:47], v9 offset:8704
 v_mfma_f32_32x32x16_bf16 a[128:143], v[48:51], v[72:75], a[128:143]
 v_mfma_f32_32x32x16_bf16 a[144:159], v[52:55], v[72:75], a[144:159]
 v_mfma_f32_32x32x16_bf16 a[160:175], v[48:51], v[76:79], a[160:175]
 v_mfma_f32_32x32x16_bf16 a[176:191], v[52:55], v[76:79], a[176:191]
 s_cmp_eq_u32 s33, 0
 s_cbranch_scc1 t_qkv2_lend
t_qkv2_loop:
 s_waitcnt lgkmcnt(0)
 v_mfma_f32_32x32x16_bf16 a[0:15], v[24:27], v[16:19], a[0:15]
 ds_read_b128 v[48:51], v7 offset:1024
 ds_read_b128 v[52:55], v7 offset:3072
 ds_read_b64_tr_b16 v[56:57], v8 offset:2048
 v_mfma_f32_32x32x16_bf16 a[16:31], v[24:27], v[20:23], a[16:31]
 ds_read_b64_tr_b16 v[58:59], v8 offset:2560
 ds_read_b64_tr_b16 v[60:61], v9 offset:2048
 v_mfma_f32_32x32x16_bf16 a[32:47], v[28:31], v[16:19], a[32:47]
 ds_read_b64_tr_b16 v[62:63], v9 offset:2560
 ds_read_b64_tr_b16 v[64:65], v8 offset:6144
 s_add_u32 m0, s32, 0
 s_nop 0
 buffer_load_dwordx4 v2, s[4:7], s30 offen sc1 lds
 v_mfma_f32_32x32x16_bf16 a[48:63], v[28:31], v[20:23], a[48:63]
 ds_read_b64_tr_b16 v[66:67], v8 offset:6656
 ds_read_b64_tr_b16 v[68:69], v9 offset:6144
 ds_read_b64_tr_b16 v[70:71], v9 offset:6656
 v_mfma_f32_32x32x16_bf16 a[64:79], v[32:35], v[16:19], a[64:79]
 ds_read_b64_tr_b16 v[72:73], v8 offset:10240
 ds_read_b64_tr_b16 v[74:75], v8 offset:10752
 s_add_u32 m0, s32, 1024
 s_nop 0
 buffer_load_dwordx4 v3, s[4:7], s30 offen sc1 lds
 v_mfma_f32_32x32x16_bf16 a[80:95], v[32:35], v[20:23], a[80:95]
 ds_read_b64_tr_b16 v[76:77], v9 offset:10240
 ds_read_b64_tr_b16 v[78:79], v9 offset:10752
 v_mfma_f32_32x32x16_bf16 a[96:111], v[36:39], v[16:19], a[96:111]
 v_mfma_f32_32x32x16_bf16 a[112:127], v[36:39], v[20:23], a[112:127]
 s_add_u32 m0, s32, 2048
 s_nop 0
 buffer_load_dwordx4 v4, s[4:7], s30 offen sc1 lds
 v_mfma_f32_32x32x16_bf16 a[128:143], v[16:19], v[40:43], a[128:143]
 v_mfma_f32_32x32x16_bf16 a[144:159], v[20:23], v[40:43], a[144:159]
 s_add_u32 m0, s32, 3072
 s_nop 0
 buffer_load_dwordx4 v5, s[4:7], s30 offen sc1 lds
 v_mfma_f32_32x32x16_bf16 a[160:175], v[16:19], v[44:47], a[160:175]
 v_mfma_f32_32x32x16_bf16 a[176:191], v[20:23], v[44:47], a[176:191]
 s_waitcnt lgkmcnt(0)
 v_mfma_f32_32x32x16_bf16 a[0:15], v[56:59], v[48:51], a[0:15]
 s_add_u32 m0, s51, 16384
 s_nop 0
 buffer_load_dwordx4 v6, s[8:11], s31 offen lds
 v_mfma_f32_32x32x16_bf16 a[16:31], v[56:59], v[52:55], a[16:31]
 v_mfma_f32_32x32x16_bf16 a[32:47], v[60:63], v[48:51], a[32:47]
 s_add_u32 m0, s51, 20480
 s_nop 0
 buffer_load_dwordx4 v6, s[12:15], s31 offen lds
 v_mfma_f32_32x32x16_bf16 a[48:63], v[60:63], v[52:55], a[48:63]
 v_mfma_f32_32x32x16_bf16 a[64:79], v[64:67], v[48:51], a[64:79]
 s_add_u32 m0, s51, 24576
 s_nop 0
 buffer_load_dwordx4 v6, s[16:19], s31 offen lds
 s_add_u32 s30, s30, 2048
 s_add_u32 s31, s31, 262144
 s_add_u32 s32, s32, 28672
 s_add_u32 s51, s51, 28672
 s_cmp_ge_u32 s32, 114688
 s_cselect_b32 s38, 114688, 0
 s_sub_u32 s32, s32, s38
 s_sub_u32 s51, s51, s38
 s_sub_u32 s62, s62, 1
 s_cmp_eq_u32 s62, 0
 s_cselect_b32 s38, 128, 0
 s_cselect_b32 s30, 0, s30
 s_cselect_b32 s62, 32, s62
 s_add_u32 s63, s63, s38
 s_cmp_lg_u32 s38, 0
 s_cselect_b32 s31, s63, s31
 v_mfma_f32_32x32x16_bf16 a[80:95], v[64:67], v[52:55], a[80:95]
 s_add_u32 s35, s35, 1
 s_cmp_eq_u32 s35, 4
 s_cselect_b32 s34, 0xfffeb000, s50
 s_cselect_b32 s35, 0, s35
 v_add_u32 v7, s34, v7
 v_add_u32 v8, s34, v8
 v_add_u32 v9, s34, v9
 s_waitcnt vmcnt(14)
 s_barrier
 ds_read_b128 v[16:19], v7 offset:0
 ds_read_b128 v[20:23], v7 offset:2048
 ds_read_b64_tr_b16 v[24:25], v8 offset:0
 ds_read_b64_tr_b16 v[26:27], v8 offset:512
 ds_read_b64_tr_b16 v[28:29], v9 offset:0
 v_mfma_f32_32x32x16_bf16 a[96:111], v[68:71], v[48:51], a[96:111]
 ds_read_b64_tr_b16 v[30:31], v9 offset:512
 ds_read_b64_tr_b16 v[32:33], v8 offset:4096
 ds_read_b64_tr_b16 v[34:35], v8 offset:4608
 ds_read_b64_tr_b16 v[36:37], v9 offset:4096
 ds_read_b64_tr_b16 v[38:39], v9 offset:4608
 v_mfma_f32_32x32x16_bf16 a[112:127], v[68:71], v[52:55], a[112:127]
 ds_read_b64_tr_b16 v[40:41], v8 offset:8192
 ds_read_b64_tr_b16 v[42:43], v8 offset:8704
 ds_read_b64_tr_b16 v[44:45], v9 offset:8192
 ds_read_b64_tr_b16 v[46:47], v9 offset:8704
 v_mfma_f32_32x32x16_bf16 a[128:143], v[48:51], v[72:75], a[128:143]
 v_mfma_f32_32x32x16_bf16 a[144:159], v[52:55], v[72:75], a[144:159]
 v_mfma_f32_32x32x16_bf16 a[160:175], v[48:51], v[76:79], a[160:175]
 v_mfma_f32_32x32x16_bf16 a[176:191], v[52:55], v[76:79], a[176:191]
 s_sub_u32 s33, s33, 1
 s_cmp_lg_u32 s33, 0
 s_cbranch_scc1 t_qkv2_loop

t_qkv2_lend:
 s_cmp_lg_u32 s78, 0
 s_cbranch_scc1 t_qkv2_epi
 s_cmp_lg_u32 s90, 0
 s_cbranch_scc1 pull_154
 v_accvgpr_write_b32 a255, 1
 v_mov_b32 v255, 0
 s_lshl_b32 s86, s100, 6
 s_add_u32 s86, s86, 159514624
 s_mov_b64 exec, 1
 buffer_atomic_add a255, v255, s[80:83], s86 offen sc0
 s_mov_b64 exec, -1

pull_154:
 s_waitcnt lgkmcnt(0)
 v_mfma_f32_32x32x16_bf16 a[0:15], v[24:27], v[16:19], a[0:15]
 ds_read_b128 v[48:51], v7 offset:1024
 ds_read_b128 v[52:55], v7 offset:3072
 ds_read_b64_tr_b16 v[56:57], v8 offset:2048
 v_mfma_f32_32x32x16_bf16 a[16:31], v[24:27], v[20:23], a[16:31]
 ds_read_b64_tr_b16 v[58:59], v8 offset:2560
 ds_read_b64_tr_b16 v[60:61], v9 offset:2048
 v_mfma_f32_32x32x16_bf16 a[32:47], v[28:31], v[16:19], a[32:47]
 ds_read_b64_tr_b16 v[62:63], v9 offset:2560
 ds_read_b64_tr_b16 v[64:65], v8 offset:6144
 v_mfma_f32_32x32x16_bf16 a[48:63], v[28:31], v[20:23], a[48:63]
 ds_read_b64_tr_b16 v[66:67], v8 offset:6656
 ds_read_b64_tr_b16 v[68:69], v9 offset:6144
 ds_read_b64_tr_b16 v[70:71], v9 offset:6656
 v_mfma_f32_32x32x16_bf16 a[64:79], v[32:35], v[16:19], a[64:79]
 ds_read_b64_tr_b16 v[72:73], v8 offset:10240
 ds_read_b64_tr_b16 v[74:75], v8 offset:10752
 v_mfma_f32_32x32x16_bf16 a[80:95], v[32:35], v[20:23], a[80:95]
 ds_read_b64_tr_b16 v[76:77], v9 offset:10240
 ds_read_b64_tr_b16 v[78:79], v9 offset:10752
 v_mfma_f32_32x32x16_bf16 a[96:111], v[36:39], v[16:19], a[96:111]
 v_mfma_f32_32x32x16_bf16 a[112:127], v[36:39], v[20:23], a[112:127]
 v_mfma_f32_32x32x16_bf16 a[128:143], v[16:19], v[40:43], a[128:143]
 v_mfma_f32_32x32x16_bf16 a[144:159], v[20:23], v[40:43], a[144:159]
 v_mfma_f32_32x32x16_bf16 a[160:175], v[16:19], v[44:47], a[160:175]
 v_mfma_f32_32x32x16_bf16 a[176:191], v[20:23], v[44:47], a[176:191]
 s_waitcnt lgkmcnt(0)
 v_mfma_f32_32x32x16_bf16 a[0:15], v[56:59], v[48:51], a[0:15]
 v_mfma_f32_32x32x16_bf16 a[16:31], v[56:59], v[52:55], a[16:31]
 v_mfma_f32_32x32x16_bf16 a[32:47], v[60:63], v[48:51], a[32:47]
 v_mfma_f32_32x32x16_bf16 a[48:63], v[60:63], v[52:55], a[48:63]
 v_mfma_f32_32x32x16_bf16 a[64:79], v[64:67], v[48:51], a[64:79]
 v_mfma_f32_32x32x16_bf16 a[80:95], v[64:67], v[52:55], a[80:95]
 s_add_u32 s35, s35, 1
 s_cmp_eq_u32 s35, 4
 s_cselect_b32 s34, 0xfffeb000, s50
 s_cselect_b32 s35, 0, s35
 v_add_u32 v7, s34, v7
 v_add_u32 v8, s34, v8
 v_add_u32 v9, s34, v9
 s_waitcnt vmcnt(7)
 s_barrier
 ds_read_b128 v[16:19], v7 offset:0
 ds_read_b128 v[20:23], v7 offset:2048
 ds_read_b64_tr_b16 v[24:25], v8 offset:0
 ds_read_b64_tr_b16 v[26:27], v8 offset:512
 ds_read_b64_tr_b16 v[28:29], v9 offset:0
 v_mfma_f32_32x32x16_bf16 a[96:111], v[68:71], v[48:51], a[96:111]
 ds_read_b64_tr_b16 v[30:31], v9 offset:512
 ds_read_b64_tr_b16 v[32:33], v8 offset:4096
 ds_read_b64_tr_b16 v[34:35], v8 offset:4608
 ds_read_b64_tr_b16 v[36:37], v9 offset:4096
 ds_read_b64_tr_b16 v[38:39], v9 offset:4608
 v_mfma_f32_32x32x16_bf16 a[112:127], v[68:71], v[52:55], a[112:127]
 ds_read_b64_tr_b16 v[40:41], v8 offset:8192
 ds_read_b64_tr_b16 v[42:43], v8 offset:8704
 ds_read_b64_tr_b16 v[44:45], v9 offset:8192
 ds_read_b64_tr_b16 v[46:47], v9 offset:8704
 v_mfma_f32_32x32x16_bf16 a[128:143], v[48:51], v[72:75], a[128:143]
 v_mfma_f32_32x32x16_bf16 a[144:159], v[52:55], v[72:75], a[144:159]
 v_mfma_f32_32x32x16_bf16 a[160:175], v[48:51], v[76:79], a[160:175]
 v_mfma_f32_32x32x16_bf16 a[176:191], v[52:55], v[76:79], a[176:191]
 s_waitcnt lgkmcnt(0)
 v_mfma_f32_32x32x16_bf16 a[0:15], v[24:27], v[16:19], a[0:15]
 ds_read_b128 v[48:51], v7 offset:1024
 ds_read_b128 v[52:55], v7 offset:3072
 ds_read_b64_tr_b16 v[56:57], v8 offset:2048
 v_mfma_f32_32x32x16_bf16 a[16:31], v[24:27], v[20:23], a[16:31]
 ds_read_b64_tr_b16 v[58:59], v8 offset:2560
 ds_read_b64_tr_b16 v[60:61], v9 offset:2048
 v_mfma_f32_32x32x16_bf16 a[32:47], v[28:31], v[16:19], a[32:47]
 ds_read_b64_tr_b16 v[62:63], v9 offset:2560
 ds_read_b64_tr_b16 v[64:65], v8 offset:6144
 v_mfma_f32_32x32x16_bf16 a[48:63], v[28:31], v[20:23], a[48:63]
 ds_read_b64_tr_b16 v[66:67], v8 offset:6656
 ds_read_b64_tr_b16 v[68:69], v9 offset:6144
 ds_read_b64_tr_b16 v[70:71], v9 offset:6656
 v_mfma_f32_32x32x16_bf16 a[64:79], v[32:35], v[16:19], a[64:79]
 ds_read_b64_tr_b16 v[72:73], v8 offset:10240
 ds_read_b64_tr_b16 v[74:75], v8 offset:10752
 v_mfma_f32_32x32x16_bf16 a[80:95], v[32:35], v[20:23], a[80:95]
 ds_read_b64_tr_b16 v[76:77], v9 offset:10240
 ds_read_b64_tr_b16 v[78:79], v9 offset:10752
 v_mfma_f32_32x32x16_bf16 a[96:111], v[36:39], v[16:19], a[96:111]
 v_mfma_f32_32x32x16_bf16 a[112:127], v[36:39], v[20:23], a[112:127]
 v_mfma_f32_32x32x16_bf16 a[128:143], v[16:19], v[40:43], a[128:143]
 v_mfma_f32_32x32x16_bf16 a[144:159], v[20:23], v[40:43], a[144:159]
 v_mfma_f32_32x32x16_bf16 a[160:175], v[16:19], v[44:47], a[160:175]
 v_mfma_f32_32x32x16_bf16 a[176:191], v[20:23], v[44:47], a[176:191]
 s_waitcnt lgkmcnt(0)
 v_mfma_f32_32x32x16_bf16 a[0:15], v[56:59], v[48:51], a[0:15]
 v_mfma_f32_32x32x16_bf16 a[16:31], v[56:59], v[52:55], a[16:31]
 v_mfma_f32_32x32x16_bf16 a[32:47], v[60:63], v[48:51], a[32:47]
 v_mfma_f32_32x32x16_bf16 a[48:63], v[60:63], v[52:55], a[48:63]
 v_mfma_f32_32x32x16_bf16 a[64:79], v[64:67], v[48:51], a[64:79]
 v_mfma_f32_32x32x16_bf16 a[80:95], v[64:67], v[52:55], a[80:95]
 s_add_u32 s35, s35, 1
 s_cmp_eq_u32 s35, 4
 s_cselect_b32 s34, 0xfffeb000, s50
 s_cselect_b32 s35, 0, s35
 v_add_u32 v7, s34, v7
 v_add_u32 v8, s34, v8
 v_add_u32 v9, s34, v9
 s_waitcnt vmcnt(0)
 s_barrier
 ds_read_b128 v[16:19], v7 offset:0
 ds_read_b128 v[20:23], v7 offset:2048
 ds_read_b64_tr_b16 v[24:25], v8 offset:0
 ds_read_b64_tr_b16 v[26:27], v8 offset:512
 ds_read_b64_tr_b16 v[28:29], v9 offset:0
 v_mfma_f32_32x32x16_bf16 a[96:111], v[68:71], v[48:51], a[96:111]
 ds_read_b64_tr_b16 v[30:31], v9 offset:512
 ds_read_b64_tr_b16 v[32:33], v8 offset:4096
 ds_read_b64_tr_b16 v[34:35], v8 offset:4608
 ds_read_b64_tr_b16 v[36:37], v9 offset:4096
 ds_read_b64_tr_b16 v[38:39], v9 offset:4608
 v_mfma_f32_32x32x16_bf16 a[112:127], v[68:71], v[52:55], a[112:127]
 ds_read_b64_tr_b16 v[40:41], v8 offset:8192
 ds_read_b64_tr_b16 v[42:43], v8 offset:8704
 ds_read_b64_tr_b16 v[44:45], v9 offset:8192
 ds_read_b64_tr_b16 v[46:47], v9 offset:8704
 v_mfma_f32_32x32x16_bf16 a[128:143], v[48:51], v[72:75], a[128:143]
 v_mfma_f32_32x32x16_bf16 a[144:159], v[52:55], v[72:75], a[144:159]
 v_mfma_f32_32x32x16_bf16 a[160:175], v[48:51], v[76:79], a[160:175]
 v_mfma_f32_32x32x16_bf16 a[176:191], v[52:55], v[76:79], a[176:191]
 s_waitcnt lgkmcnt(0)
 v_mfma_f32_32x32x16_bf16 a[0:15], v[24:27], v[16:19], a[0:15]
 ds_read_b128 v[48:51], v7 offset:1024
 ds_read_b128 v[52:55], v7 offset:3072
 ds_read_b64_tr_b16 v[56:57], v8 offset:2048
 v_mfma_f32_32x32x16_bf16 a[16:31], v[24:27], v[20:23], a[16:31]
 ds_read_b64_tr_b16 v[58:59], v8 offset:2560
 ds_read_b64_tr_b16 v[60:61], v9 offset:2048
 v_mfma_f32_32x32x16_bf16 a[32:47], v[28:31], v[16:19], a[32:47]
 ds_read_b64_tr_b16 v[62:63], v9 offset:2560
 ds_read_b64_tr_b16 v[64:65], v8 offset:6144
 v_mfma_f32_32x32x16_bf16 a[48:63], v[28:31], v[20:23], a[48:63]
 ds_read_b64_tr_b16 v[66:67], v8 offset:6656
 ds_read_b64_tr_b16 v[68:69], v9 offset:6144
 ds_read_b64_tr_b16 v[70:71], v9 offset:6656
 v_mfma_f32_32x32x16_bf16 a[64:79], v[32:35], v[16:19], a[64:79]
 ds_read_b64_tr_b16 v[72:73], v8 offset:10240
 ds_read_b64_tr_b16 v[74:75], v8 offset:10752
 v_mfma_f32_32x32x16_bf16 a[80:95], v[32:35], v[20:23], a[80:95]
 ds_read_b64_tr_b16 v[76:77], v9 offset:10240
 ds_read_b64_tr_b16 v[78:79], v9 offset:10752
 v_mfma_f32_32x32x16_bf16 a[96:111], v[36:39], v[16:19], a[96:111]
 v_mfma_f32_32x32x16_bf16 a[112:127], v[36:39], v[20:23], a[112:127]
 v_mfma_f32_32x32x16_bf16 a[128:143], v[16:19], v[40:43], a[128:143]
 v_mfma_f32_32x32x16_bf16 a[144:159], v[20:23], v[40:43], a[144:159]
 v_mfma_f32_32x32x16_bf16 a[160:175], v[16:19], v[44:47], a[160:175]
 v_mfma_f32_32x32x16_bf16 a[176:191], v[20:23], v[44:47], a[176:191]
 s_waitcnt lgkmcnt(0)
 v_mfma_f32_32x32x16_bf16 a[0:15], v[56:59], v[48:51], a[0:15]
 v_mfma_f32_32x32x16_bf16 a[16:31], v[56:59], v[52:55], a[16:31]
 v_mfma_f32_32x32x16_bf16 a[32:47], v[60:63], v[48:51], a[32:47]
 v_mfma_f32_32x32x16_bf16 a[48:63], v[60:63], v[52:55], a[48:63]
 v_mfma_f32_32x32x16_bf16 a[64:79], v[64:67], v[48:51], a[64:79]
 v_mfma_f32_32x32x16_bf16 a[80:95], v[64:67], v[52:55], a[80:95]
 v_mfma_f32_32x32x16_bf16 a[96:111], v[68:71], v[48:51], a[96:111]
 v_mfma_f32_32x32x16_bf16 a[112:127], v[68:71], v[52:55], a[112:127]
 v_mfma_f32_32x32x16_bf16 a[128:143], v[48:51], v[72:75], a[128:143]
 v_mfma_f32_32x32x16_bf16 a[144:159], v[52:55], v[72:75], a[144:159]
 v_mfma_f32_32x32x16_bf16 a[160:175], v[48:51], v[76:79], a[160:175]
 v_mfma_f32_32x32x16_bf16 a[176:191], v[52:55], v[76:79], a[176:191]
t_qkv2_epi:
 s_nop 7
 s_mul_i32 s52, s25, 8
 s_mul_i32 s37, s24, 2
 s_add_u32 s52, s52, s37
 s_lshl_b32 s52, s52, 5
 s_lshr_b32 s37, s26, 1
 s_add_u32 s52, s52, s37
 s_lshl_b32 s52, s52, 13
 s_and_b32 s37, s26, 1
 s_lshl_b32 s53, s37, 12
 s_add_u32 s53, s53, s52
 s_lshl_b32 s37, s37, 7
 s_add_u32 s52, s52, s37
 s_nop 3

 v_accvgpr_read_b32 v88, a64
 v_accvgpr_read_b32 v89, a65
 v_accvgpr_read_b32 v90, a66
 v_accvgpr_read_b32 v91, a67
 v_accvgpr_read_b32 v92, a68
 v_accvgpr_read_b32 v93, a69
 v_accvgpr_read_b32 v94, a70
 v_accvgpr_read_b32 v95, a71
 v_accvgpr_read_b32 v96, a72
 v_accvgpr_read_b32 v97, a73
 v_accvgpr_read_b32 v98, a74
 v_accvgpr_read_b32 v99, a75
 v_accvgpr_read_b32 v100, a76
 v_accvgpr_read_b32 v101, a77
 v_accvgpr_read_b32 v102, a78
 v_accvgpr_read_b32 v103, a79
 v_cvt_pk_bf16_f32 v104, v88, v89
 v_cvt_pk_bf16_f32 v105, v90, v91
 v_cvt_pk_bf16_f32 v106, v92, v93
 v_cvt_pk_bf16_f32 v107, v94, v95
 v_cvt_pk_bf16_f32 v108, v96, v97
 v_cvt_pk_bf16_f32 v109, v98, v99
 v_cvt_pk_bf16_f32 v110, v100, v101
 v_cvt_pk_bf16_f32 v111, v102, v103
 ds_write_b64 v82, v[104:105] offset:0
 ds_write_b64 v82, v[106:107] offset:16
 ds_write_b64 v82, v[108:109] offset:32
 ds_write_b64 v82, v[110:111] offset:48
 v_accvgpr_read_b32 v112, a96
 v_accvgpr_read_b32 v113, a97
 v_accvgpr_read_b32 v114, a98
 v_accvgpr_read_b32 v115, a99
 v_accvgpr_read_b32 v116, a100
 v_accvgpr_read_b32 v117, a101
 v_accvgpr_read_b32 v118, a102
 v_accvgpr_read_b32 v119, a103
 v_accvgpr_read_b32 v120, a104
 v_accvgpr_read_b32 v121, a105
 v_accvgpr_read_b32 v122, a106
 v_accvgpr_read_b32 v123, a107
 v_accvgpr_read_b32 v124, a108
 v_accvgpr_read_b32 v125, a109
 v_accvgpr_read_b32 v126, a110
 v_accvgpr_read_b32 v127, a111
 v_cvt_pk_bf16_f32 v128, v112, v113
 v_cvt_pk_bf16_f32 v129, v114, v115
 v_cvt_pk_bf16_f32 v130, v116, v117
 v_cvt_pk_bf16_f32 v131, v118, v119
 v_cvt_pk_bf16_f32 v132, v120, v121
 v_cvt_pk_bf16_f32 v133, v122, v123
 v_cvt_pk_bf16_f32 v134, v124, v125
 v_cvt_pk_bf16_f32 v135, v126, v127
 ds_write_b64 v82, v[128:129] offset:64
 ds_write_b64 v82, v[130:131] offset:80
 ds_write_b64 v82, v[132:133] offset:96
 ds_write_b64 v82, v[134:135] offset:112
 s_waitcnt lgkmcnt(0)
 ds_read_b128 v[136:139], v84 offset:0
 ds_read_b128 v[140:143], v84 offset:32
 ds_read_b128 v[144:147], v84 offset:64
 ds_read_b128 v[148:151], v84 offset:96
 v_accvgpr_read_b32 v88, a80
 v_accvgpr_read_b32 v89, a81
 v_accvgpr_read_b32 v90, a82
 v_accvgpr_read_b32 v91, a83
 v_accvgpr_read_b32 v92, a84
 v_accvgpr_read_b32 v93, a85
 v_accvgpr_read_b32 v94, a86
 v_accvgpr_read_b32 v95, a87
 v_accvgpr_read_b32 v96, a88
 v_accvgpr_read_b32 v97, a89
 v_accvgpr_read_b32 v98, a90
 v_accvgpr_read_b32 v99, a91
 v_accvgpr_read_b32 v100, a92
 v_accvgpr_read_b32 v101, a93
 v_accvgpr_read_b32 v102, a94
 v_accvgpr_read_b32 v103, a95
 v_cvt_pk_bf16_f32 v104, v88, v89
 v_cvt_pk_bf16_f32 v105, v90, v91
 v_cvt_pk_bf16_f32 v106, v92, v93
 v_cvt_pk_bf16_f32 v107, v94, v95
 v_cvt_pk_bf16_f32 v108, v96, v97
 v_cvt_pk_bf16_f32 v109, v98, v99
 v_cvt_pk_bf16_f32 v110, v100, v101
 v_cvt_pk_bf16_f32 v111, v102, v103
 ds_write_b64 v82, v[104:105] offset:6144
 ds_write_b64 v82, v[106:107] offset:6160
 ds_write_b64 v82, v[108:109] offset:6176
 ds_write_b64 v82, v[110:111] offset:6192
 v_accvgpr_read_b32 v112, a112
 v_accvgpr_read_b32 v113, a113
 v_accvgpr_read_b32 v114, a114
 v_accvgpr_read_b32 v115, a115
 v_accvgpr_read_b32 v116, a116
 v_accvgpr_read_b32 v117, a117
 v_accvgpr_read_b32 v118, a118
 v_accvgpr_read_b32 v119, a119
 v_accvgpr_read_b32 v120, a120
 v_accvgpr_read_b32 v121, a121
 v_accvgpr_read_b32 v122, a122
 v_accvgpr_read_b32 v123, a123
 v_accvgpr_read_b32 v124, a124
 v_accvgpr_read_b32 v125, a125
 v_accvgpr_read_b32 v126, a126
 v_accvgpr_read_b32 v127, a127
 v_cvt_pk_bf16_f32 v128, v112, v113
 v_cvt_pk_bf16_f32 v129, v114, v115
 v_cvt_pk_bf16_f32 v130, v116, v117
 v_cvt_pk_bf16_f32 v131, v118, v119
 v_cvt_pk_bf16_f32 v132, v120, v121
 v_cvt_pk_bf16_f32 v133, v122, v123
 v_cvt_pk_bf16_f32 v134, v124, v125
 v_cvt_pk_bf16_f32 v135, v126, v127
 ds_write_b64 v82, v[128:129] offset:6208
 ds_write_b64 v82, v[130:131] offset:6224
 ds_write_b64 v82, v[132:133] offset:6240
 ds_write_b64 v82, v[134:135] offset:6256
 s_waitcnt lgkmcnt(8)
 s_add_u32 s36, s53, 20971520
 buffer_store_dwordx4 v[136:139], v81, s[4:7], s36 offen offset:0 sc1
 buffer_store_dwordx4 v[140:143], v81, s[4:7], s36 offen offset:1024 sc1
 buffer_store_dwordx4 v[144:147], v81, s[4:7], s36 offen offset:2048 sc1
 buffer_store_dwordx4 v[148:151], v81, s[4:7], s36 offen offset:3072 sc1
 s_waitcnt lgkmcnt(0)
 ds_read_b128 v[152:155], v84 offset:6144
 ds_read_b128 v[156:159], v84 offset:6176
 ds_read_b128 v[160:163], v84 offset:6208
 ds_read_b128 v[164:167], v84 offset:6240
 v_accvgpr_read_b32 v88, a128
 v_accvgpr_read_b32 v89, a129
 v_accvgpr_read_b32 v90, a130
 v_accvgpr_read_b32 v91, a131
 v_accvgpr_read_b32 v92, a132
 v_accvgpr_read_b32 v93, a133
 v_accvgpr_read_b32 v94, a134
 v_accvgpr_read_b32 v95, a135
 v_accvgpr_read_b32 v96, a136
 v_accvgpr_read_b32 v97, a137
 v_accvgpr_read_b32 v98, a138
 v_accvgpr_read_b32 v99, a139
 v_accvgpr_read_b32 v100, a140
 v_accvgpr_read_b32 v101, a141
 v_accvgpr_read_b32 v102, a142
 v_accvgpr_read_b32 v103, a143
 v_cvt_pk_bf16_f32 v104, v88, v89
 v_cvt_pk_bf16_f32 v105, v90, v91
 v_cvt_pk_bf16_f32 v106, v92, v93
 v_cvt_pk_bf16_f32 v107, v94, v95
 v_cvt_pk_bf16_f32 v108, v96, v97
 v_cvt_pk_bf16_f32 v109, v98, v99
 v_cvt_pk_bf16_f32 v110, v100, v101
 v_cvt_pk_bf16_f32 v111, v102, v103
 ds_write_b64 v83, v[104:105] offset:0
 ds_write_b64 v83, v[106:107] offset:16
 ds_write_b64 v83, v[108:109] offset:32
 ds_write_b64 v83, v[110:111] offset:48
 v_accvgpr_read_b32 v112, a160
 v_accvgpr_read_b32 v113, a161
 v_accvgpr_read_b32 v114, a162
 v_accvgpr_read_b32 v115, a163
 v_accvgpr_read_b32 v116, a164
 v_accvgpr_read_b32 v117, a165
 v_accvgpr_read_b32 v118, a166
 v_accvgpr_read_b32 v119, a167
 v_accvgpr_read_b32 v120, a168
 v_accvgpr_read_b32 v121, a169
 v_accvgpr_read_b32 v122, a170
 v_accvgpr_read_b32 v123, a171
 v_accvgpr_read_b32 v124, a172
 v_accvgpr_read_b32 v125, a173
 v_accvgpr_read_b32 v126, a174
 v_accvgpr_read_b32 v127, a175
 v_cvt_pk_bf16_f32 v128, v112, v113
 v_cvt_pk_bf16_f32 v129, v114, v115
 v_cvt_pk_bf16_f32 v130, v116, v117
 v_cvt_pk_bf16_f32 v131, v118, v119
 v_cvt_pk_bf16_f32 v132, v120, v121
 v_cvt_pk_bf16_f32 v133, v122, v123
 v_cvt_pk_bf16_f32 v134, v124, v125
 v_cvt_pk_bf16_f32 v135, v126, v127
 ds_write_b64 v83, v[128:129] offset:2560
 ds_write_b64 v83, v[130:131] offset:2576
 ds_write_b64 v83, v[132:133] offset:2592
 ds_write_b64 v83, v[134:135] offset:2608
 s_waitcnt lgkmcnt(8)
 s_add_u32 s36, s53, 21233664
 buffer_store_dwordx4 v[152:155], v81, s[4:7], s36 offen offset:0 sc1
 buffer_store_dwordx4 v[156:159], v81, s[4:7], s36 offen offset:1024 sc1
 buffer_store_dwordx4 v[160:163], v81, s[4:7], s36 offen offset:2048 sc1
 buffer_store_dwordx4 v[164:167], v81, s[4:7], s36 offen offset:3072 sc1
 s_waitcnt lgkmcnt(0)
 ds_read_b128 v[136:139], v85 offset:0
 ds_read_b128 v[140:143], v85 offset:32
 ds_read_b128 v[144:147], v85 offset:2560
 ds_read_b128 v[148:151], v85 offset:2592
 v_accvgpr_read_b32 v88, a144
 v_accvgpr_read_b32 v89, a145
 v_accvgpr_read_b32 v90, a146
 v_accvgpr_read_b32 v91, a147
 v_accvgpr_read_b32 v92, a148
 v_accvgpr_read_b32 v93, a149
 v_accvgpr_read_b32 v94, a150
 v_accvgpr_read_b32 v95, a151
 v_accvgpr_read_b32 v96, a152
 v_accvgpr_read_b32 v97, a153
 v_accvgpr_read_b32 v98, a154
 v_accvgpr_read_b32 v99, a155
 v_accvgpr_read_b32 v100, a156
 v_accvgpr_read_b32 v101, a157
 v_accvgpr_read_b32 v102, a158
 v_accvgpr_read_b32 v103, a159
 v_cvt_pk_bf16_f32 v104, v88, v89
 v_cvt_pk_bf16_f32 v105, v90, v91
 v_cvt_pk_bf16_f32 v106, v92, v93
 v_cvt_pk_bf16_f32 v107, v94, v95
 v_cvt_pk_bf16_f32 v108, v96, v97
 v_cvt_pk_bf16_f32 v109, v98, v99
 v_cvt_pk_bf16_f32 v110, v100, v101
 v_cvt_pk_bf16_f32 v111, v102, v103
 ds_write_b64 v83, v[104:105] offset:6144
 ds_write_b64 v83, v[106:107] offset:6160
 ds_write_b64 v83, v[108:109] offset:6176
 ds_write_b64 v83, v[110:111] offset:6192
 v_accvgpr_read_b32 v112, a176
 v_accvgpr_read_b32 v113, a177
 v_accvgpr_read_b32 v114, a178
 v_accvgpr_read_b32 v115, a179
 v_accvgpr_read_b32 v116, a180
 v_accvgpr_read_b32 v117, a181
 v_accvgpr_read_b32 v118, a182
 v_accvgpr_read_b32 v119, a183
 v_accvgpr_read_b32 v120, a184
 v_accvgpr_read_b32 v121, a185
 v_accvgpr_read_b32 v122, a186
 v_accvgpr_read_b32 v123, a187
 v_accvgpr_read_b32 v124, a188
 v_accvgpr_read_b32 v125, a189
 v_accvgpr_read_b32 v126, a190
 v_accvgpr_read_b32 v127, a191
 v_cvt_pk_bf16_f32 v128, v112, v113
 v_cvt_pk_bf16_f32 v129, v114, v115
 v_cvt_pk_bf16_f32 v130, v116, v117
 v_cvt_pk_bf16_f32 v131, v118, v119
 v_cvt_pk_bf16_f32 v132, v120, v121
 v_cvt_pk_bf16_f32 v133, v122, v123
 v_cvt_pk_bf16_f32 v134, v124, v125
 v_cvt_pk_bf16_f32 v135, v126, v127
 ds_write_b64 v83, v[128:129] offset:8704
 ds_write_b64 v83, v[130:131] offset:8720
 ds_write_b64 v83, v[132:133] offset:8736
 ds_write_b64 v83, v[134:135] offset:8752
 s_waitcnt lgkmcnt(8)
 s_add_u32 s36, s53, 37748736
 buffer_store_dwordx4 v[136:139], v81, s[4:7], s36 offen offset:0 sc1
 buffer_store_dwordx4 v[140:143], v81, s[4:7], s36 offen offset:1024 sc1
 buffer_store_dwordx4 v[144:147], v81, s[4:7], s36 offen offset:2048 sc1
 buffer_store_dwordx4 v[148:151], v81, s[4:7], s36 offen offset:3072 sc1
 s_waitcnt lgkmcnt(0)
 ds_read_b128 v[152:155], v85 offset:6144
 ds_read_b128 v[156:159], v85 offset:6176
 ds_read_b128 v[160:163], v85 offset:8704
 ds_read_b128 v[164:167], v85 offset:8736
 v_accvgpr_read_b32 v88, a0
 v_accvgpr_read_b32 v89, a1
 v_accvgpr_read_b32 v90, a2
 v_accvgpr_read_b32 v91, a3
 v_accvgpr_read_b32 v92, a4
 v_accvgpr_read_b32 v93, a5
 v_accvgpr_read_b32 v94, a6
 v_accvgpr_read_b32 v95, a7
 v_accvgpr_read_b32 v96, a8
 v_accvgpr_read_b32 v97, a9
 v_accvgpr_read_b32 v98, a10
 v_accvgpr_read_b32 v99, a11
 v_accvgpr_read_b32 v100, a12
 v_accvgpr_read_b32 v101, a13
 v_accvgpr_read_b32 v102, a14
 v_accvgpr_read_b32 v103, a15
 v_cvt_pk_bf16_f32 v104, v88, v89
 v_cvt_pk_bf16_f32 v105, v90, v91
 v_cvt_pk_bf16_f32 v106, v92, v93
 v_cvt_pk_bf16_f32 v107, v94, v95
 v_cvt_pk_bf16_f32 v108, v96, v97
 v_cvt_pk_bf16_f32 v109, v98, v99
 v_cvt_pk_bf16_f32 v110, v100, v101
 v_cvt_pk_bf16_f32 v111, v102, v103
 ds_write_b64 v82, v[104:105] offset:0
 ds_write_b64 v82, v[106:107] offset:16
 ds_write_b64 v82, v[108:109] offset:32
 ds_write_b64 v82, v[110:111] offset:48
 v_accvgpr_read_b32 v112, a32
 v_accvgpr_read_b32 v113, a33
 v_accvgpr_read_b32 v114, a34
 v_accvgpr_read_b32 v115, a35
 v_accvgpr_read_b32 v116, a36
 v_accvgpr_read_b32 v117, a37
 v_accvgpr_read_b32 v118, a38
 v_accvgpr_read_b32 v119, a39
 v_accvgpr_read_b32 v120, a40
 v_accvgpr_read_b32 v121, a41
 v_accvgpr_read_b32 v122, a42
 v_accvgpr_read_b32 v123, a43
 v_accvgpr_read_b32 v124, a44
 v_accvgpr_read_b32 v125, a45
 v_accvgpr_read_b32 v126, a46
 v_accvgpr_read_b32 v127, a47
 v_cvt_pk_bf16_f32 v128, v112, v113
 v_cvt_pk_bf16_f32 v129, v114, v115
 v_cvt_pk_bf16_f32 v130, v116, v117
 v_cvt_pk_bf16_f32 v131, v118, v119
 v_cvt_pk_bf16_f32 v132, v120, v121
 v_cvt_pk_bf16_f32 v133, v122, v123
 v_cvt_pk_bf16_f32 v134, v124, v125
 v_cvt_pk_bf16_f32 v135, v126, v127
 ds_write_b64 v82, v[128:129] offset:64
 ds_write_b64 v82, v[130:131] offset:80
 ds_write_b64 v82, v[132:133] offset:96
 ds_write_b64 v82, v[134:135] offset:112
 s_waitcnt lgkmcnt(8)
 s_add_u32 s36, s53, 38010880
 buffer_store_dwordx4 v[152:155], v81, s[4:7], s36 offen offset:0 sc1
 buffer_store_dwordx4 v[156:159], v81, s[4:7], s36 offen offset:1024 sc1
 buffer_store_dwordx4 v[160:163], v81, s[4:7], s36 offen offset:2048 sc1
 buffer_store_dwordx4 v[164:167], v81, s[4:7], s36 offen offset:3072 sc1
 s_waitcnt lgkmcnt(0)
 ds_read_b128 v[136:139], v84 offset:0
 ds_read_b128 v[140:143], v84 offset:32
 ds_read_b128 v[144:147], v84 offset:64
 ds_read_b128 v[148:151], v84 offset:96
 v_accvgpr_read_b32 v88, a16
 v_accvgpr_read_b32 v89, a17
 v_accvgpr_read_b32 v90, a18
 v_accvgpr_read_b32 v91, a19
 v_accvgpr_read_b32 v92, a20
 v_accvgpr_read_b32 v93, a21
 v_accvgpr_read_b32 v94, a22
 v_accvgpr_read_b32 v95, a23
 v_accvgpr_read_b32 v96, a24
 v_accvgpr_read_b32 v97, a25
 v_accvgpr_read_b32 v98, a26
 v_accvgpr_read_b32 v99, a27
 v_accvgpr_read_b32 v100, a28
 v_accvgpr_read_b32 v101, a29
 v_accvgpr_read_b32 v102, a30
 v_accvgpr_read_b32 v103, a31
 v_cvt_pk_bf16_f32 v104, v88, v89
 v_cvt_pk_bf16_f32 v105, v90, v91
 v_cvt_pk_bf16_f32 v106, v92, v93
 v_cvt_pk_bf16_f32 v107, v94, v95
 v_cvt_pk_bf16_f32 v108, v96, v97
 v_cvt_pk_bf16_f32 v109, v98, v99
 v_cvt_pk_bf16_f32 v110, v100, v101
 v_cvt_pk_bf16_f32 v111, v102, v103
 ds_write_b64 v82, v[104:105] offset:6144
 ds_write_b64 v82, v[106:107] offset:6160
 ds_write_b64 v82, v[108:109] offset:6176
 ds_write_b64 v82, v[110:111] offset:6192
 v_accvgpr_read_b32 v112, a48
 v_accvgpr_read_b32 v113, a49
 v_accvgpr_read_b32 v114, a50
 v_accvgpr_read_b32 v115, a51
 v_accvgpr_read_b32 v116, a52
 v_accvgpr_read_b32 v117, a53
 v_accvgpr_read_b32 v118, a54
 v_accvgpr_read_b32 v119, a55
 v_accvgpr_read_b32 v120, a56
 v_accvgpr_read_b32 v121, a57
 v_accvgpr_read_b32 v122, a58
 v_accvgpr_read_b32 v123, a59
 v_accvgpr_read_b32 v124, a60
 v_accvgpr_read_b32 v125, a61
 v_accvgpr_read_b32 v126, a62
 v_accvgpr_read_b32 v127, a63
 v_cvt_pk_bf16_f32 v128, v112, v113
 v_cvt_pk_bf16_f32 v129, v114, v115
 v_cvt_pk_bf16_f32 v130, v116, v117
 v_cvt_pk_bf16_f32 v131, v118, v119
 v_cvt_pk_bf16_f32 v132, v120, v121
 v_cvt_pk_bf16_f32 v133, v122, v123
 v_cvt_pk_bf16_f32 v134, v124, v125
 v_cvt_pk_bf16_f32 v135, v126, v127
 ds_write_b64 v82, v[128:129] offset:6208
 ds_write_b64 v82, v[130:131] offset:6224
 ds_write_b64 v82, v[132:133] offset:6240
 ds_write_b64 v82, v[134:135] offset:6256
 s_waitcnt lgkmcnt(8)
 s_add_u32 s36, s53, 4194304
 buffer_store_dwordx4 v[136:139], v81, s[4:7], s36 offen offset:0 sc1
 buffer_store_dwordx4 v[140:143], v81, s[4:7], s36 offen offset:1024 sc1
 buffer_store_dwordx4 v[144:147], v81, s[4:7], s36 offen offset:2048 sc1
 buffer_store_dwordx4 v[148:151], v81, s[4:7], s36 offen offset:3072 sc1
 s_waitcnt lgkmcnt(0)
 ds_read_b128 v[152:155], v84 offset:6144
 ds_read_b128 v[156:159], v84 offset:6176
 ds_read_b128 v[160:163], v84 offset:6208
 ds_read_b128 v[164:167], v84 offset:6240
 s_waitcnt lgkmcnt(0)
 s_add_u32 s36, s53, 4456448
 buffer_store_dwordx4 v[152:155], v81, s[4:7], s36 offen offset:0 sc1
 buffer_store_dwordx4 v[156:159], v81, s[4:7], s36 offen offset:1024 sc1
 buffer_store_dwordx4 v[160:163], v81, s[4:7], s36 offen offset:2048 sc1
 buffer_store_dwordx4 v[164:167], v81, s[4:7], s36 offen offset:3072 sc1
t_qkv2_exit:
 s_add_u32 s26, s26, 1
 s_mov_b32 s79, 0
 s_cmp_lg_u32 s78, 0
 s_cbranch_scc1 t_qkv2_tile
 s_branch mega_done

t_g:
 s_load_dwordx2 s[40:41], s[0:1], 96
 s_load_dwordx2 s[42:43], s[0:1], s70
 s_load_dwordx2 s[44:45], s[0:1], 80
 s_load_dwordx2 s[48:49], s[0:1], 0
 v_and_b32 v1, 63, v0
 v_lshrrev_b32 v15, 6, v0
 s_mov_b32 s25, s92
 v_readfirstlane_b32 s24, v15
 s_mov_b32 s26, s93
 s_and_b32 s27, s24, 1
 s_lshr_b32 s36, s24, 1
 s_and_b32 s28, s36, 0
 s_lshr_b32 s29, s36, 0

 v_lshlrev_b32 v15, 4, v1
 s_mul_i32 s36, s24, 4
 s_add_u32 s36, s36, 0
 s_lshr_b32 s37, s36, 2
 s_and_b32 s36, s36, 3
 s_mul_i32 s38, s25, 4
 s_add_u32 s37, s37, s38
 s_mul_i32 s37, s37, s64
 s_lshl_b32 s36, s36, 10
 s_add_u32 s36, s36, s37
 v_add_u32 v2, s36, v15

 s_mul_i32 s36, s24, 4
 s_add_u32 s36, s36, 1
 s_lshr_b32 s37, s36, 2
 s_and_b32 s36, s36, 3
 s_mul_i32 s38, s25, 4
 s_add_u32 s37, s37, s38
 s_mul_i32 s37, s37, s64
 s_lshl_b32 s36, s36, 10
 s_add_u32 s36, s36, s37
 v_add_u32 v3, s36, v15

 s_mul_i32 s36, s24, 4
 s_add_u32 s36, s36, 2
 s_lshr_b32 s37, s36, 2
 s_and_b32 s36, s36, 3
 s_mul_i32 s38, s25, 4
 s_add_u32 s37, s37, s38
 s_mul_i32 s37, s37, s64
 s_lshl_b32 s36, s36, 10
 s_add_u32 s36, s36, s37
 v_add_u32 v4, s36, v15

 s_mul_i32 s36, s24, 4
 s_add_u32 s36, s36, 3
 s_lshr_b32 s37, s36, 2
 s_and_b32 s36, s36, 3
 s_mul_i32 s38, s25, 4
 s_add_u32 s37, s37, s38
 s_mul_i32 s37, s37, s64
 s_lshl_b32 s36, s36, 10
 s_add_u32 s36, s36, s37
 v_add_u32 v5, s36, v15

 s_mul_i32 s36, s24, 256
 v_add_u32 v15, s36, v1

 v_lshrrev_b32 v16, 4, v15
 v_and_b32 v17, 15, v15
 v_and_b32 v18, 3, v16
 v_lshlrev_b32 v18, 2, v18
 v_xor_b32 v17, v17, v18

 v_mul_lo_u32 v16, v16, s65
 v_lshl_add_u32 v6, v17, 4, v16
 v_add_u32 v15, 64, v15
 v_lshrrev_b32 v16, 4, v15
 v_and_b32 v17, 15, v15
 v_and_b32 v18, 3, v16
 v_lshlrev_b32 v18, 2, v18
 v_xor_b32 v17, v17, v18

 v_mul_lo_u32 v16, v16, s65
 v_lshl_add_u32 v7, v17, 4, v16
 v_add_u32 v15, 64, v15
 v_lshrrev_b32 v16, 4, v15
 v_and_b32 v17, 15, v15
 v_and_b32 v18, 3, v16
 v_lshlrev_b32 v18, 2, v18
 v_xor_b32 v17, v17, v18

 v_mul_lo_u32 v16, v16, s65
 v_lshl_add_u32 v8, v17, 4, v16
 v_add_u32 v15, 64, v15
 v_lshrrev_b32 v16, 4, v15
 v_and_b32 v17, 15, v15
 v_and_b32 v18, 3, v16
 v_lshlrev_b32 v18, 2, v18
 v_xor_b32 v17, v17, v18

 v_mul_lo_u32 v16, v16, s65
 v_lshl_add_u32 v9, v17, 4, v16
 s_mov_b32 s30, s66
 s_mul_i32 s63, s26, 256
 s_add_u32 s63, s63, s67
 s_mov_b32 s31, s63
 s_mul_i32 s32, s24, 4096
 s_mul_i32 s51, s24, 4096
 s_mov_b32 s35, 0
 s_mov_b32 s50, 32768
 s_mov_b32 s62, s69
 s_mov_b32 s78, s89
 s_mov_b32 s79, 1
 s_waitcnt lgkmcnt(0)

 s_mov_b32 s4, s40
 s_and_b32 s5, s41, 0xffff
 s_mov_b32 s6, 0x10000000
 s_mov_b32 s7, 0x00020000
 s_mov_b32 s8, s42
 s_and_b32 s9, s43, 0xffff
 s_mov_b32 s10, 0x0
 s_mov_b32 s11, 0x00020000
 s_mov_b32 s10, s71
 s_lshl_b32 s86, s94, 10
 s_add_u32 s86, s86, 161480704
 v_and_b32 v20, 7, v0
 v_lshlrev_b32 v20, 7, v20
 buffer_load_dword v19, v20, s[80:83], s86 offen sc1

 s_mov_b32 s36, s31
 s_add_u32 m0, s51, 16384
 s_nop 0
 buffer_load_dwordx4 v6, s[8:11], s36 offen lds
 s_add_u32 m0, s51, 17408
 s_nop 0
 buffer_load_dwordx4 v7, s[8:11], s36 offen lds
 s_add_u32 m0, s51, 18432
 s_nop 0
 buffer_load_dwordx4 v8, s[8:11], s36 offen lds
 s_add_u32 m0, s51, 19456
 s_nop 0
 buffer_load_dwordx4 v9, s[8:11], s36 offen lds
 s_add_u32 s36, s36, s68
 s_add_u32 m0, s51, 49152
 s_nop 0
 buffer_load_dwordx4 v6, s[8:11], s36 offen lds
 s_add_u32 m0, s51, 50176
 s_nop 0
 buffer_load_dwordx4 v7, s[8:11], s36 offen lds
 s_add_u32 m0, s51, 51200
 s_nop 0
 buffer_load_dwordx4 v8, s[8:11], s36 offen lds
 s_add_u32 m0, s51, 52224
 s_nop 0
 buffer_load_dwordx4 v9, s[8:11], s36 offen lds
 s_mov_b32 s12, s44
 s_and_b32 s13, s45, 0xffff
 s_mov_b32 s14, 0x400000
 s_mov_b32 s15, 0x00020000
 s_mov_b32 s20, s48
 s_and_b32 s21, s49, 0xffff
 s_mov_b32 s22, 0x400000
 s_mov_b32 s23, 0x00020000
 s_mul_i32 s36, s27, 8192
 s_mul_i32 s37, s29, 2048
 s_add_u32 s36, s36, s37
 v_lshlrev_b32 v15, 4, v1
 v_add_u32 v10, s36, v15

 v_bfe_u32 v15, v1, 2, 2
 v_lshrrev_b32 v16, 5, v1
 v_lshl_add_u32 v16, v16, 3, v15
 s_mul_i32 s36, s29, 32
 v_add_u32 v16, s36, v16
 v_mul_u32_u24 v16, 256, v16
 v_bfe_u32 v17, v1, 4, 1
 v_lshl_add_u32 v16, v17, 5, v16
 v_and_b32 v17, 3, v1
 v_lshl_add_u32 v16, v17, 3, v16
 v_add_u32 v16, 16384, v16
 v_and_b32 v18, 3, v15

 s_mul_i32 s36, s28, 4
 s_add_u32 s36, s36, 0
 v_xor_b32 v17, s36, v18
 v_lshl_add_u32 v11, v17, 6, v16
 s_mul_i32 s36, s28, 4
 s_add_u32 s36, s36, 1
 v_xor_b32 v17, s36, v18
 v_lshl_add_u32 v12, v17, 6, v16
 s_mul_i32 s36, s28, 4
 s_add_u32 s36, s36, 2
 v_xor_b32 v17, s36, v18
 v_lshl_add_u32 v13, v17, 6, v16
 s_mul_i32 s36, s28, 4
 s_add_u32 s36, s36, 3
 v_xor_b32 v17, s36, v18
 v_lshl_add_u32 v14, v17, 6, v16
 v_lshlrev_b32 v184, 4, v1
 s_lshl_b32 s36, s27, 1
 s_add_u32 s37, s36, s29
 s_lshl_b32 s37, s37, 14
 s_add_u32 s61, s37, 98304
 v_add_u32 v73, s61, v184
 s_xor_b32 s37, s29, 1
 s_add_u32 s37, s36, s37
 s_lshl_b32 s37, s37, 14
 s_add_u32 s37, s37, 98304
 v_add_u32 v72, s37, v184
 v_and_b32 v184, 31, v1
 v_lshrrev_b32 v185, 5, v1
 v_mul_lo_u32 v74, v184, s73
 v_lshl_add_u32 v74, v185, 3, v74
 v_mul_lo_u32 v76, v185, s73
 v_lshl_add_u32 v76, v184, 4, v76
 v_and_b32 v186, 15, v184
 v_xor_b32 v186, v186, v185
 v_lshlrev_b32 v186, 4, v186
 v_lshl_add_u32 v186, v184, 8, v186
 v_add_u32 v87, s61, v186
 v_lshlrev_b32 v208, 4, v1

 v_and_b32 v186, 15, v184
 v_xor_b32 v186, 0, v186
 v_lshlrev_b32 v186, 4, v186
 v_lshl_add_u32 v186, v184, 8, v186
 v_lshl_add_u32 v186, v185, 3, v186
 v_add_u32 v79, s61, v186

 v_and_b32 v186, 15, v184
 v_xor_b32 v186, 1, v186
 v_lshlrev_b32 v186, 4, v186
 v_lshl_add_u32 v186, v184, 8, v186
 v_lshl_add_u32 v186, v185, 3, v186
 v_add_u32 v80, s61, v186

 v_and_b32 v186, 15, v184
 v_xor_b32 v186, 2, v186
 v_lshlrev_b32 v186, 4, v186
 v_lshl_add_u32 v186, v184, 8, v186
 v_lshl_add_u32 v186, v185, 3, v186
 v_add_u32 v81, s61, v186

 v_and_b32 v186, 15, v184
 v_xor_b32 v186, 3, v186
 v_lshlrev_b32 v186, 4, v186
 v_lshl_add_u32 v186, v184, 8, v186
 v_lshl_add_u32 v186, v185, 3, v186
 v_add_u32 v82, s61, v186

 v_lshl_add_u32 v186, v185, 0, 0
 v_and_b32 v77, 7, v184
 v_xor_b32 v186, v186, v77
 v_lshlrev_b32 v186, 4, v186
 v_lshl_add_u32 v186, v184, 9, v186
 v_add_u32 v83, s61, v186

 v_lshl_add_u32 v186, v185, 0, 2
 v_and_b32 v77, 7, v184
 v_xor_b32 v186, v186, v77
 v_lshlrev_b32 v186, 4, v186
 v_lshl_add_u32 v186, v184, 9, v186
 v_add_u32 v84, s61, v186

 v_lshl_add_u32 v186, v185, 0, 4
 v_and_b32 v77, 7, v184
 v_xor_b32 v186, v186, v77
 v_lshlrev_b32 v186, 4, v186
 v_lshl_add_u32 v186, v184, 9, v186
 v_add_u32 v85, s61, v186

 v_lshl_add_u32 v186, v185, 0, 6
 v_and_b32 v77, 7, v184
 v_xor_b32 v186, v186, v77
 v_lshlrev_b32 v186, 4, v186
 v_lshl_add_u32 v186, v184, 9, v186
 v_add_u32 v86, s61, v186

 v_xor_b32 v186, v184, v185
 v_lshlrev_b32 v186, 4, v186
 v_lshl_add_u32 v186, v185, 9, v186
 v_add_u32 v78, s61, v186
 v_lshrrev_b32 v184, 4, v1
 v_and_b32 v185, 15, v1
 v_mul_lo_u32 v75, v184, s73
 v_lshl_add_u32 v75, v185, 4, v75
 v_xor_b32 v186, v185, v184
 v_lshlrev_b32 v186, 4, v186
 v_lshl_add_u32 v186, v184, 8, v186
 v_add_u32 v77, s61, v186
 s_cmp_eq_u32 s75, 0
 s_cselect_b32 s52, s20, s4
 s_cselect_b32 s53, s21, s5
 s_cselect_b32 s54, s22, s6
 s_mov_b32 s55, 0x00020000
 s_cselect_b32 s60, 0, 71303168
 s_cselect_b32 s56, s4, s12
 s_cselect_b32 s57, s5, s13
 s_cselect_b32 s58, s6, s14
 s_mov_b32 s59, 0x00020000
 s_lshl_b32 s61, s25, 7
 s_cmp_eq_u32 s72, 2
 s_cselect_b32 s61, 0, s61
 s_lshl_b32 s37, s27, 6
 s_add_u32 s61, s61, s37
 s_lshl_b32 s37, s29, 5
 s_add_u32 s61, s61, s37
 s_mul_i32 s61, s61, s73

 s_add_u32 s30, s30, 4096
 s_add_u32 s31, s31, s68
 s_add_u32 s32, s32, 32768
 s_add_u32 s51, s51, 32768
 s_cmp_ge_u32 s32, 98304
 s_cselect_b32 s38, 98304, 0
 s_sub_u32 s32, s32, s38
 s_sub_u32 s51, s51, s38
 s_sub_u32 s62, s62, 1
 s_cmp_eq_u32 s62, 0
 s_cselect_b32 s38, 256, 0
 s_cselect_b32 s30, s66, s30
 s_cselect_b32 s62, s69, s62
 s_add_u32 s63, s63, s38
 s_cmp_lg_u32 s38, 0
 s_cselect_b32 s31, s63, s31
 s_add_u32 s30, s30, 4096
 s_add_u32 s31, s31, s68
 s_add_u32 s32, s32, 32768
 s_add_u32 s51, s51, 32768
 s_cmp_ge_u32 s32, 98304
 s_cselect_b32 s38, 98304, 0
 s_sub_u32 s32, s32, s38
 s_sub_u32 s51, s51, s38
 s_sub_u32 s62, s62, 1
 s_cmp_eq_u32 s62, 0
 s_cselect_b32 s38, 256, 0
 s_cselect_b32 s30, s66, s30
 s_cselect_b32 s62, s69, s62
 s_add_u32 s63, s63, s38
 s_cmp_lg_u32 s38, 0
 s_cselect_b32 s31, s63, s31
 s_mov_b32 s30, s66
 s_mul_i32 s32, s24, 4096
 s_waitcnt vmcnt(8)
 s_nop 1
 v_add_u32_dpp v19, v19, v19 quad_perm:[1,0,3,2] row_mask:0xf bank_mask:0xf
 s_nop 1
 v_add_u32_dpp v19, v19, v19 quad_perm:[2,3,0,1] row_mask:0xf bank_mask:0xf
 s_nop 1
 v_add_u32_dpp v19, v19, v19 row_half_mirror row_mask:0xf bank_mask:0xf
 v_cmp_gt_u32 vcc, s95, v19
 s_cmp_lg_u32 s90, 0
 s_cbranch_scc1 dw_157
 s_cbranch_vccz dw_158

dw_155:
 s_sub_u32 s91, s91, 16
 s_cbranch_scc1 chain_exit
 v_add_u32 v19, 6, v19
 v_cmp_gt_u32 vcc, s95, v19
 s_cbranch_vccz dw_159
 s_sleep 20

dw_159:
 s_sleep 3
 buffer_load_dword v19, v20, s[80:83], s86 offen sc1
 s_waitcnt vmcnt(0)

 s_nop 1
 v_add_u32_dpp v19, v19, v19 quad_perm:[1,0,3,2] row_mask:0xf bank_mask:0xf
 s_nop 1
 v_add_u32_dpp v19, v19, v19 quad_perm:[2,3,0,1] row_mask:0xf bank_mask:0xf
 s_nop 1
 v_add_u32_dpp v19, v19, v19 row_half_mirror row_mask:0xf bank_mask:0xf
 v_cmp_gt_u32 vcc, s95, v19
 s_cbranch_vccnz dw_155

dw_158:
 v_mov_b32 v19, s101
 v_mov_b32 v20, 163824
 ds_write_b32 v20, v19
 s_branch dw_156

dw_157:
 s_cbranch_vccz dw_156
 v_mov_b32 v20, 163824
dw_160:
 s_sub_u32 s91, s91, 4
 s_cbranch_scc1 chain_exit
 s_sleep 1
 ds_read_b32 v19, v20
 s_waitcnt lgkmcnt(0)
 v_cmp_ne_u32 vcc, s101, v19
 s_cbranch_vccnz dw_160

dw_156:
 s_add_u32 s36, s30, 0
 s_add_u32 m0, s32, 0
 s_nop 0
 buffer_load_dwordx4 v2, s[4:7], s36 offen sc1 lds
 s_add_u32 m0, s32, 1024
 s_nop 0
 buffer_load_dwordx4 v3, s[4:7], s36 offen sc1 lds
 s_add_u32 m0, s32, 2048
 s_nop 0
 buffer_load_dwordx4 v4, s[4:7], s36 offen sc1 lds
 s_add_u32 m0, s32, 3072
 s_nop 0
 buffer_load_dwordx4 v5, s[4:7], s36 offen sc1 lds
 s_add_u32 s36, s30, 4096
 s_add_u32 m0, s32, 32768
 s_nop 0
 buffer_load_dwordx4 v2, s[4:7], s36 offen sc1 lds
 s_add_u32 m0, s32, 33792
 s_nop 0
 buffer_load_dwordx4 v3, s[4:7], s36 offen sc1 lds
 s_add_u32 m0, s32, 34816
 s_nop 0
 buffer_load_dwordx4 v4, s[4:7], s36 offen sc1 lds
 s_add_u32 m0, s32, 35840
 s_nop 0
 buffer_load_dwordx4 v5, s[4:7], s36 offen sc1 lds
 s_add_u32 s30, s30, 8192
 s_add_u32 s32, s32, 65536
 s_waitcnt vmcnt(4)
 s_barrier
 ds_read_b128 v[24:27], v10 offset:0
 ds_read_b128 v[28:31], v10 offset:4096
 ds_read_b64_tr_b16 v[32:33], v11 offset:0
 ds_read_b64_tr_b16 v[34:35], v11 offset:1024
 ds_read_b64_tr_b16 v[36:37], v12 offset:0
 ds_read_b64_tr_b16 v[38:39], v12 offset:1024
 ds_read_b64_tr_b16 v[40:41], v13 offset:0
 ds_read_b64_tr_b16 v[42:43], v13 offset:1024
 ds_read_b64_tr_b16 v[44:45], v14 offset:0
 ds_read_b64_tr_b16 v[46:47], v14 offset:1024
t_g_tile:
 s_sub_u32 s78, s78, 1
 s_cmp_eq_u32 s78, 0
 s_cselect_b32 s33, 3, 1
 s_sub_u32 s33, s69, s33

 s_waitcnt lgkmcnt(0)
 v_mfma_f32_32x32x16_bf16 a[0:15], v[32:35], v[24:27], 0
 ds_read_b128 v[48:51], v10 offset:1024
 ds_read_b128 v[52:55], v10 offset:5120
 ds_read_b64_tr_b16 v[56:57], v11 offset:4096
 v_mfma_f32_32x32x16_bf16 a[16:31], v[32:35], v[28:31], 0
 ds_read_b64_tr_b16 v[58:59], v11 offset:5120
 ds_read_b64_tr_b16 v[60:61], v12 offset:4096
 s_add_u32 m0, s32, 0
 s_nop 0
 buffer_load_dwordx4 v2, s[4:7], s30 offen sc1 lds
 v_mfma_f32_32x32x16_bf16 a[32:47], v[36:39], v[24:27], 0
 ds_read_b64_tr_b16 v[62:63], v12 offset:5120
 ds_read_b64_tr_b16 v[64:65], v13 offset:4096
 ds_read_b64_tr_b16 v[66:67], v13 offset:5120
 s_add_u32 m0, s32, 1024
 s_nop 0
 buffer_load_dwordx4 v3, s[4:7], s30 offen sc1 lds
 v_mfma_f32_32x32x16_bf16 a[48:63], v[36:39], v[28:31], 0
 ds_read_b64_tr_b16 v[68:69], v14 offset:4096
 ds_read_b64_tr_b16 v[70:71], v14 offset:5120
 v_mfma_f32_32x32x16_bf16 a[64:79], v[40:43], v[24:27], 0
 s_add_u32 m0, s32, 2048
 s_nop 0
 buffer_load_dwordx4 v4, s[4:7], s30 offen sc1 lds
 v_mfma_f32_32x32x16_bf16 a[80:95], v[40:43], v[28:31], 0
 s_add_u32 m0, s32, 3072
 s_nop 0
 buffer_load_dwordx4 v5, s[4:7], s30 offen sc1 lds
 v_mfma_f32_32x32x16_bf16 a[96:111], v[44:47], v[24:27], 0
 s_add_u32 m0, s51, 16384
 s_nop 0
 buffer_load_dwordx4 v6, s[8:11], s31 offen lds
 v_mfma_f32_32x32x16_bf16 a[112:127], v[44:47], v[28:31], 0
 s_waitcnt lgkmcnt(0)
 v_mfma_f32_32x32x16_bf16 a[0:15], v[56:59], v[48:51], a[0:15]
 s_add_u32 m0, s51, 17408
 s_nop 0
 buffer_load_dwordx4 v7, s[8:11], s31 offen lds
 v_mfma_f32_32x32x16_bf16 a[16:31], v[56:59], v[52:55], a[16:31]
 s_add_u32 m0, s51, 18432
 s_nop 0
 buffer_load_dwordx4 v8, s[8:11], s31 offen lds
 v_mfma_f32_32x32x16_bf16 a[32:47], v[60:63], v[48:51], a[32:47]
 s_add_u32 m0, s51, 19456
 s_nop 0
 buffer_load_dwordx4 v9, s[8:11], s31 offen lds
 s_add_u32 s30, s30, 4096
 s_add_u32 s31, s31, s68
 s_add_u32 s32, s32, 32768
 s_add_u32 s51, s51, 32768
 s_cmp_ge_u32 s32, 98304
 s_cselect_b32 s38, 98304, 0
 s_sub_u32 s32, s32, s38
 s_sub_u32 s51, s51, s38
 s_sub_u32 s62, s62, 1
 s_cmp_eq_u32 s62, 0
 s_cselect_b32 s38, 256, 0
 s_cselect_b32 s30, s66, s30
 s_cselect_b32 s62, s69, s62
 s_add_u32 s63, s63, s38
 s_cmp_lg_u32 s38, 0
 s_cselect_b32 s31, s63, s31
 v_mfma_f32_32x32x16_bf16 a[48:63], v[60:63], v[52:55], a[48:63]
 s_add_u32 s35, s35, 1
 s_cmp_eq_u32 s35, 3
 s_cselect_b32 s34, 0xffff0000, s50
 s_cselect_b32 s35, 0, s35
 v_add_u32 v10, s34, v10
 v_add_u32 v11, s34, v11
 v_add_u32 v12, s34, v12
 v_add_u32 v13, s34, v13
 v_add_u32 v14, s34, v14
 s_cmp_eq_u32 s79, 0
 s_cbranch_scc1 fw_161
 s_waitcnt vmcnt(8)
 s_branch fw_162
 fw_161:
 s_waitcnt vmcnt(16)
 fw_162:
 s_barrier
 ds_read_b128 v[24:27], v10 offset:0
 ds_read_b128 v[28:31], v10 offset:4096
 ds_read_b64_tr_b16 v[32:33], v11 offset:0
 ds_read_b64_tr_b16 v[34:35], v11 offset:1024
 ds_read_b64_tr_b16 v[36:37], v12 offset:0
 v_mfma_f32_32x32x16_bf16 a[64:79], v[64:67], v[48:51], a[64:79]
 ds_read_b64_tr_b16 v[38:39], v12 offset:1024
 ds_read_b64_tr_b16 v[40:41], v13 offset:0
 ds_read_b64_tr_b16 v[42:43], v13 offset:1024
 ds_read_b64_tr_b16 v[44:45], v14 offset:0
 ds_read_b64_tr_b16 v[46:47], v14 offset:1024
 v_mfma_f32_32x32x16_bf16 a[80:95], v[64:67], v[52:55], a[80:95]
 v_mfma_f32_32x32x16_bf16 a[96:111], v[68:71], v[48:51], a[96:111]
 v_mfma_f32_32x32x16_bf16 a[112:127], v[68:71], v[52:55], a[112:127]
 s_cmp_eq_u32 s33, 0
 s_cbranch_scc1 t_g_lend
t_g_loop:
 s_waitcnt lgkmcnt(0)
 v_mfma_f32_32x32x16_bf16 a[0:15], v[32:35], v[24:27], a[0:15]
 ds_read_b128 v[48:51], v10 offset:1024
 ds_read_b128 v[52:55], v10 offset:5120
 ds_read_b64_tr_b16 v[56:57], v11 offset:4096
 v_mfma_f32_32x32x16_bf16 a[16:31], v[32:35], v[28:31], a[16:31]
 ds_read_b64_tr_b16 v[58:59], v11 offset:5120
 ds_read_b64_tr_b16 v[60:61], v12 offset:4096
 s_add_u32 m0, s32, 0
 s_nop 0
 buffer_load_dwordx4 v2, s[4:7], s30 offen sc1 lds
 v_mfma_f32_32x32x16_bf16 a[32:47], v[36:39], v[24:27], a[32:47]
 ds_read_b64_tr_b16 v[62:63], v12 offset:5120
 ds_read_b64_tr_b16 v[64:65], v13 offset:4096
 ds_read_b64_tr_b16 v[66:67], v13 offset:5120
 s_add_u32 m0, s32, 1024
 s_nop 0
 buffer_load_dwordx4 v3, s[4:7], s30 offen sc1 lds
 v_mfma_f32_32x32x16_bf16 a[48:63], v[36:39], v[28:31], a[48:63]
 ds_read_b64_tr_b16 v[68:69], v14 offset:4096
 ds_read_b64_tr_b16 v[70:71], v14 offset:5120
 v_mfma_f32_32x32x16_bf16 a[64:79], v[40:43], v[24:27], a[64:79]
 s_add_u32 m0, s32, 2048
 s_nop 0
 buffer_load_dwordx4 v4, s[4:7], s30 offen sc1 lds
 v_mfma_f32_32x32x16_bf16 a[80:95], v[40:43], v[28:31], a[80:95]
 s_add_u32 m0, s32, 3072
 s_nop 0
 buffer_load_dwordx4 v5, s[4:7], s30 offen sc1 lds
 v_mfma_f32_32x32x16_bf16 a[96:111], v[44:47], v[24:27], a[96:111]
 s_add_u32 m0, s51, 16384
 s_nop 0
 buffer_load_dwordx4 v6, s[8:11], s31 offen lds
 v_mfma_f32_32x32x16_bf16 a[112:127], v[44:47], v[28:31], a[112:127]
 s_waitcnt lgkmcnt(0)
 v_mfma_f32_32x32x16_bf16 a[0:15], v[56:59], v[48:51], a[0:15]
 s_add_u32 m0, s51, 17408
 s_nop 0
 buffer_load_dwordx4 v7, s[8:11], s31 offen lds
 v_mfma_f32_32x32x16_bf16 a[16:31], v[56:59], v[52:55], a[16:31]
 s_add_u32 m0, s51, 18432
 s_nop 0
 buffer_load_dwordx4 v8, s[8:11], s31 offen lds
 v_mfma_f32_32x32x16_bf16 a[32:47], v[60:63], v[48:51], a[32:47]
 s_add_u32 m0, s51, 19456
 s_nop 0
 buffer_load_dwordx4 v9, s[8:11], s31 offen lds
 s_add_u32 s30, s30, 4096
 s_add_u32 s31, s31, s68
 s_add_u32 s32, s32, 32768
 s_add_u32 s51, s51, 32768
 s_cmp_ge_u32 s32, 98304
 s_cselect_b32 s38, 98304, 0
 s_sub_u32 s32, s32, s38
 s_sub_u32 s51, s51, s38
 s_sub_u32 s62, s62, 1
 s_cmp_eq_u32 s62, 0
 s_cselect_b32 s38, 256, 0
 s_cselect_b32 s30, s66, s30
 s_cselect_b32 s62, s69, s62
 s_add_u32 s63, s63, s38
 s_cmp_lg_u32 s38, 0
 s_cselect_b32 s31, s63, s31
 v_mfma_f32_32x32x16_bf16 a[48:63], v[60:63], v[52:55], a[48:63]
 s_add_u32 s35, s35, 1
 s_cmp_eq_u32 s35, 3
 s_cselect_b32 s34, 0xffff0000, s50
 s_cselect_b32 s35, 0, s35
 v_add_u32 v10, s34, v10
 v_add_u32 v11, s34, v11
 v_add_u32 v12, s34, v12
 v_add_u32 v13, s34, v13
 v_add_u32 v14, s34, v14
 s_waitcnt vmcnt(8)
 s_barrier
 ds_read_b128 v[24:27], v10 offset:0
 ds_read_b128 v[28:31], v10 offset:4096
 ds_read_b64_tr_b16 v[32:33], v11 offset:0
 ds_read_b64_tr_b16 v[34:35], v11 offset:1024
 ds_read_b64_tr_b16 v[36:37], v12 offset:0
 v_mfma_f32_32x32x16_bf16 a[64:79], v[64:67], v[48:51], a[64:79]
 ds_read_b64_tr_b16 v[38:39], v12 offset:1024
 ds_read_b64_tr_b16 v[40:41], v13 offset:0
 ds_read_b64_tr_b16 v[42:43], v13 offset:1024
 ds_read_b64_tr_b16 v[44:45], v14 offset:0
 ds_read_b64_tr_b16 v[46:47], v14 offset:1024
 v_mfma_f32_32x32x16_bf16 a[80:95], v[64:67], v[52:55], a[80:95]
 v_mfma_f32_32x32x16_bf16 a[96:111], v[68:71], v[48:51], a[96:111]
 v_mfma_f32_32x32x16_bf16 a[112:127], v[68:71], v[52:55], a[112:127]
 s_sub_u32 s33, s33, 1
 s_cmp_lg_u32 s33, 0
 s_cbranch_scc1 t_g_loop

t_g_lend:
 s_cmp_lg_u32 s78, 0
 s_cbranch_scc1 t_g_epi
 s_cmp_lg_u32 s90, 0
 s_cbranch_scc1 pull_163
 v_accvgpr_write_b32 a255, 1
 v_mov_b32 v255, 0
 s_lshl_b32 s86, s100, 6
 s_add_u32 s86, s86, 159514624
 s_mov_b64 exec, 1
 buffer_atomic_add a255, v255, s[80:83], s86 offen sc0
 s_mov_b64 exec, -1

pull_163:
 s_waitcnt lgkmcnt(0)
 v_mfma_f32_32x32x16_bf16 a[0:15], v[32:35], v[24:27], a[0:15]
 ds_read_b128 v[48:51], v10 offset:1024
 ds_read_b128 v[52:55], v10 offset:5120
 ds_read_b64_tr_b16 v[56:57], v11 offset:4096
 v_mfma_f32_32x32x16_bf16 a[16:31], v[32:35], v[28:31], a[16:31]
 ds_read_b64_tr_b16 v[58:59], v11 offset:5120
 ds_read_b64_tr_b16 v[60:61], v12 offset:4096
 v_mfma_f32_32x32x16_bf16 a[32:47], v[36:39], v[24:27], a[32:47]
 ds_read_b64_tr_b16 v[62:63], v12 offset:5120
 ds_read_b64_tr_b16 v[64:65], v13 offset:4096
 ds_read_b64_tr_b16 v[66:67], v13 offset:5120
 v_mfma_f32_32x32x16_bf16 a[48:63], v[36:39], v[28:31], a[48:63]
 ds_read_b64_tr_b16 v[68:69], v14 offset:4096
 ds_read_b64_tr_b16 v[70:71], v14 offset:5120
 v_mfma_f32_32x32x16_bf16 a[64:79], v[40:43], v[24:27], a[64:79]
 v_mfma_f32_32x32x16_bf16 a[80:95], v[40:43], v[28:31], a[80:95]
 v_mfma_f32_32x32x16_bf16 a[96:111], v[44:47], v[24:27], a[96:111]
 v_mfma_f32_32x32x16_bf16 a[112:127], v[44:47], v[28:31], a[112:127]
 s_waitcnt lgkmcnt(0)
 v_mfma_f32_32x32x16_bf16 a[0:15], v[56:59], v[48:51], a[0:15]
 v_mfma_f32_32x32x16_bf16 a[16:31], v[56:59], v[52:55], a[16:31]
 v_mfma_f32_32x32x16_bf16 a[32:47], v[60:63], v[48:51], a[32:47]
 v_mfma_f32_32x32x16_bf16 a[48:63], v[60:63], v[52:55], a[48:63]
 s_add_u32 s35, s35, 1
 s_cmp_eq_u32 s35, 3
 s_cselect_b32 s34, 0xffff0000, s50
 s_cselect_b32 s35, 0, s35
 v_add_u32 v10, s34, v10
 v_add_u32 v11, s34, v11
 v_add_u32 v12, s34, v12
 v_add_u32 v13, s34, v13
 v_add_u32 v14, s34, v14
 s_waitcnt vmcnt(0)
 s_barrier
 ds_read_b128 v[24:27], v10 offset:0
 ds_read_b128 v[28:31], v10 offset:4096
 ds_read_b64_tr_b16 v[32:33], v11 offset:0
 ds_read_b64_tr_b16 v[34:35], v11 offset:1024
 ds_read_b64_tr_b16 v[36:37], v12 offset:0
 v_mfma_f32_32x32x16_bf16 a[64:79], v[64:67], v[48:51], a[64:79]
 ds_read_b64_tr_b16 v[38:39], v12 offset:1024
 ds_read_b64_tr_b16 v[40:41], v13 offset:0
 ds_read_b64_tr_b16 v[42:43], v13 offset:1024
 ds_read_b64_tr_b16 v[44:45], v14 offset:0
 ds_read_b64_tr_b16 v[46:47], v14 offset:1024
 v_mfma_f32_32x32x16_bf16 a[80:95], v[64:67], v[52:55], a[80:95]
 v_mfma_f32_32x32x16_bf16 a[96:111], v[68:71], v[48:51], a[96:111]
 v_mfma_f32_32x32x16_bf16 a[112:127], v[68:71], v[52:55], a[112:127]
 s_waitcnt lgkmcnt(0)
 v_mfma_f32_32x32x16_bf16 a[0:15], v[32:35], v[24:27], a[0:15]
 ds_read_b128 v[48:51], v10 offset:1024
 ds_read_b128 v[52:55], v10 offset:5120
 ds_read_b64_tr_b16 v[56:57], v11 offset:4096
 v_mfma_f32_32x32x16_bf16 a[16:31], v[32:35], v[28:31], a[16:31]
 ds_read_b64_tr_b16 v[58:59], v11 offset:5120
 ds_read_b64_tr_b16 v[60:61], v12 offset:4096
 v_mfma_f32_32x32x16_bf16 a[32:47], v[36:39], v[24:27], a[32:47]
 ds_read_b64_tr_b16 v[62:63], v12 offset:5120
 ds_read_b64_tr_b16 v[64:65], v13 offset:4096
 ds_read_b64_tr_b16 v[66:67], v13 offset:5120
 v_mfma_f32_32x32x16_bf16 a[48:63], v[36:39], v[28:31], a[48:63]
 ds_read_b64_tr_b16 v[68:69], v14 offset:4096
 ds_read_b64_tr_b16 v[70:71], v14 offset:5120
 v_mfma_f32_32x32x16_bf16 a[64:79], v[40:43], v[24:27], a[64:79]
 v_mfma_f32_32x32x16_bf16 a[80:95], v[40:43], v[28:31], a[80:95]
 v_mfma_f32_32x32x16_bf16 a[96:111], v[44:47], v[24:27], a[96:111]
 v_mfma_f32_32x32x16_bf16 a[112:127], v[44:47], v[28:31], a[112:127]
 s_waitcnt lgkmcnt(0)
 v_mfma_f32_32x32x16_bf16 a[0:15], v[56:59], v[48:51], a[0:15]
 v_mfma_f32_32x32x16_bf16 a[16:31], v[56:59], v[52:55], a[16:31]
 v_mfma_f32_32x32x16_bf16 a[32:47], v[60:63], v[48:51], a[32:47]
 v_mfma_f32_32x32x16_bf16 a[48:63], v[60:63], v[52:55], a[48:63]
 v_mfma_f32_32x32x16_bf16 a[64:79], v[64:67], v[48:51], a[64:79]
 v_mfma_f32_32x32x16_bf16 a[80:95], v[64:67], v[52:55], a[80:95]
 v_mfma_f32_32x32x16_bf16 a[96:111], v[68:71], v[48:51], a[96:111]
 v_mfma_f32_32x32x16_bf16 a[112:127], v[68:71], v[52:55], a[112:127]
t_g_epi:
 s_nop 7
 s_lshl_b32 s37, s26, 8
 s_cmp_eq_u32 s72, 2
 s_cselect_b32 s36, 1, 0
 s_lshl_b32 s37, s37, s36
 s_add_u32 s39, s61, s37
 s_add_u32 s36, s39, s60
 s_add_u32 s39, s39, s74
 s_cmp_lg_u32 s72, 0
 s_cbranch_scc1 t_g_nores

 buffer_load_dwordx2 v[88:89], v74, s[52:55], s36 offen offset:0
 buffer_load_dwordx2 v[90:91], v74, s[52:55], s36 offen offset:16
 buffer_load_dwordx2 v[92:93], v74, s[52:55], s36 offen offset:32
 buffer_load_dwordx2 v[94:95], v74, s[52:55], s36 offen offset:48
 buffer_load_dwordx2 v[96:97], v74, s[52:55], s36 offen offset:64
 buffer_load_dwordx2 v[98:99], v74, s[52:55], s36 offen offset:80
 buffer_load_dwordx2 v[100:101], v74, s[52:55], s36 offen offset:96
 buffer_load_dwordx2 v[102:103], v74, s[52:55], s36 offen offset:112
 buffer_load_dwordx2 v[104:105], v74, s[52:55], s36 offen offset:128
 buffer_load_dwordx2 v[106:107], v74, s[52:55], s36 offen offset:144
 buffer_load_dwordx2 v[108:109], v74, s[52:55], s36 offen offset:160
 buffer_load_dwordx2 v[110:111], v74, s[52:55], s36 offen offset:176
 buffer_load_dwordx2 v[112:113], v74, s[52:55], s36 offen offset:192
 buffer_load_dwordx2 v[114:115], v74, s[52:55], s36 offen offset:208
 buffer_load_dwordx2 v[116:117], v74, s[52:55], s36 offen offset:224
 buffer_load_dwordx2 v[118:119], v74, s[52:55], s36 offen offset:240
t_g_nores:
 s_nop 7
 s_barrier
 s_cmp_eq_u32 s29, 0
 s_cbranch_scc1 t_g_ep_k0

 ds_write_b128 v72, a[0:3] offset:0
 ds_write_b128 v72, a[4:7] offset:1024
 ds_write_b128 v72, a[8:11] offset:2048
 ds_write_b128 v72, a[12:15] offset:3072
 ds_write_b128 v72, a[32:35] offset:4096
 ds_write_b128 v72, a[36:39] offset:5120
 ds_write_b128 v72, a[40:43] offset:6144
 ds_write_b128 v72, a[44:47] offset:7168
 ds_write_b128 v72, a[64:67] offset:8192
 ds_write_b128 v72, a[68:71] offset:9216
 ds_write_b128 v72, a[72:75] offset:10240
 ds_write_b128 v72, a[76:79] offset:11264
 ds_write_b128 v72, a[96:99] offset:12288
 ds_write_b128 v72, a[100:103] offset:13312
 ds_write_b128 v72, a[104:107] offset:14336
 ds_write_b128 v72, a[108:111] offset:15360
 s_waitcnt lgkmcnt(0)
 s_barrier
 ds_read_b128 v[120:123], v73 offset:0
 ds_read_b128 v[124:127], v73 offset:1024
 ds_read_b128 v[128:131], v73 offset:2048
 ds_read_b128 v[132:135], v73 offset:3072
 ds_read_b128 v[136:139], v73 offset:4096
 ds_read_b128 v[140:143], v73 offset:5120
 ds_read_b128 v[144:147], v73 offset:6144
 ds_read_b128 v[148:151], v73 offset:7168
 ds_read_b128 v[152:155], v73 offset:8192
 ds_read_b128 v[156:159], v73 offset:9216
 ds_read_b128 v[160:163], v73 offset:10240
 ds_read_b128 v[164:167], v73 offset:11264
 ds_read_b128 v[168:171], v73 offset:12288
 ds_read_b128 v[172:175], v73 offset:13312
 ds_read_b128 v[176:179], v73 offset:14336
 ds_read_b128 v[180:183], v73 offset:15360
 v_accvgpr_read_b32 v184, a16
 v_accvgpr_read_b32 v185, a17
 v_accvgpr_read_b32 v186, a18
 v_accvgpr_read_b32 v187, a19
 v_accvgpr_read_b32 v188, a20
 v_accvgpr_read_b32 v189, a21
 v_accvgpr_read_b32 v190, a22
 v_accvgpr_read_b32 v191, a23
 v_accvgpr_read_b32 v192, a24
 v_accvgpr_read_b32 v193, a25
 v_accvgpr_read_b32 v194, a26
 v_accvgpr_read_b32 v195, a27
 v_accvgpr_read_b32 v196, a28
 v_accvgpr_read_b32 v197, a29
 v_accvgpr_read_b32 v198, a30
 v_accvgpr_read_b32 v199, a31
 s_waitcnt lgkmcnt(12)
 v_pk_add_f32 v[120:121], v[120:121], v[184:185]
 v_pk_add_f32 v[122:123], v[122:123], v[186:187]
 v_pk_add_f32 v[124:125], v[124:125], v[188:189]
 v_pk_add_f32 v[126:127], v[126:127], v[190:191]
 v_pk_add_f32 v[128:129], v[128:129], v[192:193]
 v_pk_add_f32 v[130:131], v[130:131], v[194:195]
 v_pk_add_f32 v[132:133], v[132:133], v[196:197]
 v_pk_add_f32 v[134:135], v[134:135], v[198:199]
 v_accvgpr_read_b32 v184, a48
 v_accvgpr_read_b32 v185, a49
 v_accvgpr_read_b32 v186, a50
 v_accvgpr_read_b32 v187, a51
 v_accvgpr_read_b32 v188, a52
 v_accvgpr_read_b32 v189, a53
 v_accvgpr_read_b32 v190, a54
 v_accvgpr_read_b32 v191, a55
 v_accvgpr_read_b32 v192, a56
 v_accvgpr_read_b32 v193, a57
 v_accvgpr_read_b32 v194, a58
 v_accvgpr_read_b32 v195, a59
 v_accvgpr_read_b32 v196, a60
 v_accvgpr_read_b32 v197, a61
 v_accvgpr_read_b32 v198, a62
 v_accvgpr_read_b32 v199, a63
 s_waitcnt lgkmcnt(8)
 v_pk_add_f32 v[136:137], v[136:137], v[184:185]
 v_pk_add_f32 v[138:139], v[138:139], v[186:187]
 v_pk_add_f32 v[140:141], v[140:141], v[188:189]
 v_pk_add_f32 v[142:143], v[142:143], v[190:191]
 v_pk_add_f32 v[144:145], v[144:145], v[192:193]
 v_pk_add_f32 v[146:147], v[146:147], v[194:195]
 v_pk_add_f32 v[148:149], v[148:149], v[196:197]
 v_pk_add_f32 v[150:151], v[150:151], v[198:199]
 v_accvgpr_read_b32 v184, a80
 v_accvgpr_read_b32 v185, a81
 v_accvgpr_read_b32 v186, a82
 v_accvgpr_read_b32 v187, a83
 v_accvgpr_read_b32 v188, a84
 v_accvgpr_read_b32 v189, a85
 v_accvgpr_read_b32 v190, a86
 v_accvgpr_read_b32 v191, a87
 v_accvgpr_read_b32 v192, a88
 v_accvgpr_read_b32 v193, a89
 v_accvgpr_read_b32 v194, a90
 v_accvgpr_read_b32 v195, a91
 v_accvgpr_read_b32 v196, a92
 v_accvgpr_read_b32 v197, a93
 v_accvgpr_read_b32 v198, a94
 v_accvgpr_read_b32 v199, a95
 s_waitcnt lgkmcnt(4)
 v_pk_add_f32 v[152:153], v[152:153], v[184:185]
 v_pk_add_f32 v[154:155], v[154:155], v[186:187]
 v_pk_add_f32 v[156:157], v[156:157], v[188:189]
 v_pk_add_f32 v[158:159], v[158:159], v[190:191]
 v_pk_add_f32 v[160:161], v[160:161], v[192:193]
 v_pk_add_f32 v[162:163], v[162:163], v[194:195]
 v_pk_add_f32 v[164:165], v[164:165], v[196:197]
 v_pk_add_f32 v[166:167], v[166:167], v[198:199]
 v_accvgpr_read_b32 v184, a112
 v_accvgpr_read_b32 v185, a113
 v_accvgpr_read_b32 v186, a114
 v_accvgpr_read_b32 v187, a115
 v_accvgpr_read_b32 v188, a116
 v_accvgpr_read_b32 v189, a117
 v_accvgpr_read_b32 v190, a118
 v_accvgpr_read_b32 v191, a119
 v_accvgpr_read_b32 v192, a120
 v_accvgpr_read_b32 v193, a121
 v_accvgpr_read_b32 v194, a122
 v_accvgpr_read_b32 v195, a123
 v_accvgpr_read_b32 v196, a124
 v_accvgpr_read_b32 v197, a125
 v_accvgpr_read_b32 v198, a126
 v_accvgpr_read_b32 v199, a127
 s_waitcnt lgkmcnt(0)
 v_pk_add_f32 v[168:169], v[168:169], v[184:185]
 v_pk_add_f32 v[170:171], v[170:171], v[186:187]
 v_pk_add_f32 v[172:173], v[172:173], v[188:189]
 v_pk_add_f32 v[174:175], v[174:175], v[190:191]
 v_pk_add_f32 v[176:177], v[176:177], v[192:193]
 v_pk_add_f32 v[178:179], v[178:179], v[194:195]
 v_pk_add_f32 v[180:181], v[180:181], v[196:197]
 v_pk_add_f32 v[182:183], v[182:183], v[198:199]
 s_branch t_g_ep_j
t_g_ep_k0:
 ds_write_b128 v72, a[16:19] offset:0
 ds_write_b128 v72, a[20:23] offset:1024
 ds_write_b128 v72, a[24:27] offset:2048
 ds_write_b128 v72, a[28:31] offset:3072
 ds_write_b128 v72, a[48:51] offset:4096
 ds_write_b128 v72, a[52:55] offset:5120
 ds_write_b128 v72, a[56:59] offset:6144
 ds_write_b128 v72, a[60:63] offset:7168
 ds_write_b128 v72, a[80:83] offset:8192
 ds_write_b128 v72, a[84:87] offset:9216
 ds_write_b128 v72, a[88:91] offset:10240
 ds_write_b128 v72, a[92:95] offset:11264
 ds_write_b128 v72, a[112:115] offset:12288
 ds_write_b128 v72, a[116:119] offset:13312
 ds_write_b128 v72, a[120:123] offset:14336
 ds_write_b128 v72, a[124:127] offset:15360
 s_waitcnt lgkmcnt(0)
 s_barrier
 ds_read_b128 v[120:123], v73 offset:0
 ds_read_b128 v[124:127], v73 offset:1024
 ds_read_b128 v[128:131], v73 offset:2048
 ds_read_b128 v[132:135], v73 offset:3072
 ds_read_b128 v[136:139], v73 offset:4096
 ds_read_b128 v[140:143], v73 offset:5120
 ds_read_b128 v[144:147], v73 offset:6144
 ds_read_b128 v[148:151], v73 offset:7168
 ds_read_b128 v[152:155], v73 offset:8192
 ds_read_b128 v[156:159], v73 offset:9216
 ds_read_b128 v[160:163], v73 offset:10240
 ds_read_b128 v[164:167], v73 offset:11264
 ds_read_b128 v[168:171], v73 offset:12288
 ds_read_b128 v[172:175], v73 offset:13312
 ds_read_b128 v[176:179], v73 offset:14336
 ds_read_b128 v[180:183], v73 offset:15360
 v_accvgpr_read_b32 v184, a0
 v_accvgpr_read_b32 v185, a1
 v_accvgpr_read_b32 v186, a2
 v_accvgpr_read_b32 v187, a3
 v_accvgpr_read_b32 v188, a4
 v_accvgpr_read_b32 v189, a5
 v_accvgpr_read_b32 v190, a6
 v_accvgpr_read_b32 v191, a7
 v_accvgpr_read_b32 v192, a8
 v_accvgpr_read_b32 v193, a9
 v_accvgpr_read_b32 v194, a10
 v_accvgpr_read_b32 v195, a11
 v_accvgpr_read_b32 v196, a12
 v_accvgpr_read_b32 v197, a13
 v_accvgpr_read_b32 v198, a14
 v_accvgpr_read_b32 v199, a15
 s_waitcnt lgkmcnt(12)
 v_pk_add_f32 v[120:121], v[120:121], v[184:185]
 v_pk_add_f32 v[122:123], v[122:123], v[186:187]
 v_pk_add_f32 v[124:125], v[124:125], v[188:189]
 v_pk_add_f32 v[126:127], v[126:127], v[190:191]
 v_pk_add_f32 v[128:129], v[128:129], v[192:193]
 v_pk_add_f32 v[130:131], v[130:131], v[194:195]
 v_pk_add_f32 v[132:133], v[132:133], v[196:197]
 v_pk_add_f32 v[134:135], v[134:135], v[198:199]
 v_accvgpr_read_b32 v184, a32
 v_accvgpr_read_b32 v185, a33
 v_accvgpr_read_b32 v186, a34
 v_accvgpr_read_b32 v187, a35
 v_accvgpr_read_b32 v188, a36
 v_accvgpr_read_b32 v189, a37
 v_accvgpr_read_b32 v190, a38
 v_accvgpr_read_b32 v191, a39
 v_accvgpr_read_b32 v192, a40
 v_accvgpr_read_b32 v193, a41
 v_accvgpr_read_b32 v194, a42
 v_accvgpr_read_b32 v195, a43
 v_accvgpr_read_b32 v196, a44
 v_accvgpr_read_b32 v197, a45
 v_accvgpr_read_b32 v198, a46
 v_accvgpr_read_b32 v199, a47
 s_waitcnt lgkmcnt(8)
 v_pk_add_f32 v[136:137], v[136:137], v[184:185]
 v_pk_add_f32 v[138:139], v[138:139], v[186:187]
 v_pk_add_f32 v[140:141], v[140:141], v[188:189]
 v_pk_add_f32 v[142:143], v[142:143], v[190:191]
 v_pk_add_f32 v[144:145], v[144:145], v[192:193]
 v_pk_add_f32 v[146:147], v[146:147], v[194:195]
 v_pk_add_f32 v[148:149], v[148:149], v[196:197]
 v_pk_add_f32 v[150:151], v[150:151], v[198:199]
 v_accvgpr_read_b32 v184, a64
 v_accvgpr_read_b32 v185, a65
 v_accvgpr_read_b32 v186, a66
 v_accvgpr_read_b32 v187, a67
 v_accvgpr_read_b32 v188, a68
 v_accvgpr_read_b32 v189, a69
 v_accvgpr_read_b32 v190, a70
 v_accvgpr_read_b32 v191, a71
 v_accvgpr_read_b32 v192, a72
 v_accvgpr_read_b32 v193, a73
 v_accvgpr_read_b32 v194, a74
 v_accvgpr_read_b32 v195, a75
 v_accvgpr_read_b32 v196, a76
 v_accvgpr_read_b32 v197, a77
 v_accvgpr_read_b32 v198, a78
 v_accvgpr_read_b32 v199, a79
 s_waitcnt lgkmcnt(4)
 v_pk_add_f32 v[152:153], v[152:153], v[184:185]
 v_pk_add_f32 v[154:155], v[154:155], v[186:187]
 v_pk_add_f32 v[156:157], v[156:157], v[188:189]
 v_pk_add_f32 v[158:159], v[158:159], v[190:191]
 v_pk_add_f32 v[160:161], v[160:161], v[192:193]
 v_pk_add_f32 v[162:163], v[162:163], v[194:195]
 v_pk_add_f32 v[164:165], v[164:165], v[196:197]
 v_pk_add_f32 v[166:167], v[166:167], v[198:199]
 v_accvgpr_read_b32 v184, a96
 v_accvgpr_read_b32 v185, a97
 v_accvgpr_read_b32 v186, a98
 v_accvgpr_read_b32 v187, a99
 v_accvgpr_read_b32 v188, a100
 v_accvgpr_read_b32 v189, a101
 v_accvgpr_read_b32 v190, a102
 v_accvgpr_read_b32 v191, a103
 v_accvgpr_read_b32 v192, a104
 v_accvgpr_read_b32 v193, a105
 v_accvgpr_read_b32 v194, a106
 v_accvgpr_read_b32 v195, a107
 v_accvgpr_read_b32 v196, a108
 v_accvgpr_read_b32 v197, a109
 v_accvgpr_read_b32 v198, a110
 v_accvgpr_read_b32 v199, a111
 s_waitcnt lgkmcnt(0)
 v_pk_add_f32 v[168:169], v[168:169], v[184:185]
 v_pk_add_f32 v[170:171], v[170:171], v[186:187]
 v_pk_add_f32 v[172:173], v[172:173], v[188:189]
 v_pk_add_f32 v[174:175], v[174:175], v[190:191]
 v_pk_add_f32 v[176:177], v[176:177], v[192:193]
 v_pk_add_f32 v[178:179], v[178:179], v[194:195]
 v_pk_add_f32 v[180:181], v[180:181], v[196:197]
 v_pk_add_f32 v[182:183], v[182:183], v[198:199]
t_g_ep_j:
 s_cmp_eq_u32 s72, 1
 s_cbranch_scc1 t_g_m1
 s_cmp_eq_u32 s72, 2
 s_cbranch_scc1 t_g_m2
 s_waitcnt vmcnt(0)
 v_cvt_pk_bf16_f32 v200, v120, v121
 v_cvt_pk_bf16_f32 v201, v122, v123
 v_cvt_pk_bf16_f32 v202, v124, v125
 v_cvt_pk_bf16_f32 v203, v126, v127
 v_cvt_pk_bf16_f32 v204, v128, v129
 v_cvt_pk_bf16_f32 v205, v130, v131
 v_cvt_pk_bf16_f32 v206, v132, v133
 v_cvt_pk_bf16_f32 v207, v134, v135
 v_lshlrev_b32 v120, 16, v200
 v_and_b32 v121, 0xffff0000, v200
 v_lshlrev_b32 v122, 16, v201
 v_and_b32 v123, 0xffff0000, v201
 v_lshlrev_b32 v124, 16, v202
 v_and_b32 v125, 0xffff0000, v202
 v_lshlrev_b32 v126, 16, v203
 v_and_b32 v127, 0xffff0000, v203
 v_lshlrev_b32 v128, 16, v204
 v_and_b32 v129, 0xffff0000, v204
 v_lshlrev_b32 v130, 16, v205
 v_and_b32 v131, 0xffff0000, v205
 v_lshlrev_b32 v132, 16, v206
 v_and_b32 v133, 0xffff0000, v206
 v_lshlrev_b32 v134, 16, v207
 v_and_b32 v135, 0xffff0000, v207
 v_lshlrev_b32 v184, 16, v88
 v_and_b32 v185, 0xffff0000, v88
 v_lshlrev_b32 v186, 16, v89
 v_and_b32 v187, 0xffff0000, v89
 v_lshlrev_b32 v188, 16, v90
 v_and_b32 v189, 0xffff0000, v90
 v_lshlrev_b32 v190, 16, v91
 v_and_b32 v191, 0xffff0000, v91
 v_lshlrev_b32 v192, 16, v92
 v_and_b32 v193, 0xffff0000, v92
 v_lshlrev_b32 v194, 16, v93
 v_and_b32 v195, 0xffff0000, v93
 v_lshlrev_b32 v196, 16, v94
 v_and_b32 v197, 0xffff0000, v94
 v_lshlrev_b32 v198, 16, v95
 v_and_b32 v199, 0xffff0000, v95
 v_pk_add_f32 v[120:121], v[120:121], v[184:185]
 v_pk_add_f32 v[122:123], v[122:123], v[186:187]
 v_pk_add_f32 v[124:125], v[124:125], v[188:189]
 v_pk_add_f32 v[126:127], v[126:127], v[190:191]
 v_pk_add_f32 v[128:129], v[128:129], v[192:193]
 v_pk_add_f32 v[130:131], v[130:131], v[194:195]
 v_pk_add_f32 v[132:133], v[132:133], v[196:197]
 v_pk_add_f32 v[134:135], v[134:135], v[198:199]
 v_cvt_pk_bf16_f32 v200, v120, v121
 v_cvt_pk_bf16_f32 v201, v122, v123
 v_cvt_pk_bf16_f32 v202, v124, v125
 v_cvt_pk_bf16_f32 v203, v126, v127
 v_cvt_pk_bf16_f32 v204, v128, v129
 v_cvt_pk_bf16_f32 v205, v130, v131
 v_cvt_pk_bf16_f32 v206, v132, v133
 v_cvt_pk_bf16_f32 v207, v134, v135
 ds_write_b64 v79, v[200:201]
 ds_write_b64 v80, v[202:203]
 ds_write_b64 v81, v[204:205]
 ds_write_b64 v82, v[206:207]
 v_cvt_pk_bf16_f32 v200, v136, v137
 v_cvt_pk_bf16_f32 v201, v138, v139
 v_cvt_pk_bf16_f32 v202, v140, v141
 v_cvt_pk_bf16_f32 v203, v142, v143
 v_cvt_pk_bf16_f32 v204, v144, v145
 v_cvt_pk_bf16_f32 v205, v146, v147
 v_cvt_pk_bf16_f32 v206, v148, v149
 v_cvt_pk_bf16_f32 v207, v150, v151
 v_lshlrev_b32 v136, 16, v200
 v_and_b32 v137, 0xffff0000, v200
 v_lshlrev_b32 v138, 16, v201
 v_and_b32 v139, 0xffff0000, v201
 v_lshlrev_b32 v140, 16, v202
 v_and_b32 v141, 0xffff0000, v202
 v_lshlrev_b32 v142, 16, v203
 v_and_b32 v143, 0xffff0000, v203
 v_lshlrev_b32 v144, 16, v204
 v_and_b32 v145, 0xffff0000, v204
 v_lshlrev_b32 v146, 16, v205
 v_and_b32 v147, 0xffff0000, v205
 v_lshlrev_b32 v148, 16, v206
 v_and_b32 v149, 0xffff0000, v206
 v_lshlrev_b32 v150, 16, v207
 v_and_b32 v151, 0xffff0000, v207
 v_lshlrev_b32 v184, 16, v96
 v_and_b32 v185, 0xffff0000, v96
 v_lshlrev_b32 v186, 16, v97
 v_and_b32 v187, 0xffff0000, v97
 v_lshlrev_b32 v188, 16, v98
 v_and_b32 v189, 0xffff0000, v98
 v_lshlrev_b32 v190, 16, v99
 v_and_b32 v191, 0xffff0000, v99
 v_lshlrev_b32 v192, 16, v100
 v_and_b32 v193, 0xffff0000, v100
 v_lshlrev_b32 v194, 16, v101
 v_and_b32 v195, 0xffff0000, v101
 v_lshlrev_b32 v196, 16, v102
 v_and_b32 v197, 0xffff0000, v102
 v_lshlrev_b32 v198, 16, v103
 v_and_b32 v199, 0xffff0000, v103
 v_pk_add_f32 v[136:137], v[136:137], v[184:185]
 v_pk_add_f32 v[138:139], v[138:139], v[186:187]
 v_pk_add_f32 v[140:141], v[140:141], v[188:189]
 v_pk_add_f32 v[142:143], v[142:143], v[190:191]
 v_pk_add_f32 v[144:145], v[144:145], v[192:193]
 v_pk_add_f32 v[146:147], v[146:147], v[194:195]
 v_pk_add_f32 v[148:149], v[148:149], v[196:197]
 v_pk_add_f32 v[150:151], v[150:151], v[198:199]
 v_cvt_pk_bf16_f32 v200, v136, v137
 v_cvt_pk_bf16_f32 v201, v138, v139
 v_cvt_pk_bf16_f32 v202, v140, v141
 v_cvt_pk_bf16_f32 v203, v142, v143
 v_cvt_pk_bf16_f32 v204, v144, v145
 v_cvt_pk_bf16_f32 v205, v146, v147
 v_cvt_pk_bf16_f32 v206, v148, v149
 v_cvt_pk_bf16_f32 v207, v150, v151
 v_xor_b32 v184, 64, v79
 ds_write_b64 v184, v[200:201]
 v_xor_b32 v185, 64, v80
 ds_write_b64 v185, v[202:203]
 v_xor_b32 v186, 64, v81
 ds_write_b64 v186, v[204:205]
 v_xor_b32 v187, 64, v82
 ds_write_b64 v187, v[206:207]
 v_cvt_pk_bf16_f32 v200, v152, v153
 v_cvt_pk_bf16_f32 v201, v154, v155
 v_cvt_pk_bf16_f32 v202, v156, v157
 v_cvt_pk_bf16_f32 v203, v158, v159
 v_cvt_pk_bf16_f32 v204, v160, v161
 v_cvt_pk_bf16_f32 v205, v162, v163
 v_cvt_pk_bf16_f32 v206, v164, v165
 v_cvt_pk_bf16_f32 v207, v166, v167
 v_lshlrev_b32 v152, 16, v200
 v_and_b32 v153, 0xffff0000, v200
 v_lshlrev_b32 v154, 16, v201
 v_and_b32 v155, 0xffff0000, v201
 v_lshlrev_b32 v156, 16, v202
 v_and_b32 v157, 0xffff0000, v202
 v_lshlrev_b32 v158, 16, v203
 v_and_b32 v159, 0xffff0000, v203
 v_lshlrev_b32 v160, 16, v204
 v_and_b32 v161, 0xffff0000, v204
 v_lshlrev_b32 v162, 16, v205
 v_and_b32 v163, 0xffff0000, v205
 v_lshlrev_b32 v164, 16, v206
 v_and_b32 v165, 0xffff0000, v206
 v_lshlrev_b32 v166, 16, v207
 v_and_b32 v167, 0xffff0000, v207
 v_lshlrev_b32 v184, 16, v104
 v_and_b32 v185, 0xffff0000, v104
 v_lshlrev_b32 v186, 16, v105
 v_and_b32 v187, 0xffff0000, v105
 v_lshlrev_b32 v188, 16, v106
 v_and_b32 v189, 0xffff0000, v106
 v_lshlrev_b32 v190, 16, v107
 v_and_b32 v191, 0xffff0000, v107
 v_lshlrev_b32 v192, 16, v108
 v_and_b32 v193, 0xffff0000, v108
 v_lshlrev_b32 v194, 16, v109
 v_and_b32 v195, 0xffff0000, v109
 v_lshlrev_b32 v196, 16, v110
 v_and_b32 v197, 0xffff0000, v110
 v_lshlrev_b32 v198, 16, v111
 v_and_b32 v199, 0xffff0000, v111
 v_pk_add_f32 v[152:153], v[152:153], v[184:185]
 v_pk_add_f32 v[154:155], v[154:155], v[186:187]
 v_pk_add_f32 v[156:157], v[156:157], v[188:189]
 v_pk_add_f32 v[158:159], v[158:159], v[190:191]
 v_pk_add_f32 v[160:161], v[160:161], v[192:193]
 v_pk_add_f32 v[162:163], v[162:163], v[194:195]
 v_pk_add_f32 v[164:165], v[164:165], v[196:197]
 v_pk_add_f32 v[166:167], v[166:167], v[198:199]
 v_cvt_pk_bf16_f32 v200, v152, v153
 v_cvt_pk_bf16_f32 v201, v154, v155
 v_cvt_pk_bf16_f32 v202, v156, v157
 v_cvt_pk_bf16_f32 v203, v158, v159
 v_cvt_pk_bf16_f32 v204, v160, v161
 v_cvt_pk_bf16_f32 v205, v162, v163
 v_cvt_pk_bf16_f32 v206, v164, v165
 v_cvt_pk_bf16_f32 v207, v166, v167
 v_xor_b32 v184, 128, v79
 ds_write_b64 v184, v[200:201]
 v_xor_b32 v185, 128, v80
 ds_write_b64 v185, v[202:203]
 v_xor_b32 v186, 128, v81
 ds_write_b64 v186, v[204:205]
 v_xor_b32 v187, 128, v82
 ds_write_b64 v187, v[206:207]
 v_cvt_pk_bf16_f32 v200, v168, v169
 v_cvt_pk_bf16_f32 v201, v170, v171
 v_cvt_pk_bf16_f32 v202, v172, v173
 v_cvt_pk_bf16_f32 v203, v174, v175
 v_cvt_pk_bf16_f32 v204, v176, v177
 v_cvt_pk_bf16_f32 v205, v178, v179
 v_cvt_pk_bf16_f32 v206, v180, v181
 v_cvt_pk_bf16_f32 v207, v182, v183
 v_lshlrev_b32 v168, 16, v200
 v_and_b32 v169, 0xffff0000, v200
 v_lshlrev_b32 v170, 16, v201
 v_and_b32 v171, 0xffff0000, v201
 v_lshlrev_b32 v172, 16, v202
 v_and_b32 v173, 0xffff0000, v202
 v_lshlrev_b32 v174, 16, v203
 v_and_b32 v175, 0xffff0000, v203
 v_lshlrev_b32 v176, 16, v204
 v_and_b32 v177, 0xffff0000, v204
 v_lshlrev_b32 v178, 16, v205
 v_and_b32 v179, 0xffff0000, v205
 v_lshlrev_b32 v180, 16, v206
 v_and_b32 v181, 0xffff0000, v206
 v_lshlrev_b32 v182, 16, v207
 v_and_b32 v183, 0xffff0000, v207
 v_lshlrev_b32 v184, 16, v112
 v_and_b32 v185, 0xffff0000, v112
 v_lshlrev_b32 v186, 16, v113
 v_and_b32 v187, 0xffff0000, v113
 v_lshlrev_b32 v188, 16, v114
 v_and_b32 v189, 0xffff0000, v114
 v_lshlrev_b32 v190, 16, v115
 v_and_b32 v191, 0xffff0000, v115
 v_lshlrev_b32 v192, 16, v116
 v_and_b32 v193, 0xffff0000, v116
 v_lshlrev_b32 v194, 16, v117
 v_and_b32 v195, 0xffff0000, v117
 v_lshlrev_b32 v196, 16, v118
 v_and_b32 v197, 0xffff0000, v118
 v_lshlrev_b32 v198, 16, v119
 v_and_b32 v199, 0xffff0000, v119
 v_pk_add_f32 v[168:169], v[168:169], v[184:185]
 v_pk_add_f32 v[170:171], v[170:171], v[186:187]
 v_pk_add_f32 v[172:173], v[172:173], v[188:189]
 v_pk_add_f32 v[174:175], v[174:175], v[190:191]
 v_pk_add_f32 v[176:177], v[176:177], v[192:193]
 v_pk_add_f32 v[178:179], v[178:179], v[194:195]
 v_pk_add_f32 v[180:181], v[180:181], v[196:197]
 v_pk_add_f32 v[182:183], v[182:183], v[198:199]
 v_cvt_pk_bf16_f32 v200, v168, v169
 v_cvt_pk_bf16_f32 v201, v170, v171
 v_cvt_pk_bf16_f32 v202, v172, v173
 v_cvt_pk_bf16_f32 v203, v174, v175
 v_cvt_pk_bf16_f32 v204, v176, v177
 v_cvt_pk_bf16_f32 v205, v178, v179
 v_cvt_pk_bf16_f32 v206, v180, v181
 v_cvt_pk_bf16_f32 v207, v182, v183
 v_xor_b32 v184, 192, v79
 ds_write_b64 v184, v[200:201]
 v_xor_b32 v185, 192, v80
 ds_write_b64 v185, v[202:203]
 v_xor_b32 v186, 192, v81
 ds_write_b64 v186, v[204:205]
 v_xor_b32 v187, 192, v82
 ds_write_b64 v187, v[206:207]
 s_waitcnt lgkmcnt(0)
 ds_read_b128 v[120:123], v77 offset:0
 v_xor_b32 v185, 64, v77
 ds_read_b128 v[124:127], v185 offset:1024
 v_xor_b32 v186, 128, v77
 ds_read_b128 v[128:131], v186 offset:2048
 v_xor_b32 v187, 192, v77
 ds_read_b128 v[132:135], v187 offset:3072
 ds_read_b128 v[136:139], v77 offset:4096
 v_xor_b32 v189, 64, v77
 ds_read_b128 v[140:143], v189 offset:5120
 v_xor_b32 v190, 128, v77
 ds_read_b128 v[144:147], v190 offset:6144
 v_xor_b32 v191, 192, v77
 ds_read_b128 v[148:151], v191 offset:7168
 s_lshl_b32 s37, s73, 2
 s_waitcnt lgkmcnt(7)
 buffer_store_dwordx4 v[120:123], v75, s[56:59], s39 offen sc1
 s_add_u32 s39, s39, s37
 s_waitcnt lgkmcnt(6)
 buffer_store_dwordx4 v[124:127], v75, s[56:59], s39 offen sc1
 s_add_u32 s39, s39, s37
 s_waitcnt lgkmcnt(5)
 buffer_store_dwordx4 v[128:131], v75, s[56:59], s39 offen sc1
 s_add_u32 s39, s39, s37
 s_waitcnt lgkmcnt(4)
 buffer_store_dwordx4 v[132:135], v75, s[56:59], s39 offen sc1
 s_add_u32 s39, s39, s37
 s_waitcnt lgkmcnt(3)
 buffer_store_dwordx4 v[136:139], v75, s[56:59], s39 offen sc1
 s_add_u32 s39, s39, s37
 s_waitcnt lgkmcnt(2)
 buffer_store_dwordx4 v[140:143], v75, s[56:59], s39 offen sc1
 s_add_u32 s39, s39, s37
 s_waitcnt lgkmcnt(1)
 buffer_store_dwordx4 v[144:147], v75, s[56:59], s39 offen sc1
 s_add_u32 s39, s39, s37
 s_waitcnt lgkmcnt(0)
 buffer_store_dwordx4 v[148:151], v75, s[56:59], s39 offen sc1
 s_add_u32 s39, s39, s37
 s_branch t_g_exit
t_g_m1:
 s_mov_b32 s60, 0xbfb8aa3b
 v_cvt_pk_bf16_f32 v200, v120, v121
 v_cvt_pk_bf16_f32 v201, v122, v123
 v_cvt_pk_bf16_f32 v202, v124, v125
 v_cvt_pk_bf16_f32 v203, v126, v127
 v_cvt_pk_bf16_f32 v204, v128, v129
 v_cvt_pk_bf16_f32 v205, v130, v131
 v_cvt_pk_bf16_f32 v206, v132, v133
 v_cvt_pk_bf16_f32 v207, v134, v135
 v_lshlrev_b32 v120, 16, v200
 v_and_b32 v121, 0xffff0000, v200
 v_lshlrev_b32 v122, 16, v201
 v_and_b32 v123, 0xffff0000, v201
 v_lshlrev_b32 v124, 16, v202
 v_and_b32 v125, 0xffff0000, v202
 v_lshlrev_b32 v126, 16, v203
 v_and_b32 v127, 0xffff0000, v203
 v_lshlrev_b32 v128, 16, v204
 v_and_b32 v129, 0xffff0000, v204
 v_lshlrev_b32 v130, 16, v205
 v_and_b32 v131, 0xffff0000, v205
 v_lshlrev_b32 v132, 16, v206
 v_and_b32 v133, 0xffff0000, v206
 v_lshlrev_b32 v134, 16, v207
 v_and_b32 v135, 0xffff0000, v207
 v_mul_f32 v184, s60, v120
 v_mul_f32 v185, s60, v121
 v_mul_f32 v186, s60, v122
 v_mul_f32 v187, s60, v123
 v_mul_f32 v188, s60, v124
 v_mul_f32 v189, s60, v125
 v_mul_f32 v190, s60, v126
 v_mul_f32 v191, s60, v127
 v_mul_f32 v192, s60, v128
 v_mul_f32 v193, s60, v129
 v_mul_f32 v194, s60, v130
 v_mul_f32 v195, s60, v131
 v_mul_f32 v196, s60, v132
 v_mul_f32 v197, s60, v133
 v_mul_f32 v198, s60, v134
 v_mul_f32 v199, s60, v135
 v_exp_f32 v184, v184
 v_exp_f32 v185, v185
 v_exp_f32 v186, v186
 v_exp_f32 v187, v187
 v_exp_f32 v188, v188
 v_exp_f32 v189, v189
 v_exp_f32 v190, v190
 v_exp_f32 v191, v191
 v_exp_f32 v192, v192
 v_exp_f32 v193, v193
 v_exp_f32 v194, v194
 v_exp_f32 v195, v195
 v_exp_f32 v196, v196
 v_exp_f32 v197, v197
 v_exp_f32 v198, v198
 v_exp_f32 v199, v199
 v_add_f32 v184, 1.0, v184
 v_add_f32 v185, 1.0, v185
 v_add_f32 v186, 1.0, v186
 v_add_f32 v187, 1.0, v187
 v_add_f32 v188, 1.0, v188
 v_add_f32 v189, 1.0, v189
 v_add_f32 v190, 1.0, v190
 v_add_f32 v191, 1.0, v191
 v_add_f32 v192, 1.0, v192
 v_add_f32 v193, 1.0, v193
 v_add_f32 v194, 1.0, v194
 v_add_f32 v195, 1.0, v195
 v_add_f32 v196, 1.0, v196
 v_add_f32 v197, 1.0, v197
 v_add_f32 v198, 1.0, v198
 v_add_f32 v199, 1.0, v199
 v_rcp_f32 v184, v184
 v_rcp_f32 v185, v185
 v_rcp_f32 v186, v186
 v_rcp_f32 v187, v187
 v_rcp_f32 v188, v188
 v_rcp_f32 v189, v189
 v_rcp_f32 v190, v190
 v_rcp_f32 v191, v191
 v_rcp_f32 v192, v192
 v_rcp_f32 v193, v193
 v_rcp_f32 v194, v194
 v_rcp_f32 v195, v195
 v_rcp_f32 v196, v196
 v_rcp_f32 v197, v197
 v_rcp_f32 v198, v198
 v_rcp_f32 v199, v199
 v_mul_f32 v120, v120, v184
 v_mul_f32 v121, v121, v185
 v_mul_f32 v122, v122, v186
 v_mul_f32 v123, v123, v187
 v_mul_f32 v124, v124, v188
 v_mul_f32 v125, v125, v189
 v_mul_f32 v126, v126, v190
 v_mul_f32 v127, v127, v191
 v_mul_f32 v128, v128, v192
 v_mul_f32 v129, v129, v193
 v_mul_f32 v130, v130, v194
 v_mul_f32 v131, v131, v195
 v_mul_f32 v132, v132, v196
 v_mul_f32 v133, v133, v197
 v_mul_f32 v134, v134, v198
 v_mul_f32 v135, v135, v199
 v_cvt_pk_bf16_f32 v200, v120, v121
 v_cvt_pk_bf16_f32 v201, v122, v123
 v_cvt_pk_bf16_f32 v202, v124, v125
 v_cvt_pk_bf16_f32 v203, v126, v127
 v_cvt_pk_bf16_f32 v204, v128, v129
 v_cvt_pk_bf16_f32 v205, v130, v131
 v_cvt_pk_bf16_f32 v206, v132, v133
 v_cvt_pk_bf16_f32 v207, v134, v135
 ds_write_b64 v79, v[200:201]
 ds_write_b64 v80, v[202:203]
 ds_write_b64 v81, v[204:205]
 ds_write_b64 v82, v[206:207]
 v_cvt_pk_bf16_f32 v200, v136, v137
 v_cvt_pk_bf16_f32 v201, v138, v139
 v_cvt_pk_bf16_f32 v202, v140, v141
 v_cvt_pk_bf16_f32 v203, v142, v143
 v_cvt_pk_bf16_f32 v204, v144, v145
 v_cvt_pk_bf16_f32 v205, v146, v147
 v_cvt_pk_bf16_f32 v206, v148, v149
 v_cvt_pk_bf16_f32 v207, v150, v151
 v_lshlrev_b32 v136, 16, v200
 v_and_b32 v137, 0xffff0000, v200
 v_lshlrev_b32 v138, 16, v201
 v_and_b32 v139, 0xffff0000, v201
 v_lshlrev_b32 v140, 16, v202
 v_and_b32 v141, 0xffff0000, v202
 v_lshlrev_b32 v142, 16, v203
 v_and_b32 v143, 0xffff0000, v203
 v_lshlrev_b32 v144, 16, v204
 v_and_b32 v145, 0xffff0000, v204
 v_lshlrev_b32 v146, 16, v205
 v_and_b32 v147, 0xffff0000, v205
 v_lshlrev_b32 v148, 16, v206
 v_and_b32 v149, 0xffff0000, v206
 v_lshlrev_b32 v150, 16, v207
 v_and_b32 v151, 0xffff0000, v207
 v_mul_f32 v184, s60, v136
 v_mul_f32 v185, s60, v137
 v_mul_f32 v186, s60, v138
 v_mul_f32 v187, s60, v139
 v_mul_f32 v188, s60, v140
 v_mul_f32 v189, s60, v141
 v_mul_f32 v190, s60, v142
 v_mul_f32 v191, s60, v143
 v_mul_f32 v192, s60, v144
 v_mul_f32 v193, s60, v145
 v_mul_f32 v194, s60, v146
 v_mul_f32 v195, s60, v147
 v_mul_f32 v196, s60, v148
 v_mul_f32 v197, s60, v149
 v_mul_f32 v198, s60, v150
 v_mul_f32 v199, s60, v151
 v_exp_f32 v184, v184
 v_exp_f32 v185, v185
 v_exp_f32 v186, v186
 v_exp_f32 v187, v187
 v_exp_f32 v188, v188
 v_exp_f32 v189, v189
 v_exp_f32 v190, v190
 v_exp_f32 v191, v191
 v_exp_f32 v192, v192
 v_exp_f32 v193, v193
 v_exp_f32 v194, v194
 v_exp_f32 v195, v195
 v_exp_f32 v196, v196
 v_exp_f32 v197, v197
 v_exp_f32 v198, v198
 v_exp_f32 v199, v199
 v_add_f32 v184, 1.0, v184
 v_add_f32 v185, 1.0, v185
 v_add_f32 v186, 1.0, v186
 v_add_f32 v187, 1.0, v187
 v_add_f32 v188, 1.0, v188
 v_add_f32 v189, 1.0, v189
 v_add_f32 v190, 1.0, v190
 v_add_f32 v191, 1.0, v191
 v_add_f32 v192, 1.0, v192
 v_add_f32 v193, 1.0, v193
 v_add_f32 v194, 1.0, v194
 v_add_f32 v195, 1.0, v195
 v_add_f32 v196, 1.0, v196
 v_add_f32 v197, 1.0, v197
 v_add_f32 v198, 1.0, v198
 v_add_f32 v199, 1.0, v199
 v_rcp_f32 v184, v184
 v_rcp_f32 v185, v185
 v_rcp_f32 v186, v186
 v_rcp_f32 v187, v187
 v_rcp_f32 v188, v188
 v_rcp_f32 v189, v189
 v_rcp_f32 v190, v190
 v_rcp_f32 v191, v191
 v_rcp_f32 v192, v192
 v_rcp_f32 v193, v193
 v_rcp_f32 v194, v194
 v_rcp_f32 v195, v195
 v_rcp_f32 v196, v196
 v_rcp_f32 v197, v197
 v_rcp_f32 v198, v198
 v_rcp_f32 v199, v199
 v_mul_f32 v136, v136, v184
 v_mul_f32 v137, v137, v185
 v_mul_f32 v138, v138, v186
 v_mul_f32 v139, v139, v187
 v_mul_f32 v140, v140, v188
 v_mul_f32 v141, v141, v189
 v_mul_f32 v142, v142, v190
 v_mul_f32 v143, v143, v191
 v_mul_f32 v144, v144, v192
 v_mul_f32 v145, v145, v193
 v_mul_f32 v146, v146, v194
 v_mul_f32 v147, v147, v195
 v_mul_f32 v148, v148, v196
 v_mul_f32 v149, v149, v197
 v_mul_f32 v150, v150, v198
 v_mul_f32 v151, v151, v199
 v_cvt_pk_bf16_f32 v200, v136, v137
 v_cvt_pk_bf16_f32 v201, v138, v139
 v_cvt_pk_bf16_f32 v202, v140, v141
 v_cvt_pk_bf16_f32 v203, v142, v143
 v_cvt_pk_bf16_f32 v204, v144, v145
 v_cvt_pk_bf16_f32 v205, v146, v147
 v_cvt_pk_bf16_f32 v206, v148, v149
 v_cvt_pk_bf16_f32 v207, v150, v151
 v_xor_b32 v184, 64, v79
 ds_write_b64 v184, v[200:201]
 v_xor_b32 v185, 64, v80
 ds_write_b64 v185, v[202:203]
 v_xor_b32 v186, 64, v81
 ds_write_b64 v186, v[204:205]
 v_xor_b32 v187, 64, v82
 ds_write_b64 v187, v[206:207]
 v_cvt_pk_bf16_f32 v200, v152, v153
 v_cvt_pk_bf16_f32 v201, v154, v155
 v_cvt_pk_bf16_f32 v202, v156, v157
 v_cvt_pk_bf16_f32 v203, v158, v159
 v_cvt_pk_bf16_f32 v204, v160, v161
 v_cvt_pk_bf16_f32 v205, v162, v163
 v_cvt_pk_bf16_f32 v206, v164, v165
 v_cvt_pk_bf16_f32 v207, v166, v167
 v_lshlrev_b32 v152, 16, v200
 v_and_b32 v153, 0xffff0000, v200
 v_lshlrev_b32 v154, 16, v201
 v_and_b32 v155, 0xffff0000, v201
 v_lshlrev_b32 v156, 16, v202
 v_and_b32 v157, 0xffff0000, v202
 v_lshlrev_b32 v158, 16, v203
 v_and_b32 v159, 0xffff0000, v203
 v_lshlrev_b32 v160, 16, v204
 v_and_b32 v161, 0xffff0000, v204
 v_lshlrev_b32 v162, 16, v205
 v_and_b32 v163, 0xffff0000, v205
 v_lshlrev_b32 v164, 16, v206
 v_and_b32 v165, 0xffff0000, v206
 v_lshlrev_b32 v166, 16, v207
 v_and_b32 v167, 0xffff0000, v207
 v_mul_f32 v184, s60, v152
 v_mul_f32 v185, s60, v153
 v_mul_f32 v186, s60, v154
 v_mul_f32 v187, s60, v155
 v_mul_f32 v188, s60, v156
 v_mul_f32 v189, s60, v157
 v_mul_f32 v190, s60, v158
 v_mul_f32 v191, s60, v159
 v_mul_f32 v192, s60, v160
 v_mul_f32 v193, s60, v161
 v_mul_f32 v194, s60, v162
 v_mul_f32 v195, s60, v163
 v_mul_f32 v196, s60, v164
 v_mul_f32 v197, s60, v165
 v_mul_f32 v198, s60, v166
 v_mul_f32 v199, s60, v167
 v_exp_f32 v184, v184
 v_exp_f32 v185, v185
 v_exp_f32 v186, v186
 v_exp_f32 v187, v187
 v_exp_f32 v188, v188
 v_exp_f32 v189, v189
 v_exp_f32 v190, v190
 v_exp_f32 v191, v191
 v_exp_f32 v192, v192
 v_exp_f32 v193, v193
 v_exp_f32 v194, v194
 v_exp_f32 v195, v195
 v_exp_f32 v196, v196
 v_exp_f32 v197, v197
 v_exp_f32 v198, v198
 v_exp_f32 v199, v199
 v_add_f32 v184, 1.0, v184
 v_add_f32 v185, 1.0, v185
 v_add_f32 v186, 1.0, v186
 v_add_f32 v187, 1.0, v187
 v_add_f32 v188, 1.0, v188
 v_add_f32 v189, 1.0, v189
 v_add_f32 v190, 1.0, v190
 v_add_f32 v191, 1.0, v191
 v_add_f32 v192, 1.0, v192
 v_add_f32 v193, 1.0, v193
 v_add_f32 v194, 1.0, v194
 v_add_f32 v195, 1.0, v195
 v_add_f32 v196, 1.0, v196
 v_add_f32 v197, 1.0, v197
 v_add_f32 v198, 1.0, v198
 v_add_f32 v199, 1.0, v199
 v_rcp_f32 v184, v184
 v_rcp_f32 v185, v185
 v_rcp_f32 v186, v186
 v_rcp_f32 v187, v187
 v_rcp_f32 v188, v188
 v_rcp_f32 v189, v189
 v_rcp_f32 v190, v190
 v_rcp_f32 v191, v191
 v_rcp_f32 v192, v192
 v_rcp_f32 v193, v193
 v_rcp_f32 v194, v194
 v_rcp_f32 v195, v195
 v_rcp_f32 v196, v196
 v_rcp_f32 v197, v197
 v_rcp_f32 v198, v198
 v_rcp_f32 v199, v199
 v_mul_f32 v152, v152, v184
 v_mul_f32 v153, v153, v185
 v_mul_f32 v154, v154, v186
 v_mul_f32 v155, v155, v187
 v_mul_f32 v156, v156, v188
 v_mul_f32 v157, v157, v189
 v_mul_f32 v158, v158, v190
 v_mul_f32 v159, v159, v191
 v_mul_f32 v160, v160, v192
 v_mul_f32 v161, v161, v193
 v_mul_f32 v162, v162, v194
 v_mul_f32 v163, v163, v195
 v_mul_f32 v164, v164, v196
 v_mul_f32 v165, v165, v197
 v_mul_f32 v166, v166, v198
 v_mul_f32 v167, v167, v199
 v_cvt_pk_bf16_f32 v200, v152, v153
 v_cvt_pk_bf16_f32 v201, v154, v155
 v_cvt_pk_bf16_f32 v202, v156, v157
 v_cvt_pk_bf16_f32 v203, v158, v159
 v_cvt_pk_bf16_f32 v204, v160, v161
 v_cvt_pk_bf16_f32 v205, v162, v163
 v_cvt_pk_bf16_f32 v206, v164, v165
 v_cvt_pk_bf16_f32 v207, v166, v167
 v_xor_b32 v184, 128, v79
 ds_write_b64 v184, v[200:201]
 v_xor_b32 v185, 128, v80
 ds_write_b64 v185, v[202:203]
 v_xor_b32 v186, 128, v81
 ds_write_b64 v186, v[204:205]
 v_xor_b32 v187, 128, v82
 ds_write_b64 v187, v[206:207]
 v_cvt_pk_bf16_f32 v200, v168, v169
 v_cvt_pk_bf16_f32 v201, v170, v171
 v_cvt_pk_bf16_f32 v202, v172, v173
 v_cvt_pk_bf16_f32 v203, v174, v175
 v_cvt_pk_bf16_f32 v204, v176, v177
 v_cvt_pk_bf16_f32 v205, v178, v179
 v_cvt_pk_bf16_f32 v206, v180, v181
 v_cvt_pk_bf16_f32 v207, v182, v183
 v_lshlrev_b32 v168, 16, v200
 v_and_b32 v169, 0xffff0000, v200
 v_lshlrev_b32 v170, 16, v201
 v_and_b32 v171, 0xffff0000, v201
 v_lshlrev_b32 v172, 16, v202
 v_and_b32 v173, 0xffff0000, v202
 v_lshlrev_b32 v174, 16, v203
 v_and_b32 v175, 0xffff0000, v203
 v_lshlrev_b32 v176, 16, v204
 v_and_b32 v177, 0xffff0000, v204
 v_lshlrev_b32 v178, 16, v205
 v_and_b32 v179, 0xffff0000, v205
 v_lshlrev_b32 v180, 16, v206
 v_and_b32 v181, 0xffff0000, v206
 v_lshlrev_b32 v182, 16, v207
 v_and_b32 v183, 0xffff0000, v207
 v_mul_f32 v184, s60, v168
 v_mul_f32 v185, s60, v169
 v_mul_f32 v186, s60, v170
 v_mul_f32 v187, s60, v171
 v_mul_f32 v188, s60, v172
 v_mul_f32 v189, s60, v173
 v_mul_f32 v190, s60, v174
 v_mul_f32 v191, s60, v175
 v_mul_f32 v192, s60, v176
 v_mul_f32 v193, s60, v177
 v_mul_f32 v194, s60, v178
 v_mul_f32 v195, s60, v179
 v_mul_f32 v196, s60, v180
 v_mul_f32 v197, s60, v181
 v_mul_f32 v198, s60, v182
 v_mul_f32 v199, s60, v183
 v_exp_f32 v184, v184
 v_exp_f32 v185, v185
 v_exp_f32 v186, v186
 v_exp_f32 v187, v187
 v_exp_f32 v188, v188
 v_exp_f32 v189, v189
 v_exp_f32 v190, v190
 v_exp_f32 v191, v191
 v_exp_f32 v192, v192
 v_exp_f32 v193, v193
 v_exp_f32 v194, v194
 v_exp_f32 v195, v195
 v_exp_f32 v196, v196
 v_exp_f32 v197, v197
 v_exp_f32 v198, v198
 v_exp_f32 v199, v199
 v_add_f32 v184, 1.0, v184
 v_add_f32 v185, 1.0, v185
 v_add_f32 v186, 1.0, v186
 v_add_f32 v187, 1.0, v187
 v_add_f32 v188, 1.0, v188
 v_add_f32 v189, 1.0, v189
 v_add_f32 v190, 1.0, v190
 v_add_f32 v191, 1.0, v191
 v_add_f32 v192, 1.0, v192
 v_add_f32 v193, 1.0, v193
 v_add_f32 v194, 1.0, v194
 v_add_f32 v195, 1.0, v195
 v_add_f32 v196, 1.0, v196
 v_add_f32 v197, 1.0, v197
 v_add_f32 v198, 1.0, v198
 v_add_f32 v199, 1.0, v199
 v_rcp_f32 v184, v184
 v_rcp_f32 v185, v185
 v_rcp_f32 v186, v186
 v_rcp_f32 v187, v187
 v_rcp_f32 v188, v188
 v_rcp_f32 v189, v189
 v_rcp_f32 v190, v190
 v_rcp_f32 v191, v191
 v_rcp_f32 v192, v192
 v_rcp_f32 v193, v193
 v_rcp_f32 v194, v194
 v_rcp_f32 v195, v195
 v_rcp_f32 v196, v196
 v_rcp_f32 v197, v197
 v_rcp_f32 v198, v198
 v_rcp_f32 v199, v199
 v_mul_f32 v168, v168, v184
 v_mul_f32 v169, v169, v185
 v_mul_f32 v170, v170, v186
 v_mul_f32 v171, v171, v187
 v_mul_f32 v172, v172, v188
 v_mul_f32 v173, v173, v189
 v_mul_f32 v174, v174, v190
 v_mul_f32 v175, v175, v191
 v_mul_f32 v176, v176, v192
 v_mul_f32 v177, v177, v193
 v_mul_f32 v178, v178, v194
 v_mul_f32 v179, v179, v195
 v_mul_f32 v180, v180, v196
 v_mul_f32 v181, v181, v197
 v_mul_f32 v182, v182, v198
 v_mul_f32 v183, v183, v199
 v_cvt_pk_bf16_f32 v200, v168, v169
 v_cvt_pk_bf16_f32 v201, v170, v171
 v_cvt_pk_bf16_f32 v202, v172, v173
 v_cvt_pk_bf16_f32 v203, v174, v175
 v_cvt_pk_bf16_f32 v204, v176, v177
 v_cvt_pk_bf16_f32 v205, v178, v179
 v_cvt_pk_bf16_f32 v206, v180, v181
 v_cvt_pk_bf16_f32 v207, v182, v183
 v_xor_b32 v184, 192, v79
 ds_write_b64 v184, v[200:201]
 v_xor_b32 v185, 192, v80
 ds_write_b64 v185, v[202:203]
 v_xor_b32 v186, 192, v81
 ds_write_b64 v186, v[204:205]
 v_xor_b32 v187, 192, v82
 ds_write_b64 v187, v[206:207]
 s_waitcnt lgkmcnt(0)
 ds_read_b128 v[120:123], v87 offset:0
 v_xor_b32 v185, 32, v87
 ds_read_b128 v[124:127], v185 offset:0
 v_xor_b32 v186, 64, v87
 ds_read_b128 v[128:131], v186 offset:0
 v_xor_b32 v187, 96, v87
 ds_read_b128 v[132:135], v187 offset:0
 v_xor_b32 v188, 128, v87
 ds_read_b128 v[136:139], v188 offset:0
 v_xor_b32 v189, 160, v87
 ds_read_b128 v[140:143], v189 offset:0
 v_xor_b32 v190, 192, v87
 ds_read_b128 v[144:147], v190 offset:0
 v_xor_b32 v191, 224, v87
 ds_read_b128 v[148:151], v191 offset:0
 s_lshl_b32 s37, s26, 13
 s_add_u32 s39, s61, s37
 s_add_u32 s39, s39, s74
 s_mov_b32 s37, 1024
 s_waitcnt lgkmcnt(7)
 buffer_store_dwordx4 v[120:123], v208, s[4:7], s39 offen sc1
 s_add_u32 s39, s39, s37
 s_waitcnt lgkmcnt(6)
 buffer_store_dwordx4 v[124:127], v208, s[4:7], s39 offen sc1
 s_add_u32 s39, s39, s37
 s_waitcnt lgkmcnt(5)
 buffer_store_dwordx4 v[128:131], v208, s[4:7], s39 offen sc1
 s_add_u32 s39, s39, s37
 s_waitcnt lgkmcnt(4)
 buffer_store_dwordx4 v[132:135], v208, s[4:7], s39 offen sc1
 s_add_u32 s39, s39, s37
 s_waitcnt lgkmcnt(3)
 buffer_store_dwordx4 v[136:139], v208, s[4:7], s39 offen sc1
 s_add_u32 s39, s39, s37
 s_waitcnt lgkmcnt(2)
 buffer_store_dwordx4 v[140:143], v208, s[4:7], s39 offen sc1
 s_add_u32 s39, s39, s37
 s_waitcnt lgkmcnt(1)
 buffer_store_dwordx4 v[144:147], v208, s[4:7], s39 offen sc1
 s_add_u32 s39, s39, s37
 s_waitcnt lgkmcnt(0)
 buffer_store_dwordx4 v[148:151], v208, s[4:7], s39 offen sc1
 s_add_u32 s39, s39, s37
 s_branch t_g_exit
t_g_m2:
 ds_write_b128 v83, v[120:123] offset:0
 ds_write_b128 v84, v[124:127] offset:0
 ds_write_b128 v85, v[128:131] offset:0
 ds_write_b128 v86, v[132:135] offset:0
 ds_write_b128 v83, v[136:139] offset:128
 ds_write_b128 v84, v[140:143] offset:128
 ds_write_b128 v85, v[144:147] offset:128
 ds_write_b128 v86, v[148:151] offset:128
 ds_write_b128 v83, v[152:155] offset:256
 ds_write_b128 v84, v[156:159] offset:256
 ds_write_b128 v85, v[160:163] offset:256
 ds_write_b128 v86, v[164:167] offset:256
 ds_write_b128 v83, v[168:171] offset:384
 ds_write_b128 v84, v[172:175] offset:384
 ds_write_b128 v85, v[176:179] offset:384
 ds_write_b128 v86, v[180:183] offset:384
 s_waitcnt lgkmcnt(0)
 ds_read_b128 v[120:123], v78 offset:0
 v_xor_b32 v185, 32, v78
 ds_read_b128 v[124:127], v185 offset:1024
 v_xor_b32 v186, 64, v78
 ds_read_b128 v[128:131], v186 offset:2048
 v_xor_b32 v187, 96, v78
 ds_read_b128 v[132:135], v187 offset:3072
 ds_read_b128 v[136:139], v78 offset:4096
 v_xor_b32 v189, 32, v78
 ds_read_b128 v[140:143], v189 offset:5120
 v_xor_b32 v190, 64, v78
 ds_read_b128 v[144:147], v190 offset:6144
 v_xor_b32 v191, 96, v78
 ds_read_b128 v[148:151], v191 offset:7168
 ds_read_b128 v[152:155], v78 offset:8192
 v_xor_b32 v185, 32, v78
 ds_read_b128 v[156:159], v185 offset:9216
 v_xor_b32 v186, 64, v78
 ds_read_b128 v[160:163], v186 offset:10240
 v_xor_b32 v187, 96, v78
 ds_read_b128 v[164:167], v187 offset:11264
 ds_read_b128 v[168:171], v78 offset:12288
 v_xor_b32 v189, 32, v78
 ds_read_b128 v[172:175], v189 offset:13312
 v_xor_b32 v190, 64, v78
 ds_read_b128 v[176:179], v190 offset:14336
 v_xor_b32 v191, 96, v78
 ds_read_b128 v[180:183], v191 offset:15360
 s_lshl_b32 s37, s73, 1
 s_waitcnt lgkmcnt(15)
 buffer_store_dwordx4 v[120:123], v76, s[4:7], s39 offen sc1
 s_add_u32 s39, s39, s37
 s_waitcnt lgkmcnt(14)
 buffer_store_dwordx4 v[124:127], v76, s[4:7], s39 offen sc1
 s_add_u32 s39, s39, s37
 s_waitcnt lgkmcnt(13)
 buffer_store_dwordx4 v[128:131], v76, s[4:7], s39 offen sc1
 s_add_u32 s39, s39, s37
 s_waitcnt lgkmcnt(12)
 buffer_store_dwordx4 v[132:135], v76, s[4:7], s39 offen sc1
 s_add_u32 s39, s39, s37
 s_waitcnt lgkmcnt(11)
 buffer_store_dwordx4 v[136:139], v76, s[4:7], s39 offen sc1
 s_add_u32 s39, s39, s37
 s_waitcnt lgkmcnt(10)
 buffer_store_dwordx4 v[140:143], v76, s[4:7], s39 offen sc1
 s_add_u32 s39, s39, s37
 s_waitcnt lgkmcnt(9)
 buffer_store_dwordx4 v[144:147], v76, s[4:7], s39 offen sc1
 s_add_u32 s39, s39, s37
 s_waitcnt lgkmcnt(8)
 buffer_store_dwordx4 v[148:151], v76, s[4:7], s39 offen sc1
 s_add_u32 s39, s39, s37
 s_waitcnt lgkmcnt(7)
 buffer_store_dwordx4 v[152:155], v76, s[4:7], s39 offen sc1
 s_add_u32 s39, s39, s37
 s_waitcnt lgkmcnt(6)
 buffer_store_dwordx4 v[156:159], v76, s[4:7], s39 offen sc1
 s_add_u32 s39, s39, s37
 s_waitcnt lgkmcnt(5)
 buffer_store_dwordx4 v[160:163], v76, s[4:7], s39 offen sc1
 s_add_u32 s39, s39, s37
 s_waitcnt lgkmcnt(4)
 buffer_store_dwordx4 v[164:167], v76, s[4:7], s39 offen sc1
 s_add_u32 s39, s39, s37
 s_waitcnt lgkmcnt(3)
 buffer_store_dwordx4 v[168:171], v76, s[4:7], s39 offen sc1
 s_add_u32 s39, s39, s37
 s_waitcnt lgkmcnt(2)
 buffer_store_dwordx4 v[172:175], v76, s[4:7], s39 offen sc1
 s_add_u32 s39, s39, s37
 s_waitcnt lgkmcnt(1)
 buffer_store_dwordx4 v[176:179], v76, s[4:7], s39 offen sc1
 s_add_u32 s39, s39, s37
 s_waitcnt lgkmcnt(0)
 buffer_store_dwordx4 v[180:183], v76, s[4:7], s39 offen sc1
 s_add_u32 s39, s39, s37
t_g_exit:
 s_add_u32 s26, s26, 1
 s_mov_b32 s79, 0
 s_cmp_lg_u32 s78, 0
 s_cbranch_scc1 t_g_tile
 s_branch mega_done

t_g2:
 s_load_dwordx2 s[40:41], s[0:1], 96
 s_load_dwordx2 s[42:43], s[0:1], s70
 s_load_dwordx2 s[44:45], s[0:1], 80
 s_load_dwordx2 s[48:49], s[0:1], 0
 v_and_b32 v1, 63, v0
 v_lshrrev_b32 v13, 6, v0
 s_mov_b32 s25, s92
 v_readfirstlane_b32 s24, v13
 s_mov_b32 s26, s93
 s_and_b32 s27, s24, 3
 s_lshr_b32 s36, s24, 2
 s_and_b32 s28, s36, 0
 s_lshr_b32 s29, s36, 0

 v_lshlrev_b32 v13, 4, v1
 s_mul_i32 s36, s24, 4
 s_add_u32 s36, s36, 0
 s_lshr_b32 s37, s36, 1
 s_and_b32 s36, s36, 1
 s_mul_i32 s38, s25, 8
 s_add_u32 s37, s37, s38
 s_mul_i32 s37, s37, s64
 s_lshl_b32 s36, s36, 10
 s_add_u32 s36, s36, s37
 v_add_u32 v2, s36, v13

 s_mul_i32 s36, s24, 4
 s_add_u32 s36, s36, 1
 s_lshr_b32 s37, s36, 1
 s_and_b32 s36, s36, 1
 s_mul_i32 s38, s25, 8
 s_add_u32 s37, s37, s38
 s_mul_i32 s37, s37, s64
 s_lshl_b32 s36, s36, 10
 s_add_u32 s36, s36, s37
 v_add_u32 v3, s36, v13

 s_mul_i32 s36, s24, 4
 s_add_u32 s36, s36, 2
 s_lshr_b32 s37, s36, 1
 s_and_b32 s36, s36, 1
 s_mul_i32 s38, s25, 8
 s_add_u32 s37, s37, s38
 s_mul_i32 s37, s37, s64
 s_lshl_b32 s36, s36, 10
 s_add_u32 s36, s36, s37
 v_add_u32 v4, s36, v13

 s_mul_i32 s36, s24, 4
 s_add_u32 s36, s36, 3
 s_lshr_b32 s37, s36, 1
 s_and_b32 s36, s36, 1
 s_mul_i32 s38, s25, 8
 s_add_u32 s37, s37, s38
 s_mul_i32 s37, s37, s64
 s_lshl_b32 s36, s36, 10
 s_add_u32 s36, s36, s37
 v_add_u32 v5, s36, v13

 s_mul_i32 s36, s24, 128
 v_add_u32 v13, s36, v1

 v_lshrrev_b32 v14, 4, v13
 v_and_b32 v15, 15, v13
 v_and_b32 v16, 3, v14
 v_lshlrev_b32 v16, 2, v16
 v_xor_b32 v15, v15, v16

 v_mul_lo_u32 v14, v14, s65
 v_lshl_add_u32 v6, v15, 4, v14
 v_add_u32 v13, 64, v13
 v_lshrrev_b32 v14, 4, v13
 v_and_b32 v15, 15, v13
 v_and_b32 v16, 3, v14
 v_lshlrev_b32 v16, 2, v16
 v_xor_b32 v15, v15, v16

 v_mul_lo_u32 v14, v14, s65
 v_lshl_add_u32 v7, v15, 4, v14
 s_mov_b32 s30, s66
 s_mul_i32 s63, s26, 256
 s_add_u32 s63, s63, s67
 s_mov_b32 s31, s63
 s_mul_i32 s32, s24, 4096
 s_mul_i32 s51, s24, 2048
 s_mov_b32 s35, 0
 s_mov_b32 s50, 24576
 s_mov_b32 s62, s69
 s_mov_b32 s78, s89
 s_mov_b32 s79, 1
 s_waitcnt lgkmcnt(0)

 s_mov_b32 s4, s40
 s_and_b32 s5, s41, 0xffff
 s_mov_b32 s6, 0x10000000
 s_mov_b32 s7, 0x00020000
 s_mov_b32 s8, s42
 s_and_b32 s9, s43, 0xffff
 s_mov_b32 s10, 0x0
 s_mov_b32 s11, 0x00020000
 s_mov_b32 s10, s71
 s_lshl_b32 s86, s94, 10
 s_add_u32 s86, s86, 161480704
 v_and_b32 v18, 7, v0
 v_lshlrev_b32 v18, 7, v18
 buffer_load_dword v17, v18, s[80:83], s86 offen sc1

 s_mov_b32 s36, s31
 s_add_u32 m0, s51, 16384
 s_nop 0
 buffer_load_dwordx4 v6, s[8:11], s36 offen lds
 s_add_u32 m0, s51, 17408
 s_nop 0
 buffer_load_dwordx4 v7, s[8:11], s36 offen lds
 s_add_u32 s36, s36, s85
 s_add_u32 m0, s51, 40960
 s_nop 0
 buffer_load_dwordx4 v6, s[8:11], s36 offen lds
 s_add_u32 m0, s51, 41984
 s_nop 0
 buffer_load_dwordx4 v7, s[8:11], s36 offen lds
 s_add_u32 s36, s36, s85
 s_add_u32 m0, s51, 65536
 s_nop 0
 buffer_load_dwordx4 v6, s[8:11], s36 offen lds
 s_add_u32 m0, s51, 66560
 s_nop 0
 buffer_load_dwordx4 v7, s[8:11], s36 offen lds
 s_mov_b32 s12, s44
 s_and_b32 s13, s45, 0xffff
 s_mov_b32 s14, 0x400000
 s_mov_b32 s15, 0x00020000
 s_mov_b32 s20, s48
 s_and_b32 s21, s49, 0xffff
 s_mov_b32 s22, 0x400000
 s_mov_b32 s23, 0x00020000
 s_mul_i32 s36, s27, 4096
 s_mul_i32 s37, s29, 2048
 s_add_u32 s36, s36, s37
 v_lshlrev_b32 v13, 4, v1
 v_add_u32 v8, s36, v13

 v_bfe_u32 v13, v1, 2, 2
 v_lshrrev_b32 v14, 5, v1
 v_lshl_add_u32 v14, v14, 3, v13
 s_mul_i32 s36, s29, 32
 v_add_u32 v14, s36, v14
 v_mul_u32_u24 v14, 256, v14
 v_bfe_u32 v15, v1, 4, 1
 v_lshl_add_u32 v14, v15, 5, v14
 v_and_b32 v15, 3, v1
 v_lshl_add_u32 v14, v15, 3, v14
 v_add_u32 v14, 16384, v14
 v_and_b32 v16, 3, v13

 s_mul_i32 s36, s28, 4
 s_add_u32 s36, s36, 0
 v_xor_b32 v15, s36, v16
 v_lshl_add_u32 v9, v15, 6, v14
 s_mul_i32 s36, s28, 4
 s_add_u32 s36, s36, 1
 v_xor_b32 v15, s36, v16
 v_lshl_add_u32 v10, v15, 6, v14
 s_mul_i32 s36, s28, 4
 s_add_u32 s36, s36, 2
 v_xor_b32 v15, s36, v16
 v_lshl_add_u32 v11, v15, 6, v14
 s_mul_i32 s36, s28, 4
 s_add_u32 s36, s36, 3
 v_xor_b32 v15, s36, v16
 v_lshl_add_u32 v12, v15, 6, v14
 s_lshl_b32 s61, s24, 14
 s_add_u32 s61, s61, 98304
 v_and_b32 v156, 31, v1
 v_lshrrev_b32 v157, 5, v1
 v_mul_lo_u32 v68, v156, s73
 v_lshl_add_u32 v68, v157, 3, v68
 v_and_b32 v158, 15, v156
 v_xor_b32 v158, v158, v157
 v_lshlrev_b32 v158, 4, v158
 v_lshl_add_u32 v158, v156, 8, v158
 v_add_u32 v71, s61, v158
 v_lshlrev_b32 v212, 4, v1

 v_and_b32 v158, 15, v156
 v_xor_b32 v158, 0, v158
 v_lshlrev_b32 v158, 4, v158
 v_lshl_add_u32 v158, v156, 8, v158
 v_lshl_add_u32 v158, v157, 3, v158
 v_add_u32 v72, s61, v158

 v_and_b32 v158, 15, v156
 v_xor_b32 v158, 1, v158
 v_lshlrev_b32 v158, 4, v158
 v_lshl_add_u32 v158, v156, 8, v158
 v_lshl_add_u32 v158, v157, 3, v158
 v_add_u32 v73, s61, v158

 v_and_b32 v158, 15, v156
 v_xor_b32 v158, 2, v158
 v_lshlrev_b32 v158, 4, v158
 v_lshl_add_u32 v158, v156, 8, v158
 v_lshl_add_u32 v158, v157, 3, v158
 v_add_u32 v74, s61, v158

 v_and_b32 v158, 15, v156
 v_xor_b32 v158, 3, v158
 v_lshlrev_b32 v158, 4, v158
 v_lshl_add_u32 v158, v156, 8, v158
 v_lshl_add_u32 v158, v157, 3, v158
 v_add_u32 v75, s61, v158

 v_lshrrev_b32 v156, 4, v1
 v_and_b32 v157, 15, v1
 v_mul_lo_u32 v69, v156, s73
 v_lshl_add_u32 v69, v157, 4, v69
 v_xor_b32 v158, v157, v156
 v_lshlrev_b32 v158, 4, v158
 v_lshl_add_u32 v158, v156, 8, v158
 v_add_u32 v70, s61, v158
 s_cmp_eq_u32 s75, 0
 s_cselect_b32 s52, s20, s4
 s_cselect_b32 s53, s21, s5
 s_cselect_b32 s54, s22, s6
 s_mov_b32 s55, 0x00020000
 s_cselect_b32 s60, 0, 71303168
 s_cmp_eq_u32 s75, 2
 s_cselect_b32 s56, s12, s4
 s_cselect_b32 s57, s13, s5
 s_cselect_b32 s58, s14, s6
 s_mov_b32 s59, 0x00020000
 s_lshl_b32 s61, s25, 8
 s_lshl_b32 s37, s24, 6
 s_add_u32 s61, s61, s37
 s_mul_i32 s61, s61, s73

 s_add_u32 s30, s30, 2048
 s_add_u32 s31, s31, s85
 s_add_u32 s32, s32, 24576
 s_add_u32 s51, s51, 24576
 s_cmp_ge_u32 s32, 98304
 s_cselect_b32 s38, 98304, 0
 s_sub_u32 s32, s32, s38
 s_sub_u32 s51, s51, s38
 s_sub_u32 s62, s62, 1
 s_cmp_eq_u32 s62, 0
 s_cselect_b32 s38, 256, 0
 s_cselect_b32 s30, s66, s30
 s_cselect_b32 s62, s69, s62
 s_add_u32 s63, s63, s38
 s_cmp_lg_u32 s38, 0
 s_cselect_b32 s31, s63, s31
 s_add_u32 s30, s30, 2048
 s_add_u32 s31, s31, s85
 s_add_u32 s32, s32, 24576
 s_add_u32 s51, s51, 24576
 s_cmp_ge_u32 s32, 98304
 s_cselect_b32 s38, 98304, 0
 s_sub_u32 s32, s32, s38
 s_sub_u32 s51, s51, s38
 s_sub_u32 s62, s62, 1
 s_cmp_eq_u32 s62, 0
 s_cselect_b32 s38, 256, 0
 s_cselect_b32 s30, s66, s30
 s_cselect_b32 s62, s69, s62
 s_add_u32 s63, s63, s38
 s_cmp_lg_u32 s38, 0
 s_cselect_b32 s31, s63, s31
 s_add_u32 s30, s30, 2048
 s_add_u32 s31, s31, s85
 s_add_u32 s32, s32, 24576
 s_add_u32 s51, s51, 24576
 s_cmp_ge_u32 s32, 98304
 s_cselect_b32 s38, 98304, 0
 s_sub_u32 s32, s32, s38
 s_sub_u32 s51, s51, s38
 s_sub_u32 s62, s62, 1
 s_cmp_eq_u32 s62, 0
 s_cselect_b32 s38, 256, 0
 s_cselect_b32 s30, s66, s30
 s_cselect_b32 s62, s69, s62
 s_add_u32 s63, s63, s38
 s_cmp_lg_u32 s38, 0
 s_cselect_b32 s31, s63, s31
 s_mov_b32 s30, s66
 s_mul_i32 s32, s24, 4096
 s_waitcnt vmcnt(6)
 s_nop 1
 v_add_u32_dpp v17, v17, v17 quad_perm:[1,0,3,2] row_mask:0xf bank_mask:0xf
 s_nop 1
 v_add_u32_dpp v17, v17, v17 quad_perm:[2,3,0,1] row_mask:0xf bank_mask:0xf
 s_nop 1
 v_add_u32_dpp v17, v17, v17 row_half_mirror row_mask:0xf bank_mask:0xf
 v_cmp_gt_u32 vcc, s95, v17
 s_cmp_lg_u32 s90, 0
 s_cbranch_scc1 dw_166
 s_cbranch_vccz dw_167

dw_164:
 s_sub_u32 s91, s91, 16
 s_cbranch_scc1 chain_exit
 v_add_u32 v17, 6, v17
 v_cmp_gt_u32 vcc, s95, v17
 s_cbranch_vccz dw_168
 s_sleep 20

dw_168:
 s_sleep 3
 buffer_load_dword v17, v18, s[80:83], s86 offen sc1
 s_waitcnt vmcnt(0)

 s_nop 1
 v_add_u32_dpp v17, v17, v17 quad_perm:[1,0,3,2] row_mask:0xf bank_mask:0xf
 s_nop 1
 v_add_u32_dpp v17, v17, v17 quad_perm:[2,3,0,1] row_mask:0xf bank_mask:0xf
 s_nop 1
 v_add_u32_dpp v17, v17, v17 row_half_mirror row_mask:0xf bank_mask:0xf
 v_cmp_gt_u32 vcc, s95, v17
 s_cbranch_vccnz dw_164

dw_167:
 v_mov_b32 v17, s101
 v_mov_b32 v18, 163824
 ds_write_b32 v18, v17
 s_branch dw_165

dw_166:
 s_cbranch_vccz dw_165
 v_mov_b32 v18, 163824
dw_169:
 s_sub_u32 s91, s91, 4
 s_cbranch_scc1 chain_exit
 s_sleep 1
 ds_read_b32 v17, v18
 s_waitcnt lgkmcnt(0)
 v_cmp_ne_u32 vcc, s101, v17
 s_cbranch_vccnz dw_169

dw_165:
 s_add_u32 s36, s30, 0
 s_add_u32 m0, s32, 0
 s_nop 0
 buffer_load_dwordx4 v2, s[4:7], s36 offen sc1 lds
 s_add_u32 m0, s32, 1024
 s_nop 0
 buffer_load_dwordx4 v3, s[4:7], s36 offen sc1 lds
 s_add_u32 m0, s32, 2048
 s_nop 0
 buffer_load_dwordx4 v4, s[4:7], s36 offen sc1 lds
 s_add_u32 m0, s32, 3072
 s_nop 0
 buffer_load_dwordx4 v5, s[4:7], s36 offen sc1 lds
 s_add_u32 s36, s30, 2048
 s_add_u32 m0, s32, 24576
 s_nop 0
 buffer_load_dwordx4 v2, s[4:7], s36 offen sc1 lds
 s_add_u32 m0, s32, 25600
 s_nop 0
 buffer_load_dwordx4 v3, s[4:7], s36 offen sc1 lds
 s_add_u32 m0, s32, 26624
 s_nop 0
 buffer_load_dwordx4 v4, s[4:7], s36 offen sc1 lds
 s_add_u32 m0, s32, 27648
 s_nop 0
 buffer_load_dwordx4 v5, s[4:7], s36 offen sc1 lds
 s_add_u32 s36, s30, 4096
 s_add_u32 m0, s32, 49152
 s_nop 0
 buffer_load_dwordx4 v2, s[4:7], s36 offen sc1 lds
 s_add_u32 m0, s32, 50176
 s_nop 0
 buffer_load_dwordx4 v3, s[4:7], s36 offen sc1 lds
 s_add_u32 m0, s32, 51200
 s_nop 0
 buffer_load_dwordx4 v4, s[4:7], s36 offen sc1 lds
 s_add_u32 m0, s32, 52224
 s_nop 0
 buffer_load_dwordx4 v5, s[4:7], s36 offen sc1 lds
 s_add_u32 s30, s30, 6144
 s_add_u32 s32, s32, 73728
 s_waitcnt vmcnt(8)
 s_barrier
 ds_read_b128 v[20:23], v8 offset:0
 ds_read_b128 v[24:27], v8 offset:2048
 ds_read_b64_tr_b16 v[28:29], v9 offset:0
 ds_read_b64_tr_b16 v[30:31], v9 offset:1024
 ds_read_b64_tr_b16 v[32:33], v10 offset:0
 ds_read_b64_tr_b16 v[34:35], v10 offset:1024
 ds_read_b64_tr_b16 v[36:37], v11 offset:0
 ds_read_b64_tr_b16 v[38:39], v11 offset:1024
 ds_read_b64_tr_b16 v[40:41], v12 offset:0
 ds_read_b64_tr_b16 v[42:43], v12 offset:1024
t_g2_tile:
 s_sub_u32 s78, s78, 1
 s_cmp_eq_u32 s78, 0
 s_cselect_b32 s33, 4, 1
 s_sub_u32 s33, s69, s33

 s_waitcnt lgkmcnt(0)
 v_mfma_f32_32x32x16_bf16 a[0:15], v[28:31], v[20:23], 0
 ds_read_b128 v[44:47], v8 offset:1024
 ds_read_b128 v[48:51], v8 offset:3072
 ds_read_b64_tr_b16 v[52:53], v9 offset:4096
 v_mfma_f32_32x32x16_bf16 a[16:31], v[28:31], v[24:27], 0
 ds_read_b64_tr_b16 v[54:55], v9 offset:5120
 ds_read_b64_tr_b16 v[56:57], v10 offset:4096
 s_add_u32 m0, s32, 0
 s_nop 0
 buffer_load_dwordx4 v2, s[4:7], s30 offen sc1 lds
 v_mfma_f32_32x32x16_bf16 a[32:47], v[32:35], v[20:23], 0
 ds_read_b64_tr_b16 v[58:59], v10 offset:5120
 ds_read_b64_tr_b16 v[60:61], v11 offset:4096
 ds_read_b64_tr_b16 v[62:63], v11 offset:5120
 v_mfma_f32_32x32x16_bf16 a[48:63], v[32:35], v[24:27], 0
 ds_read_b64_tr_b16 v[64:65], v12 offset:4096
 ds_read_b64_tr_b16 v[66:67], v12 offset:5120
 s_add_u32 m0, s32, 1024
 s_nop 0
 buffer_load_dwordx4 v3, s[4:7], s30 offen sc1 lds
 v_mfma_f32_32x32x16_bf16 a[64:79], v[36:39], v[20:23], 0
 v_mfma_f32_32x32x16_bf16 a[80:95], v[36:39], v[24:27], 0
 s_add_u32 m0, s32, 2048
 s_nop 0
 buffer_load_dwordx4 v4, s[4:7], s30 offen sc1 lds
 v_mfma_f32_32x32x16_bf16 a[96:111], v[40:43], v[20:23], 0
 v_mfma_f32_32x32x16_bf16 a[112:127], v[40:43], v[24:27], 0
 s_add_u32 m0, s32, 3072
 s_nop 0
 buffer_load_dwordx4 v5, s[4:7], s30 offen sc1 lds
 s_waitcnt lgkmcnt(0)
 v_mfma_f32_32x32x16_bf16 a[0:15], v[52:55], v[44:47], a[0:15]
 v_mfma_f32_32x32x16_bf16 a[16:31], v[52:55], v[48:51], a[16:31]
 s_add_u32 m0, s51, 16384
 s_nop 0
 buffer_load_dwordx4 v6, s[8:11], s31 offen lds
 v_mfma_f32_32x32x16_bf16 a[32:47], v[56:59], v[44:47], a[32:47]
 s_add_u32 m0, s51, 17408
 s_nop 0
 buffer_load_dwordx4 v7, s[8:11], s31 offen lds
 s_add_u32 s30, s30, 2048
 s_add_u32 s31, s31, s85
 s_add_u32 s32, s32, 24576
 s_add_u32 s51, s51, 24576
 s_cmp_ge_u32 s32, 98304
 s_cselect_b32 s38, 98304, 0
 s_sub_u32 s32, s32, s38
 s_sub_u32 s51, s51, s38
 s_sub_u32 s62, s62, 1
 s_cmp_eq_u32 s62, 0
 s_cselect_b32 s38, 256, 0
 s_cselect_b32 s30, s66, s30
 s_cselect_b32 s62, s69, s62
 s_add_u32 s63, s63, s38
 s_cmp_lg_u32 s38, 0
 s_cselect_b32 s31, s63, s31
 v_mfma_f32_32x32x16_bf16 a[48:63], v[56:59], v[48:51], a[48:63]
 s_add_u32 s35, s35, 1
 s_cmp_eq_u32 s35, 4
 s_cselect_b32 s34, 0xfffee000, s50
 s_cselect_b32 s35, 0, s35
 v_add_u32 v8, s34, v8
 v_add_u32 v9, s34, v9
 v_add_u32 v10, s34, v10
 v_add_u32 v11, s34, v11
 v_add_u32 v12, s34, v12
 s_cmp_eq_u32 s79, 0
 s_cbranch_scc1 fw_170
 s_waitcnt vmcnt(10)
 s_branch fw_171
 fw_170:
 s_waitcnt vmcnt(28)
 fw_171:
 s_barrier
 ds_read_b128 v[20:23], v8 offset:0
 ds_read_b128 v[24:27], v8 offset:2048
 ds_read_b64_tr_b16 v[28:29], v9 offset:0
 ds_read_b64_tr_b16 v[30:31], v9 offset:1024
 ds_read_b64_tr_b16 v[32:33], v10 offset:0
 v_mfma_f32_32x32x16_bf16 a[64:79], v[60:63], v[44:47], a[64:79]
 ds_read_b64_tr_b16 v[34:35], v10 offset:1024
 ds_read_b64_tr_b16 v[36:37], v11 offset:0
 ds_read_b64_tr_b16 v[38:39], v11 offset:1024
 ds_read_b64_tr_b16 v[40:41], v12 offset:0
 ds_read_b64_tr_b16 v[42:43], v12 offset:1024
 v_mfma_f32_32x32x16_bf16 a[80:95], v[60:63], v[48:51], a[80:95]
 v_mfma_f32_32x32x16_bf16 a[96:111], v[64:67], v[44:47], a[96:111]
 v_mfma_f32_32x32x16_bf16 a[112:127], v[64:67], v[48:51], a[112:127]
 s_cmp_eq_u32 s33, 0
 s_cbranch_scc1 t_g2_lend
t_g2_loop:
 s_waitcnt lgkmcnt(0)
 v_mfma_f32_32x32x16_bf16 a[0:15], v[28:31], v[20:23], a[0:15]
 ds_read_b128 v[44:47], v8 offset:1024
 ds_read_b128 v[48:51], v8 offset:3072
 ds_read_b64_tr_b16 v[52:53], v9 offset:4096
 v_mfma_f32_32x32x16_bf16 a[16:31], v[28:31], v[24:27], a[16:31]
 ds_read_b64_tr_b16 v[54:55], v9 offset:5120
 ds_read_b64_tr_b16 v[56:57], v10 offset:4096
 s_add_u32 m0, s32, 0
 s_nop 0
 buffer_load_dwordx4 v2, s[4:7], s30 offen sc1 lds
 v_mfma_f32_32x32x16_bf16 a[32:47], v[32:35], v[20:23], a[32:47]
 ds_read_b64_tr_b16 v[58:59], v10 offset:5120
 ds_read_b64_tr_b16 v[60:61], v11 offset:4096
 ds_read_b64_tr_b16 v[62:63], v11 offset:5120
 v_mfma_f32_32x32x16_bf16 a[48:63], v[32:35], v[24:27], a[48:63]
 ds_read_b64_tr_b16 v[64:65], v12 offset:4096
 ds_read_b64_tr_b16 v[66:67], v12 offset:5120
 s_add_u32 m0, s32, 1024
 s_nop 0
 buffer_load_dwordx4 v3, s[4:7], s30 offen sc1 lds
 v_mfma_f32_32x32x16_bf16 a[64:79], v[36:39], v[20:23], a[64:79]
 v_mfma_f32_32x32x16_bf16 a[80:95], v[36:39], v[24:27], a[80:95]
 s_add_u32 m0, s32, 2048
 s_nop 0
 buffer_load_dwordx4 v4, s[4:7], s30 offen sc1 lds
 v_mfma_f32_32x32x16_bf16 a[96:111], v[40:43], v[20:23], a[96:111]
 v_mfma_f32_32x32x16_bf16 a[112:127], v[40:43], v[24:27], a[112:127]
 s_add_u32 m0, s32, 3072
 s_nop 0
 buffer_load_dwordx4 v5, s[4:7], s30 offen sc1 lds
 s_waitcnt lgkmcnt(0)
 v_mfma_f32_32x32x16_bf16 a[0:15], v[52:55], v[44:47], a[0:15]
 v_mfma_f32_32x32x16_bf16 a[16:31], v[52:55], v[48:51], a[16:31]
 s_add_u32 m0, s51, 16384
 s_nop 0
 buffer_load_dwordx4 v6, s[8:11], s31 offen lds
 v_mfma_f32_32x32x16_bf16 a[32:47], v[56:59], v[44:47], a[32:47]
 s_add_u32 m0, s51, 17408
 s_nop 0
 buffer_load_dwordx4 v7, s[8:11], s31 offen lds
 s_add_u32 s30, s30, 2048
 s_add_u32 s31, s31, s85
 s_add_u32 s32, s32, 24576
 s_add_u32 s51, s51, 24576
 s_cmp_ge_u32 s32, 98304
 s_cselect_b32 s38, 98304, 0
 s_sub_u32 s32, s32, s38
 s_sub_u32 s51, s51, s38
 s_sub_u32 s62, s62, 1
 s_cmp_eq_u32 s62, 0
 s_cselect_b32 s38, 256, 0
 s_cselect_b32 s30, s66, s30
 s_cselect_b32 s62, s69, s62
 s_add_u32 s63, s63, s38
 s_cmp_lg_u32 s38, 0
 s_cselect_b32 s31, s63, s31
 v_mfma_f32_32x32x16_bf16 a[48:63], v[56:59], v[48:51], a[48:63]
 s_add_u32 s35, s35, 1
 s_cmp_eq_u32 s35, 4
 s_cselect_b32 s34, 0xfffee000, s50
 s_cselect_b32 s35, 0, s35
 v_add_u32 v8, s34, v8
 v_add_u32 v9, s34, v9
 v_add_u32 v10, s34, v10
 v_add_u32 v11, s34, v11
 v_add_u32 v12, s34, v12
 s_waitcnt vmcnt(12)
 s_barrier
 ds_read_b128 v[20:23], v8 offset:0
 ds_read_b128 v[24:27], v8 offset:2048
 ds_read_b64_tr_b16 v[28:29], v9 offset:0
 ds_read_b64_tr_b16 v[30:31], v9 offset:1024
 ds_read_b64_tr_b16 v[32:33], v10 offset:0
 v_mfma_f32_32x32x16_bf16 a[64:79], v[60:63], v[44:47], a[64:79]
 ds_read_b64_tr_b16 v[34:35], v10 offset:1024
 ds_read_b64_tr_b16 v[36:37], v11 offset:0
 ds_read_b64_tr_b16 v[38:39], v11 offset:1024
 ds_read_b64_tr_b16 v[40:41], v12 offset:0
 ds_read_b64_tr_b16 v[42:43], v12 offset:1024
 v_mfma_f32_32x32x16_bf16 a[80:95], v[60:63], v[48:51], a[80:95]
 v_mfma_f32_32x32x16_bf16 a[96:111], v[64:67], v[44:47], a[96:111]
 v_mfma_f32_32x32x16_bf16 a[112:127], v[64:67], v[48:51], a[112:127]
 s_sub_u32 s33, s33, 1
 s_cmp_lg_u32 s33, 0
 s_cbranch_scc1 t_g2_loop

t_g2_lend:
 s_cmp_lg_u32 s78, 0
 s_cbranch_scc1 t_g2_epi
 s_cmp_lg_u32 s90, 0
 s_cbranch_scc1 pull_172
 v_accvgpr_write_b32 a255, 1
 v_mov_b32 v255, 0
 s_lshl_b32 s86, s100, 6
 s_add_u32 s86, s86, 159514624
 s_mov_b64 exec, 1
 buffer_atomic_add a255, v255, s[80:83], s86 offen sc0
 s_mov_b64 exec, -1

pull_172:
 s_waitcnt lgkmcnt(0)
 v_mfma_f32_32x32x16_bf16 a[0:15], v[28:31], v[20:23], a[0:15]
 ds_read_b128 v[44:47], v8 offset:1024
 ds_read_b128 v[48:51], v8 offset:3072
 ds_read_b64_tr_b16 v[52:53], v9 offset:4096
 v_mfma_f32_32x32x16_bf16 a[16:31], v[28:31], v[24:27], a[16:31]
 ds_read_b64_tr_b16 v[54:55], v9 offset:5120
 ds_read_b64_tr_b16 v[56:57], v10 offset:4096
 v_mfma_f32_32x32x16_bf16 a[32:47], v[32:35], v[20:23], a[32:47]
 ds_read_b64_tr_b16 v[58:59], v10 offset:5120
 ds_read_b64_tr_b16 v[60:61], v11 offset:4096
 ds_read_b64_tr_b16 v[62:63], v11 offset:5120
 v_mfma_f32_32x32x16_bf16 a[48:63], v[32:35], v[24:27], a[48:63]
 ds_read_b64_tr_b16 v[64:65], v12 offset:4096
 ds_read_b64_tr_b16 v[66:67], v12 offset:5120
 v_mfma_f32_32x32x16_bf16 a[64:79], v[36:39], v[20:23], a[64:79]
 v_mfma_f32_32x32x16_bf16 a[80:95], v[36:39], v[24:27], a[80:95]
 v_mfma_f32_32x32x16_bf16 a[96:111], v[40:43], v[20:23], a[96:111]
 v_mfma_f32_32x32x16_bf16 a[112:127], v[40:43], v[24:27], a[112:127]
 s_waitcnt lgkmcnt(0)
 v_mfma_f32_32x32x16_bf16 a[0:15], v[52:55], v[44:47], a[0:15]
 v_mfma_f32_32x32x16_bf16 a[16:31], v[52:55], v[48:51], a[16:31]
 v_mfma_f32_32x32x16_bf16 a[32:47], v[56:59], v[44:47], a[32:47]
 v_mfma_f32_32x32x16_bf16 a[48:63], v[56:59], v[48:51], a[48:63]
 s_add_u32 s35, s35, 1
 s_cmp_eq_u32 s35, 4
 s_cselect_b32 s34, 0xfffee000, s50
 s_cselect_b32 s35, 0, s35
 v_add_u32 v8, s34, v8
 v_add_u32 v9, s34, v9
 v_add_u32 v10, s34, v10
 v_add_u32 v11, s34, v11
 v_add_u32 v12, s34, v12
 s_waitcnt vmcnt(6)
 s_barrier
 ds_read_b128 v[20:23], v8 offset:0
 ds_read_b128 v[24:27], v8 offset:2048
 ds_read_b64_tr_b16 v[28:29], v9 offset:0
 ds_read_b64_tr_b16 v[30:31], v9 offset:1024
 ds_read_b64_tr_b16 v[32:33], v10 offset:0
 v_mfma_f32_32x32x16_bf16 a[64:79], v[60:63], v[44:47], a[64:79]
 ds_read_b64_tr_b16 v[34:35], v10 offset:1024
 ds_read_b64_tr_b16 v[36:37], v11 offset:0
 ds_read_b64_tr_b16 v[38:39], v11 offset:1024
 ds_read_b64_tr_b16 v[40:41], v12 offset:0
 ds_read_b64_tr_b16 v[42:43], v12 offset:1024
 v_mfma_f32_32x32x16_bf16 a[80:95], v[60:63], v[48:51], a[80:95]
 v_mfma_f32_32x32x16_bf16 a[96:111], v[64:67], v[44:47], a[96:111]
 v_mfma_f32_32x32x16_bf16 a[112:127], v[64:67], v[48:51], a[112:127]
 s_waitcnt lgkmcnt(0)
 v_mfma_f32_32x32x16_bf16 a[0:15], v[28:31], v[20:23], a[0:15]
 ds_read_b128 v[44:47], v8 offset:1024
 ds_read_b128 v[48:51], v8 offset:3072
 ds_read_b64_tr_b16 v[52:53], v9 offset:4096
 v_mfma_f32_32x32x16_bf16 a[16:31], v[28:31], v[24:27], a[16:31]
 ds_read_b64_tr_b16 v[54:55], v9 offset:5120
 ds_read_b64_tr_b16 v[56:57], v10 offset:4096
 v_mfma_f32_32x32x16_bf16 a[32:47], v[32:35], v[20:23], a[32:47]
 ds_read_b64_tr_b16 v[58:59], v10 offset:5120
 ds_read_b64_tr_b16 v[60:61], v11 offset:4096
 ds_read_b64_tr_b16 v[62:63], v11 offset:5120
 v_mfma_f32_32x32x16_bf16 a[48:63], v[32:35], v[24:27], a[48:63]
 ds_read_b64_tr_b16 v[64:65], v12 offset:4096
 ds_read_b64_tr_b16 v[66:67], v12 offset:5120
 v_mfma_f32_32x32x16_bf16 a[64:79], v[36:39], v[20:23], a[64:79]
 v_mfma_f32_32x32x16_bf16 a[80:95], v[36:39], v[24:27], a[80:95]
 v_mfma_f32_32x32x16_bf16 a[96:111], v[40:43], v[20:23], a[96:111]
 v_mfma_f32_32x32x16_bf16 a[112:127], v[40:43], v[24:27], a[112:127]
 s_waitcnt lgkmcnt(0)
 v_mfma_f32_32x32x16_bf16 a[0:15], v[52:55], v[44:47], a[0:15]
 v_mfma_f32_32x32x16_bf16 a[16:31], v[52:55], v[48:51], a[16:31]
 v_mfma_f32_32x32x16_bf16 a[32:47], v[56:59], v[44:47], a[32:47]
 v_mfma_f32_32x32x16_bf16 a[48:63], v[56:59], v[48:51], a[48:63]
 s_add_u32 s35, s35, 1
 s_cmp_eq_u32 s35, 4
 s_cselect_b32 s34, 0xfffee000, s50
 s_cselect_b32 s35, 0, s35
 v_add_u32 v8, s34, v8
 v_add_u32 v9, s34, v9
 v_add_u32 v10, s34, v10
 v_add_u32 v11, s34, v11
 v_add_u32 v12, s34, v12
 s_waitcnt vmcnt(0)
 s_barrier
 ds_read_b128 v[20:23], v8 offset:0
 ds_read_b128 v[24:27], v8 offset:2048
 ds_read_b64_tr_b16 v[28:29], v9 offset:0
 ds_read_b64_tr_b16 v[30:31], v9 offset:1024
 ds_read_b64_tr_b16 v[32:33], v10 offset:0
 v_mfma_f32_32x32x16_bf16 a[64:79], v[60:63], v[44:47], a[64:79]
 ds_read_b64_tr_b16 v[34:35], v10 offset:1024
 ds_read_b64_tr_b16 v[36:37], v11 offset:0
 ds_read_b64_tr_b16 v[38:39], v11 offset:1024
 ds_read_b64_tr_b16 v[40:41], v12 offset:0
 ds_read_b64_tr_b16 v[42:43], v12 offset:1024
 v_mfma_f32_32x32x16_bf16 a[80:95], v[60:63], v[48:51], a[80:95]
 v_mfma_f32_32x32x16_bf16 a[96:111], v[64:67], v[44:47], a[96:111]
 v_mfma_f32_32x32x16_bf16 a[112:127], v[64:67], v[48:51], a[112:127]
 s_waitcnt lgkmcnt(0)
 v_mfma_f32_32x32x16_bf16 a[0:15], v[28:31], v[20:23], a[0:15]
 ds_read_b128 v[44:47], v8 offset:1024
 ds_read_b128 v[48:51], v8 offset:3072
 ds_read_b64_tr_b16 v[52:53], v9 offset:4096
 v_mfma_f32_32x32x16_bf16 a[16:31], v[28:31], v[24:27], a[16:31]
 ds_read_b64_tr_b16 v[54:55], v9 offset:5120
 ds_read_b64_tr_b16 v[56:57], v10 offset:4096
 v_mfma_f32_32x32x16_bf16 a[32:47], v[32:35], v[20:23], a[32:47]
 ds_read_b64_tr_b16 v[58:59], v10 offset:5120
 ds_read_b64_tr_b16 v[60:61], v11 offset:4096
 ds_read_b64_tr_b16 v[62:63], v11 offset:5120
 v_mfma_f32_32x32x16_bf16 a[48:63], v[32:35], v[24:27], a[48:63]
 ds_read_b64_tr_b16 v[64:65], v12 offset:4096
 ds_read_b64_tr_b16 v[66:67], v12 offset:5120
 v_mfma_f32_32x32x16_bf16 a[64:79], v[36:39], v[20:23], a[64:79]
 v_mfma_f32_32x32x16_bf16 a[80:95], v[36:39], v[24:27], a[80:95]
 v_mfma_f32_32x32x16_bf16 a[96:111], v[40:43], v[20:23], a[96:111]
 v_mfma_f32_32x32x16_bf16 a[112:127], v[40:43], v[24:27], a[112:127]
 s_waitcnt lgkmcnt(0)
 v_mfma_f32_32x32x16_bf16 a[0:15], v[52:55], v[44:47], a[0:15]
 v_mfma_f32_32x32x16_bf16 a[16:31], v[52:55], v[48:51], a[16:31]
 v_mfma_f32_32x32x16_bf16 a[32:47], v[56:59], v[44:47], a[32:47]
 v_mfma_f32_32x32x16_bf16 a[48:63], v[56:59], v[48:51], a[48:63]
 v_mfma_f32_32x32x16_bf16 a[64:79], v[60:63], v[44:47], a[64:79]
 v_mfma_f32_32x32x16_bf16 a[80:95], v[60:63], v[48:51], a[80:95]
 v_mfma_f32_32x32x16_bf16 a[96:111], v[64:67], v[44:47], a[96:111]
 v_mfma_f32_32x32x16_bf16 a[112:127], v[64:67], v[48:51], a[112:127]
t_g2_epi:
 s_nop 7
 s_lshl_b32 s37, s26, 8
 s_add_u32 s39, s61, s37
 s_add_u32 s36, s39, s60
 s_add_u32 s39, s39, s74
 s_cmp_lg_u32 s72, 0
 s_cbranch_scc1 t_g2_m1
 s_add_u32 s37, s36, 65536

 buffer_load_dwordx2 v[76:77], v68, s[52:55], s36 offen offset:0
 buffer_load_dwordx2 v[78:79], v68, s[52:55], s36 offen offset:16
 buffer_load_dwordx2 v[80:81], v68, s[52:55], s36 offen offset:32
 buffer_load_dwordx2 v[82:83], v68, s[52:55], s36 offen offset:48
 buffer_load_dwordx2 v[84:85], v68, s[52:55], s36 offen offset:64
 buffer_load_dwordx2 v[86:87], v68, s[52:55], s36 offen offset:80
 buffer_load_dwordx2 v[88:89], v68, s[52:55], s36 offen offset:96
 buffer_load_dwordx2 v[90:91], v68, s[52:55], s36 offen offset:112
 buffer_load_dwordx2 v[92:93], v68, s[52:55], s36 offen offset:128
 buffer_load_dwordx2 v[94:95], v68, s[52:55], s36 offen offset:144
 buffer_load_dwordx2 v[96:97], v68, s[52:55], s36 offen offset:160
 buffer_load_dwordx2 v[98:99], v68, s[52:55], s36 offen offset:176
 buffer_load_dwordx2 v[100:101], v68, s[52:55], s36 offen offset:192
 buffer_load_dwordx2 v[102:103], v68, s[52:55], s36 offen offset:208
 buffer_load_dwordx2 v[104:105], v68, s[52:55], s36 offen offset:224
 buffer_load_dwordx2 v[106:107], v68, s[52:55], s36 offen offset:240
 buffer_load_dwordx2 v[108:109], v68, s[52:55], s37 offen offset:0
 buffer_load_dwordx2 v[110:111], v68, s[52:55], s37 offen offset:16
 buffer_load_dwordx2 v[112:113], v68, s[52:55], s37 offen offset:32
 buffer_load_dwordx2 v[114:115], v68, s[52:55], s37 offen offset:48
 buffer_load_dwordx2 v[116:117], v68, s[52:55], s37 offen offset:64
 buffer_load_dwordx2 v[118:119], v68, s[52:55], s37 offen offset:80
 buffer_load_dwordx2 v[120:121], v68, s[52:55], s37 offen offset:96
 buffer_load_dwordx2 v[122:123], v68, s[52:55], s37 offen offset:112
 buffer_load_dwordx2 v[124:125], v68, s[52:55], s37 offen offset:128
 buffer_load_dwordx2 v[126:127], v68, s[52:55], s37 offen offset:144
 buffer_load_dwordx2 v[128:129], v68, s[52:55], s37 offen offset:160
 buffer_load_dwordx2 v[130:131], v68, s[52:55], s37 offen offset:176
 buffer_load_dwordx2 v[132:133], v68, s[52:55], s37 offen offset:192
 buffer_load_dwordx2 v[134:135], v68, s[52:55], s37 offen offset:208
 buffer_load_dwordx2 v[136:137], v68, s[52:55], s37 offen offset:224
 buffer_load_dwordx2 v[138:139], v68, s[52:55], s37 offen offset:240
 s_lshl_b32 s37, s73, 2
 v_accvgpr_read_b32 v140, a0
 v_accvgpr_read_b32 v141, a1
 v_accvgpr_read_b32 v142, a2
 v_accvgpr_read_b32 v143, a3
 v_accvgpr_read_b32 v144, a4
 v_accvgpr_read_b32 v145, a5
 v_accvgpr_read_b32 v146, a6
 v_accvgpr_read_b32 v147, a7
 v_accvgpr_read_b32 v148, a8
 v_accvgpr_read_b32 v149, a9
 v_accvgpr_read_b32 v150, a10
 v_accvgpr_read_b32 v151, a11
 v_accvgpr_read_b32 v152, a12
 v_accvgpr_read_b32 v153, a13
 v_accvgpr_read_b32 v154, a14
 v_accvgpr_read_b32 v155, a15
 v_cvt_pk_bf16_f32 v172, v140, v141
 v_cvt_pk_bf16_f32 v173, v142, v143
 v_cvt_pk_bf16_f32 v174, v144, v145
 v_cvt_pk_bf16_f32 v175, v146, v147
 v_cvt_pk_bf16_f32 v176, v148, v149
 v_cvt_pk_bf16_f32 v177, v150, v151
 v_cvt_pk_bf16_f32 v178, v152, v153
 v_cvt_pk_bf16_f32 v179, v154, v155
 v_lshlrev_b32 v140, 16, v172
 v_and_b32 v141, 0xffff0000, v172
 v_lshlrev_b32 v142, 16, v173
 v_and_b32 v143, 0xffff0000, v173
 v_lshlrev_b32 v144, 16, v174
 v_and_b32 v145, 0xffff0000, v174
 v_lshlrev_b32 v146, 16, v175
 v_and_b32 v147, 0xffff0000, v175
 v_lshlrev_b32 v148, 16, v176
 v_and_b32 v149, 0xffff0000, v176
 v_lshlrev_b32 v150, 16, v177
 v_and_b32 v151, 0xffff0000, v177
 v_lshlrev_b32 v152, 16, v178
 v_and_b32 v153, 0xffff0000, v178
 v_lshlrev_b32 v154, 16, v179
 v_and_b32 v155, 0xffff0000, v179
 s_waitcnt vmcnt(28)
 v_lshlrev_b32 v156, 16, v76
 v_and_b32 v157, 0xffff0000, v76
 v_lshlrev_b32 v158, 16, v77
 v_and_b32 v159, 0xffff0000, v77
 v_lshlrev_b32 v160, 16, v78
 v_and_b32 v161, 0xffff0000, v78
 v_lshlrev_b32 v162, 16, v79
 v_and_b32 v163, 0xffff0000, v79
 v_lshlrev_b32 v164, 16, v80
 v_and_b32 v165, 0xffff0000, v80
 v_lshlrev_b32 v166, 16, v81
 v_and_b32 v167, 0xffff0000, v81
 v_lshlrev_b32 v168, 16, v82
 v_and_b32 v169, 0xffff0000, v82
 v_lshlrev_b32 v170, 16, v83
 v_and_b32 v171, 0xffff0000, v83
 v_pk_add_f32 v[140:141], v[140:141], v[156:157]
 v_pk_add_f32 v[142:143], v[142:143], v[158:159]
 v_pk_add_f32 v[144:145], v[144:145], v[160:161]
 v_pk_add_f32 v[146:147], v[146:147], v[162:163]
 v_pk_add_f32 v[148:149], v[148:149], v[164:165]
 v_pk_add_f32 v[150:151], v[150:151], v[166:167]
 v_pk_add_f32 v[152:153], v[152:153], v[168:169]
 v_pk_add_f32 v[154:155], v[154:155], v[170:171]
 v_cvt_pk_bf16_f32 v172, v140, v141
 v_cvt_pk_bf16_f32 v173, v142, v143
 v_cvt_pk_bf16_f32 v174, v144, v145
 v_cvt_pk_bf16_f32 v175, v146, v147
 v_cvt_pk_bf16_f32 v176, v148, v149
 v_cvt_pk_bf16_f32 v177, v150, v151
 v_cvt_pk_bf16_f32 v178, v152, v153
 v_cvt_pk_bf16_f32 v179, v154, v155
 ds_write_b64 v72, v[172:173] offset:0
 ds_write_b64 v73, v[174:175] offset:0
 ds_write_b64 v74, v[176:177] offset:0
 ds_write_b64 v75, v[178:179] offset:0
 v_accvgpr_read_b32 v140, a32
 v_accvgpr_read_b32 v141, a33
 v_accvgpr_read_b32 v142, a34
 v_accvgpr_read_b32 v143, a35
 v_accvgpr_read_b32 v144, a36
 v_accvgpr_read_b32 v145, a37
 v_accvgpr_read_b32 v146, a38
 v_accvgpr_read_b32 v147, a39
 v_accvgpr_read_b32 v148, a40
 v_accvgpr_read_b32 v149, a41
 v_accvgpr_read_b32 v150, a42
 v_accvgpr_read_b32 v151, a43
 v_accvgpr_read_b32 v152, a44
 v_accvgpr_read_b32 v153, a45
 v_accvgpr_read_b32 v154, a46
 v_accvgpr_read_b32 v155, a47
 v_cvt_pk_bf16_f32 v172, v140, v141
 v_cvt_pk_bf16_f32 v173, v142, v143
 v_cvt_pk_bf16_f32 v174, v144, v145
 v_cvt_pk_bf16_f32 v175, v146, v147
 v_cvt_pk_bf16_f32 v176, v148, v149
 v_cvt_pk_bf16_f32 v177, v150, v151
 v_cvt_pk_bf16_f32 v178, v152, v153
 v_cvt_pk_bf16_f32 v179, v154, v155
 v_lshlrev_b32 v140, 16, v172
 v_and_b32 v141, 0xffff0000, v172
 v_lshlrev_b32 v142, 16, v173
 v_and_b32 v143, 0xffff0000, v173
 v_lshlrev_b32 v144, 16, v174
 v_and_b32 v145, 0xffff0000, v174
 v_lshlrev_b32 v146, 16, v175
 v_and_b32 v147, 0xffff0000, v175
 v_lshlrev_b32 v148, 16, v176
 v_and_b32 v149, 0xffff0000, v176
 v_lshlrev_b32 v150, 16, v177
 v_and_b32 v151, 0xffff0000, v177
 v_lshlrev_b32 v152, 16, v178
 v_and_b32 v153, 0xffff0000, v178
 v_lshlrev_b32 v154, 16, v179
 v_and_b32 v155, 0xffff0000, v179
 s_waitcnt vmcnt(24)
 v_lshlrev_b32 v156, 16, v84
 v_and_b32 v157, 0xffff0000, v84
 v_lshlrev_b32 v158, 16, v85
 v_and_b32 v159, 0xffff0000, v85
 v_lshlrev_b32 v160, 16, v86
 v_and_b32 v161, 0xffff0000, v86
 v_lshlrev_b32 v162, 16, v87
 v_and_b32 v163, 0xffff0000, v87
 v_lshlrev_b32 v164, 16, v88
 v_and_b32 v165, 0xffff0000, v88
 v_lshlrev_b32 v166, 16, v89
 v_and_b32 v167, 0xffff0000, v89
 v_lshlrev_b32 v168, 16, v90
 v_and_b32 v169, 0xffff0000, v90
 v_lshlrev_b32 v170, 16, v91
 v_and_b32 v171, 0xffff0000, v91
 v_pk_add_f32 v[140:141], v[140:141], v[156:157]
 v_pk_add_f32 v[142:143], v[142:143], v[158:159]
 v_pk_add_f32 v[144:145], v[144:145], v[160:161]
 v_pk_add_f32 v[146:147], v[146:147], v[162:163]
 v_pk_add_f32 v[148:149], v[148:149], v[164:165]
 v_pk_add_f32 v[150:151], v[150:151], v[166:167]
 v_pk_add_f32 v[152:153], v[152:153], v[168:169]
 v_pk_add_f32 v[154:155], v[154:155], v[170:171]
 v_cvt_pk_bf16_f32 v172, v140, v141
 v_cvt_pk_bf16_f32 v173, v142, v143
 v_cvt_pk_bf16_f32 v174, v144, v145
 v_cvt_pk_bf16_f32 v175, v146, v147
 v_cvt_pk_bf16_f32 v176, v148, v149
 v_cvt_pk_bf16_f32 v177, v150, v151
 v_cvt_pk_bf16_f32 v178, v152, v153
 v_cvt_pk_bf16_f32 v179, v154, v155
 v_xor_b32 v156, 64, v72
 ds_write_b64 v156, v[172:173] offset:0
 v_xor_b32 v157, 64, v73
 ds_write_b64 v157, v[174:175] offset:0
 v_xor_b32 v158, 64, v74
 ds_write_b64 v158, v[176:177] offset:0
 v_xor_b32 v159, 64, v75
 ds_write_b64 v159, v[178:179] offset:0
 v_accvgpr_read_b32 v140, a64
 v_accvgpr_read_b32 v141, a65
 v_accvgpr_read_b32 v142, a66
 v_accvgpr_read_b32 v143, a67
 v_accvgpr_read_b32 v144, a68
 v_accvgpr_read_b32 v145, a69
 v_accvgpr_read_b32 v146, a70
 v_accvgpr_read_b32 v147, a71
 v_accvgpr_read_b32 v148, a72
 v_accvgpr_read_b32 v149, a73
 v_accvgpr_read_b32 v150, a74
 v_accvgpr_read_b32 v151, a75
 v_accvgpr_read_b32 v152, a76
 v_accvgpr_read_b32 v153, a77
 v_accvgpr_read_b32 v154, a78
 v_accvgpr_read_b32 v155, a79
 v_cvt_pk_bf16_f32 v172, v140, v141
 v_cvt_pk_bf16_f32 v173, v142, v143
 v_cvt_pk_bf16_f32 v174, v144, v145
 v_cvt_pk_bf16_f32 v175, v146, v147
 v_cvt_pk_bf16_f32 v176, v148, v149
 v_cvt_pk_bf16_f32 v177, v150, v151
 v_cvt_pk_bf16_f32 v178, v152, v153
 v_cvt_pk_bf16_f32 v179, v154, v155
 v_lshlrev_b32 v140, 16, v172
 v_and_b32 v141, 0xffff0000, v172
 v_lshlrev_b32 v142, 16, v173
 v_and_b32 v143, 0xffff0000, v173
 v_lshlrev_b32 v144, 16, v174
 v_and_b32 v145, 0xffff0000, v174
 v_lshlrev_b32 v146, 16, v175
 v_and_b32 v147, 0xffff0000, v175
 v_lshlrev_b32 v148, 16, v176
 v_and_b32 v149, 0xffff0000, v176
 v_lshlrev_b32 v150, 16, v177
 v_and_b32 v151, 0xffff0000, v177
 v_lshlrev_b32 v152, 16, v178
 v_and_b32 v153, 0xffff0000, v178
 v_lshlrev_b32 v154, 16, v179
 v_and_b32 v155, 0xffff0000, v179
 s_waitcnt vmcnt(20)
 v_lshlrev_b32 v156, 16, v92
 v_and_b32 v157, 0xffff0000, v92
 v_lshlrev_b32 v158, 16, v93
 v_and_b32 v159, 0xffff0000, v93
 v_lshlrev_b32 v160, 16, v94
 v_and_b32 v161, 0xffff0000, v94
 v_lshlrev_b32 v162, 16, v95
 v_and_b32 v163, 0xffff0000, v95
 v_lshlrev_b32 v164, 16, v96
 v_and_b32 v165, 0xffff0000, v96
 v_lshlrev_b32 v166, 16, v97
 v_and_b32 v167, 0xffff0000, v97
 v_lshlrev_b32 v168, 16, v98
 v_and_b32 v169, 0xffff0000, v98
 v_lshlrev_b32 v170, 16, v99
 v_and_b32 v171, 0xffff0000, v99
 v_pk_add_f32 v[140:141], v[140:141], v[156:157]
 v_pk_add_f32 v[142:143], v[142:143], v[158:159]
 v_pk_add_f32 v[144:145], v[144:145], v[160:161]
 v_pk_add_f32 v[146:147], v[146:147], v[162:163]
 v_pk_add_f32 v[148:149], v[148:149], v[164:165]
 v_pk_add_f32 v[150:151], v[150:151], v[166:167]
 v_pk_add_f32 v[152:153], v[152:153], v[168:169]
 v_pk_add_f32 v[154:155], v[154:155], v[170:171]
 v_cvt_pk_bf16_f32 v172, v140, v141
 v_cvt_pk_bf16_f32 v173, v142, v143
 v_cvt_pk_bf16_f32 v174, v144, v145
 v_cvt_pk_bf16_f32 v175, v146, v147
 v_cvt_pk_bf16_f32 v176, v148, v149
 v_cvt_pk_bf16_f32 v177, v150, v151
 v_cvt_pk_bf16_f32 v178, v152, v153
 v_cvt_pk_bf16_f32 v179, v154, v155
 v_xor_b32 v156, 128, v72
 ds_write_b64 v156, v[172:173] offset:0
 v_xor_b32 v157, 128, v73
 ds_write_b64 v157, v[174:175] offset:0
 v_xor_b32 v158, 128, v74
 ds_write_b64 v158, v[176:177] offset:0
 v_xor_b32 v159, 128, v75
 ds_write_b64 v159, v[178:179] offset:0
 v_accvgpr_read_b32 v140, a96
 v_accvgpr_read_b32 v141, a97
 v_accvgpr_read_b32 v142, a98
 v_accvgpr_read_b32 v143, a99
 v_accvgpr_read_b32 v144, a100
 v_accvgpr_read_b32 v145, a101
 v_accvgpr_read_b32 v146, a102
 v_accvgpr_read_b32 v147, a103
 v_accvgpr_read_b32 v148, a104
 v_accvgpr_read_b32 v149, a105
 v_accvgpr_read_b32 v150, a106
 v_accvgpr_read_b32 v151, a107
 v_accvgpr_read_b32 v152, a108
 v_accvgpr_read_b32 v153, a109
 v_accvgpr_read_b32 v154, a110
 v_accvgpr_read_b32 v155, a111
 v_cvt_pk_bf16_f32 v172, v140, v141
 v_cvt_pk_bf16_f32 v173, v142, v143
 v_cvt_pk_bf16_f32 v174, v144, v145
 v_cvt_pk_bf16_f32 v175, v146, v147
 v_cvt_pk_bf16_f32 v176, v148, v149
 v_cvt_pk_bf16_f32 v177, v150, v151
 v_cvt_pk_bf16_f32 v178, v152, v153
 v_cvt_pk_bf16_f32 v179, v154, v155
 v_lshlrev_b32 v140, 16, v172
 v_and_b32 v141, 0xffff0000, v172
 v_lshlrev_b32 v142, 16, v173
 v_and_b32 v143, 0xffff0000, v173
 v_lshlrev_b32 v144, 16, v174
 v_and_b32 v145, 0xffff0000, v174
 v_lshlrev_b32 v146, 16, v175
 v_and_b32 v147, 0xffff0000, v175
 v_lshlrev_b32 v148, 16, v176
 v_and_b32 v149, 0xffff0000, v176
 v_lshlrev_b32 v150, 16, v177
 v_and_b32 v151, 0xffff0000, v177
 v_lshlrev_b32 v152, 16, v178
 v_and_b32 v153, 0xffff0000, v178
 v_lshlrev_b32 v154, 16, v179
 v_and_b32 v155, 0xffff0000, v179
 s_waitcnt vmcnt(16)
 v_lshlrev_b32 v156, 16, v100
 v_and_b32 v157, 0xffff0000, v100
 v_lshlrev_b32 v158, 16, v101
 v_and_b32 v159, 0xffff0000, v101
 v_lshlrev_b32 v160, 16, v102
 v_and_b32 v161, 0xffff0000, v102
 v_lshlrev_b32 v162, 16, v103
 v_and_b32 v163, 0xffff0000, v103
 v_lshlrev_b32 v164, 16, v104
 v_and_b32 v165, 0xffff0000, v104
 v_lshlrev_b32 v166, 16, v105
 v_and_b32 v167, 0xffff0000, v105
 v_lshlrev_b32 v168, 16, v106
 v_and_b32 v169, 0xffff0000, v106
 v_lshlrev_b32 v170, 16, v107
 v_and_b32 v171, 0xffff0000, v107
 v_pk_add_f32 v[140:141], v[140:141], v[156:157]
 v_pk_add_f32 v[142:143], v[142:143], v[158:159]
 v_pk_add_f32 v[144:145], v[144:145], v[160:161]
 v_pk_add_f32 v[146:147], v[146:147], v[162:163]
 v_pk_add_f32 v[148:149], v[148:149], v[164:165]
 v_pk_add_f32 v[150:151], v[150:151], v[166:167]
 v_pk_add_f32 v[152:153], v[152:153], v[168:169]
 v_pk_add_f32 v[154:155], v[154:155], v[170:171]
 v_cvt_pk_bf16_f32 v172, v140, v141
 v_cvt_pk_bf16_f32 v173, v142, v143
 v_cvt_pk_bf16_f32 v174, v144, v145
 v_cvt_pk_bf16_f32 v175, v146, v147
 v_cvt_pk_bf16_f32 v176, v148, v149
 v_cvt_pk_bf16_f32 v177, v150, v151
 v_cvt_pk_bf16_f32 v178, v152, v153
 v_cvt_pk_bf16_f32 v179, v154, v155
 v_xor_b32 v156, 192, v72
 ds_write_b64 v156, v[172:173] offset:0
 v_xor_b32 v157, 192, v73
 ds_write_b64 v157, v[174:175] offset:0
 v_xor_b32 v158, 192, v74
 ds_write_b64 v158, v[176:177] offset:0
 v_xor_b32 v159, 192, v75
 ds_write_b64 v159, v[178:179] offset:0
 s_waitcnt lgkmcnt(0)
 ds_read_b128 v[180:183], v70 offset:0
 v_xor_b32 v157, 64, v70
 ds_read_b128 v[184:187], v157 offset:1024
 v_xor_b32 v158, 128, v70
 ds_read_b128 v[188:191], v158 offset:2048
 v_xor_b32 v159, 192, v70
 ds_read_b128 v[192:195], v159 offset:3072
 ds_read_b128 v[196:199], v70 offset:4096
 v_xor_b32 v161, 64, v70
 ds_read_b128 v[200:203], v161 offset:5120
 v_xor_b32 v162, 128, v70
 ds_read_b128 v[204:207], v162 offset:6144
 v_xor_b32 v163, 192, v70
 ds_read_b128 v[208:211], v163 offset:7168
 s_waitcnt lgkmcnt(7)
 buffer_store_dwordx4 v[180:183], v69, s[56:59], s39 offen sc1
 s_add_u32 s39, s39, s37
 s_waitcnt lgkmcnt(6)
 buffer_store_dwordx4 v[184:187], v69, s[56:59], s39 offen sc1
 s_add_u32 s39, s39, s37
 s_waitcnt lgkmcnt(5)
 buffer_store_dwordx4 v[188:191], v69, s[56:59], s39 offen sc1
 s_add_u32 s39, s39, s37
 s_waitcnt lgkmcnt(4)
 buffer_store_dwordx4 v[192:195], v69, s[56:59], s39 offen sc1
 s_add_u32 s39, s39, s37
 s_waitcnt lgkmcnt(3)
 buffer_store_dwordx4 v[196:199], v69, s[56:59], s39 offen sc1
 s_add_u32 s39, s39, s37
 s_waitcnt lgkmcnt(2)
 buffer_store_dwordx4 v[200:203], v69, s[56:59], s39 offen sc1
 s_add_u32 s39, s39, s37
 s_waitcnt lgkmcnt(1)
 buffer_store_dwordx4 v[204:207], v69, s[56:59], s39 offen sc1
 s_add_u32 s39, s39, s37
 s_waitcnt lgkmcnt(0)
 buffer_store_dwordx4 v[208:211], v69, s[56:59], s39 offen sc1
 s_add_u32 s39, s39, s37
 v_accvgpr_read_b32 v140, a16
 v_accvgpr_read_b32 v141, a17
 v_accvgpr_read_b32 v142, a18
 v_accvgpr_read_b32 v143, a19
 v_accvgpr_read_b32 v144, a20
 v_accvgpr_read_b32 v145, a21
 v_accvgpr_read_b32 v146, a22
 v_accvgpr_read_b32 v147, a23
 v_accvgpr_read_b32 v148, a24
 v_accvgpr_read_b32 v149, a25
 v_accvgpr_read_b32 v150, a26
 v_accvgpr_read_b32 v151, a27
 v_accvgpr_read_b32 v152, a28
 v_accvgpr_read_b32 v153, a29
 v_accvgpr_read_b32 v154, a30
 v_accvgpr_read_b32 v155, a31
 v_cvt_pk_bf16_f32 v172, v140, v141
 v_cvt_pk_bf16_f32 v173, v142, v143
 v_cvt_pk_bf16_f32 v174, v144, v145
 v_cvt_pk_bf16_f32 v175, v146, v147
 v_cvt_pk_bf16_f32 v176, v148, v149
 v_cvt_pk_bf16_f32 v177, v150, v151
 v_cvt_pk_bf16_f32 v178, v152, v153
 v_cvt_pk_bf16_f32 v179, v154, v155
 v_lshlrev_b32 v140, 16, v172
 v_and_b32 v141, 0xffff0000, v172
 v_lshlrev_b32 v142, 16, v173
 v_and_b32 v143, 0xffff0000, v173
 v_lshlrev_b32 v144, 16, v174
 v_and_b32 v145, 0xffff0000, v174
 v_lshlrev_b32 v146, 16, v175
 v_and_b32 v147, 0xffff0000, v175
 v_lshlrev_b32 v148, 16, v176
 v_and_b32 v149, 0xffff0000, v176
 v_lshlrev_b32 v150, 16, v177
 v_and_b32 v151, 0xffff0000, v177
 v_lshlrev_b32 v152, 16, v178
 v_and_b32 v153, 0xffff0000, v178
 v_lshlrev_b32 v154, 16, v179
 v_and_b32 v155, 0xffff0000, v179
 s_waitcnt vmcnt(20)
 v_lshlrev_b32 v156, 16, v108
 v_and_b32 v157, 0xffff0000, v108
 v_lshlrev_b32 v158, 16, v109
 v_and_b32 v159, 0xffff0000, v109
 v_lshlrev_b32 v160, 16, v110
 v_and_b32 v161, 0xffff0000, v110
 v_lshlrev_b32 v162, 16, v111
 v_and_b32 v163, 0xffff0000, v111
 v_lshlrev_b32 v164, 16, v112
 v_and_b32 v165, 0xffff0000, v112
 v_lshlrev_b32 v166, 16, v113
 v_and_b32 v167, 0xffff0000, v113
 v_lshlrev_b32 v168, 16, v114
 v_and_b32 v169, 0xffff0000, v114
 v_lshlrev_b32 v170, 16, v115
 v_and_b32 v171, 0xffff0000, v115
 v_pk_add_f32 v[140:141], v[140:141], v[156:157]
 v_pk_add_f32 v[142:143], v[142:143], v[158:159]
 v_pk_add_f32 v[144:145], v[144:145], v[160:161]
 v_pk_add_f32 v[146:147], v[146:147], v[162:163]
 v_pk_add_f32 v[148:149], v[148:149], v[164:165]
 v_pk_add_f32 v[150:151], v[150:151], v[166:167]
 v_pk_add_f32 v[152:153], v[152:153], v[168:169]
 v_pk_add_f32 v[154:155], v[154:155], v[170:171]
 v_cvt_pk_bf16_f32 v172, v140, v141
 v_cvt_pk_bf16_f32 v173, v142, v143
 v_cvt_pk_bf16_f32 v174, v144, v145
 v_cvt_pk_bf16_f32 v175, v146, v147
 v_cvt_pk_bf16_f32 v176, v148, v149
 v_cvt_pk_bf16_f32 v177, v150, v151
 v_cvt_pk_bf16_f32 v178, v152, v153
 v_cvt_pk_bf16_f32 v179, v154, v155
 ds_write_b64 v72, v[172:173] offset:8192
 ds_write_b64 v73, v[174:175] offset:8192
 ds_write_b64 v74, v[176:177] offset:8192
 ds_write_b64 v75, v[178:179] offset:8192
 v_accvgpr_read_b32 v140, a48
 v_accvgpr_read_b32 v141, a49
 v_accvgpr_read_b32 v142, a50
 v_accvgpr_read_b32 v143, a51
 v_accvgpr_read_b32 v144, a52
 v_accvgpr_read_b32 v145, a53
 v_accvgpr_read_b32 v146, a54
 v_accvgpr_read_b32 v147, a55
 v_accvgpr_read_b32 v148, a56
 v_accvgpr_read_b32 v149, a57
 v_accvgpr_read_b32 v150, a58
 v_accvgpr_read_b32 v151, a59
 v_accvgpr_read_b32 v152, a60
 v_accvgpr_read_b32 v153, a61
 v_accvgpr_read_b32 v154, a62
 v_accvgpr_read_b32 v155, a63
 v_cvt_pk_bf16_f32 v172, v140, v141
 v_cvt_pk_bf16_f32 v173, v142, v143
 v_cvt_pk_bf16_f32 v174, v144, v145
 v_cvt_pk_bf16_f32 v175, v146, v147
 v_cvt_pk_bf16_f32 v176, v148, v149
 v_cvt_pk_bf16_f32 v177, v150, v151
 v_cvt_pk_bf16_f32 v178, v152, v153
 v_cvt_pk_bf16_f32 v179, v154, v155
 v_lshlrev_b32 v140, 16, v172
 v_and_b32 v141, 0xffff0000, v172
 v_lshlrev_b32 v142, 16, v173
 v_and_b32 v143, 0xffff0000, v173
 v_lshlrev_b32 v144, 16, v174
 v_and_b32 v145, 0xffff0000, v174
 v_lshlrev_b32 v146, 16, v175
 v_and_b32 v147, 0xffff0000, v175
 v_lshlrev_b32 v148, 16, v176
 v_and_b32 v149, 0xffff0000, v176
 v_lshlrev_b32 v150, 16, v177
 v_and_b32 v151, 0xffff0000, v177
 v_lshlrev_b32 v152, 16, v178
 v_and_b32 v153, 0xffff0000, v178
 v_lshlrev_b32 v154, 16, v179
 v_and_b32 v155, 0xffff0000, v179
 s_waitcnt vmcnt(16)
 v_lshlrev_b32 v156, 16, v116
 v_and_b32 v157, 0xffff0000, v116
 v_lshlrev_b32 v158, 16, v117
 v_and_b32 v159, 0xffff0000, v117
 v_lshlrev_b32 v160, 16, v118
 v_and_b32 v161, 0xffff0000, v118
 v_lshlrev_b32 v162, 16, v119
 v_and_b32 v163, 0xffff0000, v119
 v_lshlrev_b32 v164, 16, v120
 v_and_b32 v165, 0xffff0000, v120
 v_lshlrev_b32 v166, 16, v121
 v_and_b32 v167, 0xffff0000, v121
 v_lshlrev_b32 v168, 16, v122
 v_and_b32 v169, 0xffff0000, v122
 v_lshlrev_b32 v170, 16, v123
 v_and_b32 v171, 0xffff0000, v123
 v_pk_add_f32 v[140:141], v[140:141], v[156:157]
 v_pk_add_f32 v[142:143], v[142:143], v[158:159]
 v_pk_add_f32 v[144:145], v[144:145], v[160:161]
 v_pk_add_f32 v[146:147], v[146:147], v[162:163]
 v_pk_add_f32 v[148:149], v[148:149], v[164:165]
 v_pk_add_f32 v[150:151], v[150:151], v[166:167]
 v_pk_add_f32 v[152:153], v[152:153], v[168:169]
 v_pk_add_f32 v[154:155], v[154:155], v[170:171]
 v_cvt_pk_bf16_f32 v172, v140, v141
 v_cvt_pk_bf16_f32 v173, v142, v143
 v_cvt_pk_bf16_f32 v174, v144, v145
 v_cvt_pk_bf16_f32 v175, v146, v147
 v_cvt_pk_bf16_f32 v176, v148, v149
 v_cvt_pk_bf16_f32 v177, v150, v151
 v_cvt_pk_bf16_f32 v178, v152, v153
 v_cvt_pk_bf16_f32 v179, v154, v155
 v_xor_b32 v156, 64, v72
 ds_write_b64 v156, v[172:173] offset:8192
 v_xor_b32 v157, 64, v73
 ds_write_b64 v157, v[174:175] offset:8192
 v_xor_b32 v158, 64, v74
 ds_write_b64 v158, v[176:177] offset:8192
 v_xor_b32 v159, 64, v75
 ds_write_b64 v159, v[178:179] offset:8192
 v_accvgpr_read_b32 v140, a80
 v_accvgpr_read_b32 v141, a81
 v_accvgpr_read_b32 v142, a82
 v_accvgpr_read_b32 v143, a83
 v_accvgpr_read_b32 v144, a84
 v_accvgpr_read_b32 v145, a85
 v_accvgpr_read_b32 v146, a86
 v_accvgpr_read_b32 v147, a87
 v_accvgpr_read_b32 v148, a88
 v_accvgpr_read_b32 v149, a89
 v_accvgpr_read_b32 v150, a90
 v_accvgpr_read_b32 v151, a91
 v_accvgpr_read_b32 v152, a92
 v_accvgpr_read_b32 v153, a93
 v_accvgpr_read_b32 v154, a94
 v_accvgpr_read_b32 v155, a95
 v_cvt_pk_bf16_f32 v172, v140, v141
 v_cvt_pk_bf16_f32 v173, v142, v143
 v_cvt_pk_bf16_f32 v174, v144, v145
 v_cvt_pk_bf16_f32 v175, v146, v147
 v_cvt_pk_bf16_f32 v176, v148, v149
 v_cvt_pk_bf16_f32 v177, v150, v151
 v_cvt_pk_bf16_f32 v178, v152, v153
 v_cvt_pk_bf16_f32 v179, v154, v155
 v_lshlrev_b32 v140, 16, v172
 v_and_b32 v141, 0xffff0000, v172
 v_lshlrev_b32 v142, 16, v173
 v_and_b32 v143, 0xffff0000, v173
 v_lshlrev_b32 v144, 16, v174
 v_and_b32 v145, 0xffff0000, v174
 v_lshlrev_b32 v146, 16, v175
 v_and_b32 v147, 0xffff0000, v175
 v_lshlrev_b32 v148, 16, v176
 v_and_b32 v149, 0xffff0000, v176
 v_lshlrev_b32 v150, 16, v177
 v_and_b32 v151, 0xffff0000, v177
 v_lshlrev_b32 v152, 16, v178
 v_and_b32 v153, 0xffff0000, v178
 v_lshlrev_b32 v154, 16, v179
 v_and_b32 v155, 0xffff0000, v179
 s_waitcnt vmcnt(12)
 v_lshlrev_b32 v156, 16, v124
 v_and_b32 v157, 0xffff0000, v124
 v_lshlrev_b32 v158, 16, v125
 v_and_b32 v159, 0xffff0000, v125
 v_lshlrev_b32 v160, 16, v126
 v_and_b32 v161, 0xffff0000, v126
 v_lshlrev_b32 v162, 16, v127
 v_and_b32 v163, 0xffff0000, v127
 v_lshlrev_b32 v164, 16, v128
 v_and_b32 v165, 0xffff0000, v128
 v_lshlrev_b32 v166, 16, v129
 v_and_b32 v167, 0xffff0000, v129
 v_lshlrev_b32 v168, 16, v130
 v_and_b32 v169, 0xffff0000, v130
 v_lshlrev_b32 v170, 16, v131
 v_and_b32 v171, 0xffff0000, v131
 v_pk_add_f32 v[140:141], v[140:141], v[156:157]
 v_pk_add_f32 v[142:143], v[142:143], v[158:159]
 v_pk_add_f32 v[144:145], v[144:145], v[160:161]
 v_pk_add_f32 v[146:147], v[146:147], v[162:163]
 v_pk_add_f32 v[148:149], v[148:149], v[164:165]
 v_pk_add_f32 v[150:151], v[150:151], v[166:167]
 v_pk_add_f32 v[152:153], v[152:153], v[168:169]
 v_pk_add_f32 v[154:155], v[154:155], v[170:171]
 v_cvt_pk_bf16_f32 v172, v140, v141
 v_cvt_pk_bf16_f32 v173, v142, v143
 v_cvt_pk_bf16_f32 v174, v144, v145
 v_cvt_pk_bf16_f32 v175, v146, v147
 v_cvt_pk_bf16_f32 v176, v148, v149
 v_cvt_pk_bf16_f32 v177, v150, v151
 v_cvt_pk_bf16_f32 v178, v152, v153
 v_cvt_pk_bf16_f32 v179, v154, v155
 v_xor_b32 v156, 128, v72
 ds_write_b64 v156, v[172:173] offset:8192
 v_xor_b32 v157, 128, v73
 ds_write_b64 v157, v[174:175] offset:8192
 v_xor_b32 v158, 128, v74
 ds_write_b64 v158, v[176:177] offset:8192
 v_xor_b32 v159, 128, v75
 ds_write_b64 v159, v[178:179] offset:8192
 v_accvgpr_read_b32 v140, a112
 v_accvgpr_read_b32 v141, a113
 v_accvgpr_read_b32 v142, a114
 v_accvgpr_read_b32 v143, a115
 v_accvgpr_read_b32 v144, a116
 v_accvgpr_read_b32 v145, a117
 v_accvgpr_read_b32 v146, a118
 v_accvgpr_read_b32 v147, a119
 v_accvgpr_read_b32 v148, a120
 v_accvgpr_read_b32 v149, a121
 v_accvgpr_read_b32 v150, a122
 v_accvgpr_read_b32 v151, a123
 v_accvgpr_read_b32 v152, a124
 v_accvgpr_read_b32 v153, a125
 v_accvgpr_read_b32 v154, a126
 v_accvgpr_read_b32 v155, a127
 v_cvt_pk_bf16_f32 v172, v140, v141
 v_cvt_pk_bf16_f32 v173, v142, v143
 v_cvt_pk_bf16_f32 v174, v144, v145
 v_cvt_pk_bf16_f32 v175, v146, v147
 v_cvt_pk_bf16_f32 v176, v148, v149
 v_cvt_pk_bf16_f32 v177, v150, v151
 v_cvt_pk_bf16_f32 v178, v152, v153
 v_cvt_pk_bf16_f32 v179, v154, v155
 v_lshlrev_b32 v140, 16, v172
 v_and_b32 v141, 0xffff0000, v172
 v_lshlrev_b32 v142, 16, v173
 v_and_b32 v143, 0xffff0000, v173
 v_lshlrev_b32 v144, 16, v174
 v_and_b32 v145, 0xffff0000, v174
 v_lshlrev_b32 v146, 16, v175
 v_and_b32 v147, 0xffff0000, v175
 v_lshlrev_b32 v148, 16, v176
 v_and_b32 v149, 0xffff0000, v176
 v_lshlrev_b32 v150, 16, v177
 v_and_b32 v151, 0xffff0000, v177
 v_lshlrev_b32 v152, 16, v178
 v_and_b32 v153, 0xffff0000, v178
 v_lshlrev_b32 v154, 16, v179
 v_and_b32 v155, 0xffff0000, v179
 s_waitcnt vmcnt(8)
 v_lshlrev_b32 v156, 16, v132
 v_and_b32 v157, 0xffff0000, v132
 v_lshlrev_b32 v158, 16, v133
 v_and_b32 v159, 0xffff0000, v133
 v_lshlrev_b32 v160, 16, v134
 v_and_b32 v161, 0xffff0000, v134
 v_lshlrev_b32 v162, 16, v135
 v_and_b32 v163, 0xffff0000, v135
 v_lshlrev_b32 v164, 16, v136
 v_and_b32 v165, 0xffff0000, v136
 v_lshlrev_b32 v166, 16, v137
 v_and_b32 v167, 0xffff0000, v137
 v_lshlrev_b32 v168, 16, v138
 v_and_b32 v169, 0xffff0000, v138
 v_lshlrev_b32 v170, 16, v139
 v_and_b32 v171, 0xffff0000, v139
 v_pk_add_f32 v[140:141], v[140:141], v[156:157]
 v_pk_add_f32 v[142:143], v[142:143], v[158:159]
 v_pk_add_f32 v[144:145], v[144:145], v[160:161]
 v_pk_add_f32 v[146:147], v[146:147], v[162:163]
 v_pk_add_f32 v[148:149], v[148:149], v[164:165]
 v_pk_add_f32 v[150:151], v[150:151], v[166:167]
 v_pk_add_f32 v[152:153], v[152:153], v[168:169]
 v_pk_add_f32 v[154:155], v[154:155], v[170:171]
 v_cvt_pk_bf16_f32 v172, v140, v141
 v_cvt_pk_bf16_f32 v173, v142, v143
 v_cvt_pk_bf16_f32 v174, v144, v145
 v_cvt_pk_bf16_f32 v175, v146, v147
 v_cvt_pk_bf16_f32 v176, v148, v149
 v_cvt_pk_bf16_f32 v177, v150, v151
 v_cvt_pk_bf16_f32 v178, v152, v153
 v_cvt_pk_bf16_f32 v179, v154, v155
 v_xor_b32 v156, 192, v72
 ds_write_b64 v156, v[172:173] offset:8192
 v_xor_b32 v157, 192, v73
 ds_write_b64 v157, v[174:175] offset:8192
 v_xor_b32 v158, 192, v74
 ds_write_b64 v158, v[176:177] offset:8192
 v_xor_b32 v159, 192, v75
 ds_write_b64 v159, v[178:179] offset:8192
 s_waitcnt lgkmcnt(0)
 ds_read_b128 v[180:183], v70 offset:8192
 v_xor_b32 v157, 64, v70
 ds_read_b128 v[184:187], v157 offset:9216
 v_xor_b32 v158, 128, v70
 ds_read_b128 v[188:191], v158 offset:10240
 v_xor_b32 v159, 192, v70
 ds_read_b128 v[192:195], v159 offset:11264
 ds_read_b128 v[196:199], v70 offset:12288
 v_xor_b32 v161, 64, v70
 ds_read_b128 v[200:203], v161 offset:13312
 v_xor_b32 v162, 128, v70
 ds_read_b128 v[204:207], v162 offset:14336
 v_xor_b32 v163, 192, v70
 ds_read_b128 v[208:211], v163 offset:15360
 s_waitcnt lgkmcnt(7)
 buffer_store_dwordx4 v[180:183], v69, s[56:59], s39 offen sc1
 s_add_u32 s39, s39, s37
 s_waitcnt lgkmcnt(6)
 buffer_store_dwordx4 v[184:187], v69, s[56:59], s39 offen sc1
 s_add_u32 s39, s39, s37
 s_waitcnt lgkmcnt(5)
 buffer_store_dwordx4 v[188:191], v69, s[56:59], s39 offen sc1
 s_add_u32 s39, s39, s37
 s_waitcnt lgkmcnt(4)
 buffer_store_dwordx4 v[192:195], v69, s[56:59], s39 offen sc1
 s_add_u32 s39, s39, s37
 s_waitcnt lgkmcnt(3)
 buffer_store_dwordx4 v[196:199], v69, s[56:59], s39 offen sc1
 s_add_u32 s39, s39, s37
 s_waitcnt lgkmcnt(2)
 buffer_store_dwordx4 v[200:203], v69, s[56:59], s39 offen sc1
 s_add_u32 s39, s39, s37
 s_waitcnt lgkmcnt(1)
 buffer_store_dwordx4 v[204:207], v69, s[56:59], s39 offen sc1
 s_add_u32 s39, s39, s37
 s_waitcnt lgkmcnt(0)
 buffer_store_dwordx4 v[208:211], v69, s[56:59], s39 offen sc1
 s_add_u32 s39, s39, s37
 s_branch t_g2_exit
t_g2_m1:
 s_mov_b32 s60, 0xbfb8aa3b
 s_mov_b32 s37, 1024
 v_accvgpr_read_b32 v140, a0
 v_accvgpr_read_b32 v141, a1
 v_accvgpr_read_b32 v142, a2
 v_accvgpr_read_b32 v143, a3
 v_accvgpr_read_b32 v144, a4
 v_accvgpr_read_b32 v145, a5
 v_accvgpr_read_b32 v146, a6
 v_accvgpr_read_b32 v147, a7
 v_accvgpr_read_b32 v148, a8
 v_accvgpr_read_b32 v149, a9
 v_accvgpr_read_b32 v150, a10
 v_accvgpr_read_b32 v151, a11
 v_accvgpr_read_b32 v152, a12
 v_accvgpr_read_b32 v153, a13
 v_accvgpr_read_b32 v154, a14
 v_accvgpr_read_b32 v155, a15
 v_cvt_pk_bf16_f32 v172, v140, v141
 v_cvt_pk_bf16_f32 v173, v142, v143
 v_cvt_pk_bf16_f32 v174, v144, v145
 v_cvt_pk_bf16_f32 v175, v146, v147
 v_cvt_pk_bf16_f32 v176, v148, v149
 v_cvt_pk_bf16_f32 v177, v150, v151
 v_cvt_pk_bf16_f32 v178, v152, v153
 v_cvt_pk_bf16_f32 v179, v154, v155
 v_lshlrev_b32 v140, 16, v172
 v_and_b32 v141, 0xffff0000, v172
 v_lshlrev_b32 v142, 16, v173
 v_and_b32 v143, 0xffff0000, v173
 v_lshlrev_b32 v144, 16, v174
 v_and_b32 v145, 0xffff0000, v174
 v_lshlrev_b32 v146, 16, v175
 v_and_b32 v147, 0xffff0000, v175
 v_lshlrev_b32 v148, 16, v176
 v_and_b32 v149, 0xffff0000, v176
 v_lshlrev_b32 v150, 16, v177
 v_and_b32 v151, 0xffff0000, v177
 v_lshlrev_b32 v152, 16, v178
 v_and_b32 v153, 0xffff0000, v178
 v_lshlrev_b32 v154, 16, v179
 v_and_b32 v155, 0xffff0000, v179
 v_mul_f32 v156, s60, v140
 v_mul_f32 v157, s60, v141
 v_mul_f32 v158, s60, v142
 v_mul_f32 v159, s60, v143
 v_mul_f32 v160, s60, v144
 v_mul_f32 v161, s60, v145
 v_mul_f32 v162, s60, v146
 v_mul_f32 v163, s60, v147
 v_mul_f32 v164, s60, v148
 v_mul_f32 v165, s60, v149
 v_mul_f32 v166, s60, v150
 v_mul_f32 v167, s60, v151
 v_mul_f32 v168, s60, v152
 v_mul_f32 v169, s60, v153
 v_mul_f32 v170, s60, v154
 v_mul_f32 v171, s60, v155
 v_exp_f32 v156, v156
 v_exp_f32 v157, v157
 v_exp_f32 v158, v158
 v_exp_f32 v159, v159
 v_exp_f32 v160, v160
 v_exp_f32 v161, v161
 v_exp_f32 v162, v162
 v_exp_f32 v163, v163
 v_exp_f32 v164, v164
 v_exp_f32 v165, v165
 v_exp_f32 v166, v166
 v_exp_f32 v167, v167
 v_exp_f32 v168, v168
 v_exp_f32 v169, v169
 v_exp_f32 v170, v170
 v_exp_f32 v171, v171
 v_add_f32 v156, 1.0, v156
 v_add_f32 v157, 1.0, v157
 v_add_f32 v158, 1.0, v158
 v_add_f32 v159, 1.0, v159
 v_add_f32 v160, 1.0, v160
 v_add_f32 v161, 1.0, v161
 v_add_f32 v162, 1.0, v162
 v_add_f32 v163, 1.0, v163
 v_add_f32 v164, 1.0, v164
 v_add_f32 v165, 1.0, v165
 v_add_f32 v166, 1.0, v166
 v_add_f32 v167, 1.0, v167
 v_add_f32 v168, 1.0, v168
 v_add_f32 v169, 1.0, v169
 v_add_f32 v170, 1.0, v170
 v_add_f32 v171, 1.0, v171
 v_rcp_f32 v156, v156
 v_rcp_f32 v157, v157
 v_rcp_f32 v158, v158
 v_rcp_f32 v159, v159
 v_rcp_f32 v160, v160
 v_rcp_f32 v161, v161
 v_rcp_f32 v162, v162
 v_rcp_f32 v163, v163
 v_rcp_f32 v164, v164
 v_rcp_f32 v165, v165
 v_rcp_f32 v166, v166
 v_rcp_f32 v167, v167
 v_rcp_f32 v168, v168
 v_rcp_f32 v169, v169
 v_rcp_f32 v170, v170
 v_rcp_f32 v171, v171
 v_mul_f32 v140, v140, v156
 v_mul_f32 v141, v141, v157
 v_mul_f32 v142, v142, v158
 v_mul_f32 v143, v143, v159
 v_mul_f32 v144, v144, v160
 v_mul_f32 v145, v145, v161
 v_mul_f32 v146, v146, v162
 v_mul_f32 v147, v147, v163
 v_mul_f32 v148, v148, v164
 v_mul_f32 v149, v149, v165
 v_mul_f32 v150, v150, v166
 v_mul_f32 v151, v151, v167
 v_mul_f32 v152, v152, v168
 v_mul_f32 v153, v153, v169
 v_mul_f32 v154, v154, v170
 v_mul_f32 v155, v155, v171
 v_cvt_pk_bf16_f32 v172, v140, v141
 v_cvt_pk_bf16_f32 v173, v142, v143
 v_cvt_pk_bf16_f32 v174, v144, v145
 v_cvt_pk_bf16_f32 v175, v146, v147
 v_cvt_pk_bf16_f32 v176, v148, v149
 v_cvt_pk_bf16_f32 v177, v150, v151
 v_cvt_pk_bf16_f32 v178, v152, v153
 v_cvt_pk_bf16_f32 v179, v154, v155
 ds_write_b64 v72, v[172:173] offset:0
 ds_write_b64 v73, v[174:175] offset:0
 ds_write_b64 v74, v[176:177] offset:0
 ds_write_b64 v75, v[178:179] offset:0
 v_accvgpr_read_b32 v140, a32
 v_accvgpr_read_b32 v141, a33
 v_accvgpr_read_b32 v142, a34
 v_accvgpr_read_b32 v143, a35
 v_accvgpr_read_b32 v144, a36
 v_accvgpr_read_b32 v145, a37
 v_accvgpr_read_b32 v146, a38
 v_accvgpr_read_b32 v147, a39
 v_accvgpr_read_b32 v148, a40
 v_accvgpr_read_b32 v149, a41
 v_accvgpr_read_b32 v150, a42
 v_accvgpr_read_b32 v151, a43
 v_accvgpr_read_b32 v152, a44
 v_accvgpr_read_b32 v153, a45
 v_accvgpr_read_b32 v154, a46
 v_accvgpr_read_b32 v155, a47
 v_cvt_pk_bf16_f32 v172, v140, v141
 v_cvt_pk_bf16_f32 v173, v142, v143
 v_cvt_pk_bf16_f32 v174, v144, v145
 v_cvt_pk_bf16_f32 v175, v146, v147
 v_cvt_pk_bf16_f32 v176, v148, v149
 v_cvt_pk_bf16_f32 v177, v150, v151
 v_cvt_pk_bf16_f32 v178, v152, v153
 v_cvt_pk_bf16_f32 v179, v154, v155
 v_lshlrev_b32 v140, 16, v172
 v_and_b32 v141, 0xffff0000, v172
 v_lshlrev_b32 v142, 16, v173
 v_and_b32 v143, 0xffff0000, v173
 v_lshlrev_b32 v144, 16, v174
 v_and_b32 v145, 0xffff0000, v174
 v_lshlrev_b32 v146, 16, v175
 v_and_b32 v147, 0xffff0000, v175
 v_lshlrev_b32 v148, 16, v176
 v_and_b32 v149, 0xffff0000, v176
 v_lshlrev_b32 v150, 16, v177
 v_and_b32 v151, 0xffff0000, v177
 v_lshlrev_b32 v152, 16, v178
 v_and_b32 v153, 0xffff0000, v178
 v_lshlrev_b32 v154, 16, v179
 v_and_b32 v155, 0xffff0000, v179
 v_mul_f32 v156, s60, v140
 v_mul_f32 v157, s60, v141
 v_mul_f32 v158, s60, v142
 v_mul_f32 v159, s60, v143
 v_mul_f32 v160, s60, v144
 v_mul_f32 v161, s60, v145
 v_mul_f32 v162, s60, v146
 v_mul_f32 v163, s60, v147
 v_mul_f32 v164, s60, v148
 v_mul_f32 v165, s60, v149
 v_mul_f32 v166, s60, v150
 v_mul_f32 v167, s60, v151
 v_mul_f32 v168, s60, v152
 v_mul_f32 v169, s60, v153
 v_mul_f32 v170, s60, v154
 v_mul_f32 v171, s60, v155
 v_exp_f32 v156, v156
 v_exp_f32 v157, v157
 v_exp_f32 v158, v158
 v_exp_f32 v159, v159
 v_exp_f32 v160, v160
 v_exp_f32 v161, v161
 v_exp_f32 v162, v162
 v_exp_f32 v163, v163
 v_exp_f32 v164, v164
 v_exp_f32 v165, v165
 v_exp_f32 v166, v166
 v_exp_f32 v167, v167
 v_exp_f32 v168, v168
 v_exp_f32 v169, v169
 v_exp_f32 v170, v170
 v_exp_f32 v171, v171
 v_add_f32 v156, 1.0, v156
 v_add_f32 v157, 1.0, v157
 v_add_f32 v158, 1.0, v158
 v_add_f32 v159, 1.0, v159
 v_add_f32 v160, 1.0, v160
 v_add_f32 v161, 1.0, v161
 v_add_f32 v162, 1.0, v162
 v_add_f32 v163, 1.0, v163
 v_add_f32 v164, 1.0, v164
 v_add_f32 v165, 1.0, v165
 v_add_f32 v166, 1.0, v166
 v_add_f32 v167, 1.0, v167
 v_add_f32 v168, 1.0, v168
 v_add_f32 v169, 1.0, v169
 v_add_f32 v170, 1.0, v170
 v_add_f32 v171, 1.0, v171
 v_rcp_f32 v156, v156
 v_rcp_f32 v157, v157
 v_rcp_f32 v158, v158
 v_rcp_f32 v159, v159
 v_rcp_f32 v160, v160
 v_rcp_f32 v161, v161
 v_rcp_f32 v162, v162
 v_rcp_f32 v163, v163
 v_rcp_f32 v164, v164
 v_rcp_f32 v165, v165
 v_rcp_f32 v166, v166
 v_rcp_f32 v167, v167
 v_rcp_f32 v168, v168
 v_rcp_f32 v169, v169
 v_rcp_f32 v170, v170
 v_rcp_f32 v171, v171
 v_mul_f32 v140, v140, v156
 v_mul_f32 v141, v141, v157
 v_mul_f32 v142, v142, v158
 v_mul_f32 v143, v143, v159
 v_mul_f32 v144, v144, v160
 v_mul_f32 v145, v145, v161
 v_mul_f32 v146, v146, v162
 v_mul_f32 v147, v147, v163
 v_mul_f32 v148, v148, v164
 v_mul_f32 v149, v149, v165
 v_mul_f32 v150, v150, v166
 v_mul_f32 v151, v151, v167
 v_mul_f32 v152, v152, v168
 v_mul_f32 v153, v153, v169
 v_mul_f32 v154, v154, v170
 v_mul_f32 v155, v155, v171
 v_cvt_pk_bf16_f32 v172, v140, v141
 v_cvt_pk_bf16_f32 v173, v142, v143
 v_cvt_pk_bf16_f32 v174, v144, v145
 v_cvt_pk_bf16_f32 v175, v146, v147
 v_cvt_pk_bf16_f32 v176, v148, v149
 v_cvt_pk_bf16_f32 v177, v150, v151
 v_cvt_pk_bf16_f32 v178, v152, v153
 v_cvt_pk_bf16_f32 v179, v154, v155
 v_xor_b32 v156, 64, v72
 ds_write_b64 v156, v[172:173] offset:0
 v_xor_b32 v157, 64, v73
 ds_write_b64 v157, v[174:175] offset:0
 v_xor_b32 v158, 64, v74
 ds_write_b64 v158, v[176:177] offset:0
 v_xor_b32 v159, 64, v75
 ds_write_b64 v159, v[178:179] offset:0
 v_accvgpr_read_b32 v140, a64
 v_accvgpr_read_b32 v141, a65
 v_accvgpr_read_b32 v142, a66
 v_accvgpr_read_b32 v143, a67
 v_accvgpr_read_b32 v144, a68
 v_accvgpr_read_b32 v145, a69
 v_accvgpr_read_b32 v146, a70
 v_accvgpr_read_b32 v147, a71
 v_accvgpr_read_b32 v148, a72
 v_accvgpr_read_b32 v149, a73
 v_accvgpr_read_b32 v150, a74
 v_accvgpr_read_b32 v151, a75
 v_accvgpr_read_b32 v152, a76
 v_accvgpr_read_b32 v153, a77
 v_accvgpr_read_b32 v154, a78
 v_accvgpr_read_b32 v155, a79
 v_cvt_pk_bf16_f32 v172, v140, v141
 v_cvt_pk_bf16_f32 v173, v142, v143
 v_cvt_pk_bf16_f32 v174, v144, v145
 v_cvt_pk_bf16_f32 v175, v146, v147
 v_cvt_pk_bf16_f32 v176, v148, v149
 v_cvt_pk_bf16_f32 v177, v150, v151
 v_cvt_pk_bf16_f32 v178, v152, v153
 v_cvt_pk_bf16_f32 v179, v154, v155
 v_lshlrev_b32 v140, 16, v172
 v_and_b32 v141, 0xffff0000, v172
 v_lshlrev_b32 v142, 16, v173
 v_and_b32 v143, 0xffff0000, v173
 v_lshlrev_b32 v144, 16, v174
 v_and_b32 v145, 0xffff0000, v174
 v_lshlrev_b32 v146, 16, v175
 v_and_b32 v147, 0xffff0000, v175
 v_lshlrev_b32 v148, 16, v176
 v_and_b32 v149, 0xffff0000, v176
 v_lshlrev_b32 v150, 16, v177
 v_and_b32 v151, 0xffff0000, v177
 v_lshlrev_b32 v152, 16, v178
 v_and_b32 v153, 0xffff0000, v178
 v_lshlrev_b32 v154, 16, v179
 v_and_b32 v155, 0xffff0000, v179
 v_mul_f32 v156, s60, v140
 v_mul_f32 v157, s60, v141
 v_mul_f32 v158, s60, v142
 v_mul_f32 v159, s60, v143
 v_mul_f32 v160, s60, v144
 v_mul_f32 v161, s60, v145
 v_mul_f32 v162, s60, v146
 v_mul_f32 v163, s60, v147
 v_mul_f32 v164, s60, v148
 v_mul_f32 v165, s60, v149
 v_mul_f32 v166, s60, v150
 v_mul_f32 v167, s60, v151
 v_mul_f32 v168, s60, v152
 v_mul_f32 v169, s60, v153
 v_mul_f32 v170, s60, v154
 v_mul_f32 v171, s60, v155
 v_exp_f32 v156, v156
 v_exp_f32 v157, v157
 v_exp_f32 v158, v158
 v_exp_f32 v159, v159
 v_exp_f32 v160, v160
 v_exp_f32 v161, v161
 v_exp_f32 v162, v162
 v_exp_f32 v163, v163
 v_exp_f32 v164, v164
 v_exp_f32 v165, v165
 v_exp_f32 v166, v166
 v_exp_f32 v167, v167
 v_exp_f32 v168, v168
 v_exp_f32 v169, v169
 v_exp_f32 v170, v170
 v_exp_f32 v171, v171
 v_add_f32 v156, 1.0, v156
 v_add_f32 v157, 1.0, v157
 v_add_f32 v158, 1.0, v158
 v_add_f32 v159, 1.0, v159
 v_add_f32 v160, 1.0, v160
 v_add_f32 v161, 1.0, v161
 v_add_f32 v162, 1.0, v162
 v_add_f32 v163, 1.0, v163
 v_add_f32 v164, 1.0, v164
 v_add_f32 v165, 1.0, v165
 v_add_f32 v166, 1.0, v166
 v_add_f32 v167, 1.0, v167
 v_add_f32 v168, 1.0, v168
 v_add_f32 v169, 1.0, v169
 v_add_f32 v170, 1.0, v170
 v_add_f32 v171, 1.0, v171
 v_rcp_f32 v156, v156
 v_rcp_f32 v157, v157
 v_rcp_f32 v158, v158
 v_rcp_f32 v159, v159
 v_rcp_f32 v160, v160
 v_rcp_f32 v161, v161
 v_rcp_f32 v162, v162
 v_rcp_f32 v163, v163
 v_rcp_f32 v164, v164
 v_rcp_f32 v165, v165
 v_rcp_f32 v166, v166
 v_rcp_f32 v167, v167
 v_rcp_f32 v168, v168
 v_rcp_f32 v169, v169
 v_rcp_f32 v170, v170
 v_rcp_f32 v171, v171
 v_mul_f32 v140, v140, v156
 v_mul_f32 v141, v141, v157
 v_mul_f32 v142, v142, v158
 v_mul_f32 v143, v143, v159
 v_mul_f32 v144, v144, v160
 v_mul_f32 v145, v145, v161
 v_mul_f32 v146, v146, v162
 v_mul_f32 v147, v147, v163
 v_mul_f32 v148, v148, v164
 v_mul_f32 v149, v149, v165
 v_mul_f32 v150, v150, v166
 v_mul_f32 v151, v151, v167
 v_mul_f32 v152, v152, v168
 v_mul_f32 v153, v153, v169
 v_mul_f32 v154, v154, v170
 v_mul_f32 v155, v155, v171
 v_cvt_pk_bf16_f32 v172, v140, v141
 v_cvt_pk_bf16_f32 v173, v142, v143
 v_cvt_pk_bf16_f32 v174, v144, v145
 v_cvt_pk_bf16_f32 v175, v146, v147
 v_cvt_pk_bf16_f32 v176, v148, v149
 v_cvt_pk_bf16_f32 v177, v150, v151
 v_cvt_pk_bf16_f32 v178, v152, v153
 v_cvt_pk_bf16_f32 v179, v154, v155
 v_xor_b32 v156, 128, v72
 ds_write_b64 v156, v[172:173] offset:0
 v_xor_b32 v157, 128, v73
 ds_write_b64 v157, v[174:175] offset:0
 v_xor_b32 v158, 128, v74
 ds_write_b64 v158, v[176:177] offset:0
 v_xor_b32 v159, 128, v75
 ds_write_b64 v159, v[178:179] offset:0
 v_accvgpr_read_b32 v140, a96
 v_accvgpr_read_b32 v141, a97
 v_accvgpr_read_b32 v142, a98
 v_accvgpr_read_b32 v143, a99
 v_accvgpr_read_b32 v144, a100
 v_accvgpr_read_b32 v145, a101
 v_accvgpr_read_b32 v146, a102
 v_accvgpr_read_b32 v147, a103
 v_accvgpr_read_b32 v148, a104
 v_accvgpr_read_b32 v149, a105
 v_accvgpr_read_b32 v150, a106
 v_accvgpr_read_b32 v151, a107
 v_accvgpr_read_b32 v152, a108
 v_accvgpr_read_b32 v153, a109
 v_accvgpr_read_b32 v154, a110
 v_accvgpr_read_b32 v155, a111
 v_cvt_pk_bf16_f32 v172, v140, v141
 v_cvt_pk_bf16_f32 v173, v142, v143
 v_cvt_pk_bf16_f32 v174, v144, v145
 v_cvt_pk_bf16_f32 v175, v146, v147
 v_cvt_pk_bf16_f32 v176, v148, v149
 v_cvt_pk_bf16_f32 v177, v150, v151
 v_cvt_pk_bf16_f32 v178, v152, v153
 v_cvt_pk_bf16_f32 v179, v154, v155
 v_lshlrev_b32 v140, 16, v172
 v_and_b32 v141, 0xffff0000, v172
 v_lshlrev_b32 v142, 16, v173
 v_and_b32 v143, 0xffff0000, v173
 v_lshlrev_b32 v144, 16, v174
 v_and_b32 v145, 0xffff0000, v174
 v_lshlrev_b32 v146, 16, v175
 v_and_b32 v147, 0xffff0000, v175
 v_lshlrev_b32 v148, 16, v176
 v_and_b32 v149, 0xffff0000, v176
 v_lshlrev_b32 v150, 16, v177
 v_and_b32 v151, 0xffff0000, v177
 v_lshlrev_b32 v152, 16, v178
 v_and_b32 v153, 0xffff0000, v178
 v_lshlrev_b32 v154, 16, v179
 v_and_b32 v155, 0xffff0000, v179
 v_mul_f32 v156, s60, v140
 v_mul_f32 v157, s60, v141
 v_mul_f32 v158, s60, v142
 v_mul_f32 v159, s60, v143
 v_mul_f32 v160, s60, v144
 v_mul_f32 v161, s60, v145
 v_mul_f32 v162, s60, v146
 v_mul_f32 v163, s60, v147
 v_mul_f32 v164, s60, v148
 v_mul_f32 v165, s60, v149
 v_mul_f32 v166, s60, v150
 v_mul_f32 v167, s60, v151
 v_mul_f32 v168, s60, v152
 v_mul_f32 v169, s60, v153
 v_mul_f32 v170, s60, v154
 v_mul_f32 v171, s60, v155
 v_exp_f32 v156, v156
 v_exp_f32 v157, v157
 v_exp_f32 v158, v158
 v_exp_f32 v159, v159
 v_exp_f32 v160, v160
 v_exp_f32 v161, v161
 v_exp_f32 v162, v162
 v_exp_f32 v163, v163
 v_exp_f32 v164, v164
 v_exp_f32 v165, v165
 v_exp_f32 v166, v166
 v_exp_f32 v167, v167
 v_exp_f32 v168, v168
 v_exp_f32 v169, v169
 v_exp_f32 v170, v170
 v_exp_f32 v171, v171
 v_add_f32 v156, 1.0, v156
 v_add_f32 v157, 1.0, v157
 v_add_f32 v158, 1.0, v158
 v_add_f32 v159, 1.0, v159
 v_add_f32 v160, 1.0, v160
 v_add_f32 v161, 1.0, v161
 v_add_f32 v162, 1.0, v162
 v_add_f32 v163, 1.0, v163
 v_add_f32 v164, 1.0, v164
 v_add_f32 v165, 1.0, v165
 v_add_f32 v166, 1.0, v166
 v_add_f32 v167, 1.0, v167
 v_add_f32 v168, 1.0, v168
 v_add_f32 v169, 1.0, v169
 v_add_f32 v170, 1.0, v170
 v_add_f32 v171, 1.0, v171
 v_rcp_f32 v156, v156
 v_rcp_f32 v157, v157
 v_rcp_f32 v158, v158
 v_rcp_f32 v159, v159
 v_rcp_f32 v160, v160
 v_rcp_f32 v161, v161
 v_rcp_f32 v162, v162
 v_rcp_f32 v163, v163
 v_rcp_f32 v164, v164
 v_rcp_f32 v165, v165
 v_rcp_f32 v166, v166
 v_rcp_f32 v167, v167
 v_rcp_f32 v168, v168
 v_rcp_f32 v169, v169
 v_rcp_f32 v170, v170
 v_rcp_f32 v171, v171
 v_mul_f32 v140, v140, v156
 v_mul_f32 v141, v141, v157
 v_mul_f32 v142, v142, v158
 v_mul_f32 v143, v143, v159
 v_mul_f32 v144, v144, v160
 v_mul_f32 v145, v145, v161
 v_mul_f32 v146, v146, v162
 v_mul_f32 v147, v147, v163
 v_mul_f32 v148, v148, v164
 v_mul_f32 v149, v149, v165
 v_mul_f32 v150, v150, v166
 v_mul_f32 v151, v151, v167
 v_mul_f32 v152, v152, v168
 v_mul_f32 v153, v153, v169
 v_mul_f32 v154, v154, v170
 v_mul_f32 v155, v155, v171
 v_cvt_pk_bf16_f32 v172, v140, v141
 v_cvt_pk_bf16_f32 v173, v142, v143
 v_cvt_pk_bf16_f32 v174, v144, v145
 v_cvt_pk_bf16_f32 v175, v146, v147
 v_cvt_pk_bf16_f32 v176, v148, v149
 v_cvt_pk_bf16_f32 v177, v150, v151
 v_cvt_pk_bf16_f32 v178, v152, v153
 v_cvt_pk_bf16_f32 v179, v154, v155
 v_xor_b32 v156, 192, v72
 ds_write_b64 v156, v[172:173] offset:0
 v_xor_b32 v157, 192, v73
 ds_write_b64 v157, v[174:175] offset:0
 v_xor_b32 v158, 192, v74
 ds_write_b64 v158, v[176:177] offset:0
 v_xor_b32 v159, 192, v75
 ds_write_b64 v159, v[178:179] offset:0
 s_waitcnt lgkmcnt(0)
 ds_read_b128 v[180:183], v71 offset:0
 v_xor_b32 v157, 32, v71
 ds_read_b128 v[184:187], v157 offset:0
 v_xor_b32 v158, 64, v71
 ds_read_b128 v[188:191], v158 offset:0
 v_xor_b32 v159, 96, v71
 ds_read_b128 v[192:195], v159 offset:0
 v_xor_b32 v160, 128, v71
 ds_read_b128 v[196:199], v160 offset:0
 v_xor_b32 v161, 160, v71
 ds_read_b128 v[200:203], v161 offset:0
 v_xor_b32 v162, 192, v71
 ds_read_b128 v[204:207], v162 offset:0
 v_xor_b32 v163, 224, v71
 ds_read_b128 v[208:211], v163 offset:0
 s_lshl_b32 s36, s26, 13
 s_add_u32 s39, s61, s36
 s_add_u32 s39, s39, 79691776
 s_waitcnt lgkmcnt(7)
 buffer_store_dwordx4 v[180:183], v212, s[56:59], s39 offen sc1
 s_add_u32 s39, s39, s37
 s_waitcnt lgkmcnt(6)
 buffer_store_dwordx4 v[184:187], v212, s[56:59], s39 offen sc1
 s_add_u32 s39, s39, s37
 s_waitcnt lgkmcnt(5)
 buffer_store_dwordx4 v[188:191], v212, s[56:59], s39 offen sc1
 s_add_u32 s39, s39, s37
 s_waitcnt lgkmcnt(4)
 buffer_store_dwordx4 v[192:195], v212, s[56:59], s39 offen sc1
 s_add_u32 s39, s39, s37
 s_waitcnt lgkmcnt(3)
 buffer_store_dwordx4 v[196:199], v212, s[56:59], s39 offen sc1
 s_add_u32 s39, s39, s37
 s_waitcnt lgkmcnt(2)
 buffer_store_dwordx4 v[200:203], v212, s[56:59], s39 offen sc1
 s_add_u32 s39, s39, s37
 s_waitcnt lgkmcnt(1)
 buffer_store_dwordx4 v[204:207], v212, s[56:59], s39 offen sc1
 s_add_u32 s39, s39, s37
 s_waitcnt lgkmcnt(0)
 buffer_store_dwordx4 v[208:211], v212, s[56:59], s39 offen sc1
 s_add_u32 s39, s39, s37
 v_accvgpr_read_b32 v140, a16
 v_accvgpr_read_b32 v141, a17
 v_accvgpr_read_b32 v142, a18
 v_accvgpr_read_b32 v143, a19
 v_accvgpr_read_b32 v144, a20
 v_accvgpr_read_b32 v145, a21
 v_accvgpr_read_b32 v146, a22
 v_accvgpr_read_b32 v147, a23
 v_accvgpr_read_b32 v148, a24
 v_accvgpr_read_b32 v149, a25
 v_accvgpr_read_b32 v150, a26
 v_accvgpr_read_b32 v151, a27
 v_accvgpr_read_b32 v152, a28
 v_accvgpr_read_b32 v153, a29
 v_accvgpr_read_b32 v154, a30
 v_accvgpr_read_b32 v155, a31
 v_cvt_pk_bf16_f32 v172, v140, v141
 v_cvt_pk_bf16_f32 v173, v142, v143
 v_cvt_pk_bf16_f32 v174, v144, v145
 v_cvt_pk_bf16_f32 v175, v146, v147
 v_cvt_pk_bf16_f32 v176, v148, v149
 v_cvt_pk_bf16_f32 v177, v150, v151
 v_cvt_pk_bf16_f32 v178, v152, v153
 v_cvt_pk_bf16_f32 v179, v154, v155
 v_lshlrev_b32 v140, 16, v172
 v_and_b32 v141, 0xffff0000, v172
 v_lshlrev_b32 v142, 16, v173
 v_and_b32 v143, 0xffff0000, v173
 v_lshlrev_b32 v144, 16, v174
 v_and_b32 v145, 0xffff0000, v174
 v_lshlrev_b32 v146, 16, v175
 v_and_b32 v147, 0xffff0000, v175
 v_lshlrev_b32 v148, 16, v176
 v_and_b32 v149, 0xffff0000, v176
 v_lshlrev_b32 v150, 16, v177
 v_and_b32 v151, 0xffff0000, v177
 v_lshlrev_b32 v152, 16, v178
 v_and_b32 v153, 0xffff0000, v178
 v_lshlrev_b32 v154, 16, v179
 v_and_b32 v155, 0xffff0000, v179
 v_mul_f32 v156, s60, v140
 v_mul_f32 v157, s60, v141
 v_mul_f32 v158, s60, v142
 v_mul_f32 v159, s60, v143
 v_mul_f32 v160, s60, v144
 v_mul_f32 v161, s60, v145
 v_mul_f32 v162, s60, v146
 v_mul_f32 v163, s60, v147
 v_mul_f32 v164, s60, v148
 v_mul_f32 v165, s60, v149
 v_mul_f32 v166, s60, v150
 v_mul_f32 v167, s60, v151
 v_mul_f32 v168, s60, v152
 v_mul_f32 v169, s60, v153
 v_mul_f32 v170, s60, v154
 v_mul_f32 v171, s60, v155
 v_exp_f32 v156, v156
 v_exp_f32 v157, v157
 v_exp_f32 v158, v158
 v_exp_f32 v159, v159
 v_exp_f32 v160, v160
 v_exp_f32 v161, v161
 v_exp_f32 v162, v162
 v_exp_f32 v163, v163
 v_exp_f32 v164, v164
 v_exp_f32 v165, v165
 v_exp_f32 v166, v166
 v_exp_f32 v167, v167
 v_exp_f32 v168, v168
 v_exp_f32 v169, v169
 v_exp_f32 v170, v170
 v_exp_f32 v171, v171
 v_add_f32 v156, 1.0, v156
 v_add_f32 v157, 1.0, v157
 v_add_f32 v158, 1.0, v158
 v_add_f32 v159, 1.0, v159
 v_add_f32 v160, 1.0, v160
 v_add_f32 v161, 1.0, v161
 v_add_f32 v162, 1.0, v162
 v_add_f32 v163, 1.0, v163
 v_add_f32 v164, 1.0, v164
 v_add_f32 v165, 1.0, v165
 v_add_f32 v166, 1.0, v166
 v_add_f32 v167, 1.0, v167
 v_add_f32 v168, 1.0, v168
 v_add_f32 v169, 1.0, v169
 v_add_f32 v170, 1.0, v170
 v_add_f32 v171, 1.0, v171
 v_rcp_f32 v156, v156
 v_rcp_f32 v157, v157
 v_rcp_f32 v158, v158
 v_rcp_f32 v159, v159
 v_rcp_f32 v160, v160
 v_rcp_f32 v161, v161
 v_rcp_f32 v162, v162
 v_rcp_f32 v163, v163
 v_rcp_f32 v164, v164
 v_rcp_f32 v165, v165
 v_rcp_f32 v166, v166
 v_rcp_f32 v167, v167
 v_rcp_f32 v168, v168
 v_rcp_f32 v169, v169
 v_rcp_f32 v170, v170
 v_rcp_f32 v171, v171
 v_mul_f32 v140, v140, v156
 v_mul_f32 v141, v141, v157
 v_mul_f32 v142, v142, v158
 v_mul_f32 v143, v143, v159
 v_mul_f32 v144, v144, v160
 v_mul_f32 v145, v145, v161
 v_mul_f32 v146, v146, v162
 v_mul_f32 v147, v147, v163
 v_mul_f32 v148, v148, v164
 v_mul_f32 v149, v149, v165
 v_mul_f32 v150, v150, v166
 v_mul_f32 v151, v151, v167
 v_mul_f32 v152, v152, v168
 v_mul_f32 v153, v153, v169
 v_mul_f32 v154, v154, v170
 v_mul_f32 v155, v155, v171
 v_cvt_pk_bf16_f32 v172, v140, v141
 v_cvt_pk_bf16_f32 v173, v142, v143
 v_cvt_pk_bf16_f32 v174, v144, v145
 v_cvt_pk_bf16_f32 v175, v146, v147
 v_cvt_pk_bf16_f32 v176, v148, v149
 v_cvt_pk_bf16_f32 v177, v150, v151
 v_cvt_pk_bf16_f32 v178, v152, v153
 v_cvt_pk_bf16_f32 v179, v154, v155
 ds_write_b64 v72, v[172:173] offset:8192
 ds_write_b64 v73, v[174:175] offset:8192
 ds_write_b64 v74, v[176:177] offset:8192
 ds_write_b64 v75, v[178:179] offset:8192
 v_accvgpr_read_b32 v140, a48
 v_accvgpr_read_b32 v141, a49
 v_accvgpr_read_b32 v142, a50
 v_accvgpr_read_b32 v143, a51
 v_accvgpr_read_b32 v144, a52
 v_accvgpr_read_b32 v145, a53
 v_accvgpr_read_b32 v146, a54
 v_accvgpr_read_b32 v147, a55
 v_accvgpr_read_b32 v148, a56
 v_accvgpr_read_b32 v149, a57
 v_accvgpr_read_b32 v150, a58
 v_accvgpr_read_b32 v151, a59
 v_accvgpr_read_b32 v152, a60
 v_accvgpr_read_b32 v153, a61
 v_accvgpr_read_b32 v154, a62
 v_accvgpr_read_b32 v155, a63
 v_cvt_pk_bf16_f32 v172, v140, v141
 v_cvt_pk_bf16_f32 v173, v142, v143
 v_cvt_pk_bf16_f32 v174, v144, v145
 v_cvt_pk_bf16_f32 v175, v146, v147
 v_cvt_pk_bf16_f32 v176, v148, v149
 v_cvt_pk_bf16_f32 v177, v150, v151
 v_cvt_pk_bf16_f32 v178, v152, v153
 v_cvt_pk_bf16_f32 v179, v154, v155
 v_lshlrev_b32 v140, 16, v172
 v_and_b32 v141, 0xffff0000, v172
 v_lshlrev_b32 v142, 16, v173
 v_and_b32 v143, 0xffff0000, v173
 v_lshlrev_b32 v144, 16, v174
 v_and_b32 v145, 0xffff0000, v174
 v_lshlrev_b32 v146, 16, v175
 v_and_b32 v147, 0xffff0000, v175
 v_lshlrev_b32 v148, 16, v176
 v_and_b32 v149, 0xffff0000, v176
 v_lshlrev_b32 v150, 16, v177
 v_and_b32 v151, 0xffff0000, v177
 v_lshlrev_b32 v152, 16, v178
 v_and_b32 v153, 0xffff0000, v178
 v_lshlrev_b32 v154, 16, v179
 v_and_b32 v155, 0xffff0000, v179
 v_mul_f32 v156, s60, v140
 v_mul_f32 v157, s60, v141
 v_mul_f32 v158, s60, v142
 v_mul_f32 v159, s60, v143
 v_mul_f32 v160, s60, v144
 v_mul_f32 v161, s60, v145
 v_mul_f32 v162, s60, v146
 v_mul_f32 v163, s60, v147
 v_mul_f32 v164, s60, v148
 v_mul_f32 v165, s60, v149
 v_mul_f32 v166, s60, v150
 v_mul_f32 v167, s60, v151
 v_mul_f32 v168, s60, v152
 v_mul_f32 v169, s60, v153
 v_mul_f32 v170, s60, v154
 v_mul_f32 v171, s60, v155
 v_exp_f32 v156, v156
 v_exp_f32 v157, v157
 v_exp_f32 v158, v158
 v_exp_f32 v159, v159
 v_exp_f32 v160, v160
 v_exp_f32 v161, v161
 v_exp_f32 v162, v162
 v_exp_f32 v163, v163
 v_exp_f32 v164, v164
 v_exp_f32 v165, v165
 v_exp_f32 v166, v166
 v_exp_f32 v167, v167
 v_exp_f32 v168, v168
 v_exp_f32 v169, v169
 v_exp_f32 v170, v170
 v_exp_f32 v171, v171
 v_add_f32 v156, 1.0, v156
 v_add_f32 v157, 1.0, v157
 v_add_f32 v158, 1.0, v158
 v_add_f32 v159, 1.0, v159
 v_add_f32 v160, 1.0, v160
 v_add_f32 v161, 1.0, v161
 v_add_f32 v162, 1.0, v162
 v_add_f32 v163, 1.0, v163
 v_add_f32 v164, 1.0, v164
 v_add_f32 v165, 1.0, v165
 v_add_f32 v166, 1.0, v166
 v_add_f32 v167, 1.0, v167
 v_add_f32 v168, 1.0, v168
 v_add_f32 v169, 1.0, v169
 v_add_f32 v170, 1.0, v170
 v_add_f32 v171, 1.0, v171
 v_rcp_f32 v156, v156
 v_rcp_f32 v157, v157
 v_rcp_f32 v158, v158
 v_rcp_f32 v159, v159
 v_rcp_f32 v160, v160
 v_rcp_f32 v161, v161
 v_rcp_f32 v162, v162
 v_rcp_f32 v163, v163
 v_rcp_f32 v164, v164
 v_rcp_f32 v165, v165
 v_rcp_f32 v166, v166
 v_rcp_f32 v167, v167
 v_rcp_f32 v168, v168
 v_rcp_f32 v169, v169
 v_rcp_f32 v170, v170
 v_rcp_f32 v171, v171
 v_mul_f32 v140, v140, v156
 v_mul_f32 v141, v141, v157
 v_mul_f32 v142, v142, v158
 v_mul_f32 v143, v143, v159
 v_mul_f32 v144, v144, v160
 v_mul_f32 v145, v145, v161
 v_mul_f32 v146, v146, v162
 v_mul_f32 v147, v147, v163
 v_mul_f32 v148, v148, v164
 v_mul_f32 v149, v149, v165
 v_mul_f32 v150, v150, v166
 v_mul_f32 v151, v151, v167
 v_mul_f32 v152, v152, v168
 v_mul_f32 v153, v153, v169
 v_mul_f32 v154, v154, v170
 v_mul_f32 v155, v155, v171
 v_cvt_pk_bf16_f32 v172, v140, v141
 v_cvt_pk_bf16_f32 v173, v142, v143
 v_cvt_pk_bf16_f32 v174, v144, v145
 v_cvt_pk_bf16_f32 v175, v146, v147
 v_cvt_pk_bf16_f32 v176, v148, v149
 v_cvt_pk_bf16_f32 v177, v150, v151
 v_cvt_pk_bf16_f32 v178, v152, v153
 v_cvt_pk_bf16_f32 v179, v154, v155
 v_xor_b32 v156, 64, v72
 ds_write_b64 v156, v[172:173] offset:8192
 v_xor_b32 v157, 64, v73
 ds_write_b64 v157, v[174:175] offset:8192
 v_xor_b32 v158, 64, v74
 ds_write_b64 v158, v[176:177] offset:8192
 v_xor_b32 v159, 64, v75
 ds_write_b64 v159, v[178:179] offset:8192
 v_accvgpr_read_b32 v140, a80
 v_accvgpr_read_b32 v141, a81
 v_accvgpr_read_b32 v142, a82
 v_accvgpr_read_b32 v143, a83
 v_accvgpr_read_b32 v144, a84
 v_accvgpr_read_b32 v145, a85
 v_accvgpr_read_b32 v146, a86
 v_accvgpr_read_b32 v147, a87
 v_accvgpr_read_b32 v148, a88
 v_accvgpr_read_b32 v149, a89
 v_accvgpr_read_b32 v150, a90
 v_accvgpr_read_b32 v151, a91
 v_accvgpr_read_b32 v152, a92
 v_accvgpr_read_b32 v153, a93
 v_accvgpr_read_b32 v154, a94
 v_accvgpr_read_b32 v155, a95
 v_cvt_pk_bf16_f32 v172, v140, v141
 v_cvt_pk_bf16_f32 v173, v142, v143
 v_cvt_pk_bf16_f32 v174, v144, v145
 v_cvt_pk_bf16_f32 v175, v146, v147
 v_cvt_pk_bf16_f32 v176, v148, v149
 v_cvt_pk_bf16_f32 v177, v150, v151
 v_cvt_pk_bf16_f32 v178, v152, v153
 v_cvt_pk_bf16_f32 v179, v154, v155
 v_lshlrev_b32 v140, 16, v172
 v_and_b32 v141, 0xffff0000, v172
 v_lshlrev_b32 v142, 16, v173
 v_and_b32 v143, 0xffff0000, v173
 v_lshlrev_b32 v144, 16, v174
 v_and_b32 v145, 0xffff0000, v174
 v_lshlrev_b32 v146, 16, v175
 v_and_b32 v147, 0xffff0000, v175
 v_lshlrev_b32 v148, 16, v176
 v_and_b32 v149, 0xffff0000, v176
 v_lshlrev_b32 v150, 16, v177
 v_and_b32 v151, 0xffff0000, v177
 v_lshlrev_b32 v152, 16, v178
 v_and_b32 v153, 0xffff0000, v178
 v_lshlrev_b32 v154, 16, v179
 v_and_b32 v155, 0xffff0000, v179
 v_mul_f32 v156, s60, v140
 v_mul_f32 v157, s60, v141
 v_mul_f32 v158, s60, v142
 v_mul_f32 v159, s60, v143
 v_mul_f32 v160, s60, v144
 v_mul_f32 v161, s60, v145
 v_mul_f32 v162, s60, v146
 v_mul_f32 v163, s60, v147
 v_mul_f32 v164, s60, v148
 v_mul_f32 v165, s60, v149
 v_mul_f32 v166, s60, v150
 v_mul_f32 v167, s60, v151
 v_mul_f32 v168, s60, v152
 v_mul_f32 v169, s60, v153
 v_mul_f32 v170, s60, v154
 v_mul_f32 v171, s60, v155
 v_exp_f32 v156, v156
 v_exp_f32 v157, v157
 v_exp_f32 v158, v158
 v_exp_f32 v159, v159
 v_exp_f32 v160, v160
 v_exp_f32 v161, v161
 v_exp_f32 v162, v162
 v_exp_f32 v163, v163
 v_exp_f32 v164, v164
 v_exp_f32 v165, v165
 v_exp_f32 v166, v166
 v_exp_f32 v167, v167
 v_exp_f32 v168, v168
 v_exp_f32 v169, v169
 v_exp_f32 v170, v170
 v_exp_f32 v171, v171
 v_add_f32 v156, 1.0, v156
 v_add_f32 v157, 1.0, v157
 v_add_f32 v158, 1.0, v158
 v_add_f32 v159, 1.0, v159
 v_add_f32 v160, 1.0, v160
 v_add_f32 v161, 1.0, v161
 v_add_f32 v162, 1.0, v162
 v_add_f32 v163, 1.0, v163
 v_add_f32 v164, 1.0, v164
 v_add_f32 v165, 1.0, v165
 v_add_f32 v166, 1.0, v166
 v_add_f32 v167, 1.0, v167
 v_add_f32 v168, 1.0, v168
 v_add_f32 v169, 1.0, v169
 v_add_f32 v170, 1.0, v170
 v_add_f32 v171, 1.0, v171
 v_rcp_f32 v156, v156
 v_rcp_f32 v157, v157
 v_rcp_f32 v158, v158
 v_rcp_f32 v159, v159
 v_rcp_f32 v160, v160
 v_rcp_f32 v161, v161
 v_rcp_f32 v162, v162
 v_rcp_f32 v163, v163
 v_rcp_f32 v164, v164
 v_rcp_f32 v165, v165
 v_rcp_f32 v166, v166
 v_rcp_f32 v167, v167
 v_rcp_f32 v168, v168
 v_rcp_f32 v169, v169
 v_rcp_f32 v170, v170
 v_rcp_f32 v171, v171
 v_mul_f32 v140, v140, v156
 v_mul_f32 v141, v141, v157
 v_mul_f32 v142, v142, v158
 v_mul_f32 v143, v143, v159
 v_mul_f32 v144, v144, v160
 v_mul_f32 v145, v145, v161
 v_mul_f32 v146, v146, v162
 v_mul_f32 v147, v147, v163
 v_mul_f32 v148, v148, v164
 v_mul_f32 v149, v149, v165
 v_mul_f32 v150, v150, v166
 v_mul_f32 v151, v151, v167
 v_mul_f32 v152, v152, v168
 v_mul_f32 v153, v153, v169
 v_mul_f32 v154, v154, v170
 v_mul_f32 v155, v155, v171
 v_cvt_pk_bf16_f32 v172, v140, v141
 v_cvt_pk_bf16_f32 v173, v142, v143
 v_cvt_pk_bf16_f32 v174, v144, v145
 v_cvt_pk_bf16_f32 v175, v146, v147
 v_cvt_pk_bf16_f32 v176, v148, v149
 v_cvt_pk_bf16_f32 v177, v150, v151
 v_cvt_pk_bf16_f32 v178, v152, v153
 v_cvt_pk_bf16_f32 v179, v154, v155
 v_xor_b32 v156, 128, v72
 ds_write_b64 v156, v[172:173] offset:8192
 v_xor_b32 v157, 128, v73
 ds_write_b64 v157, v[174:175] offset:8192
 v_xor_b32 v158, 128, v74
 ds_write_b64 v158, v[176:177] offset:8192
 v_xor_b32 v159, 128, v75
 ds_write_b64 v159, v[178:179] offset:8192
 v_accvgpr_read_b32 v140, a112
 v_accvgpr_read_b32 v141, a113
 v_accvgpr_read_b32 v142, a114
 v_accvgpr_read_b32 v143, a115
 v_accvgpr_read_b32 v144, a116
 v_accvgpr_read_b32 v145, a117
 v_accvgpr_read_b32 v146, a118
 v_accvgpr_read_b32 v147, a119
 v_accvgpr_read_b32 v148, a120
 v_accvgpr_read_b32 v149, a121
 v_accvgpr_read_b32 v150, a122
 v_accvgpr_read_b32 v151, a123
 v_accvgpr_read_b32 v152, a124
 v_accvgpr_read_b32 v153, a125
 v_accvgpr_read_b32 v154, a126
 v_accvgpr_read_b32 v155, a127
 v_cvt_pk_bf16_f32 v172, v140, v141
 v_cvt_pk_bf16_f32 v173, v142, v143
 v_cvt_pk_bf16_f32 v174, v144, v145
 v_cvt_pk_bf16_f32 v175, v146, v147
 v_cvt_pk_bf16_f32 v176, v148, v149
 v_cvt_pk_bf16_f32 v177, v150, v151
 v_cvt_pk_bf16_f32 v178, v152, v153
 v_cvt_pk_bf16_f32 v179, v154, v155
 v_lshlrev_b32 v140, 16, v172
 v_and_b32 v141, 0xffff0000, v172
 v_lshlrev_b32 v142, 16, v173
 v_and_b32 v143, 0xffff0000, v173
 v_lshlrev_b32 v144, 16, v174
 v_and_b32 v145, 0xffff0000, v174
 v_lshlrev_b32 v146, 16, v175
 v_and_b32 v147, 0xffff0000, v175
 v_lshlrev_b32 v148, 16, v176
 v_and_b32 v149, 0xffff0000, v176
 v_lshlrev_b32 v150, 16, v177
 v_and_b32 v151, 0xffff0000, v177
 v_lshlrev_b32 v152, 16, v178
 v_and_b32 v153, 0xffff0000, v178
 v_lshlrev_b32 v154, 16, v179
 v_and_b32 v155, 0xffff0000, v179
 v_mul_f32 v156, s60, v140
 v_mul_f32 v157, s60, v141
 v_mul_f32 v158, s60, v142
 v_mul_f32 v159, s60, v143
 v_mul_f32 v160, s60, v144
 v_mul_f32 v161, s60, v145
 v_mul_f32 v162, s60, v146
 v_mul_f32 v163, s60, v147
 v_mul_f32 v164, s60, v148
 v_mul_f32 v165, s60, v149
 v_mul_f32 v166, s60, v150
 v_mul_f32 v167, s60, v151
 v_mul_f32 v168, s60, v152
 v_mul_f32 v169, s60, v153
 v_mul_f32 v170, s60, v154
 v_mul_f32 v171, s60, v155
 v_exp_f32 v156, v156
 v_exp_f32 v157, v157
 v_exp_f32 v158, v158
 v_exp_f32 v159, v159
 v_exp_f32 v160, v160
 v_exp_f32 v161, v161
 v_exp_f32 v162, v162
 v_exp_f32 v163, v163
 v_exp_f32 v164, v164
 v_exp_f32 v165, v165
 v_exp_f32 v166, v166
 v_exp_f32 v167, v167
 v_exp_f32 v168, v168
 v_exp_f32 v169, v169
 v_exp_f32 v170, v170
 v_exp_f32 v171, v171
 v_add_f32 v156, 1.0, v156
 v_add_f32 v157, 1.0, v157
 v_add_f32 v158, 1.0, v158
 v_add_f32 v159, 1.0, v159
 v_add_f32 v160, 1.0, v160
 v_add_f32 v161, 1.0, v161
 v_add_f32 v162, 1.0, v162
 v_add_f32 v163, 1.0, v163
 v_add_f32 v164, 1.0, v164
 v_add_f32 v165, 1.0, v165
 v_add_f32 v166, 1.0, v166
 v_add_f32 v167, 1.0, v167
 v_add_f32 v168, 1.0, v168
 v_add_f32 v169, 1.0, v169
 v_add_f32 v170, 1.0, v170
 v_add_f32 v171, 1.0, v171
 v_rcp_f32 v156, v156
 v_rcp_f32 v157, v157
 v_rcp_f32 v158, v158
 v_rcp_f32 v159, v159
 v_rcp_f32 v160, v160
 v_rcp_f32 v161, v161
 v_rcp_f32 v162, v162
 v_rcp_f32 v163, v163
 v_rcp_f32 v164, v164
 v_rcp_f32 v165, v165
 v_rcp_f32 v166, v166
 v_rcp_f32 v167, v167
 v_rcp_f32 v168, v168
 v_rcp_f32 v169, v169
 v_rcp_f32 v170, v170
 v_rcp_f32 v171, v171
 v_mul_f32 v140, v140, v156
 v_mul_f32 v141, v141, v157
 v_mul_f32 v142, v142, v158
 v_mul_f32 v143, v143, v159
 v_mul_f32 v144, v144, v160
 v_mul_f32 v145, v145, v161
 v_mul_f32 v146, v146, v162
 v_mul_f32 v147, v147, v163
 v_mul_f32 v148, v148, v164
 v_mul_f32 v149, v149, v165
 v_mul_f32 v150, v150, v166
 v_mul_f32 v151, v151, v167
 v_mul_f32 v152, v152, v168
 v_mul_f32 v153, v153, v169
 v_mul_f32 v154, v154, v170
 v_mul_f32 v155, v155, v171
 v_cvt_pk_bf16_f32 v172, v140, v141
 v_cvt_pk_bf16_f32 v173, v142, v143
 v_cvt_pk_bf16_f32 v174, v144, v145
 v_cvt_pk_bf16_f32 v175, v146, v147
 v_cvt_pk_bf16_f32 v176, v148, v149
 v_cvt_pk_bf16_f32 v177, v150, v151
 v_cvt_pk_bf16_f32 v178, v152, v153
 v_cvt_pk_bf16_f32 v179, v154, v155
 v_xor_b32 v156, 192, v72
 ds_write_b64 v156, v[172:173] offset:8192
 v_xor_b32 v157, 192, v73
 ds_write_b64 v157, v[174:175] offset:8192
 v_xor_b32 v158, 192, v74
 ds_write_b64 v158, v[176:177] offset:8192
 v_xor_b32 v159, 192, v75
 ds_write_b64 v159, v[178:179] offset:8192
 s_waitcnt lgkmcnt(0)
 ds_read_b128 v[180:183], v71 offset:8192
 v_xor_b32 v157, 32, v71
 ds_read_b128 v[184:187], v157 offset:8192
 v_xor_b32 v158, 64, v71
 ds_read_b128 v[188:191], v158 offset:8192
 v_xor_b32 v159, 96, v71
 ds_read_b128 v[192:195], v159 offset:8192
 v_xor_b32 v160, 128, v71
 ds_read_b128 v[196:199], v160 offset:8192
 v_xor_b32 v161, 160, v71
 ds_read_b128 v[200:203], v161 offset:8192
 v_xor_b32 v162, 192, v71
 ds_read_b128 v[204:207], v162 offset:8192
 v_xor_b32 v163, 224, v71
 ds_read_b128 v[208:211], v163 offset:8192
 s_lshl_b32 s36, s26, 13
 s_add_u32 s39, s61, s36
 s_add_u32 s39, s39, 79921152
 s_waitcnt lgkmcnt(7)
 buffer_store_dwordx4 v[180:183], v212, s[56:59], s39 offen sc1
 s_add_u32 s39, s39, s37
 s_waitcnt lgkmcnt(6)
 buffer_store_dwordx4 v[184:187], v212, s[56:59], s39 offen sc1
 s_add_u32 s39, s39, s37
 s_waitcnt lgkmcnt(5)
 buffer_store_dwordx4 v[188:191], v212, s[56:59], s39 offen sc1
 s_add_u32 s39, s39, s37
 s_waitcnt lgkmcnt(4)
 buffer_store_dwordx4 v[192:195], v212, s[56:59], s39 offen sc1
 s_add_u32 s39, s39, s37
 s_waitcnt lgkmcnt(3)
 buffer_store_dwordx4 v[196:199], v212, s[56:59], s39 offen sc1
 s_add_u32 s39, s39, s37
 s_waitcnt lgkmcnt(2)
 buffer_store_dwordx4 v[200:203], v212, s[56:59], s39 offen sc1
 s_add_u32 s39, s39, s37
 s_waitcnt lgkmcnt(1)
 buffer_store_dwordx4 v[204:207], v212, s[56:59], s39 offen sc1
 s_add_u32 s39, s39, s37
 s_waitcnt lgkmcnt(0)
 buffer_store_dwordx4 v[208:211], v212, s[56:59], s39 offen sc1
 s_add_u32 s39, s39, s37
t_g2_exit:
 s_add_u32 s26, s26, 1
 s_mov_b32 s79, 0
 s_cmp_lg_u32 s78, 0
 s_cbranch_scc1 t_g2_tile
 s_branch mega_done

t_gh:
 s_load_dwordx2 s[40:41], s[0:1], 96
 s_load_dwordx2 s[42:43], s[0:1], s70
 s_load_dwordx2 s[44:45], s[0:1], 80
 s_load_dwordx2 s[48:49], s[0:1], 0
 v_and_b32 v1, 63, v0
 v_lshrrev_b32 v11, 6, v0
 s_mov_b32 s25, s92
 v_readfirstlane_b32 s24, v11
 s_mov_b32 s26, s93
 s_and_b32 s27, s24, 1
 s_lshr_b32 s36, s24, 1
 s_and_b32 s28, s36, 0
 s_lshr_b32 s29, s36, 0

 v_lshlrev_b32 v11, 4, v1
 s_mul_i32 s36, s24, 4
 s_add_u32 s36, s36, 0
 s_lshr_b32 s37, s36, 2
 s_and_b32 s36, s36, 3
 s_mul_i32 s38, s25, 4
 s_add_u32 s37, s37, s38
 s_mul_i32 s37, s37, s64
 s_lshl_b32 s36, s36, 10
 s_add_u32 s36, s36, s37
 v_add_u32 v2, s36, v11

 s_mul_i32 s36, s24, 4
 s_add_u32 s36, s36, 1
 s_lshr_b32 s37, s36, 2
 s_and_b32 s36, s36, 3
 s_mul_i32 s38, s25, 4
 s_add_u32 s37, s37, s38
 s_mul_i32 s37, s37, s64
 s_lshl_b32 s36, s36, 10
 s_add_u32 s36, s36, s37
 v_add_u32 v3, s36, v11

 s_mul_i32 s36, s24, 4
 s_add_u32 s36, s36, 2
 s_lshr_b32 s37, s36, 2
 s_and_b32 s36, s36, 3
 s_mul_i32 s38, s25, 4
 s_add_u32 s37, s37, s38
 s_mul_i32 s37, s37, s64
 s_lshl_b32 s36, s36, 10
 s_add_u32 s36, s36, s37
 v_add_u32 v4, s36, v11

 s_mul_i32 s36, s24, 4
 s_add_u32 s36, s36, 3
 s_lshr_b32 s37, s36, 2
 s_and_b32 s36, s36, 3
 s_mul_i32 s38, s25, 4
 s_add_u32 s37, s37, s38
 s_mul_i32 s37, s37, s64
 s_lshl_b32 s36, s36, 10
 s_add_u32 s36, s36, s37
 v_add_u32 v5, s36, v11

 s_mul_i32 s36, s24, 128
 v_add_u32 v11, s36, v1

 v_lshrrev_b32 v12, 3, v11
 v_and_b32 v13, 7, v11
 v_bfe_u32 v14, v12, 1, 1
 v_lshlrev_b32 v14, 2, v14
 v_xor_b32 v13, v13, v14

 v_mul_lo_u32 v12, v12, s65
 v_lshl_add_u32 v6, v13, 4, v12
 v_add_u32 v11, 64, v11
 v_lshrrev_b32 v12, 3, v11
 v_and_b32 v13, 7, v11
 v_bfe_u32 v14, v12, 1, 1
 v_lshlrev_b32 v14, 2, v14
 v_xor_b32 v13, v13, v14

 v_mul_lo_u32 v12, v12, s65
 v_lshl_add_u32 v7, v13, 4, v12
 s_mov_b32 s30, s66
 s_mul_i32 s63, s26, 128
 s_add_u32 s63, s63, s67
 s_mov_b32 s31, s63
 s_mul_i32 s32, s24, 4096
 s_mul_i32 s51, s24, 2048
 s_mov_b32 s35, 0
 s_mov_b32 s50, 24576
 s_mov_b32 s62, s69
 s_mov_b32 s78, s89
 s_mov_b32 s79, 1
 s_waitcnt lgkmcnt(0)

 s_mov_b32 s4, s40
 s_and_b32 s5, s41, 0xffff
 s_mov_b32 s6, 0x10000000
 s_mov_b32 s7, 0x00020000
 s_mov_b32 s8, s42
 s_and_b32 s9, s43, 0xffff
 s_mov_b32 s10, 0x0
 s_mov_b32 s11, 0x00020000
 s_mov_b32 s10, s71
 s_lshl_b32 s86, s94, 10
 s_add_u32 s86, s86, 161480704
 v_and_b32 v16, 7, v0
 v_lshlrev_b32 v16, 7, v16
 buffer_load_dword v15, v16, s[80:83], s86 offen sc1

 s_mov_b32 s36, s31
 s_add_u32 m0, s51, 16384
 s_nop 0
 buffer_load_dwordx4 v6, s[8:11], s36 offen lds
 s_add_u32 m0, s51, 17408
 s_nop 0
 buffer_load_dwordx4 v7, s[8:11], s36 offen lds
 s_add_u32 s36, s36, s68
 s_add_u32 m0, s51, 40960
 s_nop 0
 buffer_load_dwordx4 v6, s[8:11], s36 offen lds
 s_add_u32 m0, s51, 41984
 s_nop 0
 buffer_load_dwordx4 v7, s[8:11], s36 offen lds
 s_add_u32 s36, s36, s68
 s_add_u32 m0, s51, 65536
 s_nop 0
 buffer_load_dwordx4 v6, s[8:11], s36 offen lds
 s_add_u32 m0, s51, 66560
 s_nop 0
 buffer_load_dwordx4 v7, s[8:11], s36 offen lds
 s_mov_b32 s12, s44
 s_and_b32 s13, s45, 0xffff
 s_mov_b32 s14, 0x400000
 s_mov_b32 s15, 0x00020000
 s_mov_b32 s20, s48
 s_and_b32 s21, s49, 0xffff
 s_mov_b32 s22, 0x400000
 s_mov_b32 s23, 0x00020000
 s_mul_i32 s36, s27, 8192
 s_mul_i32 s37, s29, 2048
 s_add_u32 s36, s36, s37
 v_lshlrev_b32 v11, 4, v1
 v_add_u32 v8, s36, v11

 v_bfe_u32 v11, v1, 2, 2
 v_lshrrev_b32 v12, 5, v1
 v_lshl_add_u32 v12, v12, 3, v11
 s_mul_i32 s36, s29, 32
 v_add_u32 v12, s36, v12
 v_mul_u32_u24 v12, 128, v12
 v_bfe_u32 v13, v1, 4, 1
 v_lshl_add_u32 v12, v13, 5, v12
 v_and_b32 v13, 3, v1
 v_lshl_add_u32 v12, v13, 3, v12
 v_add_u32 v12, 16384, v12
 v_bfe_u32 v14, v11, 1, 1

 s_mul_i32 s36, s28, 2
 s_add_u32 s36, s36, 0
 v_xor_b32 v13, s36, v14
 v_lshl_add_u32 v9, v13, 6, v12
 s_mul_i32 s36, s28, 2
 s_add_u32 s36, s36, 1
 v_xor_b32 v13, s36, v14
 v_lshl_add_u32 v10, v13, 6, v12
 v_lshlrev_b32 v164, 4, v1
 s_lshl_b32 s36, s27, 1
 s_add_u32 s37, s36, s29
 s_lshl_b32 s37, s37, 14
 s_add_u32 s61, s37, 98304
 v_add_u32 v53, s61, v164
 s_xor_b32 s37, s29, 1
 s_add_u32 s37, s36, s37
 s_lshl_b32 s37, s37, 14
 s_add_u32 s37, s37, 98304
 v_add_u32 v52, s37, v164
 v_and_b32 v164, 31, v1
 v_lshrrev_b32 v165, 5, v1
 v_mul_lo_u32 v54, v164, s73
 v_lshl_add_u32 v54, v165, 3, v54
 v_mul_lo_u32 v56, v165, s73
 v_lshl_add_u32 v56, v164, 4, v56
 v_and_b32 v166, 15, v164
 v_xor_b32 v166, v166, v165
 v_lshlrev_b32 v166, 4, v166
 v_lshl_add_u32 v166, v164, 8, v166
 v_add_u32 v67, s61, v166
 v_lshlrev_b32 v188, 4, v1

 v_and_b32 v166, 15, v164
 v_xor_b32 v166, 0, v166
 v_lshlrev_b32 v166, 4, v166
 v_lshl_add_u32 v166, v164, 8, v166
 v_lshl_add_u32 v166, v165, 3, v166
 v_add_u32 v59, s61, v166

 v_and_b32 v166, 15, v164
 v_xor_b32 v166, 1, v166
 v_lshlrev_b32 v166, 4, v166
 v_lshl_add_u32 v166, v164, 8, v166
 v_lshl_add_u32 v166, v165, 3, v166
 v_add_u32 v60, s61, v166

 v_and_b32 v166, 15, v164
 v_xor_b32 v166, 2, v166
 v_lshlrev_b32 v166, 4, v166
 v_lshl_add_u32 v166, v164, 8, v166
 v_lshl_add_u32 v166, v165, 3, v166
 v_add_u32 v61, s61, v166

 v_and_b32 v166, 15, v164
 v_xor_b32 v166, 3, v166
 v_lshlrev_b32 v166, 4, v166
 v_lshl_add_u32 v166, v164, 8, v166
 v_lshl_add_u32 v166, v165, 3, v166
 v_add_u32 v62, s61, v166

 v_lshl_add_u32 v166, v165, 0, 0
 v_and_b32 v57, 7, v164
 v_xor_b32 v166, v166, v57
 v_lshlrev_b32 v166, 4, v166
 v_lshl_add_u32 v166, v164, 9, v166
 v_add_u32 v63, s61, v166

 v_lshl_add_u32 v166, v165, 0, 2
 v_and_b32 v57, 7, v164
 v_xor_b32 v166, v166, v57
 v_lshlrev_b32 v166, 4, v166
 v_lshl_add_u32 v166, v164, 9, v166
 v_add_u32 v64, s61, v166

 v_lshl_add_u32 v166, v165, 0, 4
 v_and_b32 v57, 7, v164
 v_xor_b32 v166, v166, v57
 v_lshlrev_b32 v166, 4, v166
 v_lshl_add_u32 v166, v164, 9, v166
 v_add_u32 v65, s61, v166

 v_lshl_add_u32 v166, v165, 0, 6
 v_and_b32 v57, 7, v164
 v_xor_b32 v166, v166, v57
 v_lshlrev_b32 v166, 4, v166
 v_lshl_add_u32 v166, v164, 9, v166
 v_add_u32 v66, s61, v166

 v_xor_b32 v166, v164, v165
 v_lshlrev_b32 v166, 4, v166
 v_lshl_add_u32 v166, v165, 9, v166
 v_add_u32 v58, s61, v166
 v_lshrrev_b32 v164, 4, v1
 v_and_b32 v165, 15, v1
 v_mul_lo_u32 v55, v164, s73
 v_lshl_add_u32 v55, v165, 4, v55
 v_xor_b32 v166, v165, v164
 v_lshlrev_b32 v166, 4, v166
 v_lshl_add_u32 v166, v164, 8, v166
 v_add_u32 v57, s61, v166
 s_cmp_eq_u32 s75, 0
 s_cselect_b32 s52, s20, s4
 s_cselect_b32 s53, s21, s5
 s_cselect_b32 s54, s22, s6
 s_mov_b32 s55, 0x00020000
 s_cselect_b32 s60, 0, 71303168
 s_cselect_b32 s56, s4, s12
 s_cselect_b32 s57, s5, s13
 s_cselect_b32 s58, s6, s14
 s_mov_b32 s59, 0x00020000
 s_lshl_b32 s61, s25, 7
 s_cmp_eq_u32 s72, 2
 s_cselect_b32 s61, 0, s61
 s_lshl_b32 s37, s27, 6
 s_add_u32 s61, s61, s37
 s_lshl_b32 s37, s29, 5
 s_add_u32 s61, s61, s37
 s_mul_i32 s61, s61, s73

 s_add_u32 s30, s30, 4096
 s_add_u32 s31, s31, s68
 s_add_u32 s32, s32, 24576
 s_add_u32 s51, s51, 24576
 s_cmp_ge_u32 s32, 98304
 s_cselect_b32 s38, 98304, 0
 s_sub_u32 s32, s32, s38
 s_sub_u32 s51, s51, s38
 s_sub_u32 s62, s62, 1
 s_cmp_eq_u32 s62, 0
 s_cselect_b32 s38, 128, 0
 s_cselect_b32 s30, s66, s30
 s_cselect_b32 s62, s69, s62
 s_add_u32 s63, s63, s38
 s_cmp_lg_u32 s38, 0
 s_cselect_b32 s31, s63, s31
 s_add_u32 s30, s30, 4096
 s_add_u32 s31, s31, s68
 s_add_u32 s32, s32, 24576
 s_add_u32 s51, s51, 24576
 s_cmp_ge_u32 s32, 98304
 s_cselect_b32 s38, 98304, 0
 s_sub_u32 s32, s32, s38
 s_sub_u32 s51, s51, s38
 s_sub_u32 s62, s62, 1
 s_cmp_eq_u32 s62, 0
 s_cselect_b32 s38, 128, 0
 s_cselect_b32 s30, s66, s30
 s_cselect_b32 s62, s69, s62
 s_add_u32 s63, s63, s38
 s_cmp_lg_u32 s38, 0
 s_cselect_b32 s31, s63, s31
 s_add_u32 s30, s30, 4096
 s_add_u32 s31, s31, s68
 s_add_u32 s32, s32, 24576
 s_add_u32 s51, s51, 24576
 s_cmp_ge_u32 s32, 98304
 s_cselect_b32 s38, 98304, 0
 s_sub_u32 s32, s32, s38
 s_sub_u32 s51, s51, s38
 s_sub_u32 s62, s62, 1
 s_cmp_eq_u32 s62, 0
 s_cselect_b32 s38, 128, 0
 s_cselect_b32 s30, s66, s30
 s_cselect_b32 s62, s69, s62
 s_add_u32 s63, s63, s38
 s_cmp_lg_u32 s38, 0
 s_cselect_b32 s31, s63, s31
 s_mov_b32 s30, s66
 s_mul_i32 s32, s24, 4096
 s_waitcnt vmcnt(6)
 s_nop 1
 v_add_u32_dpp v15, v15, v15 quad_perm:[1,0,3,2] row_mask:0xf bank_mask:0xf
 s_nop 1
 v_add_u32_dpp v15, v15, v15 quad_perm:[2,3,0,1] row_mask:0xf bank_mask:0xf
 s_nop 1
 v_add_u32_dpp v15, v15, v15 row_half_mirror row_mask:0xf bank_mask:0xf
 v_cmp_gt_u32 vcc, s95, v15
 s_cmp_lg_u32 s90, 0
 s_cbranch_scc1 dw_175
 s_cbranch_vccz dw_176

dw_173:
 s_sub_u32 s91, s91, 16
 s_cbranch_scc1 chain_exit
 v_add_u32 v15, 6, v15
 v_cmp_gt_u32 vcc, s95, v15
 s_cbranch_vccz dw_177
 s_sleep 20

dw_177:
 s_sleep 3
 buffer_load_dword v15, v16, s[80:83], s86 offen sc1
 s_waitcnt vmcnt(0)

 s_nop 1
 v_add_u32_dpp v15, v15, v15 quad_perm:[1,0,3,2] row_mask:0xf bank_mask:0xf
 s_nop 1
 v_add_u32_dpp v15, v15, v15 quad_perm:[2,3,0,1] row_mask:0xf bank_mask:0xf
 s_nop 1
 v_add_u32_dpp v15, v15, v15 row_half_mirror row_mask:0xf bank_mask:0xf
 v_cmp_gt_u32 vcc, s95, v15
 s_cbranch_vccnz dw_173

dw_176:
 v_mov_b32 v15, s101
 v_mov_b32 v16, 163824
 ds_write_b32 v16, v15
 s_branch dw_174

dw_175:
 s_cbranch_vccz dw_174
 v_mov_b32 v16, 163824
dw_178:
 s_sub_u32 s91, s91, 4
 s_cbranch_scc1 chain_exit
 s_sleep 1
 ds_read_b32 v15, v16
 s_waitcnt lgkmcnt(0)
 v_cmp_ne_u32 vcc, s101, v15
 s_cbranch_vccnz dw_178

dw_174:
 s_add_u32 s36, s30, 0
 s_add_u32 m0, s32, 0
 s_nop 0
 buffer_load_dwordx4 v2, s[4:7], s36 offen sc1 lds
 s_add_u32 m0, s32, 1024
 s_nop 0
 buffer_load_dwordx4 v3, s[4:7], s36 offen sc1 lds
 s_add_u32 m0, s32, 2048
 s_nop 0
 buffer_load_dwordx4 v4, s[4:7], s36 offen sc1 lds
 s_add_u32 m0, s32, 3072
 s_nop 0
 buffer_load_dwordx4 v5, s[4:7], s36 offen sc1 lds
 s_add_u32 s36, s30, 4096
 s_add_u32 m0, s32, 24576
 s_nop 0
 buffer_load_dwordx4 v2, s[4:7], s36 offen sc1 lds
 s_add_u32 m0, s32, 25600
 s_nop 0
 buffer_load_dwordx4 v3, s[4:7], s36 offen sc1 lds
 s_add_u32 m0, s32, 26624
 s_nop 0
 buffer_load_dwordx4 v4, s[4:7], s36 offen sc1 lds
 s_add_u32 m0, s32, 27648
 s_nop 0
 buffer_load_dwordx4 v5, s[4:7], s36 offen sc1 lds
 s_add_u32 s36, s30, 8192
 s_add_u32 m0, s32, 49152
 s_nop 0
 buffer_load_dwordx4 v2, s[4:7], s36 offen sc1 lds
 s_add_u32 m0, s32, 50176
 s_nop 0
 buffer_load_dwordx4 v3, s[4:7], s36 offen sc1 lds
 s_add_u32 m0, s32, 51200
 s_nop 0
 buffer_load_dwordx4 v4, s[4:7], s36 offen sc1 lds
 s_add_u32 m0, s32, 52224
 s_nop 0
 buffer_load_dwordx4 v5, s[4:7], s36 offen sc1 lds
 s_add_u32 s30, s30, 12288
 s_add_u32 s32, s32, 73728
 s_waitcnt vmcnt(8)
 s_barrier
 ds_read_b128 v[20:23], v8 offset:0
 ds_read_b128 v[24:27], v8 offset:4096
 ds_read_b64_tr_b16 v[28:29], v9 offset:0
 ds_read_b64_tr_b16 v[30:31], v9 offset:512
 ds_read_b64_tr_b16 v[32:33], v10 offset:0
 ds_read_b64_tr_b16 v[34:35], v10 offset:512
t_gh_tile:
 s_sub_u32 s78, s78, 1
 s_cmp_eq_u32 s78, 0
 s_cselect_b32 s33, 4, 1
 s_sub_u32 s33, s69, s33

 s_waitcnt lgkmcnt(0)
 v_mfma_f32_32x32x16_bf16 a[0:15], v[28:31], v[20:23], 0
 ds_read_b128 v[36:39], v8 offset:1024
 ds_read_b128 v[40:43], v8 offset:5120
 ds_read_b64_tr_b16 v[44:45], v9 offset:2048
 s_add_u32 m0, s32, 0
 s_nop 0
 buffer_load_dwordx4 v2, s[4:7], s30 offen sc1 lds
 v_mfma_f32_32x32x16_bf16 a[16:31], v[28:31], v[24:27], 0
 ds_read_b64_tr_b16 v[46:47], v9 offset:2560
 ds_read_b64_tr_b16 v[48:49], v10 offset:2048
 ds_read_b64_tr_b16 v[50:51], v10 offset:2560
 s_add_u32 m0, s32, 1024
 s_nop 0
 buffer_load_dwordx4 v3, s[4:7], s30 offen sc1 lds
 v_mfma_f32_32x32x16_bf16 a[32:47], v[32:35], v[20:23], 0
 s_add_u32 m0, s32, 2048
 s_nop 0
 buffer_load_dwordx4 v4, s[4:7], s30 offen sc1 lds
 v_mfma_f32_32x32x16_bf16 a[48:63], v[32:35], v[24:27], 0
 s_add_u32 m0, s32, 3072
 s_nop 0
 buffer_load_dwordx4 v5, s[4:7], s30 offen sc1 lds
 s_waitcnt lgkmcnt(0)
 v_mfma_f32_32x32x16_bf16 a[0:15], v[44:47], v[36:39], a[0:15]
 s_add_u32 m0, s51, 16384
 s_nop 0
 buffer_load_dwordx4 v6, s[8:11], s31 offen lds
 s_add_u32 m0, s51, 17408
 s_nop 0
 buffer_load_dwordx4 v7, s[8:11], s31 offen lds
 s_add_u32 s30, s30, 4096
 s_add_u32 s31, s31, s68
 s_add_u32 s32, s32, 24576
 s_add_u32 s51, s51, 24576
 s_cmp_ge_u32 s32, 98304
 s_cselect_b32 s38, 98304, 0
 s_sub_u32 s32, s32, s38
 s_sub_u32 s51, s51, s38
 s_sub_u32 s62, s62, 1
 s_cmp_eq_u32 s62, 0
 s_cselect_b32 s38, 128, 0
 s_cselect_b32 s30, s66, s30
 s_cselect_b32 s62, s69, s62
 s_add_u32 s63, s63, s38
 s_cmp_lg_u32 s38, 0
 s_cselect_b32 s31, s63, s31
 v_mfma_f32_32x32x16_bf16 a[16:31], v[44:47], v[40:43], a[16:31]
 s_add_u32 s35, s35, 1
 s_cmp_eq_u32 s35, 4
 s_cselect_b32 s34, 0xfffee000, s50
 s_cselect_b32 s35, 0, s35
 v_add_u32 v8, s34, v8
 v_add_u32 v9, s34, v9
 v_add_u32 v10, s34, v10
 s_cmp_eq_u32 s79, 0
 s_cbranch_scc1 fw_179
 s_waitcnt vmcnt(10)
 s_branch fw_180
 fw_179:
 s_waitcnt vmcnt(16)
 fw_180:
 s_barrier
 ds_read_b128 v[20:23], v8 offset:0
 ds_read_b128 v[24:27], v8 offset:4096
 ds_read_b64_tr_b16 v[28:29], v9 offset:0
 ds_read_b64_tr_b16 v[30:31], v9 offset:512
 ds_read_b64_tr_b16 v[32:33], v10 offset:0
 ds_read_b64_tr_b16 v[34:35], v10 offset:512
 v_mfma_f32_32x32x16_bf16 a[32:47], v[48:51], v[36:39], a[32:47]
 v_mfma_f32_32x32x16_bf16 a[48:63], v[48:51], v[40:43], a[48:63]
 s_cmp_eq_u32 s33, 0
 s_cbranch_scc1 t_gh_lend
t_gh_loop:
 s_waitcnt lgkmcnt(0)
 v_mfma_f32_32x32x16_bf16 a[0:15], v[28:31], v[20:23], a[0:15]
 ds_read_b128 v[36:39], v8 offset:1024
 ds_read_b128 v[40:43], v8 offset:5120
 ds_read_b64_tr_b16 v[44:45], v9 offset:2048
 s_add_u32 m0, s32, 0
 s_nop 0
 buffer_load_dwordx4 v2, s[4:7], s30 offen sc1 lds
 v_mfma_f32_32x32x16_bf16 a[16:31], v[28:31], v[24:27], a[16:31]
 ds_read_b64_tr_b16 v[46:47], v9 offset:2560
 ds_read_b64_tr_b16 v[48:49], v10 offset:2048
 ds_read_b64_tr_b16 v[50:51], v10 offset:2560
 s_add_u32 m0, s32, 1024
 s_nop 0
 buffer_load_dwordx4 v3, s[4:7], s30 offen sc1 lds
 v_mfma_f32_32x32x16_bf16 a[32:47], v[32:35], v[20:23], a[32:47]
 s_add_u32 m0, s32, 2048
 s_nop 0
 buffer_load_dwordx4 v4, s[4:7], s30 offen sc1 lds
 v_mfma_f32_32x32x16_bf16 a[48:63], v[32:35], v[24:27], a[48:63]
 s_add_u32 m0, s32, 3072
 s_nop 0
 buffer_load_dwordx4 v5, s[4:7], s30 offen sc1 lds
 s_waitcnt lgkmcnt(0)
 v_mfma_f32_32x32x16_bf16 a[0:15], v[44:47], v[36:39], a[0:15]
 s_add_u32 m0, s51, 16384
 s_nop 0
 buffer_load_dwordx4 v6, s[8:11], s31 offen lds
 s_add_u32 m0, s51, 17408
 s_nop 0
 buffer_load_dwordx4 v7, s[8:11], s31 offen lds
 s_add_u32 s30, s30, 4096
 s_add_u32 s31, s31, s68
 s_add_u32 s32, s32, 24576
 s_add_u32 s51, s51, 24576
 s_cmp_ge_u32 s32, 98304
 s_cselect_b32 s38, 98304, 0
 s_sub_u32 s32, s32, s38
 s_sub_u32 s51, s51, s38
 s_sub_u32 s62, s62, 1
 s_cmp_eq_u32 s62, 0
 s_cselect_b32 s38, 128, 0
 s_cselect_b32 s30, s66, s30
 s_cselect_b32 s62, s69, s62
 s_add_u32 s63, s63, s38
 s_cmp_lg_u32 s38, 0
 s_cselect_b32 s31, s63, s31
 v_mfma_f32_32x32x16_bf16 a[16:31], v[44:47], v[40:43], a[16:31]
 s_add_u32 s35, s35, 1
 s_cmp_eq_u32 s35, 4
 s_cselect_b32 s34, 0xfffee000, s50
 s_cselect_b32 s35, 0, s35
 v_add_u32 v8, s34, v8
 v_add_u32 v9, s34, v9
 v_add_u32 v10, s34, v10
 s_waitcnt vmcnt(12)
 s_barrier
 ds_read_b128 v[20:23], v8 offset:0
 ds_read_b128 v[24:27], v8 offset:4096
 ds_read_b64_tr_b16 v[28:29], v9 offset:0
 ds_read_b64_tr_b16 v[30:31], v9 offset:512
 ds_read_b64_tr_b16 v[32:33], v10 offset:0
 ds_read_b64_tr_b16 v[34:35], v10 offset:512
 v_mfma_f32_32x32x16_bf16 a[32:47], v[48:51], v[36:39], a[32:47]
 v_mfma_f32_32x32x16_bf16 a[48:63], v[48:51], v[40:43], a[48:63]
 s_sub_u32 s33, s33, 1
 s_cmp_lg_u32 s33, 0
 s_cbranch_scc1 t_gh_loop

t_gh_lend:
 s_cmp_lg_u32 s78, 0
 s_cbranch_scc1 t_gh_epi
 s_cmp_lg_u32 s90, 0
 s_cbranch_scc1 pull_181
 v_accvgpr_write_b32 a255, 1
 v_mov_b32 v255, 0
 s_lshl_b32 s86, s100, 6
 s_add_u32 s86, s86, 159514624
 s_mov_b64 exec, 1
 buffer_atomic_add a255, v255, s[80:83], s86 offen sc0
 s_mov_b64 exec, -1

pull_181:
 s_waitcnt lgkmcnt(0)
 v_mfma_f32_32x32x16_bf16 a[0:15], v[28:31], v[20:23], a[0:15]
 ds_read_b128 v[36:39], v8 offset:1024
 ds_read_b128 v[40:43], v8 offset:5120
 ds_read_b64_tr_b16 v[44:45], v9 offset:2048
 v_mfma_f32_32x32x16_bf16 a[16:31], v[28:31], v[24:27], a[16:31]
 ds_read_b64_tr_b16 v[46:47], v9 offset:2560
 ds_read_b64_tr_b16 v[48:49], v10 offset:2048
 ds_read_b64_tr_b16 v[50:51], v10 offset:2560
 v_mfma_f32_32x32x16_bf16 a[32:47], v[32:35], v[20:23], a[32:47]
 v_mfma_f32_32x32x16_bf16 a[48:63], v[32:35], v[24:27], a[48:63]
 s_waitcnt lgkmcnt(0)
 v_mfma_f32_32x32x16_bf16 a[0:15], v[44:47], v[36:39], a[0:15]
 v_mfma_f32_32x32x16_bf16 a[16:31], v[44:47], v[40:43], a[16:31]
 s_add_u32 s35, s35, 1
 s_cmp_eq_u32 s35, 4
 s_cselect_b32 s34, 0xfffee000, s50
 s_cselect_b32 s35, 0, s35
 v_add_u32 v8, s34, v8
 v_add_u32 v9, s34, v9
 v_add_u32 v10, s34, v10
 s_waitcnt vmcnt(6)
 s_barrier
 ds_read_b128 v[20:23], v8 offset:0
 ds_read_b128 v[24:27], v8 offset:4096
 ds_read_b64_tr_b16 v[28:29], v9 offset:0
 ds_read_b64_tr_b16 v[30:31], v9 offset:512
 ds_read_b64_tr_b16 v[32:33], v10 offset:0
 ds_read_b64_tr_b16 v[34:35], v10 offset:512
 v_mfma_f32_32x32x16_bf16 a[32:47], v[48:51], v[36:39], a[32:47]
 v_mfma_f32_32x32x16_bf16 a[48:63], v[48:51], v[40:43], a[48:63]
 s_waitcnt lgkmcnt(0)
 v_mfma_f32_32x32x16_bf16 a[0:15], v[28:31], v[20:23], a[0:15]
 ds_read_b128 v[36:39], v8 offset:1024
 ds_read_b128 v[40:43], v8 offset:5120
 ds_read_b64_tr_b16 v[44:45], v9 offset:2048
 v_mfma_f32_32x32x16_bf16 a[16:31], v[28:31], v[24:27], a[16:31]
 ds_read_b64_tr_b16 v[46:47], v9 offset:2560
 ds_read_b64_tr_b16 v[48:49], v10 offset:2048
 ds_read_b64_tr_b16 v[50:51], v10 offset:2560
 v_mfma_f32_32x32x16_bf16 a[32:47], v[32:35], v[20:23], a[32:47]
 v_mfma_f32_32x32x16_bf16 a[48:63], v[32:35], v[24:27], a[48:63]
 s_waitcnt lgkmcnt(0)
 v_mfma_f32_32x32x16_bf16 a[0:15], v[44:47], v[36:39], a[0:15]
 v_mfma_f32_32x32x16_bf16 a[16:31], v[44:47], v[40:43], a[16:31]
 s_add_u32 s35, s35, 1
 s_cmp_eq_u32 s35, 4
 s_cselect_b32 s34, 0xfffee000, s50
 s_cselect_b32 s35, 0, s35
 v_add_u32 v8, s34, v8
 v_add_u32 v9, s34, v9
 v_add_u32 v10, s34, v10
 s_waitcnt vmcnt(0)
 s_barrier
 ds_read_b128 v[20:23], v8 offset:0
 ds_read_b128 v[24:27], v8 offset:4096
 ds_read_b64_tr_b16 v[28:29], v9 offset:0
 ds_read_b64_tr_b16 v[30:31], v9 offset:512
 ds_read_b64_tr_b16 v[32:33], v10 offset:0
 ds_read_b64_tr_b16 v[34:35], v10 offset:512
 v_mfma_f32_32x32x16_bf16 a[32:47], v[48:51], v[36:39], a[32:47]
 v_mfma_f32_32x32x16_bf16 a[48:63], v[48:51], v[40:43], a[48:63]
 s_waitcnt lgkmcnt(0)
 v_mfma_f32_32x32x16_bf16 a[0:15], v[28:31], v[20:23], a[0:15]
 ds_read_b128 v[36:39], v8 offset:1024
 ds_read_b128 v[40:43], v8 offset:5120
 ds_read_b64_tr_b16 v[44:45], v9 offset:2048
 v_mfma_f32_32x32x16_bf16 a[16:31], v[28:31], v[24:27], a[16:31]
 ds_read_b64_tr_b16 v[46:47], v9 offset:2560
 ds_read_b64_tr_b16 v[48:49], v10 offset:2048
 ds_read_b64_tr_b16 v[50:51], v10 offset:2560
 v_mfma_f32_32x32x16_bf16 a[32:47], v[32:35], v[20:23], a[32:47]
 v_mfma_f32_32x32x16_bf16 a[48:63], v[32:35], v[24:27], a[48:63]
 s_waitcnt lgkmcnt(0)
 v_mfma_f32_32x32x16_bf16 a[0:15], v[44:47], v[36:39], a[0:15]
 v_mfma_f32_32x32x16_bf16 a[16:31], v[44:47], v[40:43], a[16:31]
 v_mfma_f32_32x32x16_bf16 a[32:47], v[48:51], v[36:39], a[32:47]
 v_mfma_f32_32x32x16_bf16 a[48:63], v[48:51], v[40:43], a[48:63]
t_gh_epi:
 s_nop 7
 s_lshl_b32 s37, s26, 7
 s_cmp_eq_u32 s72, 2
 s_cselect_b32 s36, 1, 0
 s_lshl_b32 s37, s37, s36
 s_add_u32 s39, s61, s37
 s_add_u32 s36, s39, s60
 s_add_u32 s39, s39, s74
 s_cmp_lg_u32 s72, 0
 s_cbranch_scc1 t_gh_nores

 buffer_load_dwordx2 v[68:69], v54, s[52:55], s36 offen offset:0
 buffer_load_dwordx2 v[70:71], v54, s[52:55], s36 offen offset:16
 buffer_load_dwordx2 v[72:73], v54, s[52:55], s36 offen offset:32
 buffer_load_dwordx2 v[74:75], v54, s[52:55], s36 offen offset:48
 buffer_load_dwordx2 v[76:77], v54, s[52:55], s36 offen offset:64
 buffer_load_dwordx2 v[78:79], v54, s[52:55], s36 offen offset:80
 buffer_load_dwordx2 v[80:81], v54, s[52:55], s36 offen offset:96
 buffer_load_dwordx2 v[82:83], v54, s[52:55], s36 offen offset:112
t_gh_nores:
 s_nop 7
 s_barrier
 s_cmp_eq_u32 s29, 0
 s_cbranch_scc1 t_gh_ep_k0

 ds_write_b128 v52, a[0:3] offset:0
 ds_write_b128 v52, a[4:7] offset:1024
 ds_write_b128 v52, a[8:11] offset:2048
 ds_write_b128 v52, a[12:15] offset:3072
 ds_write_b128 v52, a[32:35] offset:4096
 ds_write_b128 v52, a[36:39] offset:5120
 ds_write_b128 v52, a[40:43] offset:6144
 ds_write_b128 v52, a[44:47] offset:7168
 s_waitcnt lgkmcnt(0)
 s_barrier
 ds_read_b128 v[100:103], v53 offset:0
 ds_read_b128 v[104:107], v53 offset:1024
 ds_read_b128 v[108:111], v53 offset:2048
 ds_read_b128 v[112:115], v53 offset:3072
 ds_read_b128 v[116:119], v53 offset:4096
 ds_read_b128 v[120:123], v53 offset:5120
 ds_read_b128 v[124:127], v53 offset:6144
 ds_read_b128 v[128:131], v53 offset:7168
 v_accvgpr_read_b32 v164, a16
 v_accvgpr_read_b32 v165, a17
 v_accvgpr_read_b32 v166, a18
 v_accvgpr_read_b32 v167, a19
 v_accvgpr_read_b32 v168, a20
 v_accvgpr_read_b32 v169, a21
 v_accvgpr_read_b32 v170, a22
 v_accvgpr_read_b32 v171, a23
 v_accvgpr_read_b32 v172, a24
 v_accvgpr_read_b32 v173, a25
 v_accvgpr_read_b32 v174, a26
 v_accvgpr_read_b32 v175, a27
 v_accvgpr_read_b32 v176, a28
 v_accvgpr_read_b32 v177, a29
 v_accvgpr_read_b32 v178, a30
 v_accvgpr_read_b32 v179, a31
 s_waitcnt lgkmcnt(4)
 v_pk_add_f32 v[100:101], v[100:101], v[164:165]
 v_pk_add_f32 v[102:103], v[102:103], v[166:167]
 v_pk_add_f32 v[104:105], v[104:105], v[168:169]
 v_pk_add_f32 v[106:107], v[106:107], v[170:171]
 v_pk_add_f32 v[108:109], v[108:109], v[172:173]
 v_pk_add_f32 v[110:111], v[110:111], v[174:175]
 v_pk_add_f32 v[112:113], v[112:113], v[176:177]
 v_pk_add_f32 v[114:115], v[114:115], v[178:179]
 v_accvgpr_read_b32 v164, a48
 v_accvgpr_read_b32 v165, a49
 v_accvgpr_read_b32 v166, a50
 v_accvgpr_read_b32 v167, a51
 v_accvgpr_read_b32 v168, a52
 v_accvgpr_read_b32 v169, a53
 v_accvgpr_read_b32 v170, a54
 v_accvgpr_read_b32 v171, a55
 v_accvgpr_read_b32 v172, a56
 v_accvgpr_read_b32 v173, a57
 v_accvgpr_read_b32 v174, a58
 v_accvgpr_read_b32 v175, a59
 v_accvgpr_read_b32 v176, a60
 v_accvgpr_read_b32 v177, a61
 v_accvgpr_read_b32 v178, a62
 v_accvgpr_read_b32 v179, a63
 s_waitcnt lgkmcnt(0)
 v_pk_add_f32 v[116:117], v[116:117], v[164:165]
 v_pk_add_f32 v[118:119], v[118:119], v[166:167]
 v_pk_add_f32 v[120:121], v[120:121], v[168:169]
 v_pk_add_f32 v[122:123], v[122:123], v[170:171]
 v_pk_add_f32 v[124:125], v[124:125], v[172:173]
 v_pk_add_f32 v[126:127], v[126:127], v[174:175]
 v_pk_add_f32 v[128:129], v[128:129], v[176:177]
 v_pk_add_f32 v[130:131], v[130:131], v[178:179]
 s_branch t_gh_ep_j
t_gh_ep_k0:
 ds_write_b128 v52, a[16:19] offset:0
 ds_write_b128 v52, a[20:23] offset:1024
 ds_write_b128 v52, a[24:27] offset:2048
 ds_write_b128 v52, a[28:31] offset:3072
 ds_write_b128 v52, a[48:51] offset:4096
 ds_write_b128 v52, a[52:55] offset:5120
 ds_write_b128 v52, a[56:59] offset:6144
 ds_write_b128 v52, a[60:63] offset:7168
 s_waitcnt lgkmcnt(0)
 s_barrier
 ds_read_b128 v[100:103], v53 offset:0
 ds_read_b128 v[104:107], v53 offset:1024
 ds_read_b128 v[108:111], v53 offset:2048
 ds_read_b128 v[112:115], v53 offset:3072
 ds_read_b128 v[116:119], v53 offset:4096
 ds_read_b128 v[120:123], v53 offset:5120
 ds_read_b128 v[124:127], v53 offset:6144
 ds_read_b128 v[128:131], v53 offset:7168
 v_accvgpr_read_b32 v164, a0
 v_accvgpr_read_b32 v165, a1
 v_accvgpr_read_b32 v166, a2
 v_accvgpr_read_b32 v167, a3
 v_accvgpr_read_b32 v168, a4
 v_accvgpr_read_b32 v169, a5
 v_accvgpr_read_b32 v170, a6
 v_accvgpr_read_b32 v171, a7
 v_accvgpr_read_b32 v172, a8
 v_accvgpr_read_b32 v173, a9
 v_accvgpr_read_b32 v174, a10
 v_accvgpr_read_b32 v175, a11
 v_accvgpr_read_b32 v176, a12
 v_accvgpr_read_b32 v177, a13
 v_accvgpr_read_b32 v178, a14
 v_accvgpr_read_b32 v179, a15
 s_waitcnt lgkmcnt(4)
 v_pk_add_f32 v[100:101], v[100:101], v[164:165]
 v_pk_add_f32 v[102:103], v[102:103], v[166:167]
 v_pk_add_f32 v[104:105], v[104:105], v[168:169]
 v_pk_add_f32 v[106:107], v[106:107], v[170:171]
 v_pk_add_f32 v[108:109], v[108:109], v[172:173]
 v_pk_add_f32 v[110:111], v[110:111], v[174:175]
 v_pk_add_f32 v[112:113], v[112:113], v[176:177]
 v_pk_add_f32 v[114:115], v[114:115], v[178:179]
 v_accvgpr_read_b32 v164, a32
 v_accvgpr_read_b32 v165, a33
 v_accvgpr_read_b32 v166, a34
 v_accvgpr_read_b32 v167, a35
 v_accvgpr_read_b32 v168, a36
 v_accvgpr_read_b32 v169, a37
 v_accvgpr_read_b32 v170, a38
 v_accvgpr_read_b32 v171, a39
 v_accvgpr_read_b32 v172, a40
 v_accvgpr_read_b32 v173, a41
 v_accvgpr_read_b32 v174, a42
 v_accvgpr_read_b32 v175, a43
 v_accvgpr_read_b32 v176, a44
 v_accvgpr_read_b32 v177, a45
 v_accvgpr_read_b32 v178, a46
 v_accvgpr_read_b32 v179, a47
 s_waitcnt lgkmcnt(0)
 v_pk_add_f32 v[116:117], v[116:117], v[164:165]
 v_pk_add_f32 v[118:119], v[118:119], v[166:167]
 v_pk_add_f32 v[120:121], v[120:121], v[168:169]
 v_pk_add_f32 v[122:123], v[122:123], v[170:171]
 v_pk_add_f32 v[124:125], v[124:125], v[172:173]
 v_pk_add_f32 v[126:127], v[126:127], v[174:175]
 v_pk_add_f32 v[128:129], v[128:129], v[176:177]
 v_pk_add_f32 v[130:131], v[130:131], v[178:179]
t_gh_ep_j:
 s_cmp_eq_u32 s72, 1
 s_cbranch_scc1 t_gh_m1
 s_cmp_eq_u32 s72, 2
 s_cbranch_scc1 t_gh_m2
 s_waitcnt vmcnt(0)
 v_cvt_pk_bf16_f32 v180, v100, v101
 v_cvt_pk_bf16_f32 v181, v102, v103
 v_cvt_pk_bf16_f32 v182, v104, v105
 v_cvt_pk_bf16_f32 v183, v106, v107
 v_cvt_pk_bf16_f32 v184, v108, v109
 v_cvt_pk_bf16_f32 v185, v110, v111
 v_cvt_pk_bf16_f32 v186, v112, v113
 v_cvt_pk_bf16_f32 v187, v114, v115
 v_lshlrev_b32 v100, 16, v180
 v_and_b32 v101, 0xffff0000, v180
 v_lshlrev_b32 v102, 16, v181
 v_and_b32 v103, 0xffff0000, v181
 v_lshlrev_b32 v104, 16, v182
 v_and_b32 v105, 0xffff0000, v182
 v_lshlrev_b32 v106, 16, v183
 v_and_b32 v107, 0xffff0000, v183
 v_lshlrev_b32 v108, 16, v184
 v_and_b32 v109, 0xffff0000, v184
 v_lshlrev_b32 v110, 16, v185
 v_and_b32 v111, 0xffff0000, v185
 v_lshlrev_b32 v112, 16, v186
 v_and_b32 v113, 0xffff0000, v186
 v_lshlrev_b32 v114, 16, v187
 v_and_b32 v115, 0xffff0000, v187
 v_lshlrev_b32 v164, 16, v68
 v_and_b32 v165, 0xffff0000, v68
 v_lshlrev_b32 v166, 16, v69
 v_and_b32 v167, 0xffff0000, v69
 v_lshlrev_b32 v168, 16, v70
 v_and_b32 v169, 0xffff0000, v70
 v_lshlrev_b32 v170, 16, v71
 v_and_b32 v171, 0xffff0000, v71
 v_lshlrev_b32 v172, 16, v72
 v_and_b32 v173, 0xffff0000, v72
 v_lshlrev_b32 v174, 16, v73
 v_and_b32 v175, 0xffff0000, v73
 v_lshlrev_b32 v176, 16, v74
 v_and_b32 v177, 0xffff0000, v74
 v_lshlrev_b32 v178, 16, v75
 v_and_b32 v179, 0xffff0000, v75
 v_pk_add_f32 v[100:101], v[100:101], v[164:165]
 v_pk_add_f32 v[102:103], v[102:103], v[166:167]
 v_pk_add_f32 v[104:105], v[104:105], v[168:169]
 v_pk_add_f32 v[106:107], v[106:107], v[170:171]
 v_pk_add_f32 v[108:109], v[108:109], v[172:173]
 v_pk_add_f32 v[110:111], v[110:111], v[174:175]
 v_pk_add_f32 v[112:113], v[112:113], v[176:177]
 v_pk_add_f32 v[114:115], v[114:115], v[178:179]
 v_cvt_pk_bf16_f32 v180, v100, v101
 v_cvt_pk_bf16_f32 v181, v102, v103
 v_cvt_pk_bf16_f32 v182, v104, v105
 v_cvt_pk_bf16_f32 v183, v106, v107
 v_cvt_pk_bf16_f32 v184, v108, v109
 v_cvt_pk_bf16_f32 v185, v110, v111
 v_cvt_pk_bf16_f32 v186, v112, v113
 v_cvt_pk_bf16_f32 v187, v114, v115
 ds_write_b64 v59, v[180:181]
 ds_write_b64 v60, v[182:183]
 ds_write_b64 v61, v[184:185]
 ds_write_b64 v62, v[186:187]
 v_cvt_pk_bf16_f32 v180, v116, v117
 v_cvt_pk_bf16_f32 v181, v118, v119
 v_cvt_pk_bf16_f32 v182, v120, v121
 v_cvt_pk_bf16_f32 v183, v122, v123
 v_cvt_pk_bf16_f32 v184, v124, v125
 v_cvt_pk_bf16_f32 v185, v126, v127
 v_cvt_pk_bf16_f32 v186, v128, v129
 v_cvt_pk_bf16_f32 v187, v130, v131
 v_lshlrev_b32 v116, 16, v180
 v_and_b32 v117, 0xffff0000, v180
 v_lshlrev_b32 v118, 16, v181
 v_and_b32 v119, 0xffff0000, v181
 v_lshlrev_b32 v120, 16, v182
 v_and_b32 v121, 0xffff0000, v182
 v_lshlrev_b32 v122, 16, v183
 v_and_b32 v123, 0xffff0000, v183
 v_lshlrev_b32 v124, 16, v184
 v_and_b32 v125, 0xffff0000, v184
 v_lshlrev_b32 v126, 16, v185
 v_and_b32 v127, 0xffff0000, v185
 v_lshlrev_b32 v128, 16, v186
 v_and_b32 v129, 0xffff0000, v186
 v_lshlrev_b32 v130, 16, v187
 v_and_b32 v131, 0xffff0000, v187
 v_lshlrev_b32 v164, 16, v76
 v_and_b32 v165, 0xffff0000, v76
 v_lshlrev_b32 v166, 16, v77
 v_and_b32 v167, 0xffff0000, v77
 v_lshlrev_b32 v168, 16, v78
 v_and_b32 v169, 0xffff0000, v78
 v_lshlrev_b32 v170, 16, v79
 v_and_b32 v171, 0xffff0000, v79
 v_lshlrev_b32 v172, 16, v80
 v_and_b32 v173, 0xffff0000, v80
 v_lshlrev_b32 v174, 16, v81
 v_and_b32 v175, 0xffff0000, v81
 v_lshlrev_b32 v176, 16, v82
 v_and_b32 v177, 0xffff0000, v82
 v_lshlrev_b32 v178, 16, v83
 v_and_b32 v179, 0xffff0000, v83
 v_pk_add_f32 v[116:117], v[116:117], v[164:165]
 v_pk_add_f32 v[118:119], v[118:119], v[166:167]
 v_pk_add_f32 v[120:121], v[120:121], v[168:169]
 v_pk_add_f32 v[122:123], v[122:123], v[170:171]
 v_pk_add_f32 v[124:125], v[124:125], v[172:173]
 v_pk_add_f32 v[126:127], v[126:127], v[174:175]
 v_pk_add_f32 v[128:129], v[128:129], v[176:177]
 v_pk_add_f32 v[130:131], v[130:131], v[178:179]
 v_cvt_pk_bf16_f32 v180, v116, v117
 v_cvt_pk_bf16_f32 v181, v118, v119
 v_cvt_pk_bf16_f32 v182, v120, v121
 v_cvt_pk_bf16_f32 v183, v122, v123
 v_cvt_pk_bf16_f32 v184, v124, v125
 v_cvt_pk_bf16_f32 v185, v126, v127
 v_cvt_pk_bf16_f32 v186, v128, v129
 v_cvt_pk_bf16_f32 v187, v130, v131
 v_xor_b32 v164, 64, v59
 ds_write_b64 v164, v[180:181]
 v_xor_b32 v165, 64, v60
 ds_write_b64 v165, v[182:183]
 v_xor_b32 v166, 64, v61
 ds_write_b64 v166, v[184:185]
 v_xor_b32 v167, 64, v62
 ds_write_b64 v167, v[186:187]
 s_waitcnt lgkmcnt(0)
 ds_read_b128 v[100:103], v57 offset:0
 v_xor_b32 v165, 64, v57
 ds_read_b128 v[104:107], v165 offset:1024
 v_xor_b32 v166, 128, v57
 ds_read_b128 v[108:111], v166 offset:2048
 v_xor_b32 v167, 192, v57
 ds_read_b128 v[112:115], v167 offset:3072
 ds_read_b128 v[116:119], v57 offset:4096
 v_xor_b32 v169, 64, v57
 ds_read_b128 v[120:123], v169 offset:5120
 v_xor_b32 v170, 128, v57
 ds_read_b128 v[124:127], v170 offset:6144
 v_xor_b32 v171, 192, v57
 ds_read_b128 v[128:131], v171 offset:7168
 s_lshl_b32 s37, s73, 2
 s_mov_b32 exec_lo, 0x00ff00ff
 s_mov_b32 exec_hi, 0x00ff00ff
 s_waitcnt lgkmcnt(7)
 buffer_store_dwordx4 v[100:103], v55, s[56:59], s39 offen sc1
 s_add_u32 s39, s39, s37
 s_waitcnt lgkmcnt(6)
 buffer_store_dwordx4 v[104:107], v55, s[56:59], s39 offen sc1
 s_add_u32 s39, s39, s37
 s_waitcnt lgkmcnt(5)
 buffer_store_dwordx4 v[108:111], v55, s[56:59], s39 offen sc1
 s_add_u32 s39, s39, s37
 s_waitcnt lgkmcnt(4)
 buffer_store_dwordx4 v[112:115], v55, s[56:59], s39 offen sc1
 s_add_u32 s39, s39, s37
 s_waitcnt lgkmcnt(3)
 buffer_store_dwordx4 v[116:119], v55, s[56:59], s39 offen sc1
 s_add_u32 s39, s39, s37
 s_waitcnt lgkmcnt(2)
 buffer_store_dwordx4 v[120:123], v55, s[56:59], s39 offen sc1
 s_add_u32 s39, s39, s37
 s_waitcnt lgkmcnt(1)
 buffer_store_dwordx4 v[124:127], v55, s[56:59], s39 offen sc1
 s_add_u32 s39, s39, s37
 s_waitcnt lgkmcnt(0)
 buffer_store_dwordx4 v[128:131], v55, s[56:59], s39 offen sc1
 s_add_u32 s39, s39, s37
 s_mov_b64 exec, -1
 s_branch t_gh_exit
t_gh_m1:
 s_mov_b32 s60, 0xbfb8aa3b
 v_cvt_pk_bf16_f32 v180, v100, v101
 v_cvt_pk_bf16_f32 v181, v102, v103
 v_cvt_pk_bf16_f32 v182, v104, v105
 v_cvt_pk_bf16_f32 v183, v106, v107
 v_cvt_pk_bf16_f32 v184, v108, v109
 v_cvt_pk_bf16_f32 v185, v110, v111
 v_cvt_pk_bf16_f32 v186, v112, v113
 v_cvt_pk_bf16_f32 v187, v114, v115
 v_lshlrev_b32 v100, 16, v180
 v_and_b32 v101, 0xffff0000, v180
 v_lshlrev_b32 v102, 16, v181
 v_and_b32 v103, 0xffff0000, v181
 v_lshlrev_b32 v104, 16, v182
 v_and_b32 v105, 0xffff0000, v182
 v_lshlrev_b32 v106, 16, v183
 v_and_b32 v107, 0xffff0000, v183
 v_lshlrev_b32 v108, 16, v184
 v_and_b32 v109, 0xffff0000, v184
 v_lshlrev_b32 v110, 16, v185
 v_and_b32 v111, 0xffff0000, v185
 v_lshlrev_b32 v112, 16, v186
 v_and_b32 v113, 0xffff0000, v186
 v_lshlrev_b32 v114, 16, v187
 v_and_b32 v115, 0xffff0000, v187
 v_mul_f32 v164, s60, v100
 v_mul_f32 v165, s60, v101
 v_mul_f32 v166, s60, v102
 v_mul_f32 v167, s60, v103
 v_mul_f32 v168, s60, v104
 v_mul_f32 v169, s60, v105
 v_mul_f32 v170, s60, v106
 v_mul_f32 v171, s60, v107
 v_mul_f32 v172, s60, v108
 v_mul_f32 v173, s60, v109
 v_mul_f32 v174, s60, v110
 v_mul_f32 v175, s60, v111
 v_mul_f32 v176, s60, v112
 v_mul_f32 v177, s60, v113
 v_mul_f32 v178, s60, v114
 v_mul_f32 v179, s60, v115
 v_exp_f32 v164, v164
 v_exp_f32 v165, v165
 v_exp_f32 v166, v166
 v_exp_f32 v167, v167
 v_exp_f32 v168, v168
 v_exp_f32 v169, v169
 v_exp_f32 v170, v170
 v_exp_f32 v171, v171
 v_exp_f32 v172, v172
 v_exp_f32 v173, v173
 v_exp_f32 v174, v174
 v_exp_f32 v175, v175
 v_exp_f32 v176, v176
 v_exp_f32 v177, v177
 v_exp_f32 v178, v178
 v_exp_f32 v179, v179
 v_add_f32 v164, 1.0, v164
 v_add_f32 v165, 1.0, v165
 v_add_f32 v166, 1.0, v166
 v_add_f32 v167, 1.0, v167
 v_add_f32 v168, 1.0, v168
 v_add_f32 v169, 1.0, v169
 v_add_f32 v170, 1.0, v170
 v_add_f32 v171, 1.0, v171
 v_add_f32 v172, 1.0, v172
 v_add_f32 v173, 1.0, v173
 v_add_f32 v174, 1.0, v174
 v_add_f32 v175, 1.0, v175
 v_add_f32 v176, 1.0, v176
 v_add_f32 v177, 1.0, v177
 v_add_f32 v178, 1.0, v178
 v_add_f32 v179, 1.0, v179
 v_rcp_f32 v164, v164
 v_rcp_f32 v165, v165
 v_rcp_f32 v166, v166
 v_rcp_f32 v167, v167
 v_rcp_f32 v168, v168
 v_rcp_f32 v169, v169
 v_rcp_f32 v170, v170
 v_rcp_f32 v171, v171
 v_rcp_f32 v172, v172
 v_rcp_f32 v173, v173
 v_rcp_f32 v174, v174
 v_rcp_f32 v175, v175
 v_rcp_f32 v176, v176
 v_rcp_f32 v177, v177
 v_rcp_f32 v178, v178
 v_rcp_f32 v179, v179
 v_mul_f32 v100, v100, v164
 v_mul_f32 v101, v101, v165
 v_mul_f32 v102, v102, v166
 v_mul_f32 v103, v103, v167
 v_mul_f32 v104, v104, v168
 v_mul_f32 v105, v105, v169
 v_mul_f32 v106, v106, v170
 v_mul_f32 v107, v107, v171
 v_mul_f32 v108, v108, v172
 v_mul_f32 v109, v109, v173
 v_mul_f32 v110, v110, v174
 v_mul_f32 v111, v111, v175
 v_mul_f32 v112, v112, v176
 v_mul_f32 v113, v113, v177
 v_mul_f32 v114, v114, v178
 v_mul_f32 v115, v115, v179
 v_cvt_pk_bf16_f32 v180, v100, v101
 v_cvt_pk_bf16_f32 v181, v102, v103
 v_cvt_pk_bf16_f32 v182, v104, v105
 v_cvt_pk_bf16_f32 v183, v106, v107
 v_cvt_pk_bf16_f32 v184, v108, v109
 v_cvt_pk_bf16_f32 v185, v110, v111
 v_cvt_pk_bf16_f32 v186, v112, v113
 v_cvt_pk_bf16_f32 v187, v114, v115
 ds_write_b64 v59, v[180:181]
 ds_write_b64 v60, v[182:183]
 ds_write_b64 v61, v[184:185]
 ds_write_b64 v62, v[186:187]
 v_cvt_pk_bf16_f32 v180, v116, v117
 v_cvt_pk_bf16_f32 v181, v118, v119
 v_cvt_pk_bf16_f32 v182, v120, v121
 v_cvt_pk_bf16_f32 v183, v122, v123
 v_cvt_pk_bf16_f32 v184, v124, v125
 v_cvt_pk_bf16_f32 v185, v126, v127
 v_cvt_pk_bf16_f32 v186, v128, v129
 v_cvt_pk_bf16_f32 v187, v130, v131
 v_lshlrev_b32 v116, 16, v180
 v_and_b32 v117, 0xffff0000, v180
 v_lshlrev_b32 v118, 16, v181
 v_and_b32 v119, 0xffff0000, v181
 v_lshlrev_b32 v120, 16, v182
 v_and_b32 v121, 0xffff0000, v182
 v_lshlrev_b32 v122, 16, v183
 v_and_b32 v123, 0xffff0000, v183
 v_lshlrev_b32 v124, 16, v184
 v_and_b32 v125, 0xffff0000, v184
 v_lshlrev_b32 v126, 16, v185
 v_and_b32 v127, 0xffff0000, v185
 v_lshlrev_b32 v128, 16, v186
 v_and_b32 v129, 0xffff0000, v186
 v_lshlrev_b32 v130, 16, v187
 v_and_b32 v131, 0xffff0000, v187
 v_mul_f32 v164, s60, v116
 v_mul_f32 v165, s60, v117
 v_mul_f32 v166, s60, v118
 v_mul_f32 v167, s60, v119
 v_mul_f32 v168, s60, v120
 v_mul_f32 v169, s60, v121
 v_mul_f32 v170, s60, v122
 v_mul_f32 v171, s60, v123
 v_mul_f32 v172, s60, v124
 v_mul_f32 v173, s60, v125
 v_mul_f32 v174, s60, v126
 v_mul_f32 v175, s60, v127
 v_mul_f32 v176, s60, v128
 v_mul_f32 v177, s60, v129
 v_mul_f32 v178, s60, v130
 v_mul_f32 v179, s60, v131
 v_exp_f32 v164, v164
 v_exp_f32 v165, v165
 v_exp_f32 v166, v166
 v_exp_f32 v167, v167
 v_exp_f32 v168, v168
 v_exp_f32 v169, v169
 v_exp_f32 v170, v170
 v_exp_f32 v171, v171
 v_exp_f32 v172, v172
 v_exp_f32 v173, v173
 v_exp_f32 v174, v174
 v_exp_f32 v175, v175
 v_exp_f32 v176, v176
 v_exp_f32 v177, v177
 v_exp_f32 v178, v178
 v_exp_f32 v179, v179
 v_add_f32 v164, 1.0, v164
 v_add_f32 v165, 1.0, v165
 v_add_f32 v166, 1.0, v166
 v_add_f32 v167, 1.0, v167
 v_add_f32 v168, 1.0, v168
 v_add_f32 v169, 1.0, v169
 v_add_f32 v170, 1.0, v170
 v_add_f32 v171, 1.0, v171
 v_add_f32 v172, 1.0, v172
 v_add_f32 v173, 1.0, v173
 v_add_f32 v174, 1.0, v174
 v_add_f32 v175, 1.0, v175
 v_add_f32 v176, 1.0, v176
 v_add_f32 v177, 1.0, v177
 v_add_f32 v178, 1.0, v178
 v_add_f32 v179, 1.0, v179
 v_rcp_f32 v164, v164
 v_rcp_f32 v165, v165
 v_rcp_f32 v166, v166
 v_rcp_f32 v167, v167
 v_rcp_f32 v168, v168
 v_rcp_f32 v169, v169
 v_rcp_f32 v170, v170
 v_rcp_f32 v171, v171
 v_rcp_f32 v172, v172
 v_rcp_f32 v173, v173
 v_rcp_f32 v174, v174
 v_rcp_f32 v175, v175
 v_rcp_f32 v176, v176
 v_rcp_f32 v177, v177
 v_rcp_f32 v178, v178
 v_rcp_f32 v179, v179
 v_mul_f32 v116, v116, v164
 v_mul_f32 v117, v117, v165
 v_mul_f32 v118, v118, v166
 v_mul_f32 v119, v119, v167
 v_mul_f32 v120, v120, v168
 v_mul_f32 v121, v121, v169
 v_mul_f32 v122, v122, v170
 v_mul_f32 v123, v123, v171
 v_mul_f32 v124, v124, v172
 v_mul_f32 v125, v125, v173
 v_mul_f32 v126, v126, v174
 v_mul_f32 v127, v127, v175
 v_mul_f32 v128, v128, v176
 v_mul_f32 v129, v129, v177
 v_mul_f32 v130, v130, v178
 v_mul_f32 v131, v131, v179
 v_cvt_pk_bf16_f32 v180, v116, v117
 v_cvt_pk_bf16_f32 v181, v118, v119
 v_cvt_pk_bf16_f32 v182, v120, v121
 v_cvt_pk_bf16_f32 v183, v122, v123
 v_cvt_pk_bf16_f32 v184, v124, v125
 v_cvt_pk_bf16_f32 v185, v126, v127
 v_cvt_pk_bf16_f32 v186, v128, v129
 v_cvt_pk_bf16_f32 v187, v130, v131
 v_xor_b32 v164, 64, v59
 ds_write_b64 v164, v[180:181]
 v_xor_b32 v165, 64, v60
 ds_write_b64 v165, v[182:183]
 v_xor_b32 v166, 64, v61
 ds_write_b64 v166, v[184:185]
 v_xor_b32 v167, 64, v62
 ds_write_b64 v167, v[186:187]
 s_waitcnt lgkmcnt(0)
 ds_read_b128 v[100:103], v67 offset:0
 v_xor_b32 v165, 32, v67
 ds_read_b128 v[104:107], v165 offset:0
 v_xor_b32 v166, 64, v67
 ds_read_b128 v[108:111], v166 offset:0
 v_xor_b32 v167, 96, v67
 ds_read_b128 v[112:115], v167 offset:0
 s_lshl_b32 s37, s26, 12
 s_add_u32 s39, s61, s37
 s_add_u32 s39, s39, s74
 s_mov_b32 s37, 1024
 s_waitcnt lgkmcnt(3)
 buffer_store_dwordx4 v[100:103], v188, s[4:7], s39 offen sc1
 s_add_u32 s39, s39, s37
 s_waitcnt lgkmcnt(2)
 buffer_store_dwordx4 v[104:107], v188, s[4:7], s39 offen sc1
 s_add_u32 s39, s39, s37
 s_waitcnt lgkmcnt(1)
 buffer_store_dwordx4 v[108:111], v188, s[4:7], s39 offen sc1
 s_add_u32 s39, s39, s37
 s_waitcnt lgkmcnt(0)
 buffer_store_dwordx4 v[112:115], v188, s[4:7], s39 offen sc1
 s_add_u32 s39, s39, s37
 s_branch t_gh_exit
t_gh_m2:
 ds_write_b128 v63, v[100:103] offset:0
 ds_write_b128 v64, v[104:107] offset:0
 ds_write_b128 v65, v[108:111] offset:0
 ds_write_b128 v66, v[112:115] offset:0
 ds_write_b128 v63, v[116:119] offset:128
 ds_write_b128 v64, v[120:123] offset:128
 ds_write_b128 v65, v[124:127] offset:128
 ds_write_b128 v66, v[128:131] offset:128
 s_waitcnt lgkmcnt(0)
 ds_read_b128 v[100:103], v58 offset:0
 v_xor_b32 v165, 32, v58
 ds_read_b128 v[104:107], v165 offset:1024
 v_xor_b32 v166, 64, v58
 ds_read_b128 v[108:111], v166 offset:2048
 v_xor_b32 v167, 96, v58
 ds_read_b128 v[112:115], v167 offset:3072
 ds_read_b128 v[116:119], v58 offset:4096
 v_xor_b32 v169, 32, v58
 ds_read_b128 v[120:123], v169 offset:5120
 v_xor_b32 v170, 64, v58
 ds_read_b128 v[124:127], v170 offset:6144
 v_xor_b32 v171, 96, v58
 ds_read_b128 v[128:131], v171 offset:7168
 ds_read_b128 v[132:135], v58 offset:8192
 v_xor_b32 v165, 32, v58
 ds_read_b128 v[136:139], v165 offset:9216
 v_xor_b32 v166, 64, v58
 ds_read_b128 v[140:143], v166 offset:10240
 v_xor_b32 v167, 96, v58
 ds_read_b128 v[144:147], v167 offset:11264
 ds_read_b128 v[148:151], v58 offset:12288
 v_xor_b32 v169, 32, v58
 ds_read_b128 v[152:155], v169 offset:13312
 v_xor_b32 v170, 64, v58
 ds_read_b128 v[156:159], v170 offset:14336
 v_xor_b32 v171, 96, v58
 ds_read_b128 v[160:163], v171 offset:15360
 s_lshl_b32 s37, s73, 1
 s_mov_b32 exec_lo, 0x0000ffff
 s_mov_b32 exec_hi, 0x0000ffff
 s_waitcnt lgkmcnt(15)
 buffer_store_dwordx4 v[100:103], v56, s[4:7], s39 offen sc1
 s_add_u32 s39, s39, s37
 s_waitcnt lgkmcnt(14)
 buffer_store_dwordx4 v[104:107], v56, s[4:7], s39 offen sc1
 s_add_u32 s39, s39, s37
 s_waitcnt lgkmcnt(13)
 buffer_store_dwordx4 v[108:111], v56, s[4:7], s39 offen sc1
 s_add_u32 s39, s39, s37
 s_waitcnt lgkmcnt(12)
 buffer_store_dwordx4 v[112:115], v56, s[4:7], s39 offen sc1
 s_add_u32 s39, s39, s37
 s_waitcnt lgkmcnt(11)
 buffer_store_dwordx4 v[116:119], v56, s[4:7], s39 offen sc1
 s_add_u32 s39, s39, s37
 s_waitcnt lgkmcnt(10)
 buffer_store_dwordx4 v[120:123], v56, s[4:7], s39 offen sc1
 s_add_u32 s39, s39, s37
 s_waitcnt lgkmcnt(9)
 buffer_store_dwordx4 v[124:127], v56, s[4:7], s39 offen sc1
 s_add_u32 s39, s39, s37
 s_waitcnt lgkmcnt(8)
 buffer_store_dwordx4 v[128:131], v56, s[4:7], s39 offen sc1
 s_add_u32 s39, s39, s37
 s_waitcnt lgkmcnt(7)
 buffer_store_dwordx4 v[132:135], v56, s[4:7], s39 offen sc1
 s_add_u32 s39, s39, s37
 s_waitcnt lgkmcnt(6)
 buffer_store_dwordx4 v[136:139], v56, s[4:7], s39 offen sc1
 s_add_u32 s39, s39, s37
 s_waitcnt lgkmcnt(5)
 buffer_store_dwordx4 v[140:143], v56, s[4:7], s39 offen sc1
 s_add_u32 s39, s39, s37
 s_waitcnt lgkmcnt(4)
 buffer_store_dwordx4 v[144:147], v56, s[4:7], s39 offen sc1
 s_add_u32 s39, s39, s37
 s_waitcnt lgkmcnt(3)
 buffer_store_dwordx4 v[148:151], v56, s[4:7], s39 offen sc1
 s_add_u32 s39, s39, s37
 s_waitcnt lgkmcnt(2)
 buffer_store_dwordx4 v[152:155], v56, s[4:7], s39 offen sc1
 s_add_u32 s39, s39, s37
 s_waitcnt lgkmcnt(1)
 buffer_store_dwordx4 v[156:159], v56, s[4:7], s39 offen sc1
 s_add_u32 s39, s39, s37
 s_waitcnt lgkmcnt(0)
 buffer_store_dwordx4 v[160:163], v56, s[4:7], s39 offen sc1
 s_add_u32 s39, s39, s37
 s_mov_b64 exec, -1
t_gh_exit:
 s_add_u32 s26, s26, 1
 s_mov_b32 s79, 0
 s_cmp_lg_u32 s78, 0
 s_cbranch_scc1 t_gh_tile
 s_branch mega_done

t_att:
 s_load_dwordx2 s[12:13], s[0:1], 96
 v_and_b32 v1, 63, v0
 v_lshrrev_b32 v2, 6, v0
 s_nop 0
 v_readfirstlane_b32 s16, v2
 s_lshl_b32 s17, s92, 2
 s_add_u32 s17, s17, s16
 s_lshl_b32 s17, s17, 5
 s_xor_b32 s29, s75, 1
 s_lshl_b32 s16, s93, s29
 s_add_u32 s17, s17, s16
 s_add_u32 s29, s17, s29
 s_waitcnt lgkmcnt(0)

 s_mov_b32 s4, s12
 s_and_b32 s5, s13, 0xffff
 s_mov_b32 s6, 0x10000000
 s_mov_b32 s7, 0x00020000
 v_and_b32 v2, 31, v1
 v_lshrrev_b32 v3, 5, v1
 v_lshlrev_b32 v9, 4, v3
 v_lshlrev_b32 v4, 4, v1
 v_and_b32 v10, 7, v1
 v_lshl_add_u32 v5, v10, 5, v9
 v_add_u32 v6, 0x1000, v4
 v_lshlrev_b32 v7, 4, v2
 v_lshl_add_u32 v8, v2, 13, v9
 s_mov_b32 s27, 0x3db504f3
 s_mov_b32 s28, 0x3fb8aa3b
 v_lshlrev_b32 v9, 2, v3
 v_sub_u32 v9, v2, v9
 v_mov_b32 v10, 0xce6e6b28

 s_lshl_b32 s18, s17, 13
 s_add_u32 s19, s18, 4194304
 s_add_u32 s20, s18, 20971520
 s_add_u32 s21, s18, 37748736
 s_add_u32 s22, s21, 4096
 s_lshl_b32 s18, s17, 11
 s_add_u32 s23, s18, 117440512
 s_add_u32 s24, s18, 125829120
 s_lshr_b32 s25, s17, 5
 s_lshl_b32 s25, s25, 18
 s_and_b32 s26, s17, 31
 s_lshl_b32 s26, s26, 13
 s_add_u32 s25, s25, s26
 s_add_u32 s25, s25, 54525952

 s_lshl_b32 s18, s29, 13
 s_add_u32 s30, s18, 4194304
 s_add_u32 s31, s18, 20971520
 s_add_u32 s32, s18, 37748736
 s_add_u32 s33, s32, 4096
 s_lshl_b32 s18, s29, 11
 s_add_u32 s34, s18, 117440512
 s_add_u32 s35, s18, 125829120
 s_lshr_b32 s36, s29, 5
 s_lshl_b32 s36, s36, 18
 s_and_b32 s26, s29, 31
 s_lshl_b32 s26, s26, 13
 s_add_u32 s36, s36, s26
 s_add_u32 s36, s36, 54525952

 v_lshrrev_b32 v14, 6, v0
 v_mul_u32_u24 v14, 8704, v14
 v_mul_u32_u24 v11, 272, v2
 v_lshl_add_u32 v11, v3, 3, v11
 v_add_u32 v11, v11, v14
 v_mul_u32_u24 v12, 272, v2
 v_lshl_add_u32 v12, v3, 4, v12
 v_add_u32 v12, v12, v14
 v_lshlrev_b32 v13, 4, v1

 buffer_load_dwordx4 v[16:19], v4, s[4:7], s19 offen offset:0
 buffer_load_dwordx4 v[48:51], v4, s[4:7], s20 offen offset:0
 buffer_load_dwordx4 v[20:23], v4, s[4:7], s19 offen offset:1024
 buffer_load_dwordx4 v[52:55], v4, s[4:7], s20 offen offset:1024
 buffer_load_dwordx4 v[24:27], v4, s[4:7], s19 offen offset:2048
 buffer_load_dwordx4 v[56:59], v4, s[4:7], s20 offen offset:2048
 buffer_load_dwordx4 v[28:31], v4, s[4:7], s19 offen offset:3072
 buffer_load_dwordx4 v[60:63], v4, s[4:7], s20 offen offset:3072
 buffer_load_dwordx4 v[32:35], v6, s[4:7], s19 offen offset:0
 buffer_load_dwordx4 v[64:67], v6, s[4:7], s20 offen offset:0
 buffer_load_dwordx4 v[36:39], v6, s[4:7], s19 offen offset:1024
 buffer_load_dwordx4 v[68:71], v6, s[4:7], s20 offen offset:1024
 buffer_load_dwordx4 v[40:43], v6, s[4:7], s19 offen offset:2048
 buffer_load_dwordx4 v[72:75], v6, s[4:7], s20 offen offset:2048
 buffer_load_dwordx4 v[44:47], v6, s[4:7], s19 offen offset:3072
 buffer_load_dwordx4 v[76:79], v6, s[4:7], s20 offen offset:3072
 buffer_load_dwordx4 v[112:115], v4, s[4:7], s21 offen offset:0
 buffer_load_dwordx4 v[116:119], v4, s[4:7], s21 offen offset:1024
 buffer_load_dwordx4 v[120:123], v4, s[4:7], s21 offen offset:2048
 buffer_load_dwordx4 v[124:127], v4, s[4:7], s21 offen offset:3072
 buffer_load_dwordx4 v[128:131], v4, s[4:7], s22 offen offset:0
 buffer_load_dwordx4 v[132:135], v4, s[4:7], s22 offen offset:1024
 buffer_load_dwordx4 v[136:139], v4, s[4:7], s22 offen offset:2048
 buffer_load_dwordx4 v[140:143], v4, s[4:7], s22 offen offset:3072
 s_cmp_lg_u32 s75, 0
 s_cbranch_scc1 t_att_poll
 buffer_load_dwordx4 a[0:3], v4, s[4:7], s30 offen offset:0
 buffer_load_dwordx4 a[32:35], v4, s[4:7], s31 offen offset:0
 buffer_load_dwordx4 a[4:7], v4, s[4:7], s30 offen offset:1024
 buffer_load_dwordx4 a[36:39], v4, s[4:7], s31 offen offset:1024
 buffer_load_dwordx4 a[8:11], v4, s[4:7], s30 offen offset:2048
 buffer_load_dwordx4 a[40:43], v4, s[4:7], s31 offen offset:2048
 buffer_load_dwordx4 a[12:15], v4, s[4:7], s30 offen offset:3072
 buffer_load_dwordx4 a[44:47], v4, s[4:7], s31 offen offset:3072
 buffer_load_dwordx4 a[16:19], v6, s[4:7], s30 offen offset:0
 buffer_load_dwordx4 a[48:51], v6, s[4:7], s31 offen offset:0
 buffer_load_dwordx4 a[20:23], v6, s[4:7], s30 offen offset:1024
 buffer_load_dwordx4 a[52:55], v6, s[4:7], s31 offen offset:1024
 buffer_load_dwordx4 a[24:27], v6, s[4:7], s30 offen offset:2048
 buffer_load_dwordx4 a[56:59], v6, s[4:7], s31 offen offset:2048
 buffer_load_dwordx4 a[28:31], v6, s[4:7], s30 offen offset:3072
 buffer_load_dwordx4 a[60:63], v6, s[4:7], s31 offen offset:3072
 buffer_load_dwordx4 a[64:67], v4, s[4:7], s32 offen offset:0
 buffer_load_dwordx4 a[68:71], v4, s[4:7], s32 offen offset:1024
 buffer_load_dwordx4 a[72:75], v4, s[4:7], s32 offen offset:2048
 buffer_load_dwordx4 a[76:79], v4, s[4:7], s32 offen offset:3072
 buffer_load_dwordx4 a[80:83], v4, s[4:7], s33 offen offset:0
 buffer_load_dwordx4 a[84:87], v4, s[4:7], s33 offen offset:1024
 buffer_load_dwordx4 a[88:91], v4, s[4:7], s33 offen offset:2048
 buffer_load_dwordx4 a[92:95], v4, s[4:7], s33 offen offset:3072
t_att_poll:
 v_and_b32 v192, 15, v1
 v_lshlrev_b32 v192, 7, v192
t_att_pre:
 buffer_load_dword v193, v192, s[4:7], s35 offen sc1
 s_waitcnt vmcnt(0)
 v_cmp_eq_u32 vcc, -1, v193
 s_cbranch_vccz t_att_poll2
 s_sub_u32 s91, s91, 64
 s_cbranch_scc1 chain_exit
 s_sleep 12
 s_branch t_att_pre

t_att_poll2:
 buffer_load_dwordx4 v[80:83], v5, s[4:7], s23 offen offset:0 sc1
 buffer_load_dwordx4 v[84:87], v5, s[4:7], s23 offen offset:256 sc1
 buffer_load_dwordx4 v[88:91], v5, s[4:7], s23 offen offset:512 sc1
 buffer_load_dwordx4 v[92:95], v5, s[4:7], s23 offen offset:768 sc1
 buffer_load_dwordx4 v[96:99], v5, s[4:7], s23 offen offset:1024 sc1
 buffer_load_dwordx4 v[100:103], v5, s[4:7], s23 offen offset:1280 sc1
 buffer_load_dwordx4 v[104:107], v5, s[4:7], s23 offen offset:1536 sc1
 buffer_load_dwordx4 v[108:111], v5, s[4:7], s23 offen offset:1792 sc1
 buffer_load_dwordx4 v[144:147], v7, s[4:7], s24 offen offset:0 sc1
 buffer_load_dwordx4 v[148:151], v7, s[4:7], s24 offen offset:512 sc1
 buffer_load_dwordx4 v[152:155], v7, s[4:7], s24 offen offset:1024 sc1
 buffer_load_dwordx4 v[156:159], v7, s[4:7], s24 offen offset:1536 sc1
 buffer_load_dwordx4 v[208:211], v5, s[4:7], s34 offen offset:0 sc1
 buffer_load_dwordx4 v[212:215], v5, s[4:7], s34 offen offset:256 sc1
 buffer_load_dwordx4 v[216:219], v5, s[4:7], s34 offen offset:512 sc1
 buffer_load_dwordx4 v[220:223], v5, s[4:7], s34 offen offset:768 sc1
 buffer_load_dwordx4 v[224:227], v5, s[4:7], s34 offen offset:1024 sc1
 buffer_load_dwordx4 v[228:231], v5, s[4:7], s34 offen offset:1280 sc1
 buffer_load_dwordx4 v[232:235], v5, s[4:7], s34 offen offset:1536 sc1
 buffer_load_dwordx4 v[236:239], v5, s[4:7], s34 offen offset:1792 sc1
 buffer_load_dwordx4 v[240:243], v7, s[4:7], s35 offen offset:0 sc1
 buffer_load_dwordx4 v[244:247], v7, s[4:7], s35 offen offset:512 sc1
 buffer_load_dwordx4 v[248:251], v7, s[4:7], s35 offen offset:1024 sc1
 buffer_load_dwordx4 v[252:255], v7, s[4:7], s35 offen offset:1536 sc1
 s_waitcnt vmcnt(0)
 v_max3_u32 v192, v80, v81, v82
 v_max3_u32 v192, v192, v83, v84
 v_max3_u32 v192, v192, v85, v86
 v_max3_u32 v192, v192, v87, v88
 v_max3_u32 v192, v192, v89, v90
 v_max3_u32 v192, v192, v91, v92
 v_max3_u32 v192, v192, v93, v94
 v_max3_u32 v192, v192, v95, v96
 v_max3_u32 v192, v192, v97, v98
 v_max3_u32 v192, v192, v99, v100
 v_max3_u32 v192, v192, v101, v102
 v_max_u32 v192, v192, v103
 v_max3_u32 v193, v104, v105, v106
 v_max3_u32 v193, v193, v107, v108
 v_max3_u32 v193, v193, v109, v110
 v_max3_u32 v193, v193, v111, v144
 v_max3_u32 v193, v193, v145, v146
 v_max3_u32 v193, v193, v147, v148
 v_max3_u32 v193, v193, v149, v150
 v_max3_u32 v193, v193, v151, v152
 v_max3_u32 v193, v193, v153, v154
 v_max3_u32 v193, v193, v155, v156
 v_max3_u32 v193, v193, v157, v158
 v_max_u32 v193, v193, v159
 v_max3_u32 v194, v208, v209, v210
 v_max3_u32 v194, v194, v211, v212
 v_max3_u32 v194, v194, v213, v214
 v_max3_u32 v194, v194, v215, v216
 v_max3_u32 v194, v194, v217, v218
 v_max3_u32 v194, v194, v219, v220
 v_max3_u32 v194, v194, v221, v222
 v_max3_u32 v194, v194, v223, v224
 v_max3_u32 v194, v194, v225, v226
 v_max3_u32 v194, v194, v227, v228
 v_max3_u32 v194, v194, v229, v230
 v_max_u32 v194, v194, v231
 v_max3_u32 v195, v232, v233, v234
 v_max3_u32 v195, v195, v235, v236
 v_max3_u32 v195, v195, v237, v238
 v_max3_u32 v195, v195, v239, v240
 v_max3_u32 v195, v195, v241, v242
 v_max3_u32 v195, v195, v243, v244
 v_max3_u32 v195, v195, v245, v246
 v_max3_u32 v195, v195, v247, v248
 v_max3_u32 v195, v195, v249, v250
 v_max3_u32 v195, v195, v251, v252
 v_max3_u32 v195, v195, v253, v254
 v_max_u32 v195, v195, v255
 v_max3_u32 v192, v192, v193, v194
 v_max_u32 v192, v192, v195
 v_cmp_eq_u32 vcc, -1, v192
 s_cbranch_vccz t_att_go
 s_sub_u32 s91, s91, 64
 s_cbranch_scc1 chain_exit
 s_sleep 4
 s_branch t_att_poll2

t_att_go:
 v_mfma_f32_32x32x16_bf16 v[160:175], v[48:51], v[16:19], 0
 v_mfma_f32_32x32x16_bf16 v[160:175], v[52:55], v[20:23], v[160:175]
 v_mfma_f32_32x32x16_bf16 v[160:175], v[56:59], v[24:27], v[160:175]
 v_mfma_f32_32x32x16_bf16 v[160:175], v[60:63], v[28:31], v[160:175]
 v_mfma_f32_32x32x16_bf16 v[160:175], v[64:67], v[32:35], v[160:175]
 v_mfma_f32_32x32x16_bf16 v[160:175], v[68:71], v[36:39], v[160:175]
 v_mfma_f32_32x32x16_bf16 v[160:175], v[72:75], v[40:43], v[160:175]
 v_mfma_f32_32x32x16_bf16 v[160:175], v[76:79], v[44:47], v[160:175]
 v_mfma_f32_32x32x16_bf16 v[176:191], v[80:83], v[16:19], 0
 v_mfma_f32_32x32x16_bf16 v[176:191], v[84:87], v[20:23], v[176:191]
 v_mfma_f32_32x32x16_bf16 v[176:191], v[88:91], v[24:27], v[176:191]
 v_mfma_f32_32x32x16_bf16 v[176:191], v[92:95], v[28:31], v[176:191]
 v_mfma_f32_32x32x16_bf16 v[176:191], v[96:99], v[32:35], v[176:191]
 v_mfma_f32_32x32x16_bf16 v[176:191], v[100:103], v[36:39], v[176:191]
 v_mfma_f32_32x32x16_bf16 v[176:191], v[104:107], v[40:43], v[176:191]
 v_mfma_f32_32x32x16_bf16 v[176:191], v[108:111], v[44:47], v[176:191]
 s_nop 7
 s_nop 7
 v_cvt_pk_bf16_f32 v192, v160, v161
 v_lshlrev_b32 v160, 16, v192
 v_and_b32 v161, 0xffff0000, v192
 v_mul_f32 v160, s27, v160
 v_mul_f32 v161, s27, v161
 v_cvt_pk_bf16_f32 v192, v160, v161
 v_lshlrev_b32 v160, 16, v192
 v_and_b32 v161, 0xffff0000, v192
 v_cvt_pk_bf16_f32 v192, v162, v163
 v_lshlrev_b32 v162, 16, v192
 v_and_b32 v163, 0xffff0000, v192
 v_mul_f32 v162, s27, v162
 v_mul_f32 v163, s27, v163
 v_cvt_pk_bf16_f32 v192, v162, v163
 v_lshlrev_b32 v162, 16, v192
 v_and_b32 v163, 0xffff0000, v192
 v_cvt_pk_bf16_f32 v192, v164, v165
 v_lshlrev_b32 v164, 16, v192
 v_and_b32 v165, 0xffff0000, v192
 v_mul_f32 v164, s27, v164
 v_mul_f32 v165, s27, v165
 v_cvt_pk_bf16_f32 v192, v164, v165
 v_lshlrev_b32 v164, 16, v192
 v_and_b32 v165, 0xffff0000, v192
 v_cvt_pk_bf16_f32 v192, v166, v167
 v_lshlrev_b32 v166, 16, v192
 v_and_b32 v167, 0xffff0000, v192
 v_mul_f32 v166, s27, v166
 v_mul_f32 v167, s27, v167
 v_cvt_pk_bf16_f32 v192, v166, v167
 v_lshlrev_b32 v166, 16, v192
 v_and_b32 v167, 0xffff0000, v192
 v_cvt_pk_bf16_f32 v192, v168, v169
 v_lshlrev_b32 v168, 16, v192
 v_and_b32 v169, 0xffff0000, v192
 v_mul_f32 v168, s27, v168
 v_mul_f32 v169, s27, v169
 v_cvt_pk_bf16_f32 v192, v168, v169
 v_lshlrev_b32 v168, 16, v192
 v_and_b32 v169, 0xffff0000, v192
 v_cvt_pk_bf16_f32 v192, v170, v171
 v_lshlrev_b32 v170, 16, v192
 v_and_b32 v171, 0xffff0000, v192
 v_mul_f32 v170, s27, v170
 v_mul_f32 v171, s27, v171
 v_cvt_pk_bf16_f32 v192, v170, v171
 v_lshlrev_b32 v170, 16, v192
 v_and_b32 v171, 0xffff0000, v192
 v_cvt_pk_bf16_f32 v192, v172, v173
 v_lshlrev_b32 v172, 16, v192
 v_and_b32 v173, 0xffff0000, v192
 v_mul_f32 v172, s27, v172
 v_mul_f32 v173, s27, v173
 v_cvt_pk_bf16_f32 v192, v172, v173
 v_lshlrev_b32 v172, 16, v192
 v_and_b32 v173, 0xffff0000, v192
 v_cvt_pk_bf16_f32 v192, v174, v175
 v_lshlrev_b32 v174, 16, v192
 v_and_b32 v175, 0xffff0000, v192
 v_mul_f32 v174, s27, v174
 v_mul_f32 v175, s27, v175
 v_cvt_pk_bf16_f32 v192, v174, v175
 v_lshlrev_b32 v174, 16, v192
 v_and_b32 v175, 0xffff0000, v192
 v_cvt_pk_bf16_f32 v192, v176, v177
 v_lshlrev_b32 v176, 16, v192
 v_and_b32 v177, 0xffff0000, v192
 v_mul_f32 v176, s27, v176
 v_mul_f32 v177, s27, v177
 v_cvt_pk_bf16_f32 v192, v176, v177
 v_lshlrev_b32 v176, 16, v192
 v_and_b32 v177, 0xffff0000, v192
 v_cvt_pk_bf16_f32 v192, v178, v179
 v_lshlrev_b32 v178, 16, v192
 v_and_b32 v179, 0xffff0000, v192
 v_mul_f32 v178, s27, v178
 v_mul_f32 v179, s27, v179
 v_cvt_pk_bf16_f32 v192, v178, v179
 v_lshlrev_b32 v178, 16, v192
 v_and_b32 v179, 0xffff0000, v192
 v_cmp_le_i32 vcc, 0, v9
 s_nop 1
 v_cndmask_b32 v160, v10, v160, vcc
 v_cmp_le_i32 vcc, 1, v9
 s_nop 1
 v_cndmask_b32 v161, v10, v161, vcc
 v_cmp_le_i32 vcc, 2, v9
 s_nop 1
 v_cndmask_b32 v162, v10, v162, vcc
 v_cmp_le_i32 vcc, 3, v9
 s_nop 1
 v_cndmask_b32 v163, v10, v163, vcc
 v_cmp_le_i32 vcc, 8, v9
 s_nop 1
 v_cndmask_b32 v164, v10, v164, vcc
 v_cmp_le_i32 vcc, 9, v9
 s_nop 1
 v_cndmask_b32 v165, v10, v165, vcc
 v_cmp_le_i32 vcc, 10, v9
 s_nop 1
 v_cndmask_b32 v166, v10, v166, vcc
 v_cmp_le_i32 vcc, 11, v9
 s_nop 1
 v_cndmask_b32 v167, v10, v167, vcc
 v_cmp_le_i32 vcc, 16, v9
 s_nop 1
 v_cndmask_b32 v168, v10, v168, vcc
 v_cmp_le_i32 vcc, 17, v9
 s_nop 1
 v_cndmask_b32 v169, v10, v169, vcc
 v_cmp_le_i32 vcc, 18, v9
 s_nop 1
 v_cndmask_b32 v170, v10, v170, vcc
 v_cmp_le_i32 vcc, 19, v9
 s_nop 1
 v_cndmask_b32 v171, v10, v171, vcc
 v_cmp_le_i32 vcc, 24, v9
 s_nop 1
 v_cndmask_b32 v172, v10, v172, vcc
 v_cmp_le_i32 vcc, 25, v9
 s_nop 1
 v_cndmask_b32 v173, v10, v173, vcc
 v_cmp_le_i32 vcc, 26, v9
 s_nop 1
 v_cndmask_b32 v174, v10, v174, vcc
 v_cmp_le_i32 vcc, 27, v9
 s_nop 1
 v_cndmask_b32 v175, v10, v175, vcc
 v_max3_f32 v192, v160, v161, v162
 v_max3_f32 v192, v192, v163, v164
 v_max3_f32 v192, v192, v165, v166
 v_max3_f32 v192, v192, v167, v168
 v_max3_f32 v192, v192, v169, v170
 v_max3_f32 v192, v192, v171, v172
 v_max3_f32 v192, v192, v173, v174
 v_max3_f32 v192, v192, v175, v176
 v_max3_f32 v192, v192, v177, v178
 v_max_f32 v192, v192, v179
 v_mov_b32 v193, v192
 s_nop 1
 v_permlane32_swap_b32 v192, v193
 v_max_f32 v192, v192, v193

 v_sub_f32 v160, v160, v192
 v_sub_f32 v161, v161, v192
 v_sub_f32 v162, v162, v192
 v_sub_f32 v163, v163, v192
 v_sub_f32 v164, v164, v192
 v_sub_f32 v165, v165, v192
 v_sub_f32 v166, v166, v192
 v_sub_f32 v167, v167, v192
 v_sub_f32 v168, v168, v192
 v_sub_f32 v169, v169, v192
 v_sub_f32 v170, v170, v192
 v_sub_f32 v171, v171, v192
 v_sub_f32 v172, v172, v192
 v_sub_f32 v173, v173, v192
 v_sub_f32 v174, v174, v192
 v_sub_f32 v175, v175, v192
 v_sub_f32 v176, v176, v192
 v_sub_f32 v177, v177, v192
 v_sub_f32 v178, v178, v192
 v_sub_f32 v179, v179, v192
 v_mul_f32 v160, s28, v160
 v_mul_f32 v161, s28, v161
 v_mul_f32 v162, s28, v162
 v_mul_f32 v163, s28, v163
 v_mul_f32 v164, s28, v164
 v_mul_f32 v165, s28, v165
 v_mul_f32 v166, s28, v166
 v_mul_f32 v167, s28, v167
 v_mul_f32 v168, s28, v168
 v_mul_f32 v169, s28, v169
 v_mul_f32 v170, s28, v170
 v_mul_f32 v171, s28, v171
 v_mul_f32 v172, s28, v172
 v_mul_f32 v173, s28, v173
 v_mul_f32 v174, s28, v174
 v_mul_f32 v175, s28, v175
 v_mul_f32 v176, s28, v176
 v_mul_f32 v177, s28, v177
 v_mul_f32 v178, s28, v178
 v_mul_f32 v179, s28, v179
 v_exp_f32 v160, v160
 v_exp_f32 v161, v161
 v_exp_f32 v162, v162
 v_exp_f32 v163, v163
 v_exp_f32 v164, v164
 v_exp_f32 v165, v165
 v_exp_f32 v166, v166
 v_exp_f32 v167, v167
 v_exp_f32 v168, v168
 v_exp_f32 v169, v169
 v_exp_f32 v170, v170
 v_exp_f32 v171, v171
 v_exp_f32 v172, v172
 v_exp_f32 v173, v173
 v_exp_f32 v174, v174
 v_exp_f32 v175, v175
 v_exp_f32 v176, v176
 v_exp_f32 v177, v177
 v_exp_f32 v178, v178
 v_exp_f32 v179, v179
 s_nop 0
 v_add_f32 v194, v160, v161
 v_add_f32 v194, v194, v162
 v_add_f32 v194, v194, v163
 v_add_f32 v194, v194, v164
 v_add_f32 v194, v194, v165
 v_add_f32 v194, v194, v166
 v_add_f32 v194, v194, v167
 v_add_f32 v194, v194, v168
 v_add_f32 v194, v194, v169
 v_add_f32 v194, v194, v170
 v_add_f32 v194, v194, v171
 v_add_f32 v194, v194, v172
 v_add_f32 v194, v194, v173
 v_add_f32 v194, v194, v174
 v_add_f32 v194, v194, v175
 v_add_f32 v194, v194, v176
 v_add_f32 v194, v194, v177
 v_add_f32 v194, v194, v178
 v_add_f32 v194, v194, v179
 v_mov_b32 v193, v194
 s_nop 1
 v_permlane32_swap_b32 v194, v193
 v_add_f32 v194, v194, v193
 v_rcp_f32 v194, v194
 s_nop 0

 v_mul_f32 v160, v160, v194
 v_mul_f32 v161, v161, v194
 v_mul_f32 v162, v162, v194
 v_mul_f32 v163, v163, v194
 v_mul_f32 v164, v164, v194
 v_mul_f32 v165, v165, v194
 v_mul_f32 v166, v166, v194
 v_mul_f32 v167, v167, v194
 v_mul_f32 v168, v168, v194
 v_mul_f32 v169, v169, v194
 v_mul_f32 v170, v170, v194
 v_mul_f32 v171, v171, v194
 v_mul_f32 v172, v172, v194
 v_mul_f32 v173, v173, v194
 v_mul_f32 v174, v174, v194
 v_mul_f32 v175, v175, v194
 v_mul_f32 v176, v176, v194
 v_mul_f32 v177, v177, v194
 v_mul_f32 v178, v178, v194
 v_mul_f32 v179, v179, v194
 v_cvt_pk_bf16_f32 v204, v176, v177
 v_cvt_pk_bf16_f32 v205, v178, v179
 v_mov_b32 v206, 0
 v_mov_b32 v207, 0

 v_cvt_pk_bf16_f32 v196, v160, v161
 v_cvt_pk_bf16_f32 v197, v162, v163
 v_cvt_pk_bf16_f32 v198, v164, v165
 v_cvt_pk_bf16_f32 v199, v166, v167
 v_cvt_pk_bf16_f32 v200, v168, v169
 v_cvt_pk_bf16_f32 v201, v170, v171
 v_cvt_pk_bf16_f32 v202, v172, v173
 v_cvt_pk_bf16_f32 v203, v174, v175
 s_nop 1
 v_permlane32_swap_b32 v196, v198
 v_permlane32_swap_b32 v197, v199
 v_permlane32_swap_b32 v200, v202
 v_permlane32_swap_b32 v201, v203
 v_permlane32_swap_b32 v204, v206
 v_permlane32_swap_b32 v205, v207
 s_nop 1
 v_mfma_f32_32x32x16_bf16 v[16:31], v[112:115], v[196:199], 0
 v_mfma_f32_32x32x16_bf16 v[32:47], v[120:123], v[196:199], 0
 v_mfma_f32_32x32x16_bf16 v[48:63], v[128:131], v[196:199], 0
 v_mfma_f32_32x32x16_bf16 v[64:79], v[136:139], v[196:199], 0
 v_mfma_f32_32x32x16_bf16 v[16:31], v[116:119], v[200:203], v[16:31]
 v_mfma_f32_32x32x16_bf16 v[32:47], v[124:127], v[200:203], v[32:47]
 v_mfma_f32_32x32x16_bf16 v[48:63], v[132:135], v[200:203], v[48:63]
 v_mfma_f32_32x32x16_bf16 v[64:79], v[140:143], v[200:203], v[64:79]
 v_mfma_f32_32x32x16_bf16 v[16:31], v[144:147], v[204:207], v[16:31]
 v_mfma_f32_32x32x16_bf16 v[32:47], v[148:151], v[204:207], v[32:47]
 v_mfma_f32_32x32x16_bf16 v[48:63], v[152:155], v[204:207], v[48:63]
 v_mfma_f32_32x32x16_bf16 v[64:79], v[156:159], v[204:207], v[64:79]
 s_nop 7
 s_nop 1
 v_cvt_pk_bf16_f32 v80, v16, v17
 v_cvt_pk_bf16_f32 v81, v18, v19
 v_cvt_pk_bf16_f32 v82, v20, v21
 v_cvt_pk_bf16_f32 v83, v22, v23
 v_cvt_pk_bf16_f32 v84, v24, v25
 v_cvt_pk_bf16_f32 v85, v26, v27
 v_cvt_pk_bf16_f32 v86, v28, v29
 v_cvt_pk_bf16_f32 v87, v30, v31
 ds_write_b64 v11, v[80:81] offset:0
 ds_write_b64 v11, v[82:83] offset:16
 ds_write_b64 v11, v[84:85] offset:32
 ds_write_b64 v11, v[86:87] offset:48
 v_cvt_pk_bf16_f32 v88, v32, v33
 v_cvt_pk_bf16_f32 v89, v34, v35
 v_cvt_pk_bf16_f32 v90, v36, v37
 v_cvt_pk_bf16_f32 v91, v38, v39
 v_cvt_pk_bf16_f32 v92, v40, v41
 v_cvt_pk_bf16_f32 v93, v42, v43
 v_cvt_pk_bf16_f32 v94, v44, v45
 v_cvt_pk_bf16_f32 v95, v46, v47
 ds_write_b64 v11, v[88:89] offset:64
 ds_write_b64 v11, v[90:91] offset:80
 ds_write_b64 v11, v[92:93] offset:96
 ds_write_b64 v11, v[94:95] offset:112
 v_cvt_pk_bf16_f32 v96, v48, v49
 v_cvt_pk_bf16_f32 v97, v50, v51
 v_cvt_pk_bf16_f32 v98, v52, v53
 v_cvt_pk_bf16_f32 v99, v54, v55
 v_cvt_pk_bf16_f32 v100, v56, v57
 v_cvt_pk_bf16_f32 v101, v58, v59
 v_cvt_pk_bf16_f32 v102, v60, v61
 v_cvt_pk_bf16_f32 v103, v62, v63
 ds_write_b64 v11, v[96:97] offset:128
 ds_write_b64 v11, v[98:99] offset:144
 ds_write_b64 v11, v[100:101] offset:160
 ds_write_b64 v11, v[102:103] offset:176
 v_cvt_pk_bf16_f32 v104, v64, v65
 v_cvt_pk_bf16_f32 v105, v66, v67
 v_cvt_pk_bf16_f32 v106, v68, v69
 v_cvt_pk_bf16_f32 v107, v70, v71
 v_cvt_pk_bf16_f32 v108, v72, v73
 v_cvt_pk_bf16_f32 v109, v74, v75
 v_cvt_pk_bf16_f32 v110, v76, v77
 v_cvt_pk_bf16_f32 v111, v78, v79
 ds_write_b64 v11, v[104:105] offset:192
 ds_write_b64 v11, v[106:107] offset:208
 ds_write_b64 v11, v[108:109] offset:224
 ds_write_b64 v11, v[110:111] offset:240
 s_waitcnt lgkmcnt(0)
 ds_read_b128 v[16:19], v12 offset:0
 ds_read_b128 v[20:23], v12 offset:32
 ds_read_b128 v[24:27], v12 offset:64
 ds_read_b128 v[28:31], v12 offset:96
 ds_read_b128 v[32:35], v12 offset:128
 ds_read_b128 v[36:39], v12 offset:160
 ds_read_b128 v[40:43], v12 offset:192
 ds_read_b128 v[44:47], v12 offset:224
 s_mov_b32 s37, s25
 s_waitcnt lgkmcnt(7)
 buffer_store_dwordx4 v[16:19], v13, s[4:7], s37 offen sc1
 s_add_u32 s37, s37, 1024
 s_waitcnt lgkmcnt(6)
 buffer_store_dwordx4 v[20:23], v13, s[4:7], s37 offen sc1
 s_add_u32 s37, s37, 1024
 s_waitcnt lgkmcnt(5)
 buffer_store_dwordx4 v[24:27], v13, s[4:7], s37 offen sc1
 s_add_u32 s37, s37, 1024
 s_waitcnt lgkmcnt(4)
 buffer_store_dwordx4 v[28:31], v13, s[4:7], s37 offen sc1
 s_add_u32 s37, s37, 1024
 s_waitcnt lgkmcnt(3)
 buffer_store_dwordx4 v[32:35], v13, s[4:7], s37 offen sc1
 s_add_u32 s37, s37, 1024
 s_waitcnt lgkmcnt(2)
 buffer_store_dwordx4 v[36:39], v13, s[4:7], s37 offen sc1
 s_add_u32 s37, s37, 1024
 s_waitcnt lgkmcnt(1)
 buffer_store_dwordx4 v[40:43], v13, s[4:7], s37 offen sc1
 s_add_u32 s37, s37, 1024
 s_waitcnt lgkmcnt(0)
 buffer_store_dwordx4 v[44:47], v13, s[4:7], s37 offen sc1
 s_add_u32 s37, s37, 1024
 s_nop 1
 s_cmp_lg_u32 s75, 0
 s_cbranch_scc1 mega_loop
 v_mfma_f32_32x32x16_bf16 v[160:175], a[32:35], a[0:3], 0
 v_mfma_f32_32x32x16_bf16 v[160:175], a[36:39], a[4:7], v[160:175]
 v_mfma_f32_32x32x16_bf16 v[160:175], a[40:43], a[8:11], v[160:175]
 v_mfma_f32_32x32x16_bf16 v[160:175], a[44:47], a[12:15], v[160:175]
 v_mfma_f32_32x32x16_bf16 v[160:175], a[48:51], a[16:19], v[160:175]
 v_mfma_f32_32x32x16_bf16 v[160:175], a[52:55], a[20:23], v[160:175]
 v_mfma_f32_32x32x16_bf16 v[160:175], a[56:59], a[24:27], v[160:175]
 v_mfma_f32_32x32x16_bf16 v[160:175], a[60:63], a[28:31], v[160:175]
 v_mfma_f32_32x32x16_bf16 v[176:191], v[208:211], a[0:3], 0
 v_mfma_f32_32x32x16_bf16 v[176:191], v[212:215], a[4:7], v[176:191]
 v_mfma_f32_32x32x16_bf16 v[176:191], v[216:219], a[8:11], v[176:191]
 v_mfma_f32_32x32x16_bf16 v[176:191], v[220:223], a[12:15], v[176:191]
 v_mfma_f32_32x32x16_bf16 v[176:191], v[224:227], a[16:19], v[176:191]
 v_mfma_f32_32x32x16_bf16 v[176:191], v[228:231], a[20:23], v[176:191]
 v_mfma_f32_32x32x16_bf16 v[176:191], v[232:235], a[24:27], v[176:191]
 v_mfma_f32_32x32x16_bf16 v[176:191], v[236:239], a[28:31], v[176:191]
 s_nop 7
 s_nop 7
 v_cvt_pk_bf16_f32 v192, v160, v161
 v_lshlrev_b32 v160, 16, v192
 v_and_b32 v161, 0xffff0000, v192
 v_mul_f32 v160, s27, v160
 v_mul_f32 v161, s27, v161
 v_cvt_pk_bf16_f32 v192, v160, v161
 v_lshlrev_b32 v160, 16, v192
 v_and_b32 v161, 0xffff0000, v192
 v_cvt_pk_bf16_f32 v192, v162, v163
 v_lshlrev_b32 v162, 16, v192
 v_and_b32 v163, 0xffff0000, v192
 v_mul_f32 v162, s27, v162
 v_mul_f32 v163, s27, v163
 v_cvt_pk_bf16_f32 v192, v162, v163
 v_lshlrev_b32 v162, 16, v192
 v_and_b32 v163, 0xffff0000, v192
 v_cvt_pk_bf16_f32 v192, v164, v165
 v_lshlrev_b32 v164, 16, v192
 v_and_b32 v165, 0xffff0000, v192
 v_mul_f32 v164, s27, v164
 v_mul_f32 v165, s27, v165
 v_cvt_pk_bf16_f32 v192, v164, v165
 v_lshlrev_b32 v164, 16, v192
 v_and_b32 v165, 0xffff0000, v192
 v_cvt_pk_bf16_f32 v192, v166, v167
 v_lshlrev_b32 v166, 16, v192
 v_and_b32 v167, 0xffff0000, v192
 v_mul_f32 v166, s27, v166
 v_mul_f32 v167, s27, v167
 v_cvt_pk_bf16_f32 v192, v166, v167
 v_lshlrev_b32 v166, 16, v192
 v_and_b32 v167, 0xffff0000, v192
 v_cvt_pk_bf16_f32 v192, v168, v169
 v_lshlrev_b32 v168, 16, v192
 v_and_b32 v169, 0xffff0000, v192
 v_mul_f32 v168, s27, v168
 v_mul_f32 v169, s27, v169
 v_cvt_pk_bf16_f32 v192, v168, v169
 v_lshlrev_b32 v168, 16, v192
 v_and_b32 v169, 0xffff0000, v192
 v_cvt_pk_bf16_f32 v192, v170, v171
 v_lshlrev_b32 v170, 16, v192
 v_and_b32 v171, 0xffff0000, v192
 v_mul_f32 v170, s27, v170
 v_mul_f32 v171, s27, v171
 v_cvt_pk_bf16_f32 v192, v170, v171
 v_lshlrev_b32 v170, 16, v192
 v_and_b32 v171, 0xffff0000, v192
 v_cvt_pk_bf16_f32 v192, v172, v173
 v_lshlrev_b32 v172, 16, v192
 v_and_b32 v173, 0xffff0000, v192
 v_mul_f32 v172, s27, v172
 v_mul_f32 v173, s27, v173
 v_cvt_pk_bf16_f32 v192, v172, v173
 v_lshlrev_b32 v172, 16, v192
 v_and_b32 v173, 0xffff0000, v192
 v_cvt_pk_bf16_f32 v192, v174, v175
 v_lshlrev_b32 v174, 16, v192
 v_and_b32 v175, 0xffff0000, v192
 v_mul_f32 v174, s27, v174
 v_mul_f32 v175, s27, v175
 v_cvt_pk_bf16_f32 v192, v174, v175
 v_lshlrev_b32 v174, 16, v192
 v_and_b32 v175, 0xffff0000, v192
 v_cvt_pk_bf16_f32 v192, v176, v177
 v_lshlrev_b32 v176, 16, v192
 v_and_b32 v177, 0xffff0000, v192
 v_mul_f32 v176, s27, v176
 v_mul_f32 v177, s27, v177
 v_cvt_pk_bf16_f32 v192, v176, v177
 v_lshlrev_b32 v176, 16, v192
 v_and_b32 v177, 0xffff0000, v192
 v_cvt_pk_bf16_f32 v192, v178, v179
 v_lshlrev_b32 v178, 16, v192
 v_and_b32 v179, 0xffff0000, v192
 v_mul_f32 v178, s27, v178
 v_mul_f32 v179, s27, v179
 v_cvt_pk_bf16_f32 v192, v178, v179
 v_lshlrev_b32 v178, 16, v192
 v_and_b32 v179, 0xffff0000, v192
 v_cmp_le_i32 vcc, 0, v9
 s_nop 1
 v_cndmask_b32 v160, v10, v160, vcc
 v_cmp_le_i32 vcc, 1, v9
 s_nop 1
 v_cndmask_b32 v161, v10, v161, vcc
 v_cmp_le_i32 vcc, 2, v9
 s_nop 1
 v_cndmask_b32 v162, v10, v162, vcc
 v_cmp_le_i32 vcc, 3, v9
 s_nop 1
 v_cndmask_b32 v163, v10, v163, vcc
 v_cmp_le_i32 vcc, 8, v9
 s_nop 1
 v_cndmask_b32 v164, v10, v164, vcc
 v_cmp_le_i32 vcc, 9, v9
 s_nop 1
 v_cndmask_b32 v165, v10, v165, vcc
 v_cmp_le_i32 vcc, 10, v9
 s_nop 1
 v_cndmask_b32 v166, v10, v166, vcc
 v_cmp_le_i32 vcc, 11, v9
 s_nop 1
 v_cndmask_b32 v167, v10, v167, vcc
 v_cmp_le_i32 vcc, 16, v9
 s_nop 1
 v_cndmask_b32 v168, v10, v168, vcc
 v_cmp_le_i32 vcc, 17, v9
 s_nop 1
 v_cndmask_b32 v169, v10, v169, vcc
 v_cmp_le_i32 vcc, 18, v9
 s_nop 1
 v_cndmask_b32 v170, v10, v170, vcc
 v_cmp_le_i32 vcc, 19, v9
 s_nop 1
 v_cndmask_b32 v171, v10, v171, vcc
 v_cmp_le_i32 vcc, 24, v9
 s_nop 1
 v_cndmask_b32 v172, v10, v172, vcc
 v_cmp_le_i32 vcc, 25, v9
 s_nop 1
 v_cndmask_b32 v173, v10, v173, vcc
 v_cmp_le_i32 vcc, 26, v9
 s_nop 1
 v_cndmask_b32 v174, v10, v174, vcc
 v_cmp_le_i32 vcc, 27, v9
 s_nop 1
 v_cndmask_b32 v175, v10, v175, vcc
 v_max3_f32 v192, v160, v161, v162
 v_max3_f32 v192, v192, v163, v164
 v_max3_f32 v192, v192, v165, v166
 v_max3_f32 v192, v192, v167, v168
 v_max3_f32 v192, v192, v169, v170
 v_max3_f32 v192, v192, v171, v172
 v_max3_f32 v192, v192, v173, v174
 v_max3_f32 v192, v192, v175, v176
 v_max3_f32 v192, v192, v177, v178
 v_max_f32 v192, v192, v179
 v_mov_b32 v193, v192
 s_nop 1
 v_permlane32_swap_b32 v192, v193
 v_max_f32 v192, v192, v193

 v_sub_f32 v160, v160, v192
 v_sub_f32 v161, v161, v192
 v_sub_f32 v162, v162, v192
 v_sub_f32 v163, v163, v192
 v_sub_f32 v164, v164, v192
 v_sub_f32 v165, v165, v192
 v_sub_f32 v166, v166, v192
 v_sub_f32 v167, v167, v192
 v_sub_f32 v168, v168, v192
 v_sub_f32 v169, v169, v192
 v_sub_f32 v170, v170, v192
 v_sub_f32 v171, v171, v192
 v_sub_f32 v172, v172, v192
 v_sub_f32 v173, v173, v192
 v_sub_f32 v174, v174, v192
 v_sub_f32 v175, v175, v192
 v_sub_f32 v176, v176, v192
 v_sub_f32 v177, v177, v192
 v_sub_f32 v178, v178, v192
 v_sub_f32 v179, v179, v192
 v_mul_f32 v160, s28, v160
 v_mul_f32 v161, s28, v161
 v_mul_f32 v162, s28, v162
 v_mul_f32 v163, s28, v163
 v_mul_f32 v164, s28, v164
 v_mul_f32 v165, s28, v165
 v_mul_f32 v166, s28, v166
 v_mul_f32 v167, s28, v167
 v_mul_f32 v168, s28, v168
 v_mul_f32 v169, s28, v169
 v_mul_f32 v170, s28, v170
 v_mul_f32 v171, s28, v171
 v_mul_f32 v172, s28, v172
 v_mul_f32 v173, s28, v173
 v_mul_f32 v174, s28, v174
 v_mul_f32 v175, s28, v175
 v_mul_f32 v176, s28, v176
 v_mul_f32 v177, s28, v177
 v_mul_f32 v178, s28, v178
 v_mul_f32 v179, s28, v179
 v_exp_f32 v160, v160
 v_exp_f32 v161, v161
 v_exp_f32 v162, v162
 v_exp_f32 v163, v163
 v_exp_f32 v164, v164
 v_exp_f32 v165, v165
 v_exp_f32 v166, v166
 v_exp_f32 v167, v167
 v_exp_f32 v168, v168
 v_exp_f32 v169, v169
 v_exp_f32 v170, v170
 v_exp_f32 v171, v171
 v_exp_f32 v172, v172
 v_exp_f32 v173, v173
 v_exp_f32 v174, v174
 v_exp_f32 v175, v175
 v_exp_f32 v176, v176
 v_exp_f32 v177, v177
 v_exp_f32 v178, v178
 v_exp_f32 v179, v179
 s_nop 0
 v_add_f32 v194, v160, v161
 v_add_f32 v194, v194, v162
 v_add_f32 v194, v194, v163
 v_add_f32 v194, v194, v164
 v_add_f32 v194, v194, v165
 v_add_f32 v194, v194, v166
 v_add_f32 v194, v194, v167
 v_add_f32 v194, v194, v168
 v_add_f32 v194, v194, v169
 v_add_f32 v194, v194, v170
 v_add_f32 v194, v194, v171
 v_add_f32 v194, v194, v172
 v_add_f32 v194, v194, v173
 v_add_f32 v194, v194, v174
 v_add_f32 v194, v194, v175
 v_add_f32 v194, v194, v176
 v_add_f32 v194, v194, v177
 v_add_f32 v194, v194, v178
 v_add_f32 v194, v194, v179
 v_mov_b32 v193, v194
 s_nop 1
 v_permlane32_swap_b32 v194, v193
 v_add_f32 v194, v194, v193
 v_rcp_f32 v194, v194
 s_nop 0

 v_mul_f32 v160, v160, v194
 v_mul_f32 v161, v161, v194
 v_mul_f32 v162, v162, v194
 v_mul_f32 v163, v163, v194
 v_mul_f32 v164, v164, v194
 v_mul_f32 v165, v165, v194
 v_mul_f32 v166, v166, v194
 v_mul_f32 v167, v167, v194
 v_mul_f32 v168, v168, v194
 v_mul_f32 v169, v169, v194
 v_mul_f32 v170, v170, v194
 v_mul_f32 v171, v171, v194
 v_mul_f32 v172, v172, v194
 v_mul_f32 v173, v173, v194
 v_mul_f32 v174, v174, v194
 v_mul_f32 v175, v175, v194
 v_mul_f32 v176, v176, v194
 v_mul_f32 v177, v177, v194
 v_mul_f32 v178, v178, v194
 v_mul_f32 v179, v179, v194
 v_cvt_pk_bf16_f32 v204, v176, v177
 v_cvt_pk_bf16_f32 v205, v178, v179
 v_mov_b32 v206, 0
 v_mov_b32 v207, 0

 v_cvt_pk_bf16_f32 v196, v160, v161
 v_cvt_pk_bf16_f32 v197, v162, v163
 v_cvt_pk_bf16_f32 v198, v164, v165
 v_cvt_pk_bf16_f32 v199, v166, v167
 v_cvt_pk_bf16_f32 v200, v168, v169
 v_cvt_pk_bf16_f32 v201, v170, v171
 v_cvt_pk_bf16_f32 v202, v172, v173
 v_cvt_pk_bf16_f32 v203, v174, v175
 s_nop 1
 v_permlane32_swap_b32 v196, v198
 v_permlane32_swap_b32 v197, v199
 v_permlane32_swap_b32 v200, v202
 v_permlane32_swap_b32 v201, v203
 v_permlane32_swap_b32 v204, v206
 v_permlane32_swap_b32 v205, v207
 s_nop 1
 v_mfma_f32_32x32x16_bf16 v[16:31], a[64:67], v[196:199], 0
 v_mfma_f32_32x32x16_bf16 v[32:47], a[72:75], v[196:199], 0
 v_mfma_f32_32x32x16_bf16 v[48:63], a[80:83], v[196:199], 0
 v_mfma_f32_32x32x16_bf16 v[64:79], a[88:91], v[196:199], 0
 v_mfma_f32_32x32x16_bf16 v[16:31], a[68:71], v[200:203], v[16:31]
 v_mfma_f32_32x32x16_bf16 v[32:47], a[76:79], v[200:203], v[32:47]
 v_mfma_f32_32x32x16_bf16 v[48:63], a[84:87], v[200:203], v[48:63]
 v_mfma_f32_32x32x16_bf16 v[64:79], a[92:95], v[200:203], v[64:79]
 v_mfma_f32_32x32x16_bf16 v[16:31], v[240:243], v[204:207], v[16:31]
 v_mfma_f32_32x32x16_bf16 v[32:47], v[244:247], v[204:207], v[32:47]
 v_mfma_f32_32x32x16_bf16 v[48:63], v[248:251], v[204:207], v[48:63]
 v_mfma_f32_32x32x16_bf16 v[64:79], v[252:255], v[204:207], v[64:79]
 s_nop 7
 s_nop 1
 v_cvt_pk_bf16_f32 v80, v16, v17
 v_cvt_pk_bf16_f32 v81, v18, v19
 v_cvt_pk_bf16_f32 v82, v20, v21
 v_cvt_pk_bf16_f32 v83, v22, v23
 v_cvt_pk_bf16_f32 v84, v24, v25
 v_cvt_pk_bf16_f32 v85, v26, v27
 v_cvt_pk_bf16_f32 v86, v28, v29
 v_cvt_pk_bf16_f32 v87, v30, v31
 ds_write_b64 v11, v[80:81] offset:0
 ds_write_b64 v11, v[82:83] offset:16
 ds_write_b64 v11, v[84:85] offset:32
 ds_write_b64 v11, v[86:87] offset:48
 v_cvt_pk_bf16_f32 v88, v32, v33
 v_cvt_pk_bf16_f32 v89, v34, v35
 v_cvt_pk_bf16_f32 v90, v36, v37
 v_cvt_pk_bf16_f32 v91, v38, v39
 v_cvt_pk_bf16_f32 v92, v40, v41
 v_cvt_pk_bf16_f32 v93, v42, v43
 v_cvt_pk_bf16_f32 v94, v44, v45
 v_cvt_pk_bf16_f32 v95, v46, v47
 ds_write_b64 v11, v[88:89] offset:64
 ds_write_b64 v11, v[90:91] offset:80
 ds_write_b64 v11, v[92:93] offset:96
 ds_write_b64 v11, v[94:95] offset:112
 v_cvt_pk_bf16_f32 v96, v48, v49
 v_cvt_pk_bf16_f32 v97, v50, v51
 v_cvt_pk_bf16_f32 v98, v52, v53
 v_cvt_pk_bf16_f32 v99, v54, v55
 v_cvt_pk_bf16_f32 v100, v56, v57
 v_cvt_pk_bf16_f32 v101, v58, v59
 v_cvt_pk_bf16_f32 v102, v60, v61
 v_cvt_pk_bf16_f32 v103, v62, v63
 ds_write_b64 v11, v[96:97] offset:128
 ds_write_b64 v11, v[98:99] offset:144
 ds_write_b64 v11, v[100:101] offset:160
 ds_write_b64 v11, v[102:103] offset:176
 v_cvt_pk_bf16_f32 v104, v64, v65
 v_cvt_pk_bf16_f32 v105, v66, v67
 v_cvt_pk_bf16_f32 v106, v68, v69
 v_cvt_pk_bf16_f32 v107, v70, v71
 v_cvt_pk_bf16_f32 v108, v72, v73
 v_cvt_pk_bf16_f32 v109, v74, v75
 v_cvt_pk_bf16_f32 v110, v76, v77
 v_cvt_pk_bf16_f32 v111, v78, v79
 ds_write_b64 v11, v[104:105] offset:192
 ds_write_b64 v11, v[106:107] offset:208
 ds_write_b64 v11, v[108:109] offset:224
 ds_write_b64 v11, v[110:111] offset:240
 s_waitcnt lgkmcnt(0)
 ds_read_b128 v[16:19], v12 offset:0
 ds_read_b128 v[20:23], v12 offset:32
 ds_read_b128 v[24:27], v12 offset:64
 ds_read_b128 v[28:31], v12 offset:96
 ds_read_b128 v[32:35], v12 offset:128
 ds_read_b128 v[36:39], v12 offset:160
 ds_read_b128 v[40:43], v12 offset:192
 ds_read_b128 v[44:47], v12 offset:224
 s_mov_b32 s37, s36
 s_waitcnt lgkmcnt(7)
 buffer_store_dwordx4 v[16:19], v13, s[4:7], s37 offen sc1
 s_add_u32 s37, s37, 1024
 s_waitcnt lgkmcnt(6)
 buffer_store_dwordx4 v[20:23], v13, s[4:7], s37 offen sc1
 s_add_u32 s37, s37, 1024
 s_waitcnt lgkmcnt(5)
 buffer_store_dwordx4 v[24:27], v13, s[4:7], s37 offen sc1
 s_add_u32 s37, s37, 1024
 s_waitcnt lgkmcnt(4)
 buffer_store_dwordx4 v[28:31], v13, s[4:7], s37 offen sc1
 s_add_u32 s37, s37, 1024
 s_waitcnt lgkmcnt(3)
 buffer_store_dwordx4 v[32:35], v13, s[4:7], s37 offen sc1
 s_add_u32 s37, s37, 1024
 s_waitcnt lgkmcnt(2)
 buffer_store_dwordx4 v[36:39], v13, s[4:7], s37 offen sc1
 s_add_u32 s37, s37, 1024
 s_waitcnt lgkmcnt(1)
 buffer_store_dwordx4 v[40:43], v13, s[4:7], s37 offen sc1
 s_add_u32 s37, s37, 1024
 s_waitcnt lgkmcnt(0)
 buffer_store_dwordx4 v[44:47], v13, s[4:7], s37 offen sc1
 s_add_u32 s37, s37, 1024
 s_nop 1
 s_branch mega_loop
t_ln:
 s_load_dwordx2 s[14:15], s[0:1], 96
 v_and_b32 v1, 63, v0
 v_lshrrev_b32 v2, 6, v0
 s_lshl_b32 s3, s93, 3
 s_lshl_b32 s34, s92, 7
 s_add_u32 s3, s3, s34
 v_lshl_add_u32 v2, v2, 1, s3
 v_lshlrev_b32 v2, 11, v2
 v_lshl_add_u32 v2, v1, 4, v2
 s_mov_b32 s24, 71303168
 s_waitcnt lgkmcnt(0)

 s_mov_b32 s8, s14
 s_and_b32 s9, s15, 0xffff
 s_mov_b32 s10, 0x10000000
 s_mov_b32 s11, 0x00020000
 buffer_load_dwordx4 v[32:35], v2, s[8:11], s24 offen offset:0 sc1
 buffer_load_dwordx4 v[36:39], v2, s[8:11], s24 offen offset:1024 sc1
 buffer_load_dwordx4 v[40:43], v2, s[8:11], s24 offen offset:2048 sc1
 buffer_load_dwordx4 v[44:47], v2, s[8:11], s24 offen offset:3072 sc1
 v_lshrrev_b32 v27, 6, v0
 v_mul_u32_u24 v24, 4128, v27
 v_lshl_add_u32 v24, v1, 4, v24
 v_and_b32 v28, 7, v1
 v_lshrrev_b32 v29, 3, v1
 v_lshl_add_u32 v29, v27, 5, v29
 v_mul_u32_u24 v25, 2064, v28
 v_lshl_add_u32 v25, v29, 4, v25
 v_lshlrev_b32 v26, 9, v29
 v_lshl_add_u32 v26, v28, 4, v26
 s_lshr_b32 s36, s3, 5
 s_lshl_b32 s36, s36, 16
 s_and_b32 s37, s3, 31
 s_lshl_b32 s37, s37, 4
 s_add_u32 s36, s36, s37
 v_add_u32 v26, s36, v26

 s_waitcnt vmcnt(2)
 v_lshlrev_b32 v8, 16, v32
 v_and_b32 v9, 0xffff0000, v32
 v_lshlrev_b32 v10, 16, v33
 v_and_b32 v11, 0xffff0000, v33
 v_lshlrev_b32 v12, 16, v34
 v_and_b32 v13, 0xffff0000, v34
 v_lshlrev_b32 v14, 16, v35
 v_and_b32 v15, 0xffff0000, v35
 v_lshlrev_b32 v16, 16, v36
 v_and_b32 v17, 0xffff0000, v36
 v_lshlrev_b32 v18, 16, v37
 v_and_b32 v19, 0xffff0000, v37
 v_lshlrev_b32 v20, 16, v38
 v_and_b32 v21, 0xffff0000, v38
 v_lshlrev_b32 v22, 16, v39
 v_and_b32 v23, 0xffff0000, v39
 v_add_f32 v4, v8, v9
 v_add_f32 v4, v4, v10
 v_add_f32 v4, v4, v11
 v_add_f32 v4, v4, v12
 v_add_f32 v4, v4, v13
 v_add_f32 v4, v4, v14
 v_add_f32 v4, v4, v15
 v_add_f32 v4, v4, v16
 v_add_f32 v4, v4, v17
 v_add_f32 v4, v4, v18
 v_add_f32 v4, v4, v19
 v_add_f32 v4, v4, v20
 v_add_f32 v4, v4, v21
 v_add_f32 v4, v4, v22
 v_add_f32 v4, v4, v23
 s_nop 1
 v_add_f32_dpp v4, v4, v4 row_ror:8 row_mask:0xf bank_mask:0xf
 s_nop 1
 v_add_f32_dpp v4, v4, v4 row_ror:4 row_mask:0xf bank_mask:0xf
 s_nop 1
 v_add_f32_dpp v4, v4, v4 row_ror:2 row_mask:0xf bank_mask:0xf
 s_nop 1
 v_add_f32_dpp v4, v4, v4 row_ror:1 row_mask:0xf bank_mask:0xf
 v_mov_b32 v5, v4
 s_nop 1
 v_permlane16_swap_b32 v4, v5
 v_add_f32 v4, v4, v5
 v_mov_b32 v5, v4
 s_nop 1
 v_permlane32_swap_b32 v4, v5
 v_add_f32 v4, v4, v5
 v_mul_f32 v6, 0x3a800000, v4
 v_mov_b32 v7, 0
 v_sub_f32 v5, v8, v6
 v_fmac_f32 v7, v5, v5
 v_sub_f32 v5, v9, v6
 v_fmac_f32 v7, v5, v5
 v_sub_f32 v5, v10, v6
 v_fmac_f32 v7, v5, v5
 v_sub_f32 v5, v11, v6
 v_fmac_f32 v7, v5, v5
 v_sub_f32 v5, v12, v6
 v_fmac_f32 v7, v5, v5
 v_sub_f32 v5, v13, v6
 v_fmac_f32 v7, v5, v5
 v_sub_f32 v5, v14, v6
 v_fmac_f32 v7, v5, v5
 v_sub_f32 v5, v15, v6
 v_fmac_f32 v7, v5, v5
 v_sub_f32 v5, v16, v6
 v_fmac_f32 v7, v5, v5
 v_sub_f32 v5, v17, v6
 v_fmac_f32 v7, v5, v5
 v_sub_f32 v5, v18, v6
 v_fmac_f32 v7, v5, v5
 v_sub_f32 v5, v19, v6
 v_fmac_f32 v7, v5, v5
 v_sub_f32 v5, v20, v6
 v_fmac_f32 v7, v5, v5
 v_sub_f32 v5, v21, v6
 v_fmac_f32 v7, v5, v5
 v_sub_f32 v5, v22, v6
 v_fmac_f32 v7, v5, v5
 v_sub_f32 v5, v23, v6
 v_fmac_f32 v7, v5, v5
 s_nop 1
 v_add_f32_dpp v7, v7, v7 row_ror:8 row_mask:0xf bank_mask:0xf
 s_nop 1
 v_add_f32_dpp v7, v7, v7 row_ror:4 row_mask:0xf bank_mask:0xf
 s_nop 1
 v_add_f32_dpp v7, v7, v7 row_ror:2 row_mask:0xf bank_mask:0xf
 s_nop 1
 v_add_f32_dpp v7, v7, v7 row_ror:1 row_mask:0xf bank_mask:0xf
 v_mov_b32 v5, v7
 s_nop 1
 v_permlane16_swap_b32 v7, v5
 v_add_f32 v7, v7, v5
 v_mov_b32 v5, v7
 s_nop 1
 v_permlane32_swap_b32 v7, v5
 v_add_f32 v7, v7, v5
 v_mul_f32 v7, 0x3a800000, v7
 v_cvt_pk_bf16_f32 v7, v7, v7
 v_lshlrev_b32 v7, 16, v7
 v_add_f32 v7, 0x3727c5ac, v7
 v_cvt_pk_bf16_f32 v7, v7, v7
 v_lshlrev_b32 v7, 16, v7
 v_sqrt_f32 v7, v7
 s_nop 0
 v_cvt_pk_bf16_f32 v7, v7, v7
 v_lshlrev_b32 v7, 16, v7
 v_rcp_f32 v7, v7
 v_cvt_pk_bf16_f32 v6, v6, v6
 v_lshlrev_b32 v6, 16, v6
 v_sub_f32 v8, v8, v6
 v_sub_f32 v9, v9, v6
 v_cvt_pk_bf16_f32 v5, v8, v9
 v_lshlrev_b32 v8, 16, v5
 v_and_b32 v9, 0xffff0000, v5
 v_mul_f32 v8, v8, v7
 v_mul_f32 v9, v9, v7
 v_cvt_pk_bf16_f32 v32, v8, v9
 v_sub_f32 v10, v10, v6
 v_sub_f32 v11, v11, v6
 v_cvt_pk_bf16_f32 v5, v10, v11
 v_lshlrev_b32 v10, 16, v5
 v_and_b32 v11, 0xffff0000, v5
 v_mul_f32 v10, v10, v7
 v_mul_f32 v11, v11, v7
 v_cvt_pk_bf16_f32 v33, v10, v11
 v_sub_f32 v12, v12, v6
 v_sub_f32 v13, v13, v6
 v_cvt_pk_bf16_f32 v5, v12, v13
 v_lshlrev_b32 v12, 16, v5
 v_and_b32 v13, 0xffff0000, v5
 v_mul_f32 v12, v12, v7
 v_mul_f32 v13, v13, v7
 v_cvt_pk_bf16_f32 v34, v12, v13
 v_sub_f32 v14, v14, v6
 v_sub_f32 v15, v15, v6
 v_cvt_pk_bf16_f32 v5, v14, v15
 v_lshlrev_b32 v14, 16, v5
 v_and_b32 v15, 0xffff0000, v5
 v_mul_f32 v14, v14, v7
 v_mul_f32 v15, v15, v7
 v_cvt_pk_bf16_f32 v35, v14, v15
 v_sub_f32 v16, v16, v6
 v_sub_f32 v17, v17, v6
 v_cvt_pk_bf16_f32 v5, v16, v17
 v_lshlrev_b32 v16, 16, v5
 v_and_b32 v17, 0xffff0000, v5
 v_mul_f32 v16, v16, v7
 v_mul_f32 v17, v17, v7
 v_cvt_pk_bf16_f32 v36, v16, v17
 v_sub_f32 v18, v18, v6
 v_sub_f32 v19, v19, v6
 v_cvt_pk_bf16_f32 v5, v18, v19
 v_lshlrev_b32 v18, 16, v5
 v_and_b32 v19, 0xffff0000, v5
 v_mul_f32 v18, v18, v7
 v_mul_f32 v19, v19, v7
 v_cvt_pk_bf16_f32 v37, v18, v19
 v_sub_f32 v20, v20, v6
 v_sub_f32 v21, v21, v6
 v_cvt_pk_bf16_f32 v5, v20, v21
 v_lshlrev_b32 v20, 16, v5
 v_and_b32 v21, 0xffff0000, v5
 v_mul_f32 v20, v20, v7
 v_mul_f32 v21, v21, v7
 v_cvt_pk_bf16_f32 v38, v20, v21
 v_sub_f32 v22, v22, v6
 v_sub_f32 v23, v23, v6
 v_cvt_pk_bf16_f32 v5, v22, v23
 v_lshlrev_b32 v22, 16, v5
 v_and_b32 v23, 0xffff0000, v5
 v_mul_f32 v22, v22, v7
 v_mul_f32 v23, v23, v7
 v_cvt_pk_bf16_f32 v39, v22, v23
 s_waitcnt vmcnt(0)
 v_lshlrev_b32 v8, 16, v40
 v_and_b32 v9, 0xffff0000, v40
 v_lshlrev_b32 v10, 16, v41
 v_and_b32 v11, 0xffff0000, v41
 v_lshlrev_b32 v12, 16, v42
 v_and_b32 v13, 0xffff0000, v42
 v_lshlrev_b32 v14, 16, v43
 v_and_b32 v15, 0xffff0000, v43
 v_lshlrev_b32 v16, 16, v44
 v_and_b32 v17, 0xffff0000, v44
 v_lshlrev_b32 v18, 16, v45
 v_and_b32 v19, 0xffff0000, v45
 v_lshlrev_b32 v20, 16, v46
 v_and_b32 v21, 0xffff0000, v46
 v_lshlrev_b32 v22, 16, v47
 v_and_b32 v23, 0xffff0000, v47
 v_add_f32 v4, v8, v9
 v_add_f32 v4, v4, v10
 v_add_f32 v4, v4, v11
 v_add_f32 v4, v4, v12
 v_add_f32 v4, v4, v13
 v_add_f32 v4, v4, v14
 v_add_f32 v4, v4, v15
 v_add_f32 v4, v4, v16
 v_add_f32 v4, v4, v17
 v_add_f32 v4, v4, v18
 v_add_f32 v4, v4, v19
 v_add_f32 v4, v4, v20
 v_add_f32 v4, v4, v21
 v_add_f32 v4, v4, v22
 v_add_f32 v4, v4, v23
 s_nop 1
 v_add_f32_dpp v4, v4, v4 row_ror:8 row_mask:0xf bank_mask:0xf
 s_nop 1
 v_add_f32_dpp v4, v4, v4 row_ror:4 row_mask:0xf bank_mask:0xf
 s_nop 1
 v_add_f32_dpp v4, v4, v4 row_ror:2 row_mask:0xf bank_mask:0xf
 s_nop 1
 v_add_f32_dpp v4, v4, v4 row_ror:1 row_mask:0xf bank_mask:0xf
 v_mov_b32 v5, v4
 s_nop 1
 v_permlane16_swap_b32 v4, v5
 v_add_f32 v4, v4, v5
 v_mov_b32 v5, v4
 s_nop 1
 v_permlane32_swap_b32 v4, v5
 v_add_f32 v4, v4, v5
 v_mul_f32 v6, 0x3a800000, v4
 v_mov_b32 v7, 0
 v_sub_f32 v5, v8, v6
 v_fmac_f32 v7, v5, v5
 v_sub_f32 v5, v9, v6
 v_fmac_f32 v7, v5, v5
 v_sub_f32 v5, v10, v6
 v_fmac_f32 v7, v5, v5
 v_sub_f32 v5, v11, v6
 v_fmac_f32 v7, v5, v5
 v_sub_f32 v5, v12, v6
 v_fmac_f32 v7, v5, v5
 v_sub_f32 v5, v13, v6
 v_fmac_f32 v7, v5, v5
 v_sub_f32 v5, v14, v6
 v_fmac_f32 v7, v5, v5
 v_sub_f32 v5, v15, v6
 v_fmac_f32 v7, v5, v5
 v_sub_f32 v5, v16, v6
 v_fmac_f32 v7, v5, v5
 v_sub_f32 v5, v17, v6
 v_fmac_f32 v7, v5, v5
 v_sub_f32 v5, v18, v6
 v_fmac_f32 v7, v5, v5
 v_sub_f32 v5, v19, v6
 v_fmac_f32 v7, v5, v5
 v_sub_f32 v5, v20, v6
 v_fmac_f32 v7, v5, v5
 v_sub_f32 v5, v21, v6
 v_fmac_f32 v7, v5, v5
 v_sub_f32 v5, v22, v6
 v_fmac_f32 v7, v5, v5
 v_sub_f32 v5, v23, v6
 v_fmac_f32 v7, v5, v5
 s_nop 1
 v_add_f32_dpp v7, v7, v7 row_ror:8 row_mask:0xf bank_mask:0xf
 s_nop 1
 v_add_f32_dpp v7, v7, v7 row_ror:4 row_mask:0xf bank_mask:0xf
 s_nop 1
 v_add_f32_dpp v7, v7, v7 row_ror:2 row_mask:0xf bank_mask:0xf
 s_nop 1
 v_add_f32_dpp v7, v7, v7 row_ror:1 row_mask:0xf bank_mask:0xf
 v_mov_b32 v5, v7
 s_nop 1
 v_permlane16_swap_b32 v7, v5
 v_add_f32 v7, v7, v5
 v_mov_b32 v5, v7
 s_nop 1
 v_permlane32_swap_b32 v7, v5
 v_add_f32 v7, v7, v5
 v_mul_f32 v7, 0x3a800000, v7
 v_cvt_pk_bf16_f32 v7, v7, v7
 v_lshlrev_b32 v7, 16, v7
 v_add_f32 v7, 0x3727c5ac, v7
 v_cvt_pk_bf16_f32 v7, v7, v7
 v_lshlrev_b32 v7, 16, v7
 v_sqrt_f32 v7, v7
 s_nop 0
 v_cvt_pk_bf16_f32 v7, v7, v7
 v_lshlrev_b32 v7, 16, v7
 v_rcp_f32 v7, v7
 v_cvt_pk_bf16_f32 v6, v6, v6
 v_lshlrev_b32 v6, 16, v6
 v_sub_f32 v8, v8, v6
 v_sub_f32 v9, v9, v6
 v_cvt_pk_bf16_f32 v5, v8, v9
 v_lshlrev_b32 v8, 16, v5
 v_and_b32 v9, 0xffff0000, v5
 v_mul_f32 v8, v8, v7
 v_mul_f32 v9, v9, v7
 v_cvt_pk_bf16_f32 v40, v8, v9
 v_sub_f32 v10, v10, v6
 v_sub_f32 v11, v11, v6
 v_cvt_pk_bf16_f32 v5, v10, v11
 v_lshlrev_b32 v10, 16, v5
 v_and_b32 v11, 0xffff0000, v5
 v_mul_f32 v10, v10, v7
 v_mul_f32 v11, v11, v7
 v_cvt_pk_bf16_f32 v41, v10, v11
 v_sub_f32 v12, v12, v6
 v_sub_f32 v13, v13, v6
 v_cvt_pk_bf16_f32 v5, v12, v13
 v_lshlrev_b32 v12, 16, v5
 v_and_b32 v13, 0xffff0000, v5
 v_mul_f32 v12, v12, v7
 v_mul_f32 v13, v13, v7
 v_cvt_pk_bf16_f32 v42, v12, v13
 v_sub_f32 v14, v14, v6
 v_sub_f32 v15, v15, v6
 v_cvt_pk_bf16_f32 v5, v14, v15
 v_lshlrev_b32 v14, 16, v5
 v_and_b32 v15, 0xffff0000, v5
 v_mul_f32 v14, v14, v7
 v_mul_f32 v15, v15, v7
 v_cvt_pk_bf16_f32 v43, v14, v15
 v_sub_f32 v16, v16, v6
 v_sub_f32 v17, v17, v6
 v_cvt_pk_bf16_f32 v5, v16, v17
 v_lshlrev_b32 v16, 16, v5
 v_and_b32 v17, 0xffff0000, v5
 v_mul_f32 v16, v16, v7
 v_mul_f32 v17, v17, v7
 v_cvt_pk_bf16_f32 v44, v16, v17
 v_sub_f32 v18, v18, v6
 v_sub_f32 v19, v19, v6
 v_cvt_pk_bf16_f32 v5, v18, v19
 v_lshlrev_b32 v18, 16, v5
 v_and_b32 v19, 0xffff0000, v5
 v_mul_f32 v18, v18, v7
 v_mul_f32 v19, v19, v7
 v_cvt_pk_bf16_f32 v45, v18, v19
 v_sub_f32 v20, v20, v6
 v_sub_f32 v21, v21, v6
 v_cvt_pk_bf16_f32 v5, v20, v21
 v_lshlrev_b32 v20, 16, v5
 v_and_b32 v21, 0xffff0000, v5
 v_mul_f32 v20, v20, v7
 v_mul_f32 v21, v21, v7
 v_cvt_pk_bf16_f32 v46, v20, v21
 v_sub_f32 v22, v22, v6
 v_sub_f32 v23, v23, v6
 v_cvt_pk_bf16_f32 v5, v22, v23
 v_lshlrev_b32 v22, 16, v5
 v_and_b32 v23, 0xffff0000, v5
 v_mul_f32 v22, v22, v7
 v_mul_f32 v23, v23, v7
 v_cvt_pk_bf16_f32 v47, v22, v23
 ds_write_b128 v24, v[32:35] offset:0
 ds_write_b128 v24, v[36:39] offset:1024
 ds_write_b128 v24, v[40:43] offset:2064
 ds_write_b128 v24, v[44:47] offset:3088
 s_waitcnt lgkmcnt(0)
 s_barrier
 ds_read_b128 v[32:35], v25 offset:0
 ds_read_b128 v[36:39], v25 offset:128
 ds_read_b128 v[40:43], v25 offset:256
 ds_read_b128 v[44:47], v25 offset:384
 s_mov_b32 s36, 75497472
 s_waitcnt lgkmcnt(3)
 buffer_store_dwordx4 v[32:35], v26, s[8:11], s36 offen sc1
 s_mov_b32 s36, 75501568
 s_waitcnt lgkmcnt(2)
 buffer_store_dwordx4 v[36:39], v26, s[8:11], s36 offen sc1
 s_mov_b32 s36, 75505664
 s_waitcnt lgkmcnt(1)
 buffer_store_dwordx4 v[40:43], v26, s[8:11], s36 offen sc1
 s_mov_b32 s36, 75509760
 s_waitcnt lgkmcnt(0)
 buffer_store_dwordx4 v[44:47], v26, s[8:11], s36 offen sc1
 s_branch mega_loop
t_red:
 s_load_dwordx2 s[14:15], s[0:1], 96
 s_load_dwordx2 s[16:17], s[0:1], 0
 s_load_dwordx2 s[18:19], s[0:1], 80
 v_and_b32 v1, 63, v0
 v_lshrrev_b32 v2, 6, v0
 s_lshl_b32 s3, s93, 2
 v_add_u32 v2, s3, v2
 v_lshlrev_b32 v3, 12, v2
 v_lshl_add_u32 v3, v1, 5, v3
 s_lshl_b32 s34, s92, 7
 v_add_u32 v2, s34, v2
 v_lshlrev_b32 v2, 11, v2
 v_lshl_add_u32 v2, v1, 4, v2
 s_add_u32 s3, s3, s34
 s_mov_b32 s32, s77
 s_mov_b32 s33, s76
 s_waitcnt lgkmcnt(0)

 s_mov_b32 s8, s14
 s_and_b32 s9, s15, 0xffff
 s_mov_b32 s10, 0x10000000
 s_mov_b32 s11, 0x00020000
 s_cmp_eq_u32 s75, 0
 s_cselect_b32 s20, s16, s14
 s_cselect_b32 s21, s17, s15
 s_cselect_b32 s22, 4194304, s10
 s_cselect_b32 s24, 0, 71303168
 s_cselect_b32 s28, s14, s18
 s_cselect_b32 s29, s15, s19
 s_cselect_b32 s30, s10, 4194304
 s_cselect_b32 s25, 71303168, 0
 s_and_b32 s21, s21, 0xffff
 s_mov_b32 s23, 0x00020000
 s_and_b32 s29, s29, 0xffff
 s_mov_b32 s31, 0x00020000
 buffer_load_dwordx4 v[32:35], v2, s[20:23], s24 offen sc1
 buffer_load_dwordx4 v[36:39], v2, s[20:23], s24 offen offset:1024 sc1

 v_mov_b32 v48, 0
 v_mov_b32 v49, 0
 v_mov_b32 v50, 0
 v_mov_b32 v51, 0
 v_mov_b32 v52, 0
 v_mov_b32 v53, 0
 v_mov_b32 v54, 0
 v_mov_b32 v55, 0
 v_mov_b32 v56, 0
 v_mov_b32 v57, 0
 v_mov_b32 v58, 0
 v_mov_b32 v59, 0
 v_mov_b32 v60, 0
 v_mov_b32 v61, 0
 v_mov_b32 v62, 0
 v_mov_b32 v63, 0
t_red_sl:
 buffer_load_dwordx4 v[64:67], v3, s[8:11], s32 offen offset:0 sc1
 buffer_load_dwordx4 v[68:71], v3, s[8:11], s32 offen offset:16 sc1
 buffer_load_dwordx4 v[72:75], v3, s[8:11], s32 offen offset:2048 sc1
 buffer_load_dwordx4 v[76:79], v3, s[8:11], s32 offen offset:2064 sc1
 s_add_u32 s32, s32, 524288
 buffer_load_dwordx4 v[80:83], v3, s[8:11], s32 offen offset:0 sc1
 buffer_load_dwordx4 v[84:87], v3, s[8:11], s32 offen offset:16 sc1
 buffer_load_dwordx4 v[88:91], v3, s[8:11], s32 offen offset:2048 sc1
 buffer_load_dwordx4 v[92:95], v3, s[8:11], s32 offen offset:2064 sc1
 s_add_u32 s32, s32, 524288
 s_cmp_le_u32 s33, 2
 s_cbranch_scc1 t_red_w2
 buffer_load_dwordx4 v[96:99], v3, s[8:11], s32 offen offset:0 sc1
 buffer_load_dwordx4 v[100:103], v3, s[8:11], s32 offen offset:16 sc1
 buffer_load_dwordx4 v[104:107], v3, s[8:11], s32 offen offset:2048 sc1
 buffer_load_dwordx4 v[108:111], v3, s[8:11], s32 offen offset:2064 sc1
 s_add_u32 s32, s32, 524288
 buffer_load_dwordx4 v[112:115], v3, s[8:11], s32 offen offset:0 sc1
 buffer_load_dwordx4 v[116:119], v3, s[8:11], s32 offen offset:16 sc1
 buffer_load_dwordx4 v[120:123], v3, s[8:11], s32 offen offset:2048 sc1
 buffer_load_dwordx4 v[124:127], v3, s[8:11], s32 offen offset:2064 sc1
 s_add_u32 s32, s32, 524288
 s_cmp_le_u32 s33, 4
 s_cbranch_scc1 t_red_w4
 buffer_load_dwordx4 v[128:131], v3, s[8:11], s32 offen offset:0 sc1
 buffer_load_dwordx4 v[132:135], v3, s[8:11], s32 offen offset:16 sc1
 buffer_load_dwordx4 v[136:139], v3, s[8:11], s32 offen offset:2048 sc1
 buffer_load_dwordx4 v[140:143], v3, s[8:11], s32 offen offset:2064 sc1
 s_add_u32 s32, s32, 524288
 buffer_load_dwordx4 v[144:147], v3, s[8:11], s32 offen offset:0 sc1
 buffer_load_dwordx4 v[148:151], v3, s[8:11], s32 offen offset:16 sc1
 buffer_load_dwordx4 v[152:155], v3, s[8:11], s32 offen offset:2048 sc1
 buffer_load_dwordx4 v[156:159], v3, s[8:11], s32 offen offset:2064 sc1
 s_add_u32 s32, s32, 524288
 s_cmp_le_u32 s33, 6
 s_cbranch_scc1 t_red_w6
 buffer_load_dwordx4 v[160:163], v3, s[8:11], s32 offen offset:0 sc1
 buffer_load_dwordx4 v[164:167], v3, s[8:11], s32 offen offset:16 sc1
 buffer_load_dwordx4 v[168:171], v3, s[8:11], s32 offen offset:2048 sc1
 buffer_load_dwordx4 v[172:175], v3, s[8:11], s32 offen offset:2064 sc1
 s_add_u32 s32, s32, 524288
 buffer_load_dwordx4 v[176:179], v3, s[8:11], s32 offen offset:0 sc1
 buffer_load_dwordx4 v[180:183], v3, s[8:11], s32 offen offset:16 sc1
 buffer_load_dwordx4 v[184:187], v3, s[8:11], s32 offen offset:2048 sc1
 buffer_load_dwordx4 v[188:191], v3, s[8:11], s32 offen offset:2064 sc1
 s_add_u32 s32, s32, 524288
 s_cmp_le_u32 s33, 8
 s_cbranch_scc1 t_red_w8
 buffer_load_dwordx4 v[192:195], v3, s[8:11], s32 offen offset:0 sc1
 buffer_load_dwordx4 v[196:199], v3, s[8:11], s32 offen offset:16 sc1
 buffer_load_dwordx4 v[200:203], v3, s[8:11], s32 offen offset:2048 sc1
 buffer_load_dwordx4 v[204:207], v3, s[8:11], s32 offen offset:2064 sc1
 s_add_u32 s32, s32, 524288
 buffer_load_dwordx4 v[208:211], v3, s[8:11], s32 offen offset:0 sc1
 buffer_load_dwordx4 v[212:215], v3, s[8:11], s32 offen offset:16 sc1
 buffer_load_dwordx4 v[216:219], v3, s[8:11], s32 offen offset:2048 sc1
 buffer_load_dwordx4 v[220:223], v3, s[8:11], s32 offen offset:2064 sc1
 s_add_u32 s32, s32, 524288
 s_cmp_le_u32 s33, 10
 s_cbranch_scc1 t_red_w10
 buffer_load_dwordx4 v[224:227], v3, s[8:11], s32 offen offset:0 sc1
 buffer_load_dwordx4 v[228:231], v3, s[8:11], s32 offen offset:16 sc1
 buffer_load_dwordx4 v[232:235], v3, s[8:11], s32 offen offset:2048 sc1
 buffer_load_dwordx4 v[236:239], v3, s[8:11], s32 offen offset:2064 sc1
 s_add_u32 s32, s32, 524288
 buffer_load_dwordx4 v[240:243], v3, s[8:11], s32 offen offset:0 sc1
 buffer_load_dwordx4 v[244:247], v3, s[8:11], s32 offen offset:16 sc1
 buffer_load_dwordx4 v[248:251], v3, s[8:11], s32 offen offset:2048 sc1
 buffer_load_dwordx4 v[252:255], v3, s[8:11], s32 offen offset:2064 sc1
 s_add_u32 s32, s32, 524288
 s_waitcnt vmcnt(44)
 v_pk_add_f32 v[48:49], v[48:49], v[64:65]
 v_pk_add_f32 v[50:51], v[50:51], v[66:67]
 v_pk_add_f32 v[52:53], v[52:53], v[68:69]
 v_pk_add_f32 v[54:55], v[54:55], v[70:71]
 v_pk_add_f32 v[56:57], v[56:57], v[72:73]
 v_pk_add_f32 v[58:59], v[58:59], v[74:75]
 v_pk_add_f32 v[60:61], v[60:61], v[76:77]
 v_pk_add_f32 v[62:63], v[62:63], v[78:79]
 s_waitcnt vmcnt(40)
 v_pk_add_f32 v[48:49], v[48:49], v[80:81]
 v_pk_add_f32 v[50:51], v[50:51], v[82:83]
 v_pk_add_f32 v[52:53], v[52:53], v[84:85]
 v_pk_add_f32 v[54:55], v[54:55], v[86:87]
 v_pk_add_f32 v[56:57], v[56:57], v[88:89]
 v_pk_add_f32 v[58:59], v[58:59], v[90:91]
 v_pk_add_f32 v[60:61], v[60:61], v[92:93]
 v_pk_add_f32 v[62:63], v[62:63], v[94:95]
 s_waitcnt vmcnt(36)
 v_pk_add_f32 v[48:49], v[48:49], v[96:97]
 v_pk_add_f32 v[50:51], v[50:51], v[98:99]
 v_pk_add_f32 v[52:53], v[52:53], v[100:101]
 v_pk_add_f32 v[54:55], v[54:55], v[102:103]
 v_pk_add_f32 v[56:57], v[56:57], v[104:105]
 v_pk_add_f32 v[58:59], v[58:59], v[106:107]
 v_pk_add_f32 v[60:61], v[60:61], v[108:109]
 v_pk_add_f32 v[62:63], v[62:63], v[110:111]
 s_waitcnt vmcnt(32)
 v_pk_add_f32 v[48:49], v[48:49], v[112:113]
 v_pk_add_f32 v[50:51], v[50:51], v[114:115]
 v_pk_add_f32 v[52:53], v[52:53], v[116:117]
 v_pk_add_f32 v[54:55], v[54:55], v[118:119]
 v_pk_add_f32 v[56:57], v[56:57], v[120:121]
 v_pk_add_f32 v[58:59], v[58:59], v[122:123]
 v_pk_add_f32 v[60:61], v[60:61], v[124:125]
 v_pk_add_f32 v[62:63], v[62:63], v[126:127]
 s_waitcnt vmcnt(28)
 v_pk_add_f32 v[48:49], v[48:49], v[128:129]
 v_pk_add_f32 v[50:51], v[50:51], v[130:131]
 v_pk_add_f32 v[52:53], v[52:53], v[132:133]
 v_pk_add_f32 v[54:55], v[54:55], v[134:135]
 v_pk_add_f32 v[56:57], v[56:57], v[136:137]
 v_pk_add_f32 v[58:59], v[58:59], v[138:139]
 v_pk_add_f32 v[60:61], v[60:61], v[140:141]
 v_pk_add_f32 v[62:63], v[62:63], v[142:143]
 s_waitcnt vmcnt(24)
 v_pk_add_f32 v[48:49], v[48:49], v[144:145]
 v_pk_add_f32 v[50:51], v[50:51], v[146:147]
 v_pk_add_f32 v[52:53], v[52:53], v[148:149]
 v_pk_add_f32 v[54:55], v[54:55], v[150:151]
 v_pk_add_f32 v[56:57], v[56:57], v[152:153]
 v_pk_add_f32 v[58:59], v[58:59], v[154:155]
 v_pk_add_f32 v[60:61], v[60:61], v[156:157]
 v_pk_add_f32 v[62:63], v[62:63], v[158:159]
 s_waitcnt vmcnt(20)
 v_pk_add_f32 v[48:49], v[48:49], v[160:161]
 v_pk_add_f32 v[50:51], v[50:51], v[162:163]
 v_pk_add_f32 v[52:53], v[52:53], v[164:165]
 v_pk_add_f32 v[54:55], v[54:55], v[166:167]
 v_pk_add_f32 v[56:57], v[56:57], v[168:169]
 v_pk_add_f32 v[58:59], v[58:59], v[170:171]
 v_pk_add_f32 v[60:61], v[60:61], v[172:173]
 v_pk_add_f32 v[62:63], v[62:63], v[174:175]
 s_waitcnt vmcnt(16)
 v_pk_add_f32 v[48:49], v[48:49], v[176:177]
 v_pk_add_f32 v[50:51], v[50:51], v[178:179]
 v_pk_add_f32 v[52:53], v[52:53], v[180:181]
 v_pk_add_f32 v[54:55], v[54:55], v[182:183]
 v_pk_add_f32 v[56:57], v[56:57], v[184:185]
 v_pk_add_f32 v[58:59], v[58:59], v[186:187]
 v_pk_add_f32 v[60:61], v[60:61], v[188:189]
 v_pk_add_f32 v[62:63], v[62:63], v[190:191]
 s_waitcnt vmcnt(12)
 v_pk_add_f32 v[48:49], v[48:49], v[192:193]
 v_pk_add_f32 v[50:51], v[50:51], v[194:195]
 v_pk_add_f32 v[52:53], v[52:53], v[196:197]
 v_pk_add_f32 v[54:55], v[54:55], v[198:199]
 v_pk_add_f32 v[56:57], v[56:57], v[200:201]
 v_pk_add_f32 v[58:59], v[58:59], v[202:203]
 v_pk_add_f32 v[60:61], v[60:61], v[204:205]
 v_pk_add_f32 v[62:63], v[62:63], v[206:207]
 s_waitcnt vmcnt(8)
 v_pk_add_f32 v[48:49], v[48:49], v[208:209]
 v_pk_add_f32 v[50:51], v[50:51], v[210:211]
 v_pk_add_f32 v[52:53], v[52:53], v[212:213]
 v_pk_add_f32 v[54:55], v[54:55], v[214:215]
 v_pk_add_f32 v[56:57], v[56:57], v[216:217]
 v_pk_add_f32 v[58:59], v[58:59], v[218:219]
 v_pk_add_f32 v[60:61], v[60:61], v[220:221]
 v_pk_add_f32 v[62:63], v[62:63], v[222:223]
 s_waitcnt vmcnt(4)
 v_pk_add_f32 v[48:49], v[48:49], v[224:225]
 v_pk_add_f32 v[50:51], v[50:51], v[226:227]
 v_pk_add_f32 v[52:53], v[52:53], v[228:229]
 v_pk_add_f32 v[54:55], v[54:55], v[230:231]
 v_pk_add_f32 v[56:57], v[56:57], v[232:233]
 v_pk_add_f32 v[58:59], v[58:59], v[234:235]
 v_pk_add_f32 v[60:61], v[60:61], v[236:237]
 v_pk_add_f32 v[62:63], v[62:63], v[238:239]
 s_waitcnt vmcnt(0)
 v_pk_add_f32 v[48:49], v[48:49], v[240:241]
 v_pk_add_f32 v[50:51], v[50:51], v[242:243]
 v_pk_add_f32 v[52:53], v[52:53], v[244:245]
 v_pk_add_f32 v[54:55], v[54:55], v[246:247]
 v_pk_add_f32 v[56:57], v[56:57], v[248:249]
 v_pk_add_f32 v[58:59], v[58:59], v[250:251]
 v_pk_add_f32 v[60:61], v[60:61], v[252:253]
 v_pk_add_f32 v[62:63], v[62:63], v[254:255]
 s_sub_u32 s33, s33, 12
 s_cmp_lg_u32 s33, 0
 s_cbranch_scc1 t_red_sl
 s_branch t_red_sum
t_red_w10:
 s_waitcnt vmcnt(36)
 v_pk_add_f32 v[48:49], v[48:49], v[64:65]
 v_pk_add_f32 v[50:51], v[50:51], v[66:67]
 v_pk_add_f32 v[52:53], v[52:53], v[68:69]
 v_pk_add_f32 v[54:55], v[54:55], v[70:71]
 v_pk_add_f32 v[56:57], v[56:57], v[72:73]
 v_pk_add_f32 v[58:59], v[58:59], v[74:75]
 v_pk_add_f32 v[60:61], v[60:61], v[76:77]
 v_pk_add_f32 v[62:63], v[62:63], v[78:79]
 s_waitcnt vmcnt(32)
 v_pk_add_f32 v[48:49], v[48:49], v[80:81]
 v_pk_add_f32 v[50:51], v[50:51], v[82:83]
 v_pk_add_f32 v[52:53], v[52:53], v[84:85]
 v_pk_add_f32 v[54:55], v[54:55], v[86:87]
 v_pk_add_f32 v[56:57], v[56:57], v[88:89]
 v_pk_add_f32 v[58:59], v[58:59], v[90:91]
 v_pk_add_f32 v[60:61], v[60:61], v[92:93]
 v_pk_add_f32 v[62:63], v[62:63], v[94:95]
 s_waitcnt vmcnt(28)
 v_pk_add_f32 v[48:49], v[48:49], v[96:97]
 v_pk_add_f32 v[50:51], v[50:51], v[98:99]
 v_pk_add_f32 v[52:53], v[52:53], v[100:101]
 v_pk_add_f32 v[54:55], v[54:55], v[102:103]
 v_pk_add_f32 v[56:57], v[56:57], v[104:105]
 v_pk_add_f32 v[58:59], v[58:59], v[106:107]
 v_pk_add_f32 v[60:61], v[60:61], v[108:109]
 v_pk_add_f32 v[62:63], v[62:63], v[110:111]
 s_waitcnt vmcnt(24)
 v_pk_add_f32 v[48:49], v[48:49], v[112:113]
 v_pk_add_f32 v[50:51], v[50:51], v[114:115]
 v_pk_add_f32 v[52:53], v[52:53], v[116:117]
 v_pk_add_f32 v[54:55], v[54:55], v[118:119]
 v_pk_add_f32 v[56:57], v[56:57], v[120:121]
 v_pk_add_f32 v[58:59], v[58:59], v[122:123]
 v_pk_add_f32 v[60:61], v[60:61], v[124:125]
 v_pk_add_f32 v[62:63], v[62:63], v[126:127]
 s_waitcnt vmcnt(20)
 v_pk_add_f32 v[48:49], v[48:49], v[128:129]
 v_pk_add_f32 v[50:51], v[50:51], v[130:131]
 v_pk_add_f32 v[52:53], v[52:53], v[132:133]
 v_pk_add_f32 v[54:55], v[54:55], v[134:135]
 v_pk_add_f32 v[56:57], v[56:57], v[136:137]
 v_pk_add_f32 v[58:59], v[58:59], v[138:139]
 v_pk_add_f32 v[60:61], v[60:61], v[140:141]
 v_pk_add_f32 v[62:63], v[62:63], v[142:143]
 s_waitcnt vmcnt(16)
 v_pk_add_f32 v[48:49], v[48:49], v[144:145]
 v_pk_add_f32 v[50:51], v[50:51], v[146:147]
 v_pk_add_f32 v[52:53], v[52:53], v[148:149]
 v_pk_add_f32 v[54:55], v[54:55], v[150:151]
 v_pk_add_f32 v[56:57], v[56:57], v[152:153]
 v_pk_add_f32 v[58:59], v[58:59], v[154:155]
 v_pk_add_f32 v[60:61], v[60:61], v[156:157]
 v_pk_add_f32 v[62:63], v[62:63], v[158:159]
 s_waitcnt vmcnt(12)
 v_pk_add_f32 v[48:49], v[48:49], v[160:161]
 v_pk_add_f32 v[50:51], v[50:51], v[162:163]
 v_pk_add_f32 v[52:53], v[52:53], v[164:165]
 v_pk_add_f32 v[54:55], v[54:55], v[166:167]
 v_pk_add_f32 v[56:57], v[56:57], v[168:169]
 v_pk_add_f32 v[58:59], v[58:59], v[170:171]
 v_pk_add_f32 v[60:61], v[60:61], v[172:173]
 v_pk_add_f32 v[62:63], v[62:63], v[174:175]
 s_waitcnt vmcnt(8)
 v_pk_add_f32 v[48:49], v[48:49], v[176:177]
 v_pk_add_f32 v[50:51], v[50:51], v[178:179]
 v_pk_add_f32 v[52:53], v[52:53], v[180:181]
 v_pk_add_f32 v[54:55], v[54:55], v[182:183]
 v_pk_add_f32 v[56:57], v[56:57], v[184:185]
 v_pk_add_f32 v[58:59], v[58:59], v[186:187]
 v_pk_add_f32 v[60:61], v[60:61], v[188:189]
 v_pk_add_f32 v[62:63], v[62:63], v[190:191]
 s_waitcnt vmcnt(4)
 v_pk_add_f32 v[48:49], v[48:49], v[192:193]
 v_pk_add_f32 v[50:51], v[50:51], v[194:195]
 v_pk_add_f32 v[52:53], v[52:53], v[196:197]
 v_pk_add_f32 v[54:55], v[54:55], v[198:199]
 v_pk_add_f32 v[56:57], v[56:57], v[200:201]
 v_pk_add_f32 v[58:59], v[58:59], v[202:203]
 v_pk_add_f32 v[60:61], v[60:61], v[204:205]
 v_pk_add_f32 v[62:63], v[62:63], v[206:207]
 s_waitcnt vmcnt(0)
 v_pk_add_f32 v[48:49], v[48:49], v[208:209]
 v_pk_add_f32 v[50:51], v[50:51], v[210:211]
 v_pk_add_f32 v[52:53], v[52:53], v[212:213]
 v_pk_add_f32 v[54:55], v[54:55], v[214:215]
 v_pk_add_f32 v[56:57], v[56:57], v[216:217]
 v_pk_add_f32 v[58:59], v[58:59], v[218:219]
 v_pk_add_f32 v[60:61], v[60:61], v[220:221]
 v_pk_add_f32 v[62:63], v[62:63], v[222:223]
 s_branch t_red_sum
t_red_w8:
 s_waitcnt vmcnt(28)
 v_pk_add_f32 v[48:49], v[48:49], v[64:65]
 v_pk_add_f32 v[50:51], v[50:51], v[66:67]
 v_pk_add_f32 v[52:53], v[52:53], v[68:69]
 v_pk_add_f32 v[54:55], v[54:55], v[70:71]
 v_pk_add_f32 v[56:57], v[56:57], v[72:73]
 v_pk_add_f32 v[58:59], v[58:59], v[74:75]
 v_pk_add_f32 v[60:61], v[60:61], v[76:77]
 v_pk_add_f32 v[62:63], v[62:63], v[78:79]
 s_waitcnt vmcnt(24)
 v_pk_add_f32 v[48:49], v[48:49], v[80:81]
 v_pk_add_f32 v[50:51], v[50:51], v[82:83]
 v_pk_add_f32 v[52:53], v[52:53], v[84:85]
 v_pk_add_f32 v[54:55], v[54:55], v[86:87]
 v_pk_add_f32 v[56:57], v[56:57], v[88:89]
 v_pk_add_f32 v[58:59], v[58:59], v[90:91]
 v_pk_add_f32 v[60:61], v[60:61], v[92:93]
 v_pk_add_f32 v[62:63], v[62:63], v[94:95]
 s_waitcnt vmcnt(20)
 v_pk_add_f32 v[48:49], v[48:49], v[96:97]
 v_pk_add_f32 v[50:51], v[50:51], v[98:99]
 v_pk_add_f32 v[52:53], v[52:53], v[100:101]
 v_pk_add_f32 v[54:55], v[54:55], v[102:103]
 v_pk_add_f32 v[56:57], v[56:57], v[104:105]
 v_pk_add_f32 v[58:59], v[58:59], v[106:107]
 v_pk_add_f32 v[60:61], v[60:61], v[108:109]
 v_pk_add_f32 v[62:63], v[62:63], v[110:111]
 s_waitcnt vmcnt(16)
 v_pk_add_f32 v[48:49], v[48:49], v[112:113]
 v_pk_add_f32 v[50:51], v[50:51], v[114:115]
 v_pk_add_f32 v[52:53], v[52:53], v[116:117]
 v_pk_add_f32 v[54:55], v[54:55], v[118:119]
 v_pk_add_f32 v[56:57], v[56:57], v[120:121]
 v_pk_add_f32 v[58:59], v[58:59], v[122:123]
 v_pk_add_f32 v[60:61], v[60:61], v[124:125]
 v_pk_add_f32 v[62:63], v[62:63], v[126:127]
 s_waitcnt vmcnt(12)
 v_pk_add_f32 v[48:49], v[48:49], v[128:129]
 v_pk_add_f32 v[50:51], v[50:51], v[130:131]
 v_pk_add_f32 v[52:53], v[52:53], v[132:133]
 v_pk_add_f32 v[54:55], v[54:55], v[134:135]
 v_pk_add_f32 v[56:57], v[56:57], v[136:137]
 v_pk_add_f32 v[58:59], v[58:59], v[138:139]
 v_pk_add_f32 v[60:61], v[60:61], v[140:141]
 v_pk_add_f32 v[62:63], v[62:63], v[142:143]
 s_waitcnt vmcnt(8)
 v_pk_add_f32 v[48:49], v[48:49], v[144:145]
 v_pk_add_f32 v[50:51], v[50:51], v[146:147]
 v_pk_add_f32 v[52:53], v[52:53], v[148:149]
 v_pk_add_f32 v[54:55], v[54:55], v[150:151]
 v_pk_add_f32 v[56:57], v[56:57], v[152:153]
 v_pk_add_f32 v[58:59], v[58:59], v[154:155]
 v_pk_add_f32 v[60:61], v[60:61], v[156:157]
 v_pk_add_f32 v[62:63], v[62:63], v[158:159]
 s_waitcnt vmcnt(4)
 v_pk_add_f32 v[48:49], v[48:49], v[160:161]
 v_pk_add_f32 v[50:51], v[50:51], v[162:163]
 v_pk_add_f32 v[52:53], v[52:53], v[164:165]
 v_pk_add_f32 v[54:55], v[54:55], v[166:167]
 v_pk_add_f32 v[56:57], v[56:57], v[168:169]
 v_pk_add_f32 v[58:59], v[58:59], v[170:171]
 v_pk_add_f32 v[60:61], v[60:61], v[172:173]
 v_pk_add_f32 v[62:63], v[62:63], v[174:175]
 s_waitcnt vmcnt(0)
 v_pk_add_f32 v[48:49], v[48:49], v[176:177]
 v_pk_add_f32 v[50:51], v[50:51], v[178:179]
 v_pk_add_f32 v[52:53], v[52:53], v[180:181]
 v_pk_add_f32 v[54:55], v[54:55], v[182:183]
 v_pk_add_f32 v[56:57], v[56:57], v[184:185]
 v_pk_add_f32 v[58:59], v[58:59], v[186:187]
 v_pk_add_f32 v[60:61], v[60:61], v[188:189]
 v_pk_add_f32 v[62:63], v[62:63], v[190:191]
 s_branch t_red_sum
t_red_w6:
 s_waitcnt vmcnt(20)
 v_pk_add_f32 v[48:49], v[48:49], v[64:65]
 v_pk_add_f32 v[50:51], v[50:51], v[66:67]
 v_pk_add_f32 v[52:53], v[52:53], v[68:69]
 v_pk_add_f32 v[54:55], v[54:55], v[70:71]
 v_pk_add_f32 v[56:57], v[56:57], v[72:73]
 v_pk_add_f32 v[58:59], v[58:59], v[74:75]
 v_pk_add_f32 v[60:61], v[60:61], v[76:77]
 v_pk_add_f32 v[62:63], v[62:63], v[78:79]
 s_waitcnt vmcnt(16)
 v_pk_add_f32 v[48:49], v[48:49], v[80:81]
 v_pk_add_f32 v[50:51], v[50:51], v[82:83]
 v_pk_add_f32 v[52:53], v[52:53], v[84:85]
 v_pk_add_f32 v[54:55], v[54:55], v[86:87]
 v_pk_add_f32 v[56:57], v[56:57], v[88:89]
 v_pk_add_f32 v[58:59], v[58:59], v[90:91]
 v_pk_add_f32 v[60:61], v[60:61], v[92:93]
 v_pk_add_f32 v[62:63], v[62:63], v[94:95]
 s_waitcnt vmcnt(12)
 v_pk_add_f32 v[48:49], v[48:49], v[96:97]
 v_pk_add_f32 v[50:51], v[50:51], v[98:99]
 v_pk_add_f32 v[52:53], v[52:53], v[100:101]
 v_pk_add_f32 v[54:55], v[54:55], v[102:103]
 v_pk_add_f32 v[56:57], v[56:57], v[104:105]
 v_pk_add_f32 v[58:59], v[58:59], v[106:107]
 v_pk_add_f32 v[60:61], v[60:61], v[108:109]
 v_pk_add_f32 v[62:63], v[62:63], v[110:111]
 s_waitcnt vmcnt(8)
 v_pk_add_f32 v[48:49], v[48:49], v[112:113]
 v_pk_add_f32 v[50:51], v[50:51], v[114:115]
 v_pk_add_f32 v[52:53], v[52:53], v[116:117]
 v_pk_add_f32 v[54:55], v[54:55], v[118:119]
 v_pk_add_f32 v[56:57], v[56:57], v[120:121]
 v_pk_add_f32 v[58:59], v[58:59], v[122:123]
 v_pk_add_f32 v[60:61], v[60:61], v[124:125]
 v_pk_add_f32 v[62:63], v[62:63], v[126:127]
 s_waitcnt vmcnt(4)
 v_pk_add_f32 v[48:49], v[48:49], v[128:129]
 v_pk_add_f32 v[50:51], v[50:51], v[130:131]
 v_pk_add_f32 v[52:53], v[52:53], v[132:133]
 v_pk_add_f32 v[54:55], v[54:55], v[134:135]
 v_pk_add_f32 v[56:57], v[56:57], v[136:137]
 v_pk_add_f32 v[58:59], v[58:59], v[138:139]
 v_pk_add_f32 v[60:61], v[60:61], v[140:141]
 v_pk_add_f32 v[62:63], v[62:63], v[142:143]
 s_waitcnt vmcnt(0)
 v_pk_add_f32 v[48:49], v[48:49], v[144:145]
 v_pk_add_f32 v[50:51], v[50:51], v[146:147]
 v_pk_add_f32 v[52:53], v[52:53], v[148:149]
 v_pk_add_f32 v[54:55], v[54:55], v[150:151]
 v_pk_add_f32 v[56:57], v[56:57], v[152:153]
 v_pk_add_f32 v[58:59], v[58:59], v[154:155]
 v_pk_add_f32 v[60:61], v[60:61], v[156:157]
 v_pk_add_f32 v[62:63], v[62:63], v[158:159]
 s_branch t_red_sum
t_red_w4:
 s_waitcnt vmcnt(12)
 v_pk_add_f32 v[48:49], v[48:49], v[64:65]
 v_pk_add_f32 v[50:51], v[50:51], v[66:67]
 v_pk_add_f32 v[52:53], v[52:53], v[68:69]
 v_pk_add_f32 v[54:55], v[54:55], v[70:71]
 v_pk_add_f32 v[56:57], v[56:57], v[72:73]
 v_pk_add_f32 v[58:59], v[58:59], v[74:75]
 v_pk_add_f32 v[60:61], v[60:61], v[76:77]
 v_pk_add_f32 v[62:63], v[62:63], v[78:79]
 s_waitcnt vmcnt(8)
 v_pk_add_f32 v[48:49], v[48:49], v[80:81]
 v_pk_add_f32 v[50:51], v[50:51], v[82:83]
 v_pk_add_f32 v[52:53], v[52:53], v[84:85]
 v_pk_add_f32 v[54:55], v[54:55], v[86:87]
 v_pk_add_f32 v[56:57], v[56:57], v[88:89]
 v_pk_add_f32 v[58:59], v[58:59], v[90:91]
 v_pk_add_f32 v[60:61], v[60:61], v[92:93]
 v_pk_add_f32 v[62:63], v[62:63], v[94:95]
 s_waitcnt vmcnt(4)
 v_pk_add_f32 v[48:49], v[48:49], v[96:97]
 v_pk_add_f32 v[50:51], v[50:51], v[98:99]
 v_pk_add_f32 v[52:53], v[52:53], v[100:101]
 v_pk_add_f32 v[54:55], v[54:55], v[102:103]
 v_pk_add_f32 v[56:57], v[56:57], v[104:105]
 v_pk_add_f32 v[58:59], v[58:59], v[106:107]
 v_pk_add_f32 v[60:61], v[60:61], v[108:109]
 v_pk_add_f32 v[62:63], v[62:63], v[110:111]
 s_waitcnt vmcnt(0)
 v_pk_add_f32 v[48:49], v[48:49], v[112:113]
 v_pk_add_f32 v[50:51], v[50:51], v[114:115]
 v_pk_add_f32 v[52:53], v[52:53], v[116:117]
 v_pk_add_f32 v[54:55], v[54:55], v[118:119]
 v_pk_add_f32 v[56:57], v[56:57], v[120:121]
 v_pk_add_f32 v[58:59], v[58:59], v[122:123]
 v_pk_add_f32 v[60:61], v[60:61], v[124:125]
 v_pk_add_f32 v[62:63], v[62:63], v[126:127]
 s_branch t_red_sum
t_red_w2:
 s_waitcnt vmcnt(4)
 v_pk_add_f32 v[48:49], v[48:49], v[64:65]
 v_pk_add_f32 v[50:51], v[50:51], v[66:67]
 v_pk_add_f32 v[52:53], v[52:53], v[68:69]
 v_pk_add_f32 v[54:55], v[54:55], v[70:71]
 v_pk_add_f32 v[56:57], v[56:57], v[72:73]
 v_pk_add_f32 v[58:59], v[58:59], v[74:75]
 v_pk_add_f32 v[60:61], v[60:61], v[76:77]
 v_pk_add_f32 v[62:63], v[62:63], v[78:79]
 s_waitcnt vmcnt(0)
 v_pk_add_f32 v[48:49], v[48:49], v[80:81]
 v_pk_add_f32 v[50:51], v[50:51], v[82:83]
 v_pk_add_f32 v[52:53], v[52:53], v[84:85]
 v_pk_add_f32 v[54:55], v[54:55], v[86:87]
 v_pk_add_f32 v[56:57], v[56:57], v[88:89]
 v_pk_add_f32 v[58:59], v[58:59], v[90:91]
 v_pk_add_f32 v[60:61], v[60:61], v[92:93]
 v_pk_add_f32 v[62:63], v[62:63], v[94:95]
t_red_sum:
 v_cvt_pk_bf16_f32 v8, v48, v49
 v_lshlrev_b32 v48, 16, v8
 v_and_b32 v49, 0xffff0000, v8
 v_lshlrev_b32 v8, 16, v32
 v_and_b32 v9, 0xffff0000, v32
 v_add_f32 v48, v48, v8
 v_add_f32 v49, v49, v9
 v_cvt_pk_bf16_f32 v32, v48, v49
 v_cvt_pk_bf16_f32 v8, v50, v51
 v_lshlrev_b32 v50, 16, v8
 v_and_b32 v51, 0xffff0000, v8
 v_lshlrev_b32 v8, 16, v33
 v_and_b32 v9, 0xffff0000, v33
 v_add_f32 v50, v50, v8
 v_add_f32 v51, v51, v9
 v_cvt_pk_bf16_f32 v33, v50, v51
 v_cvt_pk_bf16_f32 v8, v52, v53
 v_lshlrev_b32 v52, 16, v8
 v_and_b32 v53, 0xffff0000, v8
 v_lshlrev_b32 v8, 16, v34
 v_and_b32 v9, 0xffff0000, v34
 v_add_f32 v52, v52, v8
 v_add_f32 v53, v53, v9
 v_cvt_pk_bf16_f32 v34, v52, v53
 v_cvt_pk_bf16_f32 v8, v54, v55
 v_lshlrev_b32 v54, 16, v8
 v_and_b32 v55, 0xffff0000, v8
 v_lshlrev_b32 v8, 16, v35
 v_and_b32 v9, 0xffff0000, v35
 v_add_f32 v54, v54, v8
 v_add_f32 v55, v55, v9
 v_cvt_pk_bf16_f32 v35, v54, v55
 v_cvt_pk_bf16_f32 v8, v56, v57
 v_lshlrev_b32 v56, 16, v8
 v_and_b32 v57, 0xffff0000, v8
 v_lshlrev_b32 v8, 16, v36
 v_and_b32 v9, 0xffff0000, v36
 v_add_f32 v56, v56, v8
 v_add_f32 v57, v57, v9
 v_cvt_pk_bf16_f32 v36, v56, v57
 v_cvt_pk_bf16_f32 v8, v58, v59
 v_lshlrev_b32 v58, 16, v8
 v_and_b32 v59, 0xffff0000, v8
 v_lshlrev_b32 v8, 16, v37
 v_and_b32 v9, 0xffff0000, v37
 v_add_f32 v58, v58, v8
 v_add_f32 v59, v59, v9
 v_cvt_pk_bf16_f32 v37, v58, v59
 v_cvt_pk_bf16_f32 v8, v60, v61
 v_lshlrev_b32 v60, 16, v8
 v_and_b32 v61, 0xffff0000, v8
 v_lshlrev_b32 v8, 16, v38
 v_and_b32 v9, 0xffff0000, v38
 v_add_f32 v60, v60, v8
 v_add_f32 v61, v61, v9
 v_cvt_pk_bf16_f32 v38, v60, v61
 v_cvt_pk_bf16_f32 v8, v62, v63
 v_lshlrev_b32 v62, 16, v8
 v_and_b32 v63, 0xffff0000, v8
 v_lshlrev_b32 v8, 16, v39
 v_and_b32 v9, 0xffff0000, v39
 v_add_f32 v62, v62, v8
 v_add_f32 v63, v63, v9
 v_cvt_pk_bf16_f32 v39, v62, v63
 buffer_store_dwordx4 v[32:35], v2, s[28:31], s25 offen sc1
 buffer_store_dwordx4 v[36:39], v2, s[28:31], s25 offen offset:1024 sc1
 s_cmp_lg_u32 s75, 0
 s_cbranch_scc1 mega_loop

 v_lshrrev_b32 v27, 6, v0
 v_mul_u32_u24 v24, 2064, v27
 v_lshl_add_u32 v24, v1, 4, v24
 v_and_b32 v28, 3, v1
 v_lshrrev_b32 v29, 2, v1
 v_lshl_add_u32 v29, v27, 5, v29
 v_mul_u32_u24 v25, 2064, v28
 v_lshl_add_u32 v25, v29, 4, v25
 v_lshlrev_b32 v26, 9, v29
 v_lshl_add_u32 v26, v28, 4, v26
 s_lshr_b32 s36, s3, 5
 s_lshl_b32 s36, s36, 16
 s_and_b32 s37, s3, 31
 s_lshl_b32 s37, s37, 4
 s_add_u32 s36, s36, s37
 v_add_u32 v26, s36, v26

 v_mov_b32 v40, v32
 v_mov_b32 v41, v33
 v_mov_b32 v42, v34
 v_mov_b32 v43, v35
 v_mov_b32 v44, v36
 v_mov_b32 v45, v37
 v_mov_b32 v46, v38
 v_mov_b32 v47, v39
 v_lshlrev_b32 v8, 16, v40
 v_and_b32 v9, 0xffff0000, v40
 v_lshlrev_b32 v10, 16, v41
 v_and_b32 v11, 0xffff0000, v41
 v_lshlrev_b32 v12, 16, v42
 v_and_b32 v13, 0xffff0000, v42
 v_lshlrev_b32 v14, 16, v43
 v_and_b32 v15, 0xffff0000, v43
 v_lshlrev_b32 v16, 16, v44
 v_and_b32 v17, 0xffff0000, v44
 v_lshlrev_b32 v18, 16, v45
 v_and_b32 v19, 0xffff0000, v45
 v_lshlrev_b32 v20, 16, v46
 v_and_b32 v21, 0xffff0000, v46
 v_lshlrev_b32 v22, 16, v47
 v_and_b32 v23, 0xffff0000, v47
 v_add_f32 v4, v8, v9
 v_add_f32 v4, v4, v10
 v_add_f32 v4, v4, v11
 v_add_f32 v4, v4, v12
 v_add_f32 v4, v4, v13
 v_add_f32 v4, v4, v14
 v_add_f32 v4, v4, v15
 v_add_f32 v4, v4, v16
 v_add_f32 v4, v4, v17
 v_add_f32 v4, v4, v18
 v_add_f32 v4, v4, v19
 v_add_f32 v4, v4, v20
 v_add_f32 v4, v4, v21
 v_add_f32 v4, v4, v22
 v_add_f32 v4, v4, v23
 s_nop 1
 v_add_f32_dpp v4, v4, v4 row_ror:8 row_mask:0xf bank_mask:0xf
 s_nop 1
 v_add_f32_dpp v4, v4, v4 row_ror:4 row_mask:0xf bank_mask:0xf
 s_nop 1
 v_add_f32_dpp v4, v4, v4 row_ror:2 row_mask:0xf bank_mask:0xf
 s_nop 1
 v_add_f32_dpp v4, v4, v4 row_ror:1 row_mask:0xf bank_mask:0xf
 v_mov_b32 v5, v4
 s_nop 1
 v_permlane16_swap_b32 v4, v5
 v_add_f32 v4, v4, v5
 v_mov_b32 v5, v4
 s_nop 1
 v_permlane32_swap_b32 v4, v5
 v_add_f32 v4, v4, v5
 v_mul_f32 v6, 0x3a800000, v4
 v_mov_b32 v7, 0
 v_sub_f32 v5, v8, v6
 v_fmac_f32 v7, v5, v5
 v_sub_f32 v5, v9, v6
 v_fmac_f32 v7, v5, v5
 v_sub_f32 v5, v10, v6
 v_fmac_f32 v7, v5, v5
 v_sub_f32 v5, v11, v6
 v_fmac_f32 v7, v5, v5
 v_sub_f32 v5, v12, v6
 v_fmac_f32 v7, v5, v5
 v_sub_f32 v5, v13, v6
 v_fmac_f32 v7, v5, v5
 v_sub_f32 v5, v14, v6
 v_fmac_f32 v7, v5, v5
 v_sub_f32 v5, v15, v6
 v_fmac_f32 v7, v5, v5
 v_sub_f32 v5, v16, v6
 v_fmac_f32 v7, v5, v5
 v_sub_f32 v5, v17, v6
 v_fmac_f32 v7, v5, v5
 v_sub_f32 v5, v18, v6
 v_fmac_f32 v7, v5, v5
 v_sub_f32 v5, v19, v6
 v_fmac_f32 v7, v5, v5
 v_sub_f32 v5, v20, v6
 v_fmac_f32 v7, v5, v5
 v_sub_f32 v5, v21, v6
 v_fmac_f32 v7, v5, v5
 v_sub_f32 v5, v22, v6
 v_fmac_f32 v7, v5, v5
 v_sub_f32 v5, v23, v6
 v_fmac_f32 v7, v5, v5
 s_nop 1
 v_add_f32_dpp v7, v7, v7 row_ror:8 row_mask:0xf bank_mask:0xf
 s_nop 1
 v_add_f32_dpp v7, v7, v7 row_ror:4 row_mask:0xf bank_mask:0xf
 s_nop 1
 v_add_f32_dpp v7, v7, v7 row_ror:2 row_mask:0xf bank_mask:0xf
 s_nop 1
 v_add_f32_dpp v7, v7, v7 row_ror:1 row_mask:0xf bank_mask:0xf
 v_mov_b32 v5, v7
 s_nop 1
 v_permlane16_swap_b32 v7, v5
 v_add_f32 v7, v7, v5
 v_mov_b32 v5, v7
 s_nop 1
 v_permlane32_swap_b32 v7, v5
 v_add_f32 v7, v7, v5
 v_mul_f32 v7, 0x3a800000, v7
 v_cvt_pk_bf16_f32 v7, v7, v7
 v_lshlrev_b32 v7, 16, v7
 v_add_f32 v7, 0x3727c5ac, v7
 v_cvt_pk_bf16_f32 v7, v7, v7
 v_lshlrev_b32 v7, 16, v7
 v_sqrt_f32 v7, v7
 s_nop 0
 v_cvt_pk_bf16_f32 v7, v7, v7
 v_lshlrev_b32 v7, 16, v7
 v_rcp_f32 v7, v7
 v_cvt_pk_bf16_f32 v6, v6, v6
 v_lshlrev_b32 v6, 16, v6
 v_sub_f32 v8, v8, v6
 v_sub_f32 v9, v9, v6
 v_cvt_pk_bf16_f32 v5, v8, v9
 v_lshlrev_b32 v8, 16, v5
 v_and_b32 v9, 0xffff0000, v5
 v_mul_f32 v8, v8, v7
 v_mul_f32 v9, v9, v7
 v_cvt_pk_bf16_f32 v40, v8, v9
 v_sub_f32 v10, v10, v6
 v_sub_f32 v11, v11, v6
 v_cvt_pk_bf16_f32 v5, v10, v11
 v_lshlrev_b32 v10, 16, v5
 v_and_b32 v11, 0xffff0000, v5
 v_mul_f32 v10, v10, v7
 v_mul_f32 v11, v11, v7
 v_cvt_pk_bf16_f32 v41, v10, v11
 v_sub_f32 v12, v12, v6
 v_sub_f32 v13, v13, v6
 v_cvt_pk_bf16_f32 v5, v12, v13
 v_lshlrev_b32 v12, 16, v5
 v_and_b32 v13, 0xffff0000, v5
 v_mul_f32 v12, v12, v7
 v_mul_f32 v13, v13, v7
 v_cvt_pk_bf16_f32 v42, v12, v13
 v_sub_f32 v14, v14, v6
 v_sub_f32 v15, v15, v6
 v_cvt_pk_bf16_f32 v5, v14, v15
 v_lshlrev_b32 v14, 16, v5
 v_and_b32 v15, 0xffff0000, v5
 v_mul_f32 v14, v14, v7
 v_mul_f32 v15, v15, v7
 v_cvt_pk_bf16_f32 v43, v14, v15
 v_sub_f32 v16, v16, v6
 v_sub_f32 v17, v17, v6
 v_cvt_pk_bf16_f32 v5, v16, v17
 v_lshlrev_b32 v16, 16, v5
 v_and_b32 v17, 0xffff0000, v5
 v_mul_f32 v16, v16, v7
 v_mul_f32 v17, v17, v7
 v_cvt_pk_bf16_f32 v44, v16, v17
 v_sub_f32 v18, v18, v6
 v_sub_f32 v19, v19, v6
 v_cvt_pk_bf16_f32 v5, v18, v19
 v_lshlrev_b32 v18, 16, v5
 v_and_b32 v19, 0xffff0000, v5
 v_mul_f32 v18, v18, v7
 v_mul_f32 v19, v19, v7
 v_cvt_pk_bf16_f32 v45, v18, v19
 v_sub_f32 v20, v20, v6
 v_sub_f32 v21, v21, v6
 v_cvt_pk_bf16_f32 v5, v20, v21
 v_lshlrev_b32 v20, 16, v5
 v_and_b32 v21, 0xffff0000, v5
 v_mul_f32 v20, v20, v7
 v_mul_f32 v21, v21, v7
 v_cvt_pk_bf16_f32 v46, v20, v21
 v_sub_f32 v22, v22, v6
 v_sub_f32 v23, v23, v6
 v_cvt_pk_bf16_f32 v5, v22, v23
 v_lshlrev_b32 v22, 16, v5
 v_and_b32 v23, 0xffff0000, v5
 v_mul_f32 v22, v22, v7
 v_mul_f32 v23, v23, v7
 v_cvt_pk_bf16_f32 v47, v22, v23
 ds_write_b128 v24, v[40:43]
 ds_write_b128 v24, v[44:47] offset:1024
 s_waitcnt lgkmcnt(0)
 s_barrier
 ds_read_b128 v[40:43], v25 offset:0
 ds_read_b128 v[44:47], v25 offset:256
 s_mov_b32 s36, 75497472
 s_waitcnt lgkmcnt(1)
 buffer_store_dwordx4 v[40:43], v26, s[8:11], s36 offen sc1
 s_mov_b32 s36, 75505664
 s_waitcnt lgkmcnt(0)
 buffer_store_dwordx4 v[44:47], v26, s[8:11], s36 offen sc1
 s_branch mega_loop
.p2align 4
mega_table:
.long 0x0,0x2000,0x1000000,0x0
.long 0x10000,0x2000,0x1000000,0x0
.long 0x20000,0x2000,0x1000000,0x0
.long 0x30000,0x2000,0x1000000,0x0
.long 0x40000,0x2400,0x1000000,0x0
.long 0x50000,0x2400,0x1000000,0x0
.long 0x60000,0x2400,0x1000000,0x0
.long 0x70000,0x2400,0x1000000,0x0
.long 0x80000,0x2800,0x1000000,0x0
.long 0x90000,0x2800,0x1000000,0x0
.long 0xa0000,0x2800,0x1000000,0x0
.long 0xb0000,0x2800,0x1000000,0x0
.long 0xc0000,0x2c00,0x1000000,0x0
.long 0xd0000,0x2c00,0x1000000,0x0
.long 0xe0000,0x2c00,0x1000000,0x0
.long 0xf0000,0x2c00,0x1000000,0x0
.long 0x100,0x6000,0x1000000,0x0
.long 0x10100,0x6000,0x1000000,0x0
.long 0x20100,0x6000,0x1000000,0x0
.long 0x30100,0x6000,0x1000000,0x0
.long 0x40100,0x6400,0x1000000,0x0
.long 0x50100,0x6400,0x1000000,0x0
.long 0x60100,0x6400,0x1000000,0x0
.long 0x70100,0x6400,0x1000000,0x0
.long 0x80100,0x6800,0x1000000,0x0
.long 0x90100,0x6800,0x1000000,0x0
.long 0xa0100,0x6800,0x1000000,0x0
.long 0xb0100,0x6800,0x1000000,0x0
.long 0xc0100,0x6c00,0x1000000,0x0
.long 0xd0100,0x6c00,0x1000000,0x0
.long 0xe0100,0x6c00,0x1000000,0x0
.long 0xf0100,0x6c00,0x1000000,0x0
.long 0x200,0xa000,0x1000000,0x0
.long 0x10200,0xa000,0x1000000,0x0
.long 0x20200,0xa000,0x1000000,0x0
.long 0x30200,0xa000,0x1000000,0x0
.long 0x40200,0xa400,0x1000000,0x0
.long 0x50200,0xa400,0x1000000,0x0
.long 0x60200,0xa400,0x1000000,0x0
.long 0x70200,0xa400,0x1000000,0x0
.long 0x80200,0xa800,0x1000000,0x0
.long 0x90200,0xa800,0x1000000,0x0
.long 0xa0200,0xa800,0x1000000,0x0
.long 0xb0200,0xa800,0x1000000,0x0
.long 0xc0200,0xac00,0x1000000,0x0
.long 0xd0200,0xac00,0x1000000,0x0
.long 0xe0200,0xac00,0x1000000,0x0
.long 0xf0200,0xac00,0x1000000,0x0
.long 0x300,0xe000,0x1000000,0x0
.long 0x10300,0xe000,0x1000000,0x0
.long 0x20300,0xe000,0x1000000,0x0
.long 0x30300,0xe000,0x1000000,0x0
.long 0x40300,0xe400,0x1000000,0x0
.long 0x50300,0xe400,0x1000000,0x0
.long 0x60300,0xe400,0x1000000,0x0
.long 0x70300,0xe400,0x1000000,0x0
.long 0x80300,0xe800,0x1000000,0x0
.long 0x90300,0xe800,0x1000000,0x0
.long 0xa0300,0xe800,0x1000000,0x0
.long 0xb0300,0xe800,0x1000000,0x0
.long 0xc0300,0xec00,0x1000000,0x0
.long 0xd0300,0xec00,0x1000000,0x0
.long 0xe0300,0xec00,0x1000000,0x0
.long 0xf0300,0xec00,0x1000000,0x0
.long 0x201,0x12000,0x1000000,0x0
.long 0x10201,0x12000,0x1000000,0x0
.long 0x20201,0x12000,0x1000000,0x0
.long 0x30201,0x12000,0x1000000,0x0
.long 0x40201,0x12400,0x1000000,0x0
.long 0x50201,0x12400,0x1000000,0x0
.long 0x60201,0x12400,0x1000000,0x0
.long 0x70201,0x12400,0x1000000,0x0
.long 0x80201,0x12800,0x1000000,0x0
.long 0x90201,0x12800,0x1000000,0x0
.long 0xa0201,0x12800,0x1000000,0x0
.long 0xb0201,0x12800,0x1000000,0x0
.long 0xc0201,0x12c00,0x1000000,0x0
.long 0xd0201,0x12c00,0x1000000,0x0
.long 0xe0201,0x12c00,0x1000000,0x0
.long 0xf0201,0x12c00,0x1000000,0x0
.long 0x301,0x1a000,0x1000000,0x0
.long 0x10301,0x1a000,0x1000000,0x0
.long 0x20301,0x1a000,0x1000000,0x0
.long 0x30301,0x1a000,0x1000000,0x0
.long 0x40301,0x1a400,0x1000000,0x0
.long 0x50301,0x1a400,0x1000000,0x0
.long 0x60301,0x1a400,0x1000000,0x0
.long 0x70301,0x1a400,0x1000000,0x0
.long 0x80301,0x1a800,0x1000000,0x0
.long 0x90301,0x1a800,0x1000000,0x0
.long 0xa0301,0x1a800,0x1000000,0x0
.long 0xb0301,0x1a800,0x1000000,0x0
.long 0xc0301,0x1ac00,0x1000000,0x0
.long 0xd0301,0x1ac00,0x1000000,0x0
.long 0xe0301,0x1ac00,0x1000000,0x0
.long 0xf0301,0x1ac00,0x1000000,0x0
.long 0x401,0x22000,0x2000000,0x0
.long 0x20401,0x22000,0x2000000,0x0
.long 0x40401,0x22400,0x2000000,0x0
.long 0x60401,0x22400,0x2000000,0x0
.long 0x80401,0x22800,0x2000000,0x0
.long 0xa0401,0x22800,0x2000000,0x0
.long 0xc0401,0x22c00,0x2000000,0x0
.long 0xe0401,0x22c00,0x2000000,0x0
.long 0x501,0x2a000,0x2000000,0x0
.long 0x20501,0x2a000,0x2000000,0x0
.long 0x40501,0x2a400,0x2000000,0x0
.long 0x60501,0x2a400,0x2000000,0x0
.long 0x80501,0x2a800,0x2000000,0x0
.long 0xa0501,0x2a800,0x2000000,0x0
.long 0xc0501,0x2ac00,0x2000000,0x0
.long 0xe0501,0x2ac00,0x2000000,0x0
.long 0x2,0x442008,0x0,0x0
.long 0x10002,0x442009,0x0,0x0
.long 0x20002,0x44200a,0x0,0x0
.long 0x30002,0x44200b,0x0,0x0
.long 0x102,0x442018,0x0,0x0
.long 0x10102,0x442019,0x0,0x0
.long 0x20102,0x44201a,0x0,0x0
.long 0x30102,0x44201b,0x0,0x0
.long 0x601,0x32000,0x2000000,0x0
.long 0x20601,0x32000,0x2000000,0x0
.long 0x40601,0x32400,0x2000000,0x0
.long 0x60601,0x32400,0x2000000,0x0
.long 0x80601,0x32800,0x2000000,0x0
.long 0xa0601,0x32800,0x2000000,0x0
.long 0xc0601,0x32c00,0x2000000,0x0
.long 0xe0601,0x32c00,0x2000000,0x0
.long 0x701,0x3a000,0x2000000,0x0
.long 0x20701,0x3a000,0x2000000,0x0
.long 0x40701,0x3a400,0x2000000,0x0
.long 0x60701,0x3a400,0x2000000,0x0
.long 0x80701,0x3a800,0x2000000,0x0
.long 0xa0701,0x3a800,0x2000000,0x0
.long 0xc0701,0x3ac00,0x2000000,0x0
.long 0xe0701,0x3ac00,0x2000000,0x0
.long 0x202,0x442828,0x0,0x0
.long 0x10202,0x442829,0x0,0x0
.long 0x20202,0x44282a,0x0,0x0
.long 0x30202,0x44282b,0x0,0x0
.long 0x302,0x442838,0x0,0x0
.long 0x10302,0x442839,0x0,0x0
.long 0x20302,0x44283a,0x0,0x0
.long 0x30302,0x44283b,0x0,0x0
.long 0x5,0x2052508,0x1800000,0x0
.long 0x10005,0x2052508,0x1800000,0x0
.long 0x402,0x443048,0x0,0x0
.long 0x10402,0x443049,0x0,0x0
.long 0x20402,0x44304a,0x0,0x0
.long 0x30402,0x44304b,0x0,0x0
.long 0x502,0x443448,0x0,0x0
.long 0x10502,0x443449,0x0,0x0
.long 0x20502,0x44344a,0x0,0x0
.long 0x30502,0x44344b,0x0,0x0
.long 0x105,0x2052d0a,0x1800000,0x0
.long 0x10105,0x2052d0a,0x1800000,0x0
.long 0x403,0x105350c,0x1400000,0x0
.long 0x10403,0x105350c,0x1400000,0x0
.long 0x503,0x105390d,0x1400000,0x0
.long 0x10503,0x105390d,0x1400000,0x0
.long 0x602,0x443868,0x0,0x0
.long 0x10602,0x443869,0x0,0x0
.long 0x20602,0x44386a,0x0,0x0
.long 0x30602,0x44386b,0x0,0x0
.long 0x603,0x1053d0e,0x1400000,0x0
.long 0x10603,0x1053d0e,0x1400000,0x0
.long 0x702,0x443c68,0x0,0x0
.long 0x10702,0x443c69,0x0,0x0
.long 0x20702,0x443c6a,0x0,0x0
.long 0x30702,0x443c6b,0x0,0x0
.long 0x703,0x105410f,0x1400000,0x0
.long 0x10703,0x105410f,0x1400000,0x0
.long 0x802,0x444088,0x0,0x0
.long 0x10802,0x444089,0x0,0x0
.long 0x20802,0x44408a,0x0,0x0
.long 0x30802,0x44408b,0x0,0x0
.long 0x406,0x84b14d,0x0,0x0
.long 0x10406,0x84b14d,0x0,0x0
.long 0x20406,0x84b14d,0x0,0x0
.long 0x30406,0x84b14d,0x0,0x0
.long 0x506,0x84b54e,0x0,0x0
.long 0x10506,0x84b54e,0x0,0x0
.long 0x20506,0x84b54e,0x0,0x0
.long 0x30506,0x84b54e,0x0,0x0
.long 0x403,0x104f12c,0x1100005,0x0
.long 0x10403,0x104f12c,0x1100005,0x0
.long 0x20403,0x104f12c,0x1100005,0x0
.long 0x30403,0x104f12c,0x1100005,0x0
.long 0x40403,0x104f12c,0x1100005,0x0
.long 0x50403,0x104f12c,0x1100005,0x0
.long 0x60403,0x104f12c,0x1100005,0x0
.long 0x503,0x104f52d,0x1100005,0x0
.long 0x10503,0x104f52d,0x1100005,0x0
.long 0x20503,0x104f52d,0x1100005,0x0
.long 0x30503,0x104f52d,0x1100005,0x0
.long 0x40503,0x104f52d,0x1100005,0x0
.long 0x50503,0x104f52d,0x1100005,0x0
.long 0x60503,0x104f52d,0x1100005,0x0
.long 0x803,0x1054510,0x1400000,0x0
.long 0x10803,0x1054510,0x1400000,0x0
.long 0x902,0x444488,0x0,0x0
.long 0x10902,0x444489,0x0,0x0
.long 0x20902,0x44448a,0x0,0x0
.long 0x30902,0x44448b,0x0,0x0
.long 0x606,0x84b94f,0x0,0x0
.long 0x10606,0x84b94f,0x0,0x0
.long 0x20606,0x84b94f,0x0,0x0
.long 0x30606,0x84b94f,0x0,0x0
.long 0x603,0x104f92e,0x2100005,0x0
.long 0x20603,0x104f92e,0x2100005,0x0
.long 0x40603,0x104f92e,0x2100005,0x0
.long 0x60603,0x104f92e,0x1100005,0x0
.long 0x403,0x1c5213c,0x1380002,0x0
.long 0x10403,0x1c5213c,0x1380002,0x0
.long 0x503,0x1c5213d,0x1380002,0x0
.long 0x10503,0x1c5213d,0x1380002,0x0
.long 0x903,0x1054911,0x1400000,0x0
.long 0x10903,0x1054911,0x1400000,0x0
.long 0x6,0x84a149,0x0,0x0
.long 0x10006,0x84a149,0x0,0x0
.long 0x20006,0x84a149,0x0,0x0
.long 0x30006,0x84a149,0x0,0x0
.long 0x106,0x84a149,0x0,0x0
.long 0x10106,0x84a149,0x0,0x0
.long 0x20106,0x84a149,0x0,0x0
.long 0x30106,0x84a149,0x0,0x0
.long 0x5,0x204e128,0x1200005,0x0
.long 0x10005,0x204e128,0x1200005,0x0
.long 0x20005,0x204e128,0x1200005,0x0
.long 0x30005,0x204e128,0x1200005,0x0
.long 0x40005,0x204e128,0x1200005,0x0
.long 0x50005,0x204e128,0x1200005,0x0
.long 0x60005,0x204e128,0x1200005,0x0
.long 0xa02,0x4448a8,0x0,0x0
.long 0x10a02,0x4448a9,0x0,0x0
.long 0x20a02,0x4448aa,0x0,0x0
.long 0x30a02,0x4448ab,0x0,0x0
.long 0x706,0x84bd50,0x0,0x0
.long 0x10706,0x84bd50,0x0,0x0
.long 0x20706,0x84bd50,0x0,0x0
.long 0x30706,0x84bd50,0x0,0x0
.long 0x206,0x84a94b,0x0,0x0
.long 0x10206,0x84a94b,0x0,0x0
.long 0x20206,0x84a94b,0x0,0x0
.long 0x30206,0x84a94b,0x0,0x0
.long 0x306,0x84a94b,0x0,0x0
.long 0x10306,0x84a94b,0x0,0x0
.long 0x20306,0x84a94b,0x0,0x0
.long 0x30306,0x84a94b,0x0,0x0
.long 0x703,0x104fd2f,0x2100005,0x0
.long 0x20703,0x104fd2f,0x2100005,0x0
.long 0x40703,0x104fd2f,0x2100005,0x0
.long 0x60703,0x104fd2f,0x1100005,0x0
.long 0x105,0x204e92a,0x1200005,0x0
.long 0x10105,0x204e92a,0x1200005,0x0
.long 0x20105,0x204e92a,0x1200005,0x0
.long 0x30105,0x204e92a,0x1200005,0x0
.long 0x40105,0x204e92a,0x1200005,0x0
.long 0x50105,0x204e92a,0x1200005,0x0
.long 0xa03,0x1054d12,0x1400000,0x0
.long 0x10a03,0x1054d12,0x1400000,0x0
.long 0x60105,0x204e92a,0x1200005,0x0
.long 0xb02,0x444ca8,0x0,0x0
.long 0x10b02,0x444ca9,0x0,0x0
.long 0x20b02,0x444caa,0x0,0x0
.long 0x30b02,0x444cab,0x0,0x0
.long 0x806,0x84c151,0x0,0x0
.long 0x10806,0x84c151,0x0,0x0
.long 0x20806,0x84c151,0x0,0x0
.long 0x30806,0x84c151,0x0,0x0
.long 0x5,0x1c52138,0x1700002,0x0
.long 0x10005,0x1c52138,0x1700002,0x0
.long 0x603,0x1c5213e,0x1380002,0x0
.long 0x10603,0x1c5213e,0x1380002,0x0
.long 0x803,0x1050130,0x2100005,0x0
.long 0x20803,0x1050130,0x2100005,0x0
.long 0x40803,0x1050130,0x2100005,0x0
.long 0x60803,0x1050130,0x1100005,0x0
.long 0xb03,0x1055113,0x1400000,0x0
.long 0x10b03,0x1055113,0x1400000,0x0
.long 0x105,0x1c5213a,0x1700002,0x0
.long 0x10105,0x1c5213a,0x1700002,0x0
.long 0xc02,0x4450c8,0x0,0x0
.long 0x10c02,0x4450c9,0x0,0x0
.long 0x20c02,0x4450ca,0x0,0x0
.long 0x30c02,0x4450cb,0x0,0x0
.long 0x906,0x84c552,0x0,0x0
.long 0x10906,0x84c552,0x0,0x0
.long 0x20906,0x84c552,0x0,0x0
.long 0x30906,0x84c552,0x0,0x0
.long 0x703,0x1c5213f,0x1380002,0x0
.long 0x10703,0x1c5213f,0x1380002,0x0
.long 0x903,0x1050531,0x2100005,0x0
.long 0x20903,0x1050531,0x2100005,0x0
.long 0x40903,0x1050531,0x2100005,0x0
.long 0x60903,0x1050531,0x1100005,0x0
.long 0xc03,0x1055514,0x1200008,0xab00000
.long 0x10c03,0x1055514,0x1200008,0xab00000
.long 0xc03,0x1055514,0x1202008,0xab80000
.long 0x10c03,0x1055514,0x1202008,0xab80000
.long 0xd02,0x4454c8,0x0,0x0
.long 0x10d02,0x4454c9,0x0,0x0
.long 0x20d02,0x4454ca,0x0,0x0
.long 0x30d02,0x4454cb,0x0,0x0
.long 0xa06,0x84c953,0x0,0x0
.long 0x10a06,0x84c953,0x0,0x0
.long 0x20a06,0x84c953,0x0,0x0
.long 0x30a06,0x84c953,0x0,0x0
.long 0x803,0x1c52140,0x1380002,0x0
.long 0x10803,0x1c52140,0x1380002,0x0
.long 0xa03,0x1050932,0x1100005,0x0
.long 0x10a03,0x1050932,0x1100005,0x0
.long 0x20a03,0x1050932,0x1100005,0x0
.long 0x30a03,0x1050932,0x1100005,0x0
.long 0x40a03,0x1050932,0x1100005,0x0
.long 0x50a03,0x1050932,0x1100005,0x0
.long 0x60a03,0x1050932,0x1100005,0x0
.long 0xd03,0x1055915,0x1200008,0xad00000
.long 0x10d03,0x1055915,0x1200008,0xad00000
.long 0xd03,0x1055915,0x1202008,0xad80000
.long 0x10d03,0x1055915,0x1202008,0xad80000
.long 0xc04,0x104d155,0x200,0xab00000
.long 0x10c04,0x104d155,0x200,0xab00000
.long 0x20c04,0x104d155,0x200,0xab00000
.long 0x30c04,0x104d155,0x200,0xab00000
.long 0x40c04,0x104d155,0x200,0xab00000
.long 0x50c04,0x104d155,0x200,0xab00000
.long 0x60c04,0x104d155,0x200,0xab00000
.long 0x70c04,0x104d155,0x200,0xab00000
.long 0xe02,0x4458e8,0x0,0x0
.long 0x10e02,0x4458e9,0x0,0x0
.long 0x20e02,0x4458ea,0x0,0x0
.long 0x30e02,0x4458eb,0x0,0x0
.long 0xb06,0x84cd54,0x0,0x0
.long 0x10b06,0x84cd54,0x0,0x0
.long 0x20b06,0x84cd54,0x0,0x0
.long 0x30b06,0x84cd54,0x0,0x0
.long 0x903,0x1c52141,0x1380002,0x0
.long 0x10903,0x1c52141,0x1380002,0x0
.long 0xa03,0x1c52142,0x1380002,0x0
.long 0x10a03,0x1c52142,0x1380002,0x0
.long 0xc03,0x2051134,0x1100005,0x0
.long 0x10c03,0x2051134,0x1100005,0x0
.long 0x20c03,0x2051134,0x1100005,0x0
.long 0x30c03,0x2051134,0x1100005,0x0
.long 0x40c03,0x2051134,0x1100005,0x0
.long 0x50c03,0x2051134,0x1100005,0x0
.long 0x60c03,0x2051134,0x1100005,0x0
.long 0xb03,0x1050d33,0x1100005,0x0
.long 0x10b03,0x1050d33,0x1100005,0x0
.long 0x20b03,0x1050d33,0x1100005,0x0
.long 0x30b03,0x1050d33,0x1100005,0x0
.long 0x40b03,0x1050d33,0x1100005,0x0
.long 0x50b03,0x1050d33,0x1100005,0x0
.long 0x60b03,0x1050d33,0x1100005,0x0
.long 0xe03,0x1055d16,0x1100008,0xb000000
.long 0x10e03,0x1055d16,0x1100008,0xb000000
.long 0xe03,0x1055d16,0x1101008,0xb080000
.long 0x10e03,0x1055d16,0x1101008,0xb080000
.long 0xe03,0x1055d16,0x1102008,0xb100000
.long 0x10e03,0x1055d16,0x1102008,0xb100000
.long 0xe03,0x1055d16,0x1103008,0xb180000
.long 0x10e03,0x1055d16,0x1103008,0xb180000
.long 0xd04,0x104d556,0x200,0xad00000
.long 0x10d04,0x104d556,0x200,0xad00000
.long 0x20d04,0x104d556,0x200,0xad00000
.long 0x30d04,0x104d556,0x200,0xad00000
.long 0x40d04,0x104d556,0x200,0xad00000
.long 0x50d04,0x104d556,0x200,0xad00000
.long 0x60d04,0x104d556,0x200,0xad00000
.long 0x70d04,0x104d556,0x200,0xad00000
.long 0xc03,0x1c59544,0x11c000a,0xac00000
.long 0x10c03,0x1c59544,0x11c000a,0xac00000
.long 0xc03,0x1c59544,0x11c1c0a,0xac80000
.long 0xb03,0x1c59143,0x11c000a,0xaa00000
.long 0x10b03,0x1c59143,0x11c000a,0xaa00000
.long 0xb03,0x1c59143,0x11c1c0a,0xaa80000
.long 0x10b03,0x1c59143,0x11c1c0a,0xaa80000
.long 0x10c03,0x1c59544,0x11c1c0a,0xac80000
.long 0xd03,0x2051535,0x1100005,0x0
.long 0x10d03,0x2051535,0x1100005,0x0
.long 0x20d03,0x2051535,0x1100005,0x0
.long 0x30d03,0x2051535,0x1100005,0x0
.long 0x40d03,0x2051535,0x1100005,0x0
.long 0x50d03,0x2051535,0x1100005,0x0
.long 0x60d03,0x2051535,0x1100005,0x0
.long 0xe04,0x204d957,0x400,0xb000000
.long 0x10e04,0x204d957,0x400,0xb000000
.long 0x20e04,0x204d957,0x400,0xb000000
.long 0x30e04,0x204d957,0x400,0xb000000
.long 0x40e04,0x204d957,0x400,0xb000000
.long 0x50e04,0x204d957,0x400,0xb000000
.long 0x60e04,0x204d957,0x400,0xb000000
.long 0x70e04,0x204d957,0x400,0xb000000
.long 0xe03,0x2051936,0x1100005,0x0
.long 0x10e03,0x2051936,0x1100005,0x0
.long 0x20e03,0x2051936,0x1100005,0x0
.long 0x30e03,0x2051936,0x1100005,0x0
.long 0x40e03,0x2051936,0x1100005,0x0
.long 0x50e03,0x2051936,0x1100005,0x0
.long 0x60e03,0x2051936,0x1100005,0x0
.long 0xd03,0x1c59945,0x10e000a,0xae00000
.long 0x10d03,0x1c59945,0x10e000a,0xae00000
.long 0xd03,0x1c59945,0x10e0e0a,0xae80000
.long 0x10d03,0x1c59945,0x10e0e0a,0xae80000
.long 0xd03,0x1c59945,0x10e1c0a,0xaf00000
.long 0x10d03,0x1c59945,0x10e1c0a,0xaf00000
.long 0xd03,0x1c59945,0x10e2a0a,0xaf80000
.long 0x10d03,0x1c59945,0x10e2a0a,0xaf80000
.long 0xb04,0x1052164,0x202,0xaa00000
.long 0x10b04,0x1052164,0x202,0xaa00000
.long 0x20b04,0x1052164,0x202,0xaa00000
.long 0x30b04,0x1052164,0x202,0xaa00000
.long 0x40b04,0x1052164,0x202,0xaa00000
.long 0x50b04,0x1052164,0x202,0xaa00000
.long 0x60b04,0x1052164,0x202,0xaa00000
.long 0x70b04,0x1052164,0x202,0xaa00000
.long 0xc04,0x1052165,0x202,0xac00000
.long 0x10c04,0x1052165,0x202,0xac00000
.long 0x20c04,0x1052165,0x202,0xac00000
.long 0x30c04,0x1052165,0x202,0xac00000
.long 0x40c04,0x1052165,0x202,0xac00000
.long 0x50c04,0x1052165,0x202,0xac00000
.long 0x60c04,0x1052165,0x202,0xac00000
.long 0x70c04,0x1052165,0x202,0xac00000
.long 0xe03,0x1c59d46,0x10e000a,0xb200000
.long 0x10e03,0x1c59d46,0x10e000a,0xb200000
.long 0xe03,0x1c59d46,0x10e0e0a,0xb280000
.long 0x10e03,0x1c59d46,0x10e0e0a,0xb280000
.long 0xe03,0x1c59d46,0x10e1c0a,0xb300000
.long 0x10e03,0x1c59d46,0x10e1c0a,0xb300000
.long 0xe03,0x1c59d46,0x10e2a0a,0xb380000
.long 0x10e03,0x1c59d46,0x10e2a0a,0xb380000
.long 0xd04,0x2052166,0x402,0xae00000
.long 0x10d04,0x2052166,0x402,0xae00000
.long 0x20d04,0x2052166,0x402,0xae00000
.long 0x30d04,0x2052166,0x402,0xae00000
.long 0x40d04,0x2052166,0x402,0xae00000
.long 0x50d04,0x2052166,0x402,0xae00000
.long 0x60d04,0x2052166,0x402,0xae00000
.long 0x70d04,0x2052166,0x402,0xae00000
.long 0xe04,0x2052167,0x402,0xb200000
.long 0x10e04,0x2052167,0x402,0xb200000
.long 0x20e04,0x2052167,0x402,0xb200000
.long 0x30e04,0x2052167,0x402,0xb200000
.long 0x40e04,0x2052167,0x402,0xb200000
.long 0x50e04,0x2052167,0x402,0xb200000
.long 0x60e04,0x2052167,0x402,0xb200000
.long 0x70e04,0x2052167,0x402,0xb200000
.long -1,-1,-1,-1
.long 0x100000,0x3000,0x1000000,0x0
.long 0x110000,0x3000,0x1000000,0x0
.long 0x120000,0x3000,0x1000000,0x0
.long 0x130000,0x3000,0x1000000,0x0
.long 0x140000,0x3400,0x1000000,0x0
.long 0x150000,0x3400,0x1000000,0x0
.long 0x160000,0x3400,0x1000000,0x0
.long 0x170000,0x3400,0x1000000,0x0
.long 0x180000,0x3800,0x1000000,0x0
.long 0x190000,0x3800,0x1000000,0x0
.long 0x1a0000,0x3800,0x1000000,0x0
.long 0x1b0000,0x3800,0x1000000,0x0
.long 0x1c0000,0x3c00,0x1000000,0x0
.long 0x1d0000,0x3c00,0x1000000,0x0
.long 0x1e0000,0x3c00,0x1000000,0x0
.long 0x1f0000,0x3c00,0x1000000,0x0
.long 0x100100,0x7000,0x1000000,0x0
.long 0x110100,0x7000,0x1000000,0x0
.long 0x120100,0x7000,0x1000000,0x0
.long 0x130100,0x7000,0x1000000,0x0
.long 0x140100,0x7400,0x1000000,0x0
.long 0x150100,0x7400,0x1000000,0x0
.long 0x160100,0x7400,0x1000000,0x0
.long 0x170100,0x7400,0x1000000,0x0
.long 0x180100,0x7800,0x1000000,0x0
.long 0x190100,0x7800,0x1000000,0x0
.long 0x1a0100,0x7800,0x1000000,0x0
.long 0x1b0100,0x7800,0x1000000,0x0
.long 0x1c0100,0x7c00,0x1000000,0x0
.long 0x1d0100,0x7c00,0x1000000,0x0
.long 0x1e0100,0x7c00,0x1000000,0x0
.long 0x1f0100,0x7c00,0x1000000,0x0
.long 0x100200,0xb000,0x1000000,0x0
.long 0x110200,0xb000,0x1000000,0x0
.long 0x120200,0xb000,0x1000000,0x0
.long 0x130200,0xb000,0x1000000,0x0
.long 0x140200,0xb400,0x1000000,0x0
.long 0x150200,0xb400,0x1000000,0x0
.long 0x160200,0xb400,0x1000000,0x0
.long 0x170200,0xb400,0x1000000,0x0
.long 0x180200,0xb800,0x1000000,0x0
.long 0x190200,0xb800,0x1000000,0x0
.long 0x1a0200,0xb800,0x1000000,0x0
.long 0x1b0200,0xb800,0x1000000,0x0
.long 0x1c0200,0xbc00,0x1000000,0x0
.long 0x1d0200,0xbc00,0x1000000,0x0
.long 0x1e0200,0xbc00,0x1000000,0x0
.long 0x1f0200,0xbc00,0x1000000,0x0
.long 0x100300,0xf000,0x1000000,0x0
.long 0x110300,0xf000,0x1000000,0x0
.long 0x120300,0xf000,0x1000000,0x0
.long 0x130300,0xf000,0x1000000,0x0
.long 0x140300,0xf400,0x1000000,0x0
.long 0x150300,0xf400,0x1000000,0x0
.long 0x160300,0xf400,0x1000000,0x0
.long 0x170300,0xf400,0x1000000,0x0
.long 0x180300,0xf800,0x1000000,0x0
.long 0x190300,0xf800,0x1000000,0x0
.long 0x1a0300,0xf800,0x1000000,0x0
.long 0x1b0300,0xf800,0x1000000,0x0
.long 0x1c0300,0xfc00,0x1000000,0x0
.long 0x1d0300,0xfc00,0x1000000,0x0
.long 0x1e0300,0xfc00,0x1000000,0x0
.long 0x1f0300,0xfc00,0x1000000,0x0
.long 0x100201,0x13000,0x1000000,0x0
.long 0x110201,0x13000,0x1000000,0x0
.long 0x120201,0x13000,0x1000000,0x0
.long 0x130201,0x13000,0x1000000,0x0
.long 0x140201,0x13400,0x1000000,0x0
.long 0x150201,0x13400,0x1000000,0x0
.long 0x160201,0x13400,0x1000000,0x0
.long 0x170201,0x13400,0x1000000,0x0
.long 0x180201,0x13800,0x1000000,0x0
.long 0x190201,0x13800,0x1000000,0x0
.long 0x1a0201,0x13800,0x1000000,0x0
.long 0x1b0201,0x13800,0x1000000,0x0
.long 0x1c0201,0x13c00,0x1000000,0x0
.long 0x1d0201,0x13c00,0x1000000,0x0
.long 0x1e0201,0x13c00,0x1000000,0x0
.long 0x1f0201,0x13c00,0x1000000,0x0
.long 0x100301,0x1b000,0x1000000,0x0
.long 0x110301,0x1b000,0x1000000,0x0
.long 0x120301,0x1b000,0x1000000,0x0
.long 0x130301,0x1b000,0x1000000,0x0
.long 0x140301,0x1b400,0x1000000,0x0
.long 0x150301,0x1b400,0x1000000,0x0
.long 0x160301,0x1b400,0x1000000,0x0
.long 0x170301,0x1b400,0x1000000,0x0
.long 0x180301,0x1b800,0x1000000,0x0
.long 0x190301,0x1b800,0x1000000,0x0
.long 0x1a0301,0x1b800,0x1000000,0x0
.long 0x1b0301,0x1b800,0x1000000,0x0
.long 0x1c0301,0x1bc00,0x1000000,0x0
.long 0x1d0301,0x1bc00,0x1000000,0x0
.long 0x1e0301,0x1bc00,0x1000000,0x0
.long 0x1f0301,0x1bc00,0x1000000,0x0
.long 0x100401,0x23000,0x2000000,0x0
.long 0x120401,0x23000,0x2000000,0x0
.long 0x140401,0x23400,0x2000000,0x0
.long 0x160401,0x23400,0x2000000,0x0
.long 0x180401,0x23800,0x2000000,0x0
.long 0x1a0401,0x23800,0x2000000,0x0
.long 0x1c0401,0x23c00,0x2000000,0x0
.long 0x1e0401,0x23c00,0x2000000,0x0
.long 0x100501,0x2b000,0x2000000,0x0
.long 0x120501,0x2b000,0x2000000,0x0
.long 0x140501,0x2b400,0x2000000,0x0
.long 0x160501,0x2b400,0x2000000,0x0
.long 0x180501,0x2b800,0x2000000,0x0
.long 0x1a0501,0x2b800,0x2000000,0x0
.long 0x1c0501,0x2bc00,0x2000000,0x0
.long 0x1e0501,0x2bc00,0x2000000,0x0
.long 0x40002,0x44200c,0x0,0x0
.long 0x50002,0x44200d,0x0,0x0
.long 0x60002,0x44200e,0x0,0x0
.long 0x70002,0x44200f,0x0,0x0
.long 0x40102,0x44201c,0x0,0x0
.long 0x50102,0x44201d,0x0,0x0
.long 0x60102,0x44201e,0x0,0x0
.long 0x70102,0x44201f,0x0,0x0
.long 0x100601,0x33000,0x2000000,0x0
.long 0x120601,0x33000,0x2000000,0x0
.long 0x140601,0x33400,0x2000000,0x0
.long 0x160601,0x33400,0x2000000,0x0
.long 0x180601,0x33800,0x2000000,0x0
.long 0x1a0601,0x33800,0x2000000,0x0
.long 0x1c0601,0x33c00,0x2000000,0x0
.long 0x1e0601,0x33c00,0x2000000,0x0
.long 0x100701,0x3b000,0x2000000,0x0
.long 0x120701,0x3b000,0x2000000,0x0
.long 0x140701,0x3b400,0x2000000,0x0
.long 0x160701,0x3b400,0x2000000,0x0
.long 0x180701,0x3b800,0x2000000,0x0
.long 0x1a0701,0x3b800,0x2000000,0x0
.long 0x1c0701,0x3bc00,0x2000000,0x0
.long 0x1e0701,0x3bc00,0x2000000,0x0
.long 0x40202,0x44282c,0x0,0x0
.long 0x50202,0x44282d,0x0,0x0
.long 0x60202,0x44282e,0x0,0x0
.long 0x70202,0x44282f,0x0,0x0
.long 0x40302,0x44283c,0x0,0x0
.long 0x50302,0x44283d,0x0,0x0
.long 0x60302,0x44283e,0x0,0x0
.long 0x70302,0x44283f,0x0,0x0
.long 0x20005,0x2052508,0x1800000,0x0
.long 0x30005,0x2052508,0x1800000,0x0
.long 0x40402,0x44304c,0x0,0x0
.long 0x50402,0x44304d,0x0,0x0
.long 0x60402,0x44304e,0x0,0x0
.long 0x70402,0x44304f,0x0,0x0
.long 0x40502,0x44344c,0x0,0x0
.long 0x50502,0x44344d,0x0,0x0
.long 0x60502,0x44344e,0x0,0x0
.long 0x70502,0x44344f,0x0,0x0
.long 0x20105,0x2052d0a,0x1800000,0x0
.long 0x30105,0x2052d0a,0x1800000,0x0
.long 0x20403,0x105350c,0x1400000,0x0
.long 0x30403,0x105350c,0x1400000,0x0
.long 0x20503,0x105390d,0x1400000,0x0
.long 0x30503,0x105390d,0x1400000,0x0
.long 0x40602,0x44386c,0x0,0x0
.long 0x50602,0x44386d,0x0,0x0
.long 0x60602,0x44386e,0x0,0x0
.long 0x70602,0x44386f,0x0,0x0
.long 0x20603,0x1053d0e,0x1400000,0x0
.long 0x30603,0x1053d0e,0x1400000,0x0
.long 0x40702,0x443c6c,0x0,0x0
.long 0x50702,0x443c6d,0x0,0x0
.long 0x60702,0x443c6e,0x0,0x0
.long 0x70702,0x443c6f,0x0,0x0
.long 0x20703,0x105410f,0x1400000,0x0
.long 0x30703,0x105410f,0x1400000,0x0
.long 0x40802,0x44408c,0x0,0x0
.long 0x50802,0x44408d,0x0,0x0
.long 0x60802,0x44408e,0x0,0x0
.long 0x70802,0x44408f,0x0,0x0
.long 0x40406,0x84b14d,0x0,0x0
.long 0x50406,0x84b14d,0x0,0x0
.long 0x60406,0x84b14d,0x0,0x0
.long 0x70406,0x84b14d,0x0,0x0
.long 0x40506,0x84b54e,0x0,0x0
.long 0x50506,0x84b54e,0x0,0x0
.long 0x60506,0x84b54e,0x0,0x0
.long 0x70506,0x84b54e,0x0,0x0
.long 0x70403,0x104f12c,0x1100005,0x0
.long 0x80403,0x104f12c,0x1100005,0x0
.long 0x90403,0x104f12c,0x1100005,0x0
.long 0xa0403,0x104f12c,0x1100005,0x0
.long 0xb0403,0x104f12c,0x1100005,0x0
.long 0xc0403,0x104f12c,0x1100005,0x0
.long 0xd0403,0x104f12c,0x1100005,0x0
.long 0x70503,0x104f52d,0x1100005,0x0
.long 0x80503,0x104f52d,0x1100005,0x0
.long 0x90503,0x104f52d,0x1100005,0x0
.long 0xa0503,0x104f52d,0x1100005,0x0
.long 0xb0503,0x104f52d,0x1100005,0x0
.long 0xc0503,0x104f52d,0x1100005,0x0
.long 0xd0503,0x104f52d,0x1100005,0x0
.long 0x20803,0x1054510,0x1400000,0x0
.long 0x30803,0x1054510,0x1400000,0x0
.long 0x40902,0x44448c,0x0,0x0
.long 0x50902,0x44448d,0x0,0x0
.long 0x60902,0x44448e,0x0,0x0
.long 0x70902,0x44448f,0x0,0x0
.long 0x40606,0x84b94f,0x0,0x0
.long 0x50606,0x84b94f,0x0,0x0
.long 0x60606,0x84b94f,0x0,0x0
.long 0x70606,0x84b94f,0x0,0x0
.long 0x70603,0x104f92e,0x2100005,0x0
.long 0x90603,0x104f92e,0x2100005,0x0
.long 0xb0603,0x104f92e,0x2100005,0x0
.long 0xd0603,0x104f92e,0x1100005,0x0
.long 0x20403,0x1c5213c,0x1380002,0x0
.long 0x30403,0x1c5213c,0x1380002,0x0
.long 0x20503,0x1c5213d,0x1380002,0x0
.long 0x30503,0x1c5213d,0x1380002,0x0
.long 0x20903,0x1054911,0x1400000,0x0
.long 0x30903,0x1054911,0x1400000,0x0
.long 0x40006,0x84a149,0x0,0x0
.long 0x50006,0x84a149,0x0,0x0
.long 0x60006,0x84a149,0x0,0x0
.long 0x70006,0x84a149,0x0,0x0
.long 0x40106,0x84a149,0x0,0x0
.long 0x50106,0x84a149,0x0,0x0
.long 0x60106,0x84a149,0x0,0x0
.long 0x70106,0x84a149,0x0,0x0
.long 0x70005,0x204e128,0x1200005,0x0
.long 0x80005,0x204e128,0x1200005,0x0
.long 0x90005,0x204e128,0x1200005,0x0
.long 0xa0005,0x204e128,0x1200005,0x0
.long 0xb0005,0x204e128,0x1200005,0x0
.long 0xc0005,0x204e128,0x1200005,0x0
.long 0xd0005,0x204e128,0x1200005,0x0
.long 0x40a02,0x4448ac,0x0,0x0
.long 0x50a02,0x4448ad,0x0,0x0
.long 0x60a02,0x4448ae,0x0,0x0
.long 0x70a02,0x4448af,0x0,0x0
.long 0x40706,0x84bd50,0x0,0x0
.long 0x50706,0x84bd50,0x0,0x0
.long 0x60706,0x84bd50,0x0,0x0
.long 0x70706,0x84bd50,0x0,0x0
.long 0x40206,0x84a94b,0x0,0x0
.long 0x50206,0x84a94b,0x0,0x0
.long 0x60206,0x84a94b,0x0,0x0
.long 0x70206,0x84a94b,0x0,0x0
.long 0x40306,0x84a94b,0x0,0x0
.long 0x50306,0x84a94b,0x0,0x0
.long 0x60306,0x84a94b,0x0,0x0
.long 0x70306,0x84a94b,0x0,0x0
.long 0x70703,0x104fd2f,0x2100005,0x0
.long 0x90703,0x104fd2f,0x2100005,0x0
.long 0xb0703,0x104fd2f,0x2100005,0x0
.long 0xd0703,0x104fd2f,0x1100005,0x0
.long 0x70105,0x204e92a,0x1200005,0x0
.long 0x80105,0x204e92a,0x1200005,0x0
.long 0x90105,0x204e92a,0x1200005,0x0
.long 0xa0105,0x204e92a,0x1200005,0x0
.long 0xb0105,0x204e92a,0x1200005,0x0
.long 0xc0105,0x204e92a,0x1200005,0x0
.long 0x20a03,0x1054d12,0x1400000,0x0
.long 0x30a03,0x1054d12,0x1400000,0x0
.long 0xd0105,0x204e92a,0x1200005,0x0
.long 0x40b02,0x444cac,0x0,0x0
.long 0x50b02,0x444cad,0x0,0x0
.long 0x60b02,0x444cae,0x0,0x0
.long 0x70b02,0x444caf,0x0,0x0
.long 0x40806,0x84c151,0x0,0x0
.long 0x50806,0x84c151,0x0,0x0
.long 0x60806,0x84c151,0x0,0x0
.long 0x70806,0x84c151,0x0,0x0
.long 0x20005,0x1c52138,0x1700002,0x0
.long 0x30005,0x1c52138,0x1700002,0x0
.long 0x20603,0x1c5213e,0x1380002,0x0
.long 0x30603,0x1c5213e,0x1380002,0x0
.long 0x70803,0x1050130,0x2100005,0x0
.long 0x90803,0x1050130,0x2100005,0x0
.long 0xb0803,0x1050130,0x2100005,0x0
.long 0xd0803,0x1050130,0x1100005,0x0
.long 0x20b03,0x1055113,0x1400000,0x0
.long 0x30b03,0x1055113,0x1400000,0x0
.long 0x20105,0x1c5213a,0x1700002,0x0
.long 0x30105,0x1c5213a,0x1700002,0x0
.long 0x40c02,0x4450cc,0x0,0x0
.long 0x50c02,0x4450cd,0x0,0x0
.long 0x60c02,0x4450ce,0x0,0x0
.long 0x70c02,0x4450cf,0x0,0x0
.long 0x40906,0x84c552,0x0,0x0
.long 0x50906,0x84c552,0x0,0x0
.long 0x60906,0x84c552,0x0,0x0
.long 0x70906,0x84c552,0x0,0x0
.long 0x20703,0x1c5213f,0x1380002,0x0
.long 0x30703,0x1c5213f,0x1380002,0x0
.long 0x70903,0x1050531,0x2100005,0x0
.long 0x90903,0x1050531,0x2100005,0x0
.long 0xb0903,0x1050531,0x2100005,0x0
.long 0xd0903,0x1050531,0x1100005,0x0
.long 0x20c03,0x1055514,0x1200008,0xab00000
.long 0x30c03,0x1055514,0x1200008,0xab00000
.long 0x20c03,0x1055514,0x1202008,0xab80000
.long 0x30c03,0x1055514,0x1202008,0xab80000
.long 0x40d02,0x4454cc,0x0,0x0
.long 0x50d02,0x4454cd,0x0,0x0
.long 0x60d02,0x4454ce,0x0,0x0
.long 0x70d02,0x4454cf,0x0,0x0
.long 0x40a06,0x84c953,0x0,0x0
.long 0x50a06,0x84c953,0x0,0x0
.long 0x60a06,0x84c953,0x0,0x0
.long 0x70a06,0x84c953,0x0,0x0
.long 0x20803,0x1c52140,0x1380002,0x0
.long 0x30803,0x1c52140,0x1380002,0x0
.long 0x70a03,0x1050932,0x1100005,0x0
.long 0x80a03,0x1050932,0x1100005,0x0
.long 0x90a03,0x1050932,0x1100005,0x0
.long 0xa0a03,0x1050932,0x1100005,0x0
.long 0xb0a03,0x1050932,0x1100005,0x0
.long 0xc0a03,0x1050932,0x1100005,0x0
.long 0xd0a03,0x1050932,0x1100005,0x0
.long 0x20d03,0x1055915,0x1200008,0xad00000
.long 0x30d03,0x1055915,0x1200008,0xad00000
.long 0x20d03,0x1055915,0x1202008,0xad80000
.long 0x30d03,0x1055915,0x1202008,0xad80000
.long 0x80c04,0x104d155,0x200,0xab00000
.long 0x90c04,0x104d155,0x200,0xab00000
.long 0xa0c04,0x104d155,0x200,0xab00000
.long 0xb0c04,0x104d155,0x200,0xab00000
.long 0xc0c04,0x104d155,0x200,0xab00000
.long 0xd0c04,0x104d155,0x200,0xab00000
.long 0xe0c04,0x104d155,0x200,0xab00000
.long 0xf0c04,0x104d155,0x200,0xab00000
.long 0x40e02,0x4458ec,0x0,0x0
.long 0x50e02,0x4458ed,0x0,0x0
.long 0x60e02,0x4458ee,0x0,0x0
.long 0x70e02,0x4458ef,0x0,0x0
.long 0x40b06,0x84cd54,0x0,0x0
.long 0x50b06,0x84cd54,0x0,0x0
.long 0x60b06,0x84cd54,0x0,0x0
.long 0x70b06,0x84cd54,0x0,0x0
.long 0x20903,0x1c52141,0x1380002,0x0
.long 0x30903,0x1c52141,0x1380002,0x0
.long 0x20a03,0x1c52142,0x1380002,0x0
.long 0x30a03,0x1c52142,0x1380002,0x0
.long 0x70c03,0x2051134,0x1100005,0x0
.long 0x80c03,0x2051134,0x1100005,0x0
.long 0x90c03,0x2051134,0x1100005,0x0
.long 0xa0c03,0x2051134,0x1100005,0x0
.long 0xb0c03,0x2051134,0x1100005,0x0
.long 0xc0c03,0x2051134,0x1100005,0x0
.long 0xd0c03,0x2051134,0x1100005,0x0
.long 0x70b03,0x1050d33,0x1100005,0x0
.long 0x80b03,0x1050d33,0x1100005,0x0
.long 0x90b03,0x1050d33,0x1100005,0x0
.long 0xa0b03,0x1050d33,0x1100005,0x0
.long 0xb0b03,0x1050d33,0x1100005,0x0
.long 0xc0b03,0x1050d33,0x1100005,0x0
.long 0xd0b03,0x1050d33,0x1100005,0x0
.long 0x20e03,0x1055d16,0x1100008,0xb000000
.long 0x30e03,0x1055d16,0x1100008,0xb000000
.long 0x20e03,0x1055d16,0x1101008,0xb080000
.long 0x30e03,0x1055d16,0x1101008,0xb080000
.long 0x20e03,0x1055d16,0x1102008,0xb100000
.long 0x30e03,0x1055d16,0x1102008,0xb100000
.long 0x20e03,0x1055d16,0x1103008,0xb180000
.long 0x30e03,0x1055d16,0x1103008,0xb180000
.long 0x80d04,0x104d556,0x200,0xad00000
.long 0x90d04,0x104d556,0x200,0xad00000
.long 0xa0d04,0x104d556,0x200,0xad00000
.long 0xb0d04,0x104d556,0x200,0xad00000
.long 0xc0d04,0x104d556,0x200,0xad00000
.long 0xd0d04,0x104d556,0x200,0xad00000
.long 0xe0d04,0x104d556,0x200,0xad00000
.long 0xf0d04,0x104d556,0x200,0xad00000
.long 0x20c03,0x1c59544,0x11c000a,0xac00000
.long 0x30c03,0x1c59544,0x11c000a,0xac00000
.long 0x20c03,0x1c59544,0x11c1c0a,0xac80000
.long 0x20b03,0x1c59143,0x11c000a,0xaa00000
.long 0x30b03,0x1c59143,0x11c000a,0xaa00000
.long 0x20b03,0x1c59143,0x11c1c0a,0xaa80000
.long 0x30b03,0x1c59143,0x11c1c0a,0xaa80000
.long 0x30c03,0x1c59544,0x11c1c0a,0xac80000
.long 0x70d03,0x2051535,0x1100005,0x0
.long 0x80d03,0x2051535,0x1100005,0x0
.long 0x90d03,0x2051535,0x1100005,0x0
.long 0xa0d03,0x2051535,0x1100005,0x0
.long 0xb0d03,0x2051535,0x1100005,0x0
.long 0xc0d03,0x2051535,0x1100005,0x0
.long 0xd0d03,0x2051535,0x1100005,0x0
.long 0x80e04,0x204d957,0x400,0xb000000
.long 0x90e04,0x204d957,0x400,0xb000000
.long 0xa0e04,0x204d957,0x400,0xb000000
.long 0xb0e04,0x204d957,0x400,0xb000000
.long 0xc0e04,0x204d957,0x400,0xb000000
.long 0xd0e04,0x204d957,0x400,0xb000000
.long 0xe0e04,0x204d957,0x400,0xb000000
.long 0xf0e04,0x204d957,0x400,0xb000000
.long 0x70e03,0x2051936,0x1100005,0x0
.long 0x80e03,0x2051936,0x1100005,0x0
.long 0x90e03,0x2051936,0x1100005,0x0
.long 0xa0e03,0x2051936,0x1100005,0x0
.long 0xb0e03,0x2051936,0x1100005,0x0
.long 0xc0e03,0x2051936,0x1100005,0x0
.long 0xd0e03,0x2051936,0x1100005,0x0
.long 0x20d03,0x1c59945,0x10e000a,0xae00000
.long 0x30d03,0x1c59945,0x10e000a,0xae00000
.long 0x20d03,0x1c59945,0x10e0e0a,0xae80000
.long 0x30d03,0x1c59945,0x10e0e0a,0xae80000
.long 0x20d03,0x1c59945,0x10e1c0a,0xaf00000
.long 0x30d03,0x1c59945,0x10e1c0a,0xaf00000
.long 0x20d03,0x1c59945,0x10e2a0a,0xaf80000
.long 0x30d03,0x1c59945,0x10e2a0a,0xaf80000
.long 0x80b04,0x1052164,0x202,0xaa00000
.long 0x90b04,0x1052164,0x202,0xaa00000
.long 0xa0b04,0x1052164,0x202,0xaa00000
.long 0xb0b04,0x1052164,0x202,0xaa00000
.long 0xc0b04,0x1052164,0x202,0xaa00000
.long 0xd0b04,0x1052164,0x202,0xaa00000
.long 0xe0b04,0x1052164,0x202,0xaa00000
.long 0xf0b04,0x1052164,0x202,0xaa00000
.long 0x80c04,0x1052165,0x202,0xac00000
.long 0x90c04,0x1052165,0x202,0xac00000
.long 0xa0c04,0x1052165,0x202,0xac00000
.long 0xb0c04,0x1052165,0x202,0xac00000
.long 0xc0c04,0x1052165,0x202,0xac00000
.long 0xd0c04,0x1052165,0x202,0xac00000
.long 0xe0c04,0x1052165,0x202,0xac00000
.long 0xf0c04,0x1052165,0x202,0xac00000
.long 0x20e03,0x1c59d46,0x10e000a,0xb200000
.long 0x30e03,0x1c59d46,0x10e000a,0xb200000
.long 0x20e03,0x1c59d46,0x10e0e0a,0xb280000
.long 0x30e03,0x1c59d46,0x10e0e0a,0xb280000
.long 0x20e03,0x1c59d46,0x10e1c0a,0xb300000
.long 0x30e03,0x1c59d46,0x10e1c0a,0xb300000
.long 0x20e03,0x1c59d46,0x10e2a0a,0xb380000
.long 0x30e03,0x1c59d46,0x10e2a0a,0xb380000
.long 0x80d04,0x2052166,0x402,0xae00000
.long 0x90d04,0x2052166,0x402,0xae00000
.long 0xa0d04,0x2052166,0x402,0xae00000
.long 0xb0d04,0x2052166,0x402,0xae00000
.long 0xc0d04,0x2052166,0x402,0xae00000
.long 0xd0d04,0x2052166,0x402,0xae00000
.long 0xe0d04,0x2052166,0x402,0xae00000
.long 0xf0d04,0x2052166,0x402,0xae00000
.long 0x80e04,0x2052167,0x402,0xb200000
.long 0x90e04,0x2052167,0x402,0xb200000
.long 0xa0e04,0x2052167,0x402,0xb200000
.long 0xb0e04,0x2052167,0x402,0xb200000
.long 0xc0e04,0x2052167,0x402,0xb200000
.long 0xd0e04,0x2052167,0x402,0xb200000
.long 0xe0e04,0x2052167,0x402,0xb200000
.long 0xf0e04,0x2052167,0x402,0xb200000
.long -1,-1,-1,-1
.long 0x200000,0x4000,0x1000000,0x0
.long 0x210000,0x4000,0x1000000,0x0
.long 0x220000,0x4000,0x1000000,0x0
.long 0x230000,0x4000,0x1000000,0x0
.long 0x240000,0x4400,0x1000000,0x0
.long 0x250000,0x4400,0x1000000,0x0
.long 0x260000,0x4400,0x1000000,0x0
.long 0x270000,0x4400,0x1000000,0x0
.long 0x280000,0x4800,0x1000000,0x0
.long 0x290000,0x4800,0x1000000,0x0
.long 0x2a0000,0x4800,0x1000000,0x0
.long 0x2b0000,0x4800,0x1000000,0x0
.long 0x2c0000,0x4c00,0x1000000,0x0
.long 0x2d0000,0x4c00,0x1000000,0x0
.long 0x2e0000,0x4c00,0x1000000,0x0
.long 0x2f0000,0x4c00,0x1000000,0x0
.long 0x200100,0x8000,0x1000000,0x0
.long 0x210100,0x8000,0x1000000,0x0
.long 0x220100,0x8000,0x1000000,0x0
.long 0x230100,0x8000,0x1000000,0x0
.long 0x240100,0x8400,0x1000000,0x0
.long 0x250100,0x8400,0x1000000,0x0
.long 0x260100,0x8400,0x1000000,0x0
.long 0x270100,0x8400,0x1000000,0x0
.long 0x280100,0x8800,0x1000000,0x0
.long 0x290100,0x8800,0x1000000,0x0
.long 0x2a0100,0x8800,0x1000000,0x0
.long 0x2b0100,0x8800,0x1000000,0x0
.long 0x2c0100,0x8c00,0x1000000,0x0
.long 0x2d0100,0x8c00,0x1000000,0x0
.long 0x2e0100,0x8c00,0x1000000,0x0
.long 0x2f0100,0x8c00,0x1000000,0x0
.long 0x200200,0xc000,0x1000000,0x0
.long 0x210200,0xc000,0x1000000,0x0
.long 0x220200,0xc000,0x1000000,0x0
.long 0x230200,0xc000,0x1000000,0x0
.long 0x240200,0xc400,0x1000000,0x0
.long 0x250200,0xc400,0x1000000,0x0
.long 0x260200,0xc400,0x1000000,0x0
.long 0x270200,0xc400,0x1000000,0x0
.long 0x280200,0xc800,0x1000000,0x0
.long 0x290200,0xc800,0x1000000,0x0
.long 0x2a0200,0xc800,0x1000000,0x0
.long 0x2b0200,0xc800,0x1000000,0x0
.long 0x2c0200,0xcc00,0x1000000,0x0
.long 0x2d0200,0xcc00,0x1000000,0x0
.long 0x2e0200,0xcc00,0x1000000,0x0
.long 0x2f0200,0xcc00,0x1000000,0x0
.long 0x200300,0x10000,0x1000000,0x0
.long 0x210300,0x10000,0x1000000,0x0
.long 0x220300,0x10000,0x1000000,0x0
.long 0x230300,0x10000,0x1000000,0x0
.long 0x240300,0x10400,0x1000000,0x0
.long 0x250300,0x10400,0x1000000,0x0
.long 0x260300,0x10400,0x1000000,0x0
.long 0x270300,0x10400,0x1000000,0x0
.long 0x280300,0x10800,0x1000000,0x0
.long 0x290300,0x10800,0x1000000,0x0
.long 0x2a0300,0x10800,0x1000000,0x0
.long 0x2b0300,0x10800,0x1000000,0x0
.long 0x2c0300,0x10c00,0x1000000,0x0
.long 0x2d0300,0x10c00,0x1000000,0x0
.long 0x2e0300,0x10c00,0x1000000,0x0
.long 0x2f0300,0x10c00,0x1000000,0x0
.long 0x200201,0x14000,0x1000000,0x0
.long 0x210201,0x14000,0x1000000,0x0
.long 0x220201,0x14000,0x1000000,0x0
.long 0x230201,0x14000,0x1000000,0x0
.long 0x240201,0x14400,0x1000000,0x0
.long 0x250201,0x14400,0x1000000,0x0
.long 0x260201,0x14400,0x1000000,0x0
.long 0x270201,0x14400,0x1000000,0x0
.long 0x280201,0x14800,0x1000000,0x0
.long 0x290201,0x14800,0x1000000,0x0
.long 0x2a0201,0x14800,0x1000000,0x0
.long 0x2b0201,0x14800,0x1000000,0x0
.long 0x2c0201,0x14c00,0x1000000,0x0
.long 0x2d0201,0x14c00,0x1000000,0x0
.long 0x2e0201,0x14c00,0x1000000,0x0
.long 0x2f0201,0x14c00,0x1000000,0x0
.long 0x200301,0x1c000,0x1000000,0x0
.long 0x210301,0x1c000,0x1000000,0x0
.long 0x220301,0x1c000,0x1000000,0x0
.long 0x230301,0x1c000,0x1000000,0x0
.long 0x240301,0x1c400,0x1000000,0x0
.long 0x250301,0x1c400,0x1000000,0x0
.long 0x260301,0x1c400,0x1000000,0x0
.long 0x270301,0x1c400,0x1000000,0x0
.long 0x280301,0x1c800,0x1000000,0x0
.long 0x290301,0x1c800,0x1000000,0x0
.long 0x2a0301,0x1c800,0x1000000,0x0
.long 0x2b0301,0x1c800,0x1000000,0x0
.long 0x2c0301,0x1cc00,0x1000000,0x0
.long 0x2d0301,0x1cc00,0x1000000,0x0
.long 0x2e0301,0x1cc00,0x1000000,0x0
.long 0x2f0301,0x1cc00,0x1000000,0x0
.long 0x200401,0x24000,0x2000000,0x0
.long 0x220401,0x24000,0x2000000,0x0
.long 0x240401,0x24400,0x2000000,0x0
.long 0x260401,0x24400,0x2000000,0x0
.long 0x280401,0x24800,0x2000000,0x0
.long 0x2a0401,0x24800,0x2000000,0x0
.long 0x2c0401,0x24c00,0x2000000,0x0
.long 0x2e0401,0x24c00,0x2000000,0x0
.long 0x200501,0x2c000,0x2000000,0x0
.long 0x220501,0x2c000,0x2000000,0x0
.long 0x240501,0x2c400,0x2000000,0x0
.long 0x260501,0x2c400,0x2000000,0x0
.long 0x280501,0x2c800,0x2000000,0x0
.long 0x2a0501,0x2c800,0x2000000,0x0
.long 0x2c0501,0x2cc00,0x2000000,0x0
.long 0x2e0501,0x2cc00,0x2000000,0x0
.long 0x80002,0x442010,0x0,0x0
.long 0x90002,0x442011,0x0,0x0
.long 0xa0002,0x442012,0x0,0x0
.long 0xb0002,0x442013,0x0,0x0
.long 0x80102,0x442020,0x0,0x0
.long 0x90102,0x442021,0x0,0x0
.long 0xa0102,0x442022,0x0,0x0
.long 0xb0102,0x442023,0x0,0x0
.long 0x200601,0x34000,0x2000000,0x0
.long 0x220601,0x34000,0x2000000,0x0
.long 0x240601,0x34400,0x2000000,0x0
.long 0x260601,0x34400,0x2000000,0x0
.long 0x280601,0x34800,0x2000000,0x0
.long 0x2a0601,0x34800,0x2000000,0x0
.long 0x2c0601,0x34c00,0x2000000,0x0
.long 0x2e0601,0x34c00,0x2000000,0x0
.long 0x200701,0x3c000,0x2000000,0x0
.long 0x220701,0x3c000,0x2000000,0x0
.long 0x240701,0x3c400,0x2000000,0x0
.long 0x260701,0x3c400,0x2000000,0x0
.long 0x280701,0x3c800,0x2000000,0x0
.long 0x2a0701,0x3c800,0x2000000,0x0
.long 0x2c0701,0x3cc00,0x2000000,0x0
.long 0x2e0701,0x3cc00,0x2000000,0x0
.long 0x80202,0x442830,0x0,0x0
.long 0x90202,0x442831,0x0,0x0
.long 0xa0202,0x442832,0x0,0x0
.long 0xb0202,0x442833,0x0,0x0
.long 0x80302,0x442840,0x0,0x0
.long 0x90302,0x442841,0x0,0x0
.long 0xa0302,0x442842,0x0,0x0
.long 0xb0302,0x442843,0x0,0x0
.long 0x40005,0x2052508,0x1800000,0x0
.long 0x50005,0x2052508,0x1800000,0x0
.long 0x80402,0x443050,0x0,0x0
.long 0x90402,0x443051,0x0,0x0
.long 0xa0402,0x443052,0x0,0x0
.long 0xb0402,0x443053,0x0,0x0
.long 0x80502,0x443450,0x0,0x0
.long 0x90502,0x443451,0x0,0x0
.long 0xa0502,0x443452,0x0,0x0
.long 0xb0502,0x443453,0x0,0x0
.long 0x40105,0x2052d0a,0x1800000,0x0
.long 0x50105,0x2052d0a,0x1800000,0x0
.long 0x40403,0x105350c,0x1400000,0x0
.long 0x50403,0x105350c,0x1400000,0x0
.long 0x40503,0x105390d,0x1400000,0x0
.long 0x50503,0x105390d,0x1400000,0x0
.long 0x80602,0x443870,0x0,0x0
.long 0x90602,0x443871,0x0,0x0
.long 0xa0602,0x443872,0x0,0x0
.long 0xb0602,0x443873,0x0,0x0
.long 0x40603,0x1053d0e,0x1400000,0x0
.long 0x50603,0x1053d0e,0x1400000,0x0
.long 0x80702,0x443c70,0x0,0x0
.long 0x90702,0x443c71,0x0,0x0
.long 0xa0702,0x443c72,0x0,0x0
.long 0xb0702,0x443c73,0x0,0x0
.long 0x40703,0x105410f,0x1400000,0x0
.long 0x50703,0x105410f,0x1400000,0x0
.long 0x80802,0x444090,0x0,0x0
.long 0x90802,0x444091,0x0,0x0
.long 0xa0802,0x444092,0x0,0x0
.long 0xb0802,0x444093,0x0,0x0
.long 0x80406,0x84b14d,0x0,0x0
.long 0x90406,0x84b14d,0x0,0x0
.long 0xa0406,0x84b14d,0x0,0x0
.long 0xb0406,0x84b14d,0x0,0x0
.long 0x80506,0x84b54e,0x0,0x0
.long 0x90506,0x84b54e,0x0,0x0
.long 0xa0506,0x84b54e,0x0,0x0
.long 0xb0506,0x84b54e,0x0,0x0
.long 0xe0403,0x104f12c,0x1100005,0x0
.long 0xf0403,0x104f12c,0x1100005,0x0
.long 0x100403,0x104f12c,0x1100005,0x0
.long 0x110403,0x104f12c,0x1100005,0x0
.long 0x120403,0x104f12c,0x1100005,0x0
.long 0x130403,0x104f12c,0x1100005,0x0
.long 0x140403,0x104f12c,0x1100005,0x0
.long 0xe0503,0x104f52d,0x1100005,0x0
.long 0xf0503,0x104f52d,0x1100005,0x0
.long 0x100503,0x104f52d,0x1100005,0x0
.long 0x110503,0x104f52d,0x1100005,0x0
.long 0x120503,0x104f52d,0x1100005,0x0
.long 0x130503,0x104f52d,0x1100005,0x0
.long 0x140503,0x104f52d,0x1100005,0x0
.long 0x40803,0x1054510,0x1400000,0x0
.long 0x50803,0x1054510,0x1400000,0x0
.long 0x80902,0x444490,0x0,0x0
.long 0x90902,0x444491,0x0,0x0
.long 0xa0902,0x444492,0x0,0x0
.long 0xb0902,0x444493,0x0,0x0
.long 0x80606,0x84b94f,0x0,0x0
.long 0x90606,0x84b94f,0x0,0x0
.long 0xa0606,0x84b94f,0x0,0x0
.long 0xb0606,0x84b94f,0x0,0x0
.long 0xe0603,0x104f92e,0x2100005,0x0
.long 0x100603,0x104f92e,0x2100005,0x0
.long 0x120603,0x104f92e,0x2100005,0x0
.long 0x140603,0x104f92e,0x1100005,0x0
.long 0x40403,0x1c5213c,0x1380002,0x0
.long 0x50403,0x1c5213c,0x1380002,0x0
.long 0x40503,0x1c5213d,0x1380002,0x0
.long 0x50503,0x1c5213d,0x1380002,0x0
.long 0x40903,0x1054911,0x1400000,0x0
.long 0x50903,0x1054911,0x1400000,0x0
.long 0x80006,0x84a149,0x0,0x0
.long 0x90006,0x84a149,0x0,0x0
.long 0xa0006,0x84a149,0x0,0x0
.long 0xb0006,0x84a149,0x0,0x0
.long 0x80106,0x84a149,0x0,0x0
.long 0x90106,0x84a149,0x0,0x0
.long 0xa0106,0x84a149,0x0,0x0
.long 0xb0106,0x84a149,0x0,0x0
.long 0xe0005,0x204e128,0x1200005,0x0
.long 0xf0005,0x204e128,0x1200005,0x0
.long 0x100005,0x204e128,0x1200005,0x0
.long 0x110005,0x204e128,0x1200005,0x0
.long 0x120005,0x204e128,0x1200005,0x0
.long 0x130005,0x204e128,0x1200005,0x0
.long 0x140005,0x204e128,0x1200005,0x0
.long 0x80a02,0x4448b0,0x0,0x0
.long 0x90a02,0x4448b1,0x0,0x0
.long 0xa0a02,0x4448b2,0x0,0x0
.long 0xb0a02,0x4448b3,0x0,0x0
.long 0x80706,0x84bd50,0x0,0x0
.long 0x90706,0x84bd50,0x0,0x0
.long 0xa0706,0x84bd50,0x0,0x0
.long 0xb0706,0x84bd50,0x0,0x0
.long 0x80206,0x84a94b,0x0,0x0
.long 0x90206,0x84a94b,0x0,0x0
.long 0xa0206,0x84a94b,0x0,0x0
.long 0xb0206,0x84a94b,0x0,0x0
.long 0x80306,0x84a94b,0x0,0x0
.long 0x90306,0x84a94b,0x0,0x0
.long 0xa0306,0x84a94b,0x0,0x0
.long 0xb0306,0x84a94b,0x0,0x0
.long 0xe0703,0x104fd2f,0x2100005,0x0
.long 0x100703,0x104fd2f,0x2100005,0x0
.long 0x120703,0x104fd2f,0x2100005,0x0
.long 0x140703,0x104fd2f,0x1100005,0x0
.long 0xe0105,0x204e92a,0x1200005,0x0
.long 0xf0105,0x204e92a,0x1200005,0x0
.long 0x100105,0x204e92a,0x1200005,0x0
.long 0x110105,0x204e92a,0x1200005,0x0
.long 0x120105,0x204e92a,0x1200005,0x0
.long 0x130105,0x204e92a,0x1200005,0x0
.long 0x40a03,0x1054d12,0x1400000,0x0
.long 0x50a03,0x1054d12,0x1400000,0x0
.long 0x140105,0x204e92a,0x1200005,0x0
.long 0x80b02,0x444cb0,0x0,0x0
.long 0x90b02,0x444cb1,0x0,0x0
.long 0xa0b02,0x444cb2,0x0,0x0
.long 0xb0b02,0x444cb3,0x0,0x0
.long 0x80806,0x84c151,0x0,0x0
.long 0x90806,0x84c151,0x0,0x0
.long 0xa0806,0x84c151,0x0,0x0
.long 0xb0806,0x84c151,0x0,0x0
.long 0x40005,0x1c52138,0x1700002,0x0
.long 0x50005,0x1c52138,0x1700002,0x0
.long 0x40603,0x1c5213e,0x1380002,0x0
.long 0x50603,0x1c5213e,0x1380002,0x0
.long 0xe0803,0x1050130,0x2100005,0x0
.long 0x100803,0x1050130,0x2100005,0x0
.long 0x120803,0x1050130,0x2100005,0x0
.long 0x140803,0x1050130,0x1100005,0x0
.long 0x40b03,0x1055113,0x1400000,0x0
.long 0x50b03,0x1055113,0x1400000,0x0
.long 0x40105,0x1c5213a,0x1700002,0x0
.long 0x50105,0x1c5213a,0x1700002,0x0
.long 0x80c02,0x4450d0,0x0,0x0
.long 0x90c02,0x4450d1,0x0,0x0
.long 0xa0c02,0x4450d2,0x0,0x0
.long 0xb0c02,0x4450d3,0x0,0x0
.long 0x80906,0x84c552,0x0,0x0
.long 0x90906,0x84c552,0x0,0x0
.long 0xa0906,0x84c552,0x0,0x0
.long 0xb0906,0x84c552,0x0,0x0
.long 0x40703,0x1c5213f,0x1380002,0x0
.long 0x50703,0x1c5213f,0x1380002,0x0
.long 0xe0903,0x1050531,0x2100005,0x0
.long 0x100903,0x1050531,0x2100005,0x0
.long 0x120903,0x1050531,0x2100005,0x0
.long 0x140903,0x1050531,0x1100005,0x0
.long 0x40c03,0x1055514,0x1200008,0xab00000
.long 0x50c03,0x1055514,0x1200008,0xab00000
.long 0x40c03,0x1055514,0x1202008,0xab80000
.long 0x50c03,0x1055514,0x1202008,0xab80000
.long 0x80d02,0x4454d0,0x0,0x0
.long 0x90d02,0x4454d1,0x0,0x0
.long 0xa0d02,0x4454d2,0x0,0x0
.long 0xb0d02,0x4454d3,0x0,0x0
.long 0x80a06,0x84c953,0x0,0x0
.long 0x90a06,0x84c953,0x0,0x0
.long 0xa0a06,0x84c953,0x0,0x0
.long 0xb0a06,0x84c953,0x0,0x0
.long 0x40803,0x1c52140,0x1380002,0x0
.long 0x50803,0x1c52140,0x1380002,0x0
.long 0xe0a03,0x1050932,0x1100005,0x0
.long 0xf0a03,0x1050932,0x1100005,0x0
.long 0x100a03,0x1050932,0x1100005,0x0
.long 0x110a03,0x1050932,0x1100005,0x0
.long 0x120a03,0x1050932,0x1100005,0x0
.long 0x130a03,0x1050932,0x1100005,0x0
.long 0x140a03,0x1050932,0x1100005,0x0
.long 0x40d03,0x1055915,0x1200008,0xad00000
.long 0x50d03,0x1055915,0x1200008,0xad00000
.long 0x40d03,0x1055915,0x1202008,0xad80000
.long 0x50d03,0x1055915,0x1202008,0xad80000
.long 0x100c04,0x104d155,0x200,0xab00000
.long 0x110c04,0x104d155,0x200,0xab00000
.long 0x120c04,0x104d155,0x200,0xab00000
.long 0x130c04,0x104d155,0x200,0xab00000
.long 0x140c04,0x104d155,0x200,0xab00000
.long 0x150c04,0x104d155,0x200,0xab00000
.long 0x160c04,0x104d155,0x200,0xab00000
.long 0x170c04,0x104d155,0x200,0xab00000
.long 0x80e02,0x4458f0,0x0,0x0
.long 0x90e02,0x4458f1,0x0,0x0
.long 0xa0e02,0x4458f2,0x0,0x0
.long 0xb0e02,0x4458f3,0x0,0x0
.long 0x80b06,0x84cd54,0x0,0x0
.long 0x90b06,0x84cd54,0x0,0x0
.long 0xa0b06,0x84cd54,0x0,0x0
.long 0xb0b06,0x84cd54,0x0,0x0
.long 0x40903,0x1c52141,0x1380002,0x0
.long 0x50903,0x1c52141,0x1380002,0x0
.long 0x40a03,0x1c52142,0x1380002,0x0
.long 0x50a03,0x1c52142,0x1380002,0x0
.long 0xe0c03,0x2051134,0x1100005,0x0
.long 0xf0c03,0x2051134,0x1100005,0x0
.long 0x100c03,0x2051134,0x1100005,0x0
.long 0x110c03,0x2051134,0x1100005,0x0
.long 0x120c03,0x2051134,0x1100005,0x0
.long 0x130c03,0x2051134,0x1100005,0x0
.long 0x140c03,0x2051134,0x1100005,0x0
.long 0xe0b03,0x1050d33,0x1100005,0x0
.long 0xf0b03,0x1050d33,0x1100005,0x0
.long 0x100b03,0x1050d33,0x1100005,0x0
.long 0x110b03,0x1050d33,0x1100005,0x0
.long 0x120b03,0x1050d33,0x1100005,0x0
.long 0x130b03,0x1050d33,0x1100005,0x0
.long 0x140b03,0x1050d33,0x1100005,0x0
.long 0x40e03,0x1055d16,0x1100008,0xb000000
.long 0x50e03,0x1055d16,0x1100008,0xb000000
.long 0x40e03,0x1055d16,0x1101008,0xb080000
.long 0x50e03,0x1055d16,0x1101008,0xb080000
.long 0x40e03,0x1055d16,0x1102008,0xb100000
.long 0x50e03,0x1055d16,0x1102008,0xb100000
.long 0x40e03,0x1055d16,0x1103008,0xb180000
.long 0x50e03,0x1055d16,0x1103008,0xb180000
.long 0x100d04,0x104d556,0x200,0xad00000
.long 0x110d04,0x104d556,0x200,0xad00000
.long 0x120d04,0x104d556,0x200,0xad00000
.long 0x130d04,0x104d556,0x200,0xad00000
.long 0x140d04,0x104d556,0x200,0xad00000
.long 0x150d04,0x104d556,0x200,0xad00000
.long 0x160d04,0x104d556,0x200,0xad00000
.long 0x170d04,0x104d556,0x200,0xad00000
.long 0x40c03,0x1c59544,0x11c000a,0xac00000
.long 0x50c03,0x1c59544,0x11c000a,0xac00000
.long 0x40c03,0x1c59544,0x11c1c0a,0xac80000
.long 0x40b03,0x1c59143,0x11c000a,0xaa00000
.long 0x50b03,0x1c59143,0x11c000a,0xaa00000
.long 0x40b03,0x1c59143,0x11c1c0a,0xaa80000
.long 0x50b03,0x1c59143,0x11c1c0a,0xaa80000
.long 0x50c03,0x1c59544,0x11c1c0a,0xac80000
.long 0xe0d03,0x2051535,0x1100005,0x0
.long 0xf0d03,0x2051535,0x1100005,0x0
.long 0x100d03,0x2051535,0x1100005,0x0
.long 0x110d03,0x2051535,0x1100005,0x0
.long 0x120d03,0x2051535,0x1100005,0x0
.long 0x130d03,0x2051535,0x1100005,0x0
.long 0x140d03,0x2051535,0x1100005,0x0
.long 0x100e04,0x204d957,0x400,0xb000000
.long 0x110e04,0x204d957,0x400,0xb000000
.long 0x120e04,0x204d957,0x400,0xb000000
.long 0x130e04,0x204d957,0x400,0xb000000
.long 0x140e04,0x204d957,0x400,0xb000000
.long 0x150e04,0x204d957,0x400,0xb000000
.long 0x160e04,0x204d957,0x400,0xb000000
.long 0x170e04,0x204d957,0x400,0xb000000
.long 0xe0e03,0x2051936,0x1100005,0x0
.long 0xf0e03,0x2051936,0x1100005,0x0
.long 0x100e03,0x2051936,0x1100005,0x0
.long 0x110e03,0x2051936,0x1100005,0x0
.long 0x120e03,0x2051936,0x1100005,0x0
.long 0x130e03,0x2051936,0x1100005,0x0
.long 0x140e03,0x2051936,0x1100005,0x0
.long 0x40d03,0x1c59945,0x10e000a,0xae00000
.long 0x50d03,0x1c59945,0x10e000a,0xae00000
.long 0x40d03,0x1c59945,0x10e0e0a,0xae80000
.long 0x50d03,0x1c59945,0x10e0e0a,0xae80000
.long 0x40d03,0x1c59945,0x10e1c0a,0xaf00000
.long 0x50d03,0x1c59945,0x10e1c0a,0xaf00000
.long 0x40d03,0x1c59945,0x10e2a0a,0xaf80000
.long 0x50d03,0x1c59945,0x10e2a0a,0xaf80000
.long 0x100b04,0x1052164,0x202,0xaa00000
.long 0x110b04,0x1052164,0x202,0xaa00000
.long 0x120b04,0x1052164,0x202,0xaa00000
.long 0x130b04,0x1052164,0x202,0xaa00000
.long 0x140b04,0x1052164,0x202,0xaa00000
.long 0x150b04,0x1052164,0x202,0xaa00000
.long 0x160b04,0x1052164,0x202,0xaa00000
.long 0x170b04,0x1052164,0x202,0xaa00000
.long 0x100c04,0x1052165,0x202,0xac00000
.long 0x110c04,0x1052165,0x202,0xac00000
.long 0x120c04,0x1052165,0x202,0xac00000
.long 0x130c04,0x1052165,0x202,0xac00000
.long 0x140c04,0x1052165,0x202,0xac00000
.long 0x150c04,0x1052165,0x202,0xac00000
.long 0x160c04,0x1052165,0x202,0xac00000
.long 0x170c04,0x1052165,0x202,0xac00000
.long 0x40e03,0x1c59d46,0x10e000a,0xb200000
.long 0x50e03,0x1c59d46,0x10e000a,0xb200000
.long 0x40e03,0x1c59d46,0x10e0e0a,0xb280000
.long 0x50e03,0x1c59d46,0x10e0e0a,0xb280000
.long 0x40e03,0x1c59d46,0x10e1c0a,0xb300000
.long 0x50e03,0x1c59d46,0x10e1c0a,0xb300000
.long 0x40e03,0x1c59d46,0x10e2a0a,0xb380000
.long 0x50e03,0x1c59d46,0x10e2a0a,0xb380000
.long 0x100d04,0x2052166,0x402,0xae00000
.long 0x110d04,0x2052166,0x402,0xae00000
.long 0x120d04,0x2052166,0x402,0xae00000
.long 0x130d04,0x2052166,0x402,0xae00000
.long 0x140d04,0x2052166,0x402,0xae00000
.long 0x150d04,0x2052166,0x402,0xae00000
.long 0x160d04,0x2052166,0x402,0xae00000
.long 0x170d04,0x2052166,0x402,0xae00000
.long 0x100e04,0x2052167,0x402,0xb200000
.long 0x110e04,0x2052167,0x402,0xb200000
.long 0x120e04,0x2052167,0x402,0xb200000
.long 0x130e04,0x2052167,0x402,0xb200000
.long 0x140e04,0x2052167,0x402,0xb200000
.long 0x150e04,0x2052167,0x402,0xb200000
.long 0x160e04,0x2052167,0x402,0xb200000
.long 0x170e04,0x2052167,0x402,0xb200000
.long -1,-1,-1,-1
.long 0x300000,0x5000,0x1000000,0x0
.long 0x310000,0x5000,0x1000000,0x0
.long 0x320000,0x5000,0x1000000,0x0
.long 0x330000,0x5000,0x1000000,0x0
.long 0x340000,0x5400,0x1000000,0x0
.long 0x350000,0x5400,0x1000000,0x0
.long 0x360000,0x5400,0x1000000,0x0
.long 0x370000,0x5400,0x1000000,0x0
.long 0x380000,0x5800,0x1000000,0x0
.long 0x390000,0x5800,0x1000000,0x0
.long 0x3a0000,0x5800,0x1000000,0x0
.long 0x3b0000,0x5800,0x1000000,0x0
.long 0x3c0000,0x5c00,0x1000000,0x0
.long 0x3d0000,0x5c00,0x1000000,0x0
.long 0x3e0000,0x5c00,0x1000000,0x0
.long 0x3f0000,0x5c00,0x1000000,0x0
.long 0x300100,0x9000,0x1000000,0x0
.long 0x310100,0x9000,0x1000000,0x0
.long 0x320100,0x9000,0x1000000,0x0
.long 0x330100,0x9000,0x1000000,0x0
.long 0x340100,0x9400,0x1000000,0x0
.long 0x350100,0x9400,0x1000000,0x0
.long 0x360100,0x9400,0x1000000,0x0
.long 0x370100,0x9400,0x1000000,0x0
.long 0x380100,0x9800,0x1000000,0x0
.long 0x390100,0x9800,0x1000000,0x0
.long 0x3a0100,0x9800,0x1000000,0x0
.long 0x3b0100,0x9800,0x1000000,0x0
.long 0x3c0100,0x9c00,0x1000000,0x0
.long 0x3d0100,0x9c00,0x1000000,0x0
.long 0x3e0100,0x9c00,0x1000000,0x0
.long 0x3f0100,0x9c00,0x1000000,0x0
.long 0x300200,0xd000,0x1000000,0x0
.long 0x310200,0xd000,0x1000000,0x0
.long 0x320200,0xd000,0x1000000,0x0
.long 0x330200,0xd000,0x1000000,0x0
.long 0x340200,0xd400,0x1000000,0x0
.long 0x350200,0xd400,0x1000000,0x0
.long 0x360200,0xd400,0x1000000,0x0
.long 0x370200,0xd400,0x1000000,0x0
.long 0x380200,0xd800,0x1000000,0x0
.long 0x390200,0xd800,0x1000000,0x0
.long 0x3a0200,0xd800,0x1000000,0x0
.long 0x3b0200,0xd800,0x1000000,0x0
.long 0x3c0200,0xdc00,0x1000000,0x0
.long 0x3d0200,0xdc00,0x1000000,0x0
.long 0x3e0200,0xdc00,0x1000000,0x0
.long 0x3f0200,0xdc00,0x1000000,0x0
.long 0x300300,0x11000,0x1000000,0x0
.long 0x310300,0x11000,0x1000000,0x0
.long 0x320300,0x11000,0x1000000,0x0
.long 0x330300,0x11000,0x1000000,0x0
.long 0x340300,0x11400,0x1000000,0x0
.long 0x350300,0x11400,0x1000000,0x0
.long 0x360300,0x11400,0x1000000,0x0
.long 0x370300,0x11400,0x1000000,0x0
.long 0x380300,0x11800,0x1000000,0x0
.long 0x390300,0x11800,0x1000000,0x0
.long 0x3a0300,0x11800,0x1000000,0x0
.long 0x3b0300,0x11800,0x1000000,0x0
.long 0x3c0300,0x11c00,0x1000000,0x0
.long 0x3d0300,0x11c00,0x1000000,0x0
.long 0x3e0300,0x11c00,0x1000000,0x0
.long 0x3f0300,0x11c00,0x1000000,0x0
.long 0x300201,0x15000,0x1000000,0x0
.long 0x310201,0x15000,0x1000000,0x0
.long 0x320201,0x15000,0x1000000,0x0
.long 0x330201,0x15000,0x1000000,0x0
.long 0x340201,0x15400,0x1000000,0x0
.long 0x350201,0x15400,0x1000000,0x0
.long 0x360201,0x15400,0x1000000,0x0
.long 0x370201,0x15400,0x1000000,0x0
.long 0x380201,0x15800,0x1000000,0x0
.long 0x390201,0x15800,0x1000000,0x0
.long 0x3a0201,0x15800,0x1000000,0x0
.long 0x3b0201,0x15800,0x1000000,0x0
.long 0x3c0201,0x15c00,0x1000000,0x0
.long 0x3d0201,0x15c00,0x1000000,0x0
.long 0x3e0201,0x15c00,0x1000000,0x0
.long 0x3f0201,0x15c00,0x1000000,0x0
.long 0x300301,0x1d000,0x1000000,0x0
.long 0x310301,0x1d000,0x1000000,0x0
.long 0x320301,0x1d000,0x1000000,0x0
.long 0x330301,0x1d000,0x1000000,0x0
.long 0x340301,0x1d400,0x1000000,0x0
.long 0x350301,0x1d400,0x1000000,0x0
.long 0x360301,0x1d400,0x1000000,0x0
.long 0x370301,0x1d400,0x1000000,0x0
.long 0x380301,0x1d800,0x1000000,0x0
.long 0x390301,0x1d800,0x1000000,0x0
.long 0x3a0301,0x1d800,0x1000000,0x0
.long 0x3b0301,0x1d800,0x1000000,0x0
.long 0x3c0301,0x1dc00,0x1000000,0x0
.long 0x3d0301,0x1dc00,0x1000000,0x0
.long 0x3e0301,0x1dc00,0x1000000,0x0
.long 0x3f0301,0x1dc00,0x1000000,0x0
.long 0x300401,0x25000,0x2000000,0x0
.long 0x320401,0x25000,0x2000000,0x0
.long 0x340401,0x25400,0x2000000,0x0
.long 0x360401,0x25400,0x2000000,0x0
.long 0x380401,0x25800,0x2000000,0x0
.long 0x3a0401,0x25800,0x2000000,0x0
.long 0x3c0401,0x25c00,0x2000000,0x0
.long 0x3e0401,0x25c00,0x2000000,0x0
.long 0x300501,0x2d000,0x2000000,0x0
.long 0x320501,0x2d000,0x2000000,0x0
.long 0x340501,0x2d400,0x2000000,0x0
.long 0x360501,0x2d400,0x2000000,0x0
.long 0x380501,0x2d800,0x2000000,0x0
.long 0x3a0501,0x2d800,0x2000000,0x0
.long 0x3c0501,0x2dc00,0x2000000,0x0
.long 0x3e0501,0x2dc00,0x2000000,0x0
.long 0xc0002,0x442014,0x0,0x0
.long 0xd0002,0x442015,0x0,0x0
.long 0xe0002,0x442016,0x0,0x0
.long 0xf0002,0x442017,0x0,0x0
.long 0xc0102,0x442024,0x0,0x0
.long 0xd0102,0x442025,0x0,0x0
.long 0xe0102,0x442026,0x0,0x0
.long 0xf0102,0x442027,0x0,0x0
.long 0x300601,0x35000,0x2000000,0x0
.long 0x320601,0x35000,0x2000000,0x0
.long 0x340601,0x35400,0x2000000,0x0
.long 0x360601,0x35400,0x2000000,0x0
.long 0x380601,0x35800,0x2000000,0x0
.long 0x3a0601,0x35800,0x2000000,0x0
.long 0x3c0601,0x35c00,0x2000000,0x0
.long 0x3e0601,0x35c00,0x2000000,0x0
.long 0x300701,0x3d000,0x2000000,0x0
.long 0x320701,0x3d000,0x2000000,0x0
.long 0x340701,0x3d400,0x2000000,0x0
.long 0x360701,0x3d400,0x2000000,0x0
.long 0x380701,0x3d800,0x2000000,0x0
.long 0x3a0701,0x3d800,0x2000000,0x0
.long 0x3c0701,0x3dc00,0x2000000,0x0
.long 0x3e0701,0x3dc00,0x2000000,0x0
.long 0xc0202,0x442834,0x0,0x0
.long 0xd0202,0x442835,0x0,0x0
.long 0xe0202,0x442836,0x0,0x0
.long 0xf0202,0x442837,0x0,0x0
.long 0xc0302,0x442844,0x0,0x0
.long 0xd0302,0x442845,0x0,0x0
.long 0xe0302,0x442846,0x0,0x0
.long 0xf0302,0x442847,0x0,0x0
.long 0x60005,0x2052508,0x1800000,0x0
.long 0x70005,0x2052508,0x1800000,0x0
.long 0xc0402,0x443054,0x0,0x0
.long 0xd0402,0x443055,0x0,0x0
.long 0xe0402,0x443056,0x0,0x0
.long 0xf0402,0x443057,0x0,0x0
.long 0xc0502,0x443454,0x0,0x0
.long 0xd0502,0x443455,0x0,0x0
.long 0xe0502,0x443456,0x0,0x0
.long 0xf0502,0x443457,0x0,0x0
.long 0x60105,0x2052d0a,0x1800000,0x0
.long 0x70105,0x2052d0a,0x1800000,0x0
.long 0x60403,0x105350c,0x1400000,0x0
.long 0x70403,0x105350c,0x1400000,0x0
.long 0x60503,0x105390d,0x1400000,0x0
.long 0x70503,0x105390d,0x1400000,0x0
.long 0xc0602,0x443874,0x0,0x0
.long 0xd0602,0x443875,0x0,0x0
.long 0xe0602,0x443876,0x0,0x0
.long 0xf0602,0x443877,0x0,0x0
.long 0x60603,0x1053d0e,0x1400000,0x0
.long 0x70603,0x1053d0e,0x1400000,0x0
.long 0xc0702,0x443c74,0x0,0x0
.long 0xd0702,0x443c75,0x0,0x0
.long 0xe0702,0x443c76,0x0,0x0
.long 0xf0702,0x443c77,0x0,0x0
.long 0x60703,0x105410f,0x1400000,0x0
.long 0x70703,0x105410f,0x1400000,0x0
.long 0xc0802,0x444094,0x0,0x0
.long 0xd0802,0x444095,0x0,0x0
.long 0xe0802,0x444096,0x0,0x0
.long 0xf0802,0x444097,0x0,0x0
.long 0xc0406,0x84b14d,0x0,0x0
.long 0xd0406,0x84b14d,0x0,0x0
.long 0xe0406,0x84b14d,0x0,0x0
.long 0xf0406,0x84b14d,0x0,0x0
.long 0xc0506,0x84b54e,0x0,0x0
.long 0xd0506,0x84b54e,0x0,0x0
.long 0xe0506,0x84b54e,0x0,0x0
.long 0xf0506,0x84b54e,0x0,0x0
.long 0x150403,0x104f12c,0x1100005,0x0
.long 0x160403,0x104f12c,0x1100005,0x0
.long 0x170403,0x104f12c,0x1100005,0x0
.long 0x180403,0x104f12c,0x1100005,0x0
.long 0x190403,0x104f12c,0x1100005,0x0
.long 0x1a0403,0x104f12c,0x1100005,0x0
.long 0x1b0403,0x104f12c,0x1100005,0x0
.long 0x150503,0x104f52d,0x1100005,0x0
.long 0x160503,0x104f52d,0x1100005,0x0
.long 0x170503,0x104f52d,0x1100005,0x0
.long 0x180503,0x104f52d,0x1100005,0x0
.long 0x190503,0x104f52d,0x1100005,0x0
.long 0x1a0503,0x104f52d,0x1100005,0x0
.long 0x1b0503,0x104f52d,0x1100005,0x0
.long 0x60803,0x1054510,0x1400000,0x0
.long 0x70803,0x1054510,0x1400000,0x0
.long 0xc0902,0x444494,0x0,0x0
.long 0xd0902,0x444495,0x0,0x0
.long 0xe0902,0x444496,0x0,0x0
.long 0xf0902,0x444497,0x0,0x0
.long 0xc0606,0x84b94f,0x0,0x0
.long 0xd0606,0x84b94f,0x0,0x0
.long 0xe0606,0x84b94f,0x0,0x0
.long 0xf0606,0x84b94f,0x0,0x0
.long 0x150603,0x104f92e,0x2100005,0x0
.long 0x170603,0x104f92e,0x2100005,0x0
.long 0x190603,0x104f92e,0x2100005,0x0
.long 0x1b0603,0x104f92e,0x1100005,0x0
.long 0x60403,0x1c5213c,0x1380002,0x0
.long 0x70403,0x1c5213c,0x1380002,0x0
.long 0x60503,0x1c5213d,0x1380002,0x0
.long 0x70503,0x1c5213d,0x1380002,0x0
.long 0x60903,0x1054911,0x1400000,0x0
.long 0x70903,0x1054911,0x1400000,0x0
.long 0xc0006,0x84a149,0x0,0x0
.long 0xd0006,0x84a149,0x0,0x0
.long 0xe0006,0x84a149,0x0,0x0
.long 0xf0006,0x84a149,0x0,0x0
.long 0xc0106,0x84a149,0x0,0x0
.long 0xd0106,0x84a149,0x0,0x0
.long 0xe0106,0x84a149,0x0,0x0
.long 0xf0106,0x84a149,0x0,0x0
.long 0x150005,0x204e128,0x1200005,0x0
.long 0x160005,0x204e128,0x1200005,0x0
.long 0x170005,0x204e128,0x1200005,0x0
.long 0x180005,0x204e128,0x1200005,0x0
.long 0x190005,0x204e128,0x1200005,0x0
.long 0x1a0005,0x204e128,0x1200005,0x0
.long 0x1b0005,0x204e128,0x1200005,0x0
.long 0xc0a02,0x4448b4,0x0,0x0
.long 0xd0a02,0x4448b5,0x0,0x0
.long 0xe0a02,0x4448b6,0x0,0x0
.long 0xf0a02,0x4448b7,0x0,0x0
.long 0xc0706,0x84bd50,0x0,0x0
.long 0xd0706,0x84bd50,0x0,0x0
.long 0xe0706,0x84bd50,0x0,0x0
.long 0xf0706,0x84bd50,0x0,0x0
.long 0xc0206,0x84a94b,0x0,0x0
.long 0xd0206,0x84a94b,0x0,0x0
.long 0xe0206,0x84a94b,0x0,0x0
.long 0xf0206,0x84a94b,0x0,0x0
.long 0xc0306,0x84a94b,0x0,0x0
.long 0xd0306,0x84a94b,0x0,0x0
.long 0xe0306,0x84a94b,0x0,0x0
.long 0xf0306,0x84a94b,0x0,0x0
.long 0x150703,0x104fd2f,0x2100005,0x0
.long 0x170703,0x104fd2f,0x2100005,0x0
.long 0x190703,0x104fd2f,0x2100005,0x0
.long 0x1b0703,0x104fd2f,0x1100005,0x0
.long 0x150105,0x204e92a,0x1200005,0x0
.long 0x160105,0x204e92a,0x1200005,0x0
.long 0x170105,0x204e92a,0x1200005,0x0
.long 0x180105,0x204e92a,0x1200005,0x0
.long 0x190105,0x204e92a,0x1200005,0x0
.long 0x1a0105,0x204e92a,0x1200005,0x0
.long 0x60a03,0x1054d12,0x1400000,0x0
.long 0x70a03,0x1054d12,0x1400000,0x0
.long 0x1b0105,0x204e92a,0x1200005,0x0
.long 0xc0b02,0x444cb4,0x0,0x0
.long 0xd0b02,0x444cb5,0x0,0x0
.long 0xe0b02,0x444cb6,0x0,0x0
.long 0xf0b02,0x444cb7,0x0,0x0
.long 0xc0806,0x84c151,0x0,0x0
.long 0xd0806,0x84c151,0x0,0x0
.long 0xe0806,0x84c151,0x0,0x0
.long 0xf0806,0x84c151,0x0,0x0
.long 0x60005,0x1c52138,0x1700002,0x0
.long 0x70005,0x1c52138,0x1700002,0x0
.long 0x60603,0x1c5213e,0x1380002,0x0
.long 0x70603,0x1c5213e,0x1380002,0x0
.long 0x150803,0x1050130,0x2100005,0x0
.long 0x170803,0x1050130,0x2100005,0x0
.long 0x190803,0x1050130,0x2100005,0x0
.long 0x1b0803,0x1050130,0x1100005,0x0
.long 0x60b03,0x1055113,0x1400000,0x0
.long 0x70b03,0x1055113,0x1400000,0x0
.long 0x60105,0x1c5213a,0x1700002,0x0
.long 0x70105,0x1c5213a,0x1700002,0x0
.long 0xc0c02,0x4450d4,0x0,0x0
.long 0xd0c02,0x4450d5,0x0,0x0
.long 0xe0c02,0x4450d6,0x0,0x0
.long 0xf0c02,0x4450d7,0x0,0x0
.long 0xc0906,0x84c552,0x0,0x0
.long 0xd0906,0x84c552,0x0,0x0
.long 0xe0906,0x84c552,0x0,0x0
.long 0xf0906,0x84c552,0x0,0x0
.long 0x60703,0x1c5213f,0x1380002,0x0
.long 0x70703,0x1c5213f,0x1380002,0x0
.long 0x150903,0x1050531,0x2100005,0x0
.long 0x170903,0x1050531,0x2100005,0x0
.long 0x190903,0x1050531,0x2100005,0x0
.long 0x1b0903,0x1050531,0x1100005,0x0
.long 0x60c03,0x1055514,0x1200008,0xab00000
.long 0x70c03,0x1055514,0x1200008,0xab00000
.long 0x60c03,0x1055514,0x1202008,0xab80000
.long 0x70c03,0x1055514,0x1202008,0xab80000
.long 0xc0d02,0x4454d4,0x0,0x0
.long 0xd0d02,0x4454d5,0x0,0x0
.long 0xe0d02,0x4454d6,0x0,0x0
.long 0xf0d02,0x4454d7,0x0,0x0
.long 0xc0a06,0x84c953,0x0,0x0
.long 0xd0a06,0x84c953,0x0,0x0
.long 0xe0a06,0x84c953,0x0,0x0
.long 0xf0a06,0x84c953,0x0,0x0
.long 0x60803,0x1c52140,0x1380002,0x0
.long 0x70803,0x1c52140,0x1380002,0x0
.long 0x150a03,0x1050932,0x1100005,0x0
.long 0x160a03,0x1050932,0x1100005,0x0
.long 0x170a03,0x1050932,0x1100005,0x0
.long 0x180a03,0x1050932,0x1100005,0x0
.long 0x190a03,0x1050932,0x1100005,0x0
.long 0x1a0a03,0x1050932,0x1100005,0x0
.long 0x1b0a03,0x1050932,0x1100005,0x0
.long 0x60d03,0x1055915,0x1200008,0xad00000
.long 0x70d03,0x1055915,0x1200008,0xad00000
.long 0x60d03,0x1055915,0x1202008,0xad80000
.long 0x70d03,0x1055915,0x1202008,0xad80000
.long 0x180c04,0x104d155,0x200,0xab00000
.long 0x190c04,0x104d155,0x200,0xab00000
.long 0x1a0c04,0x104d155,0x200,0xab00000
.long 0x1b0c04,0x104d155,0x200,0xab00000
.long 0x1c0c04,0x104d155,0x200,0xab00000
.long 0x1d0c04,0x104d155,0x200,0xab00000
.long 0x1e0c04,0x104d155,0x200,0xab00000
.long 0x1f0c04,0x104d155,0x200,0xab00000
.long 0xc0e02,0x4458f4,0x0,0x0
.long 0xd0e02,0x4458f5,0x0,0x0
.long 0xe0e02,0x4458f6,0x0,0x0
.long 0xf0e02,0x4458f7,0x0,0x0
.long 0xc0b06,0x84cd54,0x0,0x0
.long 0xd0b06,0x84cd54,0x0,0x0
.long 0xe0b06,0x84cd54,0x0,0x0
.long 0xf0b06,0x84cd54,0x0,0x0
.long 0x60903,0x1c52141,0x1380002,0x0
.long 0x70903,0x1c52141,0x1380002,0x0
.long 0x60a03,0x1c52142,0x1380002,0x0
.long 0x70a03,0x1c52142,0x1380002,0x0
.long 0x150c03,0x2051134,0x1100005,0x0
.long 0x160c03,0x2051134,0x1100005,0x0
.long 0x170c03,0x2051134,0x1100005,0x0
.long 0x180c03,0x2051134,0x1100005,0x0
.long 0x190c03,0x2051134,0x1100005,0x0
.long 0x1a0c03,0x2051134,0x1100005,0x0
.long 0x1b0c03,0x2051134,0x1100005,0x0
.long 0x150b03,0x1050d33,0x1100005,0x0
.long 0x160b03,0x1050d33,0x1100005,0x0
.long 0x170b03,0x1050d33,0x1100005,0x0
.long 0x180b03,0x1050d33,0x1100005,0x0
.long 0x190b03,0x1050d33,0x1100005,0x0
.long 0x1a0b03,0x1050d33,0x1100005,0x0
.long 0x1b0b03,0x1050d33,0x1100005,0x0
.long 0x60e03,0x1055d16,0x1100008,0xb000000
.long 0x70e03,0x1055d16,0x1100008,0xb000000
.long 0x60e03,0x1055d16,0x1101008,0xb080000
.long 0x70e03,0x1055d16,0x1101008,0xb080000
.long 0x60e03,0x1055d16,0x1102008,0xb100000
.long 0x70e03,0x1055d16,0x1102008,0xb100000
.long 0x60e03,0x1055d16,0x1103008,0xb180000
.long 0x70e03,0x1055d16,0x1103008,0xb180000
.long 0x180d04,0x104d556,0x200,0xad00000
.long 0x190d04,0x104d556,0x200,0xad00000
.long 0x1a0d04,0x104d556,0x200,0xad00000
.long 0x1b0d04,0x104d556,0x200,0xad00000
.long 0x1c0d04,0x104d556,0x200,0xad00000
.long 0x1d0d04,0x104d556,0x200,0xad00000
.long 0x1e0d04,0x104d556,0x200,0xad00000
.long 0x1f0d04,0x104d556,0x200,0xad00000
.long 0x60c03,0x1c59544,0x11c000a,0xac00000
.long 0x70c03,0x1c59544,0x11c000a,0xac00000
.long 0x60c03,0x1c59544,0x11c1c0a,0xac80000
.long 0x60b03,0x1c59143,0x11c000a,0xaa00000
.long 0x70b03,0x1c59143,0x11c000a,0xaa00000
.long 0x60b03,0x1c59143,0x11c1c0a,0xaa80000
.long 0x70b03,0x1c59143,0x11c1c0a,0xaa80000
.long 0x70c03,0x1c59544,0x11c1c0a,0xac80000
.long 0x150d03,0x2051535,0x1100005,0x0
.long 0x160d03,0x2051535,0x1100005,0x0
.long 0x170d03,0x2051535,0x1100005,0x0
.long 0x180d03,0x2051535,0x1100005,0x0
.long 0x190d03,0x2051535,0x1100005,0x0
.long 0x1a0d03,0x2051535,0x1100005,0x0
.long 0x1b0d03,0x2051535,0x1100005,0x0
.long 0x180e04,0x204d957,0x400,0xb000000
.long 0x190e04,0x204d957,0x400,0xb000000
.long 0x1a0e04,0x204d957,0x400,0xb000000
.long 0x1b0e04,0x204d957,0x400,0xb000000
.long 0x1c0e04,0x204d957,0x400,0xb000000
.long 0x1d0e04,0x204d957,0x400,0xb000000
.long 0x1e0e04,0x204d957,0x400,0xb000000
.long 0x1f0e04,0x204d957,0x400,0xb000000
.long 0x150e03,0x2051936,0x1100005,0x0
.long 0x160e03,0x2051936,0x1100005,0x0
.long 0x170e03,0x2051936,0x1100005,0x0
.long 0x180e03,0x2051936,0x1100005,0x0
.long 0x190e03,0x2051936,0x1100005,0x0
.long 0x1a0e03,0x2051936,0x1100005,0x0
.long 0x1b0e03,0x2051936,0x1100005,0x0
.long 0x60d03,0x1c59945,0x10e000a,0xae00000
.long 0x70d03,0x1c59945,0x10e000a,0xae00000
.long 0x60d03,0x1c59945,0x10e0e0a,0xae80000
.long 0x70d03,0x1c59945,0x10e0e0a,0xae80000
.long 0x60d03,0x1c59945,0x10e1c0a,0xaf00000
.long 0x70d03,0x1c59945,0x10e1c0a,0xaf00000
.long 0x60d03,0x1c59945,0x10e2a0a,0xaf80000
.long 0x70d03,0x1c59945,0x10e2a0a,0xaf80000
.long 0x180b04,0x1052164,0x202,0xaa00000
.long 0x190b04,0x1052164,0x202,0xaa00000
.long 0x1a0b04,0x1052164,0x202,0xaa00000
.long 0x1b0b04,0x1052164,0x202,0xaa00000
.long 0x1c0b04,0x1052164,0x202,0xaa00000
.long 0x1d0b04,0x1052164,0x202,0xaa00000
.long 0x1e0b04,0x1052164,0x202,0xaa00000
.long 0x1f0b04,0x1052164,0x202,0xaa00000
.long 0x180c04,0x1052165,0x202,0xac00000
.long 0x190c04,0x1052165,0x202,0xac00000
.long 0x1a0c04,0x1052165,0x202,0xac00000
.long 0x1b0c04,0x1052165,0x202,0xac00000
.long 0x1c0c04,0x1052165,0x202,0xac00000
.long 0x1d0c04,0x1052165,0x202,0xac00000
.long 0x1e0c04,0x1052165,0x202,0xac00000
.long 0x1f0c04,0x1052165,0x202,0xac00000
.long 0x60e03,0x1c59d46,0x10e000a,0xb200000
.long 0x70e03,0x1c59d46,0x10e000a,0xb200000
.long 0x60e03,0x1c59d46,0x10e0e0a,0xb280000
.long 0x70e03,0x1c59d46,0x10e0e0a,0xb280000
.long 0x60e03,0x1c59d46,0x10e1c0a,0xb300000
.long 0x70e03,0x1c59d46,0x10e1c0a,0xb300000
.long 0x60e03,0x1c59d46,0x10e2a0a,0xb380000
.long 0x70e03,0x1c59d46,0x10e2a0a,0xb380000
.long 0x180d04,0x2052166,0x402,0xae00000
.long 0x190d04,0x2052166,0x402,0xae00000
.long 0x1a0d04,0x2052166,0x402,0xae00000
.long 0x1b0d04,0x2052166,0x402,0xae00000
.long 0x1c0d04,0x2052166,0x402,0xae00000
.long 0x1d0d04,0x2052166,0x402,0xae00000
.long 0x1e0d04,0x2052166,0x402,0xae00000
.long 0x1f0d04,0x2052166,0x402,0xae00000
.long 0x180e04,0x2052167,0x402,0xb200000
.long 0x190e04,0x2052167,0x402,0xb200000
.long 0x1a0e04,0x2052167,0x402,0xb200000
.long 0x1b0e04,0x2052167,0x402,0xb200000
.long 0x1c0e04,0x2052167,0x402,0xb200000
.long 0x1d0e04,0x2052167,0x402,0xb200000
.long 0x1e0e04,0x2052167,0x402,0xb200000
.long 0x1f0e04,0x2052167,0x402,0xb200000
.long -1,-1,-1,-1
.long 0xf02,0x445ce8,0x1,0x0
.long 0x10f02,0x445ce8,0x1,0x0
.long 0x20f02,0x445ce9,0x1,0x0
.long 0x30f02,0x445ce9,0x1,0x0
.long 0x40f02,0x445cea,0x1,0x0
.long 0x50f02,0x445cea,0x1,0x0
.long 0x60f02,0x445ceb,0x1,0x0
.long 0x70f02,0x445ceb,0x1,0x0
.long 0xf07,0x2056117,0x1100008,0xb400000
.long 0x10f07,0x2056117,0x1100008,0xb400000
.long 0x20f07,0x2056117,0x1100008,0xb400000
.long 0x30f07,0x2056117,0x1100008,0xb400000
.long 0xf07,0x2056117,0x1101008,0xb480000
.long 0x10f07,0x2056117,0x1101008,0xb480000
.long 0x20f07,0x2056117,0x1101008,0xb480000
.long 0x30f07,0x2056117,0x1101008,0xb480000
.long 0xf07,0x2056117,0x1102008,0xb500000
.long 0x10f07,0x2056117,0x1102008,0xb500000
.long 0x20f07,0x2056117,0x1102008,0xb500000
.long 0x30f07,0x2056117,0x1102008,0xb500000
.long 0xf07,0x2056117,0x1103008,0xb580000
.long 0x10f07,0x2056117,0x1103008,0xb580000
.long 0x20f07,0x2056117,0x1103008,0xb580000
.long 0x30f07,0x2056117,0x1103008,0xb580000
.long 0xf04,0x404dd58,0x400,0xb400000
.long 0x10f04,0x404dd58,0x400,0xb400000
.long 0x20f04,0x404dd58,0x400,0xb400000
.long 0x30f04,0x404dd58,0x400,0xb400000
.long 0x40f04,0x404dd58,0x400,0xb400000
.long 0x50f04,0x404dd58,0x400,0xb400000
.long 0x60f04,0x404dd58,0x400,0xb400000
.long 0x70f04,0x404dd58,0x400,0xb400000
.long 0xf07,0x2051d37,0x1100005,0x0
.long 0x10f07,0x2051d37,0x1100005,0x0
.long 0x20f07,0x2051d37,0x1100005,0x0
.long 0x30f07,0x2051d37,0x1100005,0x0
.long 0x40f07,0x2051d37,0x1100005,0x0
.long 0x50f07,0x2051d37,0x1100005,0x0
.long 0x60f07,0x2051d37,0x1100005,0x0
.long 0x70f07,0x2051d37,0x1100005,0x0
.long 0x80f07,0x2051d37,0x1100005,0x0
.long 0x90f07,0x2051d37,0x1100005,0x0
.long 0xa0f07,0x2051d37,0x1100005,0x0
.long 0xb0f07,0x2051d37,0x1100005,0x0
.long 0xc0f07,0x2051d37,0x1100005,0x0
.long 0xd0f07,0x2051d37,0x1100005,0x0
.long 0xf07,0x385a147,0x10e000a,0xb600000
.long 0x10f07,0x385a147,0x10e000a,0xb600000
.long 0x20f07,0x385a147,0x10e000a,0xb600000
.long 0x30f07,0x385a147,0x10e000a,0xb600000
.long 0xf07,0x385a147,0x10e0e0a,0xb680000
.long 0x10f07,0x385a147,0x10e0e0a,0xb680000
.long 0x20f07,0x385a147,0x10e0e0a,0xb680000
.long 0x30f07,0x385a147,0x10e0e0a,0xb680000
.long 0xf07,0x385a147,0x10e1c0a,0xb700000
.long 0x10f07,0x385a147,0x10e1c0a,0xb700000
.long 0x20f07,0x385a147,0x10e1c0a,0xb700000
.long 0x30f07,0x385a147,0x10e1c0a,0xb700000
.long 0xf07,0x385a147,0x10e2a0a,0xb780000
.long 0x10f07,0x385a147,0x10e2a0a,0xb780000
.long 0x20f07,0x385a147,0x10e2a0a,0xb780000
.long 0x30f07,0x385a147,0x10e2a0a,0xb780000
.long 0xf04,0x4052168,0x402,0xb600000
.long 0x10f04,0x4052168,0x402,0xb600000
.long 0x20f04,0x4052168,0x402,0xb600000
.long 0x30f04,0x4052168,0x402,0xb600000
.long 0x40f04,0x4052168,0x402,0xb600000
.long 0x50f04,0x4052168,0x402,0xb600000
.long 0x60f04,0x4052168,0x402,0xb600000
.long 0x70f04,0x4052168,0x402,0xb600000
.long -1,-1,-1,-1
.long -1,-1,-1,-1
.long -1,-1,-1,-1
.long -1,-1,-1,-1
.long -1,-1,-1,-1
.long -1,-1,-1,-1
.long -1,-1,-1,-1
.long -1,-1,-1,-1
.long -1,-1,-1,-1
.long -1,-1,-1,-1
.long -1,-1,-1,-1
.long -1,-1,-1,-1
.long -1,-1,-1,-1
.long -1,-1,-1,-1
.long -1,-1,-1,-1
.long -1,-1,-1,-1
.long -1,-1,-1,-1
.long -1,-1,-1,-1
.long -1,-1,-1,-1
.long -1,-1,-1,-1
.long -1,-1,-1,-1
.long -1,-1,-1,-1
.long -1,-1,-1,-1
.long -1,-1,-1,-1
.long -1,-1,-1,-1
.long -1,-1,-1,-1
.long -1,-1,-1,-1
.long -1,-1,-1,-1
.long -1,-1,-1,-1
.long -1,-1,-1,-1
.long -1,-1,-1,-1
.long -1,-1,-1,-1
.long -1,-1,-1,-1
.long -1,-1,-1,-1
.long -1,-1,-1,-1
.long -1,-1,-1,-1
.long -1,-1,-1,-1
.long -1,-1,-1,-1
.long -1,-1,-1,-1
.long -1,-1,-1,-1
.long -1,-1,-1,-1
.long -1,-1,-1,-1
.long -1,-1,-1,-1
.long -1,-1,-1,-1
.long -1,-1,-1,-1
.long -1,-1,-1,-1
.long -1,-1,-1,-1
.long -1,-1,-1,-1
.long -1,-1,-1,-1
.long -1,-1,-1,-1
.long -1,-1,-1,-1
.long -1,-1,-1,-1
.long -1,-1,-1,-1
.long -1,-1,-1,-1
.long -1,-1,-1,-1
.long -1,-1,-1,-1
.long -1,-1,-1,-1
.long -1,-1,-1,-1
.long -1,-1,-1,-1
.long -1,-1,-1,-1
.long -1,-1,-1,-1
.long -1,-1,-1,-1
.long -1,-1,-1,-1
.long -1,-1,-1,-1
.long -1,-1,-1,-1
.long -1,-1,-1,-1
.long -1,-1,-1,-1
.long -1,-1,-1,-1
.long -1,-1,-1,-1
.long -1,-1,-1,-1
.long -1,-1,-1,-1
.long -1,-1,-1,-1
.long -1,-1,-1,-1
.long -1,-1,-1,-1
.long -1,-1,-1,-1
.long -1,-1,-1,-1
.long -1,-1,-1,-1
.long -1,-1,-1,-1
.long -1,-1,-1,-1
.long -1,-1,-1,-1
.long -1,-1,-1,-1
.long -1,-1,-1,-1
.long -1,-1,-1,-1
.long -1,-1,-1,-1
.long -1,-1,-1,-1
.long -1,-1,-1,-1
.long -1,-1,-1,-1
.long -1,-1,-1,-1
.long -1,-1,-1,-1
.long -1,-1,-1,-1
.long -1,-1,-1,-1
.long -1,-1,-1,-1
.long -1,-1,-1,-1
.long -1,-1,-1,-1
.long -1,-1,-1,-1
.long -1,-1,-1,-1
.long -1,-1,-1,-1
.long -1,-1,-1,-1
.long -1,-1,-1,-1
.long -1,-1,-1,-1
.long -1,-1,-1,-1
.long -1,-1,-1,-1
.long -1,-1,-1,-1
.long -1,-1,-1,-1
.long -1,-1,-1,-1
.long -1,-1,-1,-1
.long -1,-1,-1,-1
.long -1,-1,-1,-1
.long -1,-1,-1,-1
.long -1,-1,-1,-1
.long -1,-1,-1,-1
.long -1,-1,-1,-1
.long -1,-1,-1,-1
.long -1,-1,-1,-1
.long -1,-1,-1,-1
.long -1,-1,-1,-1
.long -1,-1,-1,-1
.long -1,-1,-1,-1
.long -1,-1,-1,-1
.long -1,-1,-1,-1
.long -1,-1,-1,-1
.long -1,-1,-1,-1
.long -1,-1,-1,-1
.long -1,-1,-1,-1
.long -1,-1,-1,-1
.long -1,-1,-1,-1
.long -1,-1,-1,-1
.long -1,-1,-1,-1
.long -1,-1,-1,-1
.long -1,-1,-1,-1
.long -1,-1,-1,-1
.long -1,-1,-1,-1
.long -1,-1,-1,-1
.long -1,-1,-1,-1
.long -1,-1,-1,-1
.long -1,-1,-1,-1
.long -1,-1,-1,-1
.long -1,-1,-1,-1
.long -1,-1,-1,-1
.long -1,-1,-1,-1
.long -1,-1,-1,-1
.long -1,-1,-1,-1
.long -1,-1,-1,-1
.long -1,-1,-1,-1
.long -1,-1,-1,-1
.long -1,-1,-1,-1
.long -1,-1,-1,-1
.long -1,-1,-1,-1
.long -1,-1,-1,-1
.long -1,-1,-1,-1
.long -1,-1,-1,-1
.long -1,-1,-1,-1
.long -1,-1,-1,-1
.long -1,-1,-1,-1
.long -1,-1,-1,-1
.long -1,-1,-1,-1
.long -1,-1,-1,-1
.long -1,-1,-1,-1
.long -1,-1,-1,-1
.long -1,-1,-1,-1
.long -1,-1,-1,-1
.long -1,-1,-1,-1
.long -1,-1,-1,-1
.long -1,-1,-1,-1
.long -1,-1,-1,-1
.long -1,-1,-1,-1
.long -1,-1,-1,-1
.long -1,-1,-1,-1
.long -1,-1,-1,-1
.long -1,-1,-1,-1
.long -1,-1,-1,-1
.long -1,-1,-1,-1
.long -1,-1,-1,-1
.long -1,-1,-1,-1
.long -1,-1,-1,-1
.long -1,-1,-1,-1
.long -1,-1,-1,-1
.long -1,-1,-1,-1
.long -1,-1,-1,-1
.long -1,-1,-1,-1
.long -1,-1,-1,-1
.long -1,-1,-1,-1
.long -1,-1,-1,-1
.long -1,-1,-1,-1
.long -1,-1,-1,-1
.long -1,-1,-1,-1
.long -1,-1,-1,-1
.long -1,-1,-1,-1
.long -1,-1,-1,-1
.long -1,-1,-1,-1
.long -1,-1,-1,-1
.long -1,-1,-1,-1
.long -1,-1,-1,-1
.long -1,-1,-1,-1
.long -1,-1,-1,-1
.long -1,-1,-1,-1
.long -1,-1,-1,-1
.long -1,-1,-1,-1
.long -1,-1,-1,-1
.long -1,-1,-1,-1
.long -1,-1,-1,-1
.long -1,-1,-1,-1
.long -1,-1,-1,-1
.long -1,-1,-1,-1
.long -1,-1,-1,-1
.long -1,-1,-1,-1
.long -1,-1,-1,-1
.long -1,-1,-1,-1
.long -1,-1,-1,-1
.long -1,-1,-1,-1
.long -1,-1,-1,-1
.long -1,-1,-1,-1
.long -1,-1,-1,-1
.long -1,-1,-1,-1
.long -1,-1,-1,-1
.long -1,-1,-1,-1
.long -1,-1,-1,-1
.long -1,-1,-1,-1
.long -1,-1,-1,-1
.long -1,-1,-1,-1
.long -1,-1,-1,-1
.long -1,-1,-1,-1
.long -1,-1,-1,-1
.long -1,-1,-1,-1
.long -1,-1,-1,-1
.long -1,-1,-1,-1
.long -1,-1,-1,-1
.long -1,-1,-1,-1
.long -1,-1,-1,-1
.long -1,-1,-1,-1
.long -1,-1,-1,-1
.long -1,-1,-1,-1
.long -1,-1,-1,-1
.long -1,-1,-1,-1
.long -1,-1,-1,-1
.long -1,-1,-1,-1
.long -1,-1,-1,-1
.long -1,-1,-1,-1
.long -1,-1,-1,-1
.long -1,-1,-1,-1
.long -1,-1,-1,-1
.long -1,-1,-1,-1
.long -1,-1,-1,-1
.long -1,-1,-1,-1
.long -1,-1,-1,-1
.long -1,-1,-1,-1
.long -1,-1,-1,-1
.long -1,-1,-1,-1
.long -1,-1,-1,-1
.long -1,-1,-1,-1
.long -1,-1,-1,-1
.long -1,-1,-1,-1
.long -1,-1,-1,-1
.long -1,-1,-1,-1
.long -1,-1,-1,-1
.long -1,-1,-1,-1
.long -1,-1,-1,-1
.long -1,-1,-1,-1
.long -1,-1,-1,-1
.long -1,-1,-1,-1
.long -1,-1,-1,-1
.long -1,-1,-1,-1
.long -1,-1,-1,-1
.long -1,-1,-1,-1
.long -1,-1,-1,-1
.long -1,-1,-1,-1
.long -1,-1,-1,-1
.long -1,-1,-1,-1
.long -1,-1,-1,-1
.long -1,-1,-1,-1
.long -1,-1,-1,-1
.long -1,-1,-1,-1
.long -1,-1,-1,-1
.long -1,-1,-1,-1
.long -1,-1,-1,-1
.long -1,-1,-1,-1
.long -1,-1,-1,-1
.long -1,-1,-1,-1
.long -1,-1,-1,-1
.long -1,-1,-1,-1
.long -1,-1,-1,-1
.long -1,-1,-1,-1
.long -1,-1,-1,-1
.long -1,-1,-1,-1
.long -1,-1,-1,-1
.long -1,-1,-1,-1
.long -1,-1,-1,-1
.long -1,-1,-1,-1
.long -1,-1,-1,-1
.long -1,-1,-1,-1
.long -1,-1,-1,-1
.long -1,-1,-1,-1
.long -1,-1,-1,-1
.long -1,-1,-1,-1
.long -1,-1,-1,-1
.long -1,-1,-1,-1
.long -1,-1,-1,-1
.long -1,-1,-1,-1
.long -1,-1,-1,-1
.long -1,-1,-1,-1
.long -1,-1,-1,-1
.long -1,-1,-1,-1
.long -1,-1,-1,-1
.long -1,-1,-1,-1
.long -1,-1,-1,-1
.long -1,-1,-1,-1
.long -1,-1,-1,-1
.long -1,-1,-1,-1
.long -1,-1,-1,-1
.long -1,-1,-1,-1
.long -1,-1,-1,-1
.long -1,-1,-1,-1
.long -1,-1,-1,-1
.long -1,-1,-1,-1
.long -1,-1,-1,-1
.long -1,-1,-1,-1
.long -1,-1,-1,-1
.long -1,-1,-1,-1
.long -1,-1,-1,-1
.long -1,-1,-1,-1
.long -1,-1,-1,-1
.long -1,-1,-1,-1
.long -1,-1,-1,-1
.long -1,-1,-1,-1
.long -1,-1,-1,-1
.long -1,-1,-1,-1
.long -1,-1,-1,-1
.long -1,-1,-1,-1
.long -1,-1,-1,-1
.long -1,-1,-1,-1
.long -1,-1,-1,-1
.long -1,-1,-1,-1
.long -1,-1,-1,-1
.long -1,-1,-1,-1
.long -1,-1,-1,-1
.long -1,-1,-1,-1
.long -1,-1,-1,-1
.long -1,-1,-1,-1
.long -1,-1,-1,-1
.long -1,-1,-1,-1
.long -1,-1,-1,-1
.long -1,-1,-1,-1
.long -1,-1,-1,-1
.long -1,-1,-1,-1
.long -1,-1,-1,-1
.long -1,-1,-1,-1
.long -1,-1,-1,-1
.long -1,-1,-1,-1
.long -1,-1,-1,-1
.long -1,-1,-1,-1
.long -1,-1,-1,-1
.long -1,-1,-1,-1
.long -1,-1,-1,-1
.long -1,-1,-1,-1
.long -1,-1,-1,-1
.long -1,-1,-1,-1
.long -1,-1,-1,-1
.long -1,-1,-1,-1
.long -1,-1,-1,-1
.long -1,-1,-1,-1
.long -1,-1,-1,-1
.long -1,-1,-1,-1
.long -1,-1,-1,-1
.long -1,-1,-1,-1
.long -1,-1,-1,-1
.long -1,-1,-1,-1
.long -1,-1,-1,-1
.long -1,-1,-1,-1
.long -1,-1,-1,-1
.long -1,-1,-1,-1
.long -1,-1,-1,-1
.long -1,-1,-1,-1
.long -1,-1,-1,-1
.long -1,-1,-1,-1
.long -1,-1,-1,-1
.long -1,-1,-1,-1
.long -1,-1,-1,-1
.long -1,-1,-1,-1
.long -1,-1,-1,-1
.long -1,-1,-1,-1
.long 0x80f02,0x445cec,0x1,0x0
.long 0x90f02,0x445cec,0x1,0x0
.long 0xa0f02,0x445ced,0x1,0x0
.long 0xb0f02,0x445ced,0x1,0x0
.long 0xc0f02,0x445cee,0x1,0x0
.long 0xd0f02,0x445cee,0x1,0x0
.long 0xe0f02,0x445cef,0x1,0x0
.long 0xf0f02,0x445cef,0x1,0x0
.long 0x40f07,0x2056117,0x1100008,0xb400000
.long 0x50f07,0x2056117,0x1100008,0xb400000
.long 0x60f07,0x2056117,0x1100008,0xb400000
.long 0x70f07,0x2056117,0x1100008,0xb400000
.long 0x40f07,0x2056117,0x1101008,0xb480000
.long 0x50f07,0x2056117,0x1101008,0xb480000
.long 0x60f07,0x2056117,0x1101008,0xb480000
.long 0x70f07,0x2056117,0x1101008,0xb480000
.long 0x40f07,0x2056117,0x1102008,0xb500000
.long 0x50f07,0x2056117,0x1102008,0xb500000
.long 0x60f07,0x2056117,0x1102008,0xb500000
.long 0x70f07,0x2056117,0x1102008,0xb500000
.long 0x40f07,0x2056117,0x1103008,0xb580000
.long 0x50f07,0x2056117,0x1103008,0xb580000
.long 0x60f07,0x2056117,0x1103008,0xb580000
.long 0x70f07,0x2056117,0x1103008,0xb580000
.long 0x80f04,0x404dd58,0x400,0xb400000
.long 0x90f04,0x404dd58,0x400,0xb400000
.long 0xa0f04,0x404dd58,0x400,0xb400000
.long 0xb0f04,0x404dd58,0x400,0xb400000
.long 0xc0f04,0x404dd58,0x400,0xb400000
.long 0xd0f04,0x404dd58,0x400,0xb400000
.long 0xe0f04,0x404dd58,0x400,0xb400000
.long 0xf0f04,0x404dd58,0x400,0xb400000
.long 0xe0f07,0x2051d37,0x1100005,0x0
.long 0xf0f07,0x2051d37,0x1100005,0x0
.long 0x100f07,0x2051d37,0x1100005,0x0
.long 0x110f07,0x2051d37,0x1100005,0x0
.long 0x120f07,0x2051d37,0x1100005,0x0
.long 0x130f07,0x2051d37,0x1100005,0x0
.long 0x140f07,0x2051d37,0x1100005,0x0
.long 0x150f07,0x2051d37,0x1100005,0x0
.long 0x160f07,0x2051d37,0x1100005,0x0
.long 0x170f07,0x2051d37,0x1100005,0x0
.long 0x180f07,0x2051d37,0x1100005,0x0
.long 0x190f07,0x2051d37,0x1100005,0x0
.long 0x1a0f07,0x2051d37,0x1100005,0x0
.long 0x1b0f07,0x2051d37,0x1100005,0x0
.long 0x40f07,0x385a147,0x10e000a,0xb600000
.long 0x50f07,0x385a147,0x10e000a,0xb600000
.long 0x60f07,0x385a147,0x10e000a,0xb600000
.long 0x70f07,0x385a147,0x10e000a,0xb600000
.long 0x40f07,0x385a147,0x10e0e0a,0xb680000
.long 0x50f07,0x385a147,0x10e0e0a,0xb680000
.long 0x60f07,0x385a147,0x10e0e0a,0xb680000
.long 0x70f07,0x385a147,0x10e0e0a,0xb680000
.long 0x40f07,0x385a147,0x10e1c0a,0xb700000
.long 0x50f07,0x385a147,0x10e1c0a,0xb700000
.long 0x60f07,0x385a147,0x10e1c0a,0xb700000
.long 0x70f07,0x385a147,0x10e1c0a,0xb700000
.long 0x40f07,0x385a147,0x10e2a0a,0xb780000
.long 0x50f07,0x385a147,0x10e2a0a,0xb780000
.long 0x60f07,0x385a147,0x10e2a0a,0xb780000
.long 0x70f07,0x385a147,0x10e2a0a,0xb780000
.long 0x80f04,0x4052168,0x402,0xb600000
.long 0x90f04,0x4052168,0x402,0xb600000
.long 0xa0f04,0x4052168,0x402,0xb600000
.long 0xb0f04,0x4052168,0x402,0xb600000
.long 0xc0f04,0x4052168,0x402,0xb600000
.long 0xd0f04,0x4052168,0x402,0xb600000
.long 0xe0f04,0x4052168,0x402,0xb600000
.long 0xf0f04,0x4052168,0x402,0xb600000
.long -1,-1,-1,-1
.long -1,-1,-1,-1
.long -1,-1,-1,-1
.long -1,-1,-1,-1
.long -1,-1,-1,-1
.long -1,-1,-1,-1
.long -1,-1,-1,-1
.long -1,-1,-1,-1
.long -1,-1,-1,-1
.long -1,-1,-1,-1
.long -1,-1,-1,-1
.long -1,-1,-1,-1
.long -1,-1,-1,-1
.long -1,-1,-1,-1
.long -1,-1,-1,-1
.long -1,-1,-1,-1
.long -1,-1,-1,-1
.long -1,-1,-1,-1
.long -1,-1,-1,-1
.long -1,-1,-1,-1
.long -1,-1,-1,-1
.long -1,-1,-1,-1
.long -1,-1,-1,-1
.long -1,-1,-1,-1
.long -1,-1,-1,-1
.long -1,-1,-1,-1
.long -1,-1,-1,-1
.long -1,-1,-1,-1
.long -1,-1,-1,-1
.long -1,-1,-1,-1
.long -1,-1,-1,-1
.long -1,-1,-1,-1
.long -1,-1,-1,-1
.long -1,-1,-1,-1
.long -1,-1,-1,-1
.long -1,-1,-1,-1
.long -1,-1,-1,-1
.long -1,-1,-1,-1
.long -1,-1,-1,-1
.long -1,-1,-1,-1
.long -1,-1,-1,-1
.long -1,-1,-1,-1
.long -1,-1,-1,-1
.long -1,-1,-1,-1
.long -1,-1,-1,-1
.long -1,-1,-1,-1
.long -1,-1,-1,-1
.long -1,-1,-1,-1
.long -1,-1,-1,-1
.long -1,-1,-1,-1
.long -1,-1,-1,-1
.long -1,-1,-1,-1
.long -1,-1,-1,-1
.long -1,-1,-1,-1
.long -1,-1,-1,-1
.long -1,-1,-1,-1
.long -1,-1,-1,-1
.long -1,-1,-1,-1
.long -1,-1,-1,-1
.long -1,-1,-1,-1
.long -1,-1,-1,-1
.long -1,-1,-1,-1
.long -1,-1,-1,-1
.long -1,-1,-1,-1
.long -1,-1,-1,-1
.long -1,-1,-1,-1
.long -1,-1,-1,-1
.long -1,-1,-1,-1
.long -1,-1,-1,-1
.long -1,-1,-1,-1
.long -1,-1,-1,-1
.long -1,-1,-1,-1
.long -1,-1,-1,-1
.long -1,-1,-1,-1
.long -1,-1,-1,-1
.long -1,-1,-1,-1
.long -1,-1,-1,-1
.long -1,-1,-1,-1
.long -1,-1,-1,-1
.long -1,-1,-1,-1
.long -1,-1,-1,-1
.long -1,-1,-1,-1
.long -1,-1,-1,-1
.long -1,-1,-1,-1
.long -1,-1,-1,-1
.long -1,-1,-1,-1
.long -1,-1,-1,-1
.long -1,-1,-1,-1
.long -1,-1,-1,-1
.long -1,-1,-1,-1
.long -1,-1,-1,-1
.long -1,-1,-1,-1
.long -1,-1,-1,-1
.long -1,-1,-1,-1
.long -1,-1,-1,-1
.long -1,-1,-1,-1
.long -1,-1,-1,-1
.long -1,-1,-1,-1
.long -1,-1,-1,-1
.long -1,-1,-1,-1
.long -1,-1,-1,-1
.long -1,-1,-1,-1
.long -1,-1,-1,-1
.long -1,-1,-1,-1
.long -1,-1,-1,-1
.long -1,-1,-1,-1
.long -1,-1,-1,-1
.long -1,-1,-1,-1
.long -1,-1,-1,-1
.long -1,-1,-1,-1
.long -1,-1,-1,-1
.long -1,-1,-1,-1
.long -1,-1,-1,-1
.long -1,-1,-1,-1
.long -1,-1,-1,-1
.long -1,-1,-1,-1
.long -1,-1,-1,-1
.long -1,-1,-1,-1
.long -1,-1,-1,-1
.long -1,-1,-1,-1
.long -1,-1,-1,-1
.long -1,-1,-1,-1
.long -1,-1,-1,-1
.long -1,-1,-1,-1
.long -1,-1,-1,-1
.long -1,-1,-1,-1
.long -1,-1,-1,-1
.long -1,-1,-1,-1
.long -1,-1,-1,-1
.long -1,-1,-1,-1
.long -1,-1,-1,-1
.long -1,-1,-1,-1
.long -1,-1,-1,-1
.long -1,-1,-1,-1
.long -1,-1,-1,-1
.long -1,-1,-1,-1
.long -1,-1,-1,-1
.long -1,-1,-1,-1
.long -1,-1,-1,-1
.long -1,-1,-1,-1
.long -1,-1,-1,-1
.long -1,-1,-1,-1
.long -1,-1,-1,-1
.long -1,-1,-1,-1
.long -1,-1,-1,-1
.long -1,-1,-1,-1
.long -1,-1,-1,-1
.long -1,-1,-1,-1
.long -1,-1,-1,-1
.long -1,-1,-1,-1
.long -1,-1,-1,-1
.long -1,-1,-1,-1
.long -1,-1,-1,-1
.long -1,-1,-1,-1
.long -1,-1,-1,-1
.long -1,-1,-1,-1
.long -1,-1,-1,-1
.long -1,-1,-1,-1
.long -1,-1,-1,-1
.long -1,-1,-1,-1
.long -1,-1,-1,-1
.long -1,-1,-1,-1
.long -1,-1,-1,-1
.long -1,-1,-1,-1
.long -1,-1,-1,-1
.long -1,-1,-1,-1
.long -1,-1,-1,-1
.long -1,-1,-1,-1
.long -1,-1,-1,-1
.long -1,-1,-1,-1
.long -1,-1,-1,-1
.long -1,-1,-1,-1
.long -1,-1,-1,-1
.long -1,-1,-1,-1
.long -1,-1,-1,-1
.long -1,-1,-1,-1
.long -1,-1,-1,-1
.long -1,-1,-1,-1
.long -1,-1,-1,-1
.long -1,-1,-1,-1
.long -1,-1,-1,-1
.long -1,-1,-1,-1
.long -1,-1,-1,-1
.long -1,-1,-1,-1
.long -1,-1,-1,-1
.long -1,-1,-1,-1
.long -1,-1,-1,-1
.long -1,-1,-1,-1
.long -1,-1,-1,-1
.long -1,-1,-1,-1
.long -1,-1,-1,-1
.long -1,-1,-1,-1
.long -1,-1,-1,-1
.long -1,-1,-1,-1
.long -1,-1,-1,-1
.long -1,-1,-1,-1
.long -1,-1,-1,-1
.long -1,-1,-1,-1
.long -1,-1,-1,-1
.long -1,-1,-1,-1
.long -1,-1,-1,-1
.long -1,-1,-1,-1
.long -1,-1,-1,-1
.long -1,-1,-1,-1
.long -1,-1,-1,-1
.long -1,-1,-1,-1
.long -1,-1,-1,-1
.long -1,-1,-1,-1
.long -1,-1,-1,-1
.long -1,-1,-1,-1
.long -1,-1,-1,-1
.long -1,-1,-1,-1
.long -1,-1,-1,-1
.long -1,-1,-1,-1
.long -1,-1,-1,-1
.long -1,-1,-1,-1
.long -1,-1,-1,-1
.long -1,-1,-1,-1
.long -1,-1,-1,-1
.long -1,-1,-1,-1
.long -1,-1,-1,-1
.long -1,-1,-1,-1
.long -1,-1,-1,-1
.long -1,-1,-1,-1
.long -1,-1,-1,-1
.long -1,-1,-1,-1
.long -1,-1,-1,-1
.long -1,-1,-1,-1
.long -1,-1,-1,-1
.long -1,-1,-1,-1
.long -1,-1,-1,-1
.long -1,-1,-1,-1
.long -1,-1,-1,-1
.long -1,-1,-1,-1
.long -1,-1,-1,-1
.long -1,-1,-1,-1
.long -1,-1,-1,-1
.long -1,-1,-1,-1
.long -1,-1,-1,-1
.long -1,-1,-1,-1
.long -1,-1,-1,-1
.long -1,-1,-1,-1
.long -1,-1,-1,-1
.long -1,-1,-1,-1
.long -1,-1,-1,-1
.long -1,-1,-1,-1
.long -1,-1,-1,-1
.long -1,-1,-1,-1
.long -1,-1,-1,-1
.long -1,-1,-1,-1
.long -1,-1,-1,-1
.long -1,-1,-1,-1
.long -1,-1,-1,-1
.long -1,-1,-1,-1
.long -1,-1,-1,-1
.long -1,-1,-1,-1
.long -1,-1,-1,-1
.long -1,-1,-1,-1
.long -1,-1,-1,-1
.long -1,-1,-1,-1
.long -1,-1,-1,-1
.long -1,-1,-1,-1
.long -1,-1,-1,-1
.long -1,-1,-1,-1
.long -1,-1,-1,-1
.long -1,-1,-1,-1
.long -1,-1,-1,-1
.long -1,-1,-1,-1
.long -1,-1,-1,-1
.long -1,-1,-1,-1
.long -1,-1,-1,-1
.long -1,-1,-1,-1
.long -1,-1,-1,-1
.long -1,-1,-1,-1
.long -1,-1,-1,-1
.long -1,-1,-1,-1
.long -1,-1,-1,-1
.long -1,-1,-1,-1
.long -1,-1,-1,-1
.long -1,-1,-1,-1
.long -1,-1,-1,-1
.long -1,-1,-1,-1
.long -1,-1,-1,-1
.long -1,-1,-1,-1
.long -1,-1,-1,-1
.long -1,-1,-1,-1
.long -1,-1,-1,-1
.long -1,-1,-1,-1
.long -1,-1,-1,-1
.long -1,-1,-1,-1
.long -1,-1,-1,-1
.long -1,-1,-1,-1
.long -1,-1,-1,-1
.long -1,-1,-1,-1
.long -1,-1,-1,-1
.long -1,-1,-1,-1
.long -1,-1,-1,-1
.long -1,-1,-1,-1
.long -1,-1,-1,-1
.long -1,-1,-1,-1
.long -1,-1,-1,-1
.long -1,-1,-1,-1
.long -1,-1,-1,-1
.long -1,-1,-1,-1
.long -1,-1,-1,-1
.long -1,-1,-1,-1
.long -1,-1,-1,-1
.long -1,-1,-1,-1
.long -1,-1,-1,-1
.long -1,-1,-1,-1
.long -1,-1,-1,-1
.long -1,-1,-1,-1
.long -1,-1,-1,-1
.long -1,-1,-1,-1
.long -1,-1,-1,-1
.long -1,-1,-1,-1
.long -1,-1,-1,-1
.long -1,-1,-1,-1
.long -1,-1,-1,-1
.long -1,-1,-1,-1
.long -1,-1,-1,-1
.long -1,-1,-1,-1
.long -1,-1,-1,-1
.long -1,-1,-1,-1
.long -1,-1,-1,-1
.long -1,-1,-1,-1
.long -1,-1,-1,-1
.long -1,-1,-1,-1
.long -1,-1,-1,-1
.long -1,-1,-1,-1
.long -1,-1,-1,-1
.long -1,-1,-1,-1
.long -1,-1,-1,-1
.long -1,-1,-1,-1
.long -1,-1,-1,-1
.long -1,-1,-1,-1
.long -1,-1,-1,-1
.long -1,-1,-1,-1
.long -1,-1,-1,-1
.long -1,-1,-1,-1
.long -1,-1,-1,-1
.long -1,-1,-1,-1
.long -1,-1,-1,-1
.long -1,-1,-1,-1
.long -1,-1,-1,-1
.long -1,-1,-1,-1
.long -1,-1,-1,-1
.long -1,-1,-1,-1
.long -1,-1,-1,-1
.long -1,-1,-1,-1
.long -1,-1,-1,-1
.long -1,-1,-1,-1
.long -1,-1,-1,-1
.long -1,-1,-1,-1
.long -1,-1,-1,-1
.long -1,-1,-1,-1
.long -1,-1,-1,-1
.long -1,-1,-1,-1
.long -1,-1,-1,-1
.long -1,-1,-1,-1
.long -1,-1,-1,-1
.long -1,-1,-1,-1
.long -1,-1,-1,-1
.long -1,-1,-1,-1
.long -1,-1,-1,-1
.long -1,-1,-1,-1
.long -1,-1,-1,-1
.long -1,-1,-1,-1
.long -1,-1,-1,-1
.long -1,-1,-1,-1
.long -1,-1,-1,-1
.long -1,-1,-1,-1
.long -1,-1,-1,-1
.long -1,-1,-1,-1
.long -1,-1,-1,-1
.long -1,-1,-1,-1
.long -1,-1,-1,-1
.long -1,-1,-1,-1
.long -1,-1,-1,-1
.long -1,-1,-1,-1
.long 0x100f02,0x445cf0,0x1,0x0
.long 0x110f02,0x445cf0,0x1,0x0
.long 0x120f02,0x445cf1,0x1,0x0
.long 0x130f02,0x445cf1,0x1,0x0
.long 0x140f02,0x445cf2,0x1,0x0
.long 0x150f02,0x445cf2,0x1,0x0
.long 0x160f02,0x445cf3,0x1,0x0
.long 0x170f02,0x445cf3,0x1,0x0
.long 0x80f07,0x2056117,0x1100008,0xb400000
.long 0x90f07,0x2056117,0x1100008,0xb400000
.long 0xa0f07,0x2056117,0x1100008,0xb400000
.long 0xb0f07,0x2056117,0x1100008,0xb400000
.long 0x80f07,0x2056117,0x1101008,0xb480000
.long 0x90f07,0x2056117,0x1101008,0xb480000
.long 0xa0f07,0x2056117,0x1101008,0xb480000
.long 0xb0f07,0x2056117,0x1101008,0xb480000
.long 0x80f07,0x2056117,0x1102008,0xb500000
.long 0x90f07,0x2056117,0x1102008,0xb500000
.long 0xa0f07,0x2056117,0x1102008,0xb500000
.long 0xb0f07,0x2056117,0x1102008,0xb500000
.long 0x80f07,0x2056117,0x1103008,0xb580000
.long 0x90f07,0x2056117,0x1103008,0xb580000
.long 0xa0f07,0x2056117,0x1103008,0xb580000
.long 0xb0f07,0x2056117,0x1103008,0xb580000
.long 0x100f04,0x404dd58,0x400,0xb400000
.long 0x110f04,0x404dd58,0x400,0xb400000
.long 0x120f04,0x404dd58,0x400,0xb400000
.long 0x130f04,0x404dd58,0x400,0xb400000
.long 0x140f04,0x404dd58,0x400,0xb400000
.long 0x150f04,0x404dd58,0x400,0xb400000
.long 0x160f04,0x404dd58,0x400,0xb400000
.long 0x170f04,0x404dd58,0x400,0xb400000
.long 0x1c0f07,0x2051d37,0x1100005,0x0
.long 0x1d0f07,0x2051d37,0x1100005,0x0
.long 0x1e0f07,0x2051d37,0x1100005,0x0
.long 0x1f0f07,0x2051d37,0x1100005,0x0
.long 0x200f07,0x2051d37,0x1100005,0x0
.long 0x210f07,0x2051d37,0x1100005,0x0
.long 0x220f07,0x2051d37,0x1100005,0x0
.long 0x230f07,0x2051d37,0x1100005,0x0
.long 0x240f07,0x2051d37,0x1100005,0x0
.long 0x250f07,0x2051d37,0x1100005,0x0
.long 0x260f07,0x2051d37,0x1100005,0x0
.long 0x270f07,0x2051d37,0x1100005,0x0
.long 0x280f07,0x2051d37,0x1100005,0x0
.long 0x290f07,0x2051d37,0x1100005,0x0
.long 0x80f07,0x385a147,0x10e000a,0xb600000
.long 0x90f07,0x385a147,0x10e000a,0xb600000
.long 0xa0f07,0x385a147,0x10e000a,0xb600000
.long 0xb0f07,0x385a147,0x10e000a,0xb600000
.long 0x80f07,0x385a147,0x10e0e0a,0xb680000
.long 0x90f07,0x385a147,0x10e0e0a,0xb680000
.long 0xa0f07,0x385a147,0x10e0e0a,0xb680000
.long 0xb0f07,0x385a147,0x10e0e0a,0xb680000
.long 0x80f07,0x385a147,0x10e1c0a,0xb700000
.long 0x90f07,0x385a147,0x10e1c0a,0xb700000
.long 0xa0f07,0x385a147,0x10e1c0a,0xb700000
.long 0xb0f07,0x385a147,0x10e1c0a,0xb700000
.long 0x80f07,0x385a147,0x10e2a0a,0xb780000
.long 0x90f07,0x385a147,0x10e2a0a,0xb780000
.long 0xa0f07,0x385a147,0x10e2a0a,0xb780000
.long 0xb0f07,0x385a147,0x10e2a0a,0xb780000
.long 0x100f04,0x4052168,0x402,0xb600000
.long 0x110f04,0x4052168,0x402,0xb600000
.long 0x120f04,0x4052168,0x402,0xb600000
.long 0x130f04,0x4052168,0x402,0xb600000
.long 0x140f04,0x4052168,0x402,0xb600000
.long 0x150f04,0x4052168,0x402,0xb600000
.long 0x160f04,0x4052168,0x402,0xb600000
.long 0x170f04,0x4052168,0x402,0xb600000
.long -1,-1,-1,-1
.long -1,-1,-1,-1
.long -1,-1,-1,-1
.long -1,-1,-1,-1
.long -1,-1,-1,-1
.long -1,-1,-1,-1
.long -1,-1,-1,-1
.long -1,-1,-1,-1
.long -1,-1,-1,-1
.long -1,-1,-1,-1
.long -1,-1,-1,-1
.long -1,-1,-1,-1
.long -1,-1,-1,-1
.long -1,-1,-1,-1
.long -1,-1,-1,-1
.long -1,-1,-1,-1
.long -1,-1,-1,-1
.long -1,-1,-1,-1
.long -1,-1,-1,-1
.long -1,-1,-1,-1
.long -1,-1,-1,-1
.long -1,-1,-1,-1
.long -1,-1,-1,-1
.long -1,-1,-1,-1
.long -1,-1,-1,-1
.long -1,-1,-1,-1
.long -1,-1,-1,-1
.long -1,-1,-1,-1
.long -1,-1,-1,-1
.long -1,-1,-1,-1
.long -1,-1,-1,-1
.long -1,-1,-1,-1
.long -1,-1,-1,-1
.long -1,-1,-1,-1
.long -1,-1,-1,-1
.long -1,-1,-1,-1
.long -1,-1,-1,-1
.long -1,-1,-1,-1
.long -1,-1,-1,-1
.long -1,-1,-1,-1
.long -1,-1,-1,-1
.long -1,-1,-1,-1
.long -1,-1,-1,-1
.long -1,-1,-1,-1
.long -1,-1,-1,-1
.long -1,-1,-1,-1
.long -1,-1,-1,-1
.long -1,-1,-1,-1
.long -1,-1,-1,-1
.long -1,-1,-1,-1
.long -1,-1,-1,-1
.long -1,-1,-1,-1
.long -1,-1,-1,-1
.long -1,-1,-1,-1
.long -1,-1,-1,-1
.long -1,-1,-1,-1
.long -1,-1,-1,-1
.long -1,-1,-1,-1
.long -1,-1,-1,-1
.long -1,-1,-1,-1
.long -1,-1,-1,-1
.long -1,-1,-1,-1
.long -1,-1,-1,-1
.long -1,-1,-1,-1
.long -1,-1,-1,-1
.long -1,-1,-1,-1
.long -1,-1,-1,-1
.long -1,-1,-1,-1
.long -1,-1,-1,-1
.long -1,-1,-1,-1
.long -1,-1,-1,-1
.long -1,-1,-1,-1
.long -1,-1,-1,-1
.long -1,-1,-1,-1
.long -1,-1,-1,-1
.long -1,-1,-1,-1
.long -1,-1,-1,-1
.long -1,-1,-1,-1
.long -1,-1,-1,-1
.long -1,-1,-1,-1
.long -1,-1,-1,-1
.long -1,-1,-1,-1
.long -1,-1,-1,-1
.long -1,-1,-1,-1
.long -1,-1,-1,-1
.long -1,-1,-1,-1
.long -1,-1,-1,-1
.long -1,-1,-1,-1
.long -1,-1,-1,-1
.long -1,-1,-1,-1
.long -1,-1,-1,-1
.long -1,-1,-1,-1
.long -1,-1,-1,-1
.long -1,-1,-1,-1
.long -1,-1,-1,-1
.long -1,-1,-1,-1
.long -1,-1,-1,-1
.long -1,-1,-1,-1
.long -1,-1,-1,-1
.long -1,-1,-1,-1
.long -1,-1,-1,-1
.long -1,-1,-1,-1
.long -1,-1,-1,-1
.long -1,-1,-1,-1
.long -1,-1,-1,-1
.long -1,-1,-1,-1
.long -1,-1,-1,-1
.long -1,-1,-1,-1
.long -1,-1,-1,-1
.long -1,-1,-1,-1
.long -1,-1,-1,-1
.long -1,-1,-1,-1
.long -1,-1,-1,-1
.long -1,-1,-1,-1
.long -1,-1,-1,-1
.long -1,-1,-1,-1
.long -1,-1,-1,-1
.long -1,-1,-1,-1
.long -1,-1,-1,-1
.long -1,-1,-1,-1
.long -1,-1,-1,-1
.long -1,-1,-1,-1
.long -1,-1,-1,-1
.long -1,-1,-1,-1
.long -1,-1,-1,-1
.long -1,-1,-1,-1
.long -1,-1,-1,-1
.long -1,-1,-1,-1
.long -1,-1,-1,-1
.long -1,-1,-1,-1
.long -1,-1,-1,-1
.long -1,-1,-1,-1
.long -1,-1,-1,-1
.long -1,-1,-1,-1
.long -1,-1,-1,-1
.long -1,-1,-1,-1
.long -1,-1,-1,-1
.long -1,-1,-1,-1
.long -1,-1,-1,-1
.long -1,-1,-1,-1
.long -1,-1,-1,-1
.long -1,-1,-1,-1
.long -1,-1,-1,-1
.long -1,-1,-1,-1
.long -1,-1,-1,-1
.long -1,-1,-1,-1
.long -1,-1,-1,-1
.long -1,-1,-1,-1
.long -1,-1,-1,-1
.long -1,-1,-1,-1
.long -1,-1,-1,-1
.long -1,-1,-1,-1
.long -1,-1,-1,-1
.long -1,-1,-1,-1
.long -1,-1,-1,-1
.long -1,-1,-1,-1
.long -1,-1,-1,-1
.long -1,-1,-1,-1
.long -1,-1,-1,-1
.long -1,-1,-1,-1
.long -1,-1,-1,-1
.long -1,-1,-1,-1
.long -1,-1,-1,-1
.long -1,-1,-1,-1
.long -1,-1,-1,-1
.long -1,-1,-1,-1
.long -1,-1,-1,-1
.long -1,-1,-1,-1
.long -1,-1,-1,-1
.long -1,-1,-1,-1
.long -1,-1,-1,-1
.long -1,-1,-1,-1
.long -1,-1,-1,-1
.long -1,-1,-1,-1
.long -1,-1,-1,-1
.long -1,-1,-1,-1
.long -1,-1,-1,-1
.long -1,-1,-1,-1
.long -1,-1,-1,-1
.long -1,-1,-1,-1
.long -1,-1,-1,-1
.long -1,-1,-1,-1
.long -1,-1,-1,-1
.long -1,-1,-1,-1
.long -1,-1,-1,-1
.long -1,-1,-1,-1
.long -1,-1,-1,-1
.long -1,-1,-1,-1
.long -1,-1,-1,-1
.long -1,-1,-1,-1
.long -1,-1,-1,-1
.long -1,-1,-1,-1
.long -1,-1,-1,-1
.long -1,-1,-1,-1
.long -1,-1,-1,-1
.long -1,-1,-1,-1
.long -1,-1,-1,-1
.long -1,-1,-1,-1
.long -1,-1,-1,-1
.long -1,-1,-1,-1
.long -1,-1,-1,-1
.long -1,-1,-1,-1
.long -1,-1,-1,-1
.long -1,-1,-1,-1
.long -1,-1,-1,-1
.long -1,-1,-1,-1
.long -1,-1,-1,-1
.long -1,-1,-1,-1
.long -1,-1,-1,-1
.long -1,-1,-1,-1
.long -1,-1,-1,-1
.long -1,-1,-1,-1
.long -1,-1,-1,-1
.long -1,-1,-1,-1
.long -1,-1,-1,-1
.long -1,-1,-1,-1
.long -1,-1,-1,-1
.long -1,-1,-1,-1
.long -1,-1,-1,-1
.long -1,-1,-1,-1
.long -1,-1,-1,-1
.long -1,-1,-1,-1
.long -1,-1,-1,-1
.long -1,-1,-1,-1
.long -1,-1,-1,-1
.long -1,-1,-1,-1
.long -1,-1,-1,-1
.long -1,-1,-1,-1
.long -1,-1,-1,-1
.long -1,-1,-1,-1
.long -1,-1,-1,-1
.long -1,-1,-1,-1
.long -1,-1,-1,-1
.long -1,-1,-1,-1
.long -1,-1,-1,-1
.long -1,-1,-1,-1
.long -1,-1,-1,-1
.long -1,-1,-1,-1
.long -1,-1,-1,-1
.long -1,-1,-1,-1
.long -1,-1,-1,-1
.long -1,-1,-1,-1
.long -1,-1,-1,-1
.long -1,-1,-1,-1
.long -1,-1,-1,-1
.long -1,-1,-1,-1
.long -1,-1,-1,-1
.long -1,-1,-1,-1
.long -1,-1,-1,-1
.long -1,-1,-1,-1
.long -1,-1,-1,-1
.long -1,-1,-1,-1
.long -1,-1,-1,-1
.long -1,-1,-1,-1
.long -1,-1,-1,-1
.long -1,-1,-1,-1
.long -1,-1,-1,-1
.long -1,-1,-1,-1
.long -1,-1,-1,-1
.long -1,-1,-1,-1
.long -1,-1,-1,-1
.long -1,-1,-1,-1
.long -1,-1,-1,-1
.long -1,-1,-1,-1
.long -1,-1,-1,-1
.long -1,-1,-1,-1
.long -1,-1,-1,-1
.long -1,-1,-1,-1
.long -1,-1,-1,-1
.long -1,-1,-1,-1
.long -1,-1,-1,-1
.long -1,-1,-1,-1
.long -1,-1,-1,-1
.long -1,-1,-1,-1
.long -1,-1,-1,-1
.long -1,-1,-1,-1
.long -1,-1,-1,-1
.long -1,-1,-1,-1
.long -1,-1,-1,-1
.long -1,-1,-1,-1
.long -1,-1,-1,-1
.long -1,-1,-1,-1
.long -1,-1,-1,-1
.long -1,-1,-1,-1
.long -1,-1,-1,-1
.long -1,-1,-1,-1
.long -1,-1,-1,-1
.long -1,-1,-1,-1
.long -1,-1,-1,-1
.long -1,-1,-1,-1
.long -1,-1,-1,-1
.long -1,-1,-1,-1
.long -1,-1,-1,-1
.long -1,-1,-1,-1
.long -1,-1,-1,-1
.long -1,-1,-1,-1
.long -1,-1,-1,-1
.long -1,-1,-1,-1
.long -1,-1,-1,-1
.long -1,-1,-1,-1
.long -1,-1,-1,-1
.long -1,-1,-1,-1
.long -1,-1,-1,-1
.long -1,-1,-1,-1
.long -1,-1,-1,-1
.long -1,-1,-1,-1
.long -1,-1,-1,-1
.long -1,-1,-1,-1
.long -1,-1,-1,-1
.long -1,-1,-1,-1
.long -1,-1,-1,-1
.long -1,-1,-1,-1
.long -1,-1,-1,-1
.long -1,-1,-1,-1
.long -1,-1,-1,-1
.long -1,-1,-1,-1
.long -1,-1,-1,-1
.long -1,-1,-1,-1
.long -1,-1,-1,-1
.long -1,-1,-1,-1
.long -1,-1,-1,-1
.long -1,-1,-1,-1
.long -1,-1,-1,-1
.long -1,-1,-1,-1
.long -1,-1,-1,-1
.long -1,-1,-1,-1
.long -1,-1,-1,-1
.long -1,-1,-1,-1
.long -1,-1,-1,-1
.long -1,-1,-1,-1
.long -1,-1,-1,-1
.long -1,-1,-1,-1
.long -1,-1,-1,-1
.long -1,-1,-1,-1
.long -1,-1,-1,-1
.long -1,-1,-1,-1
.long -1,-1,-1,-1
.long -1,-1,-1,-1
.long -1,-1,-1,-1
.long -1,-1,-1,-1
.long -1,-1,-1,-1
.long -1,-1,-1,-1
.long -1,-1,-1,-1
.long -1,-1,-1,-1
.long -1,-1,-1,-1
.long -1,-1,-1,-1
.long -1,-1,-1,-1
.long -1,-1,-1,-1
.long -1,-1,-1,-1
.long -1,-1,-1,-1
.long -1,-1,-1,-1
.long -1,-1,-1,-1
.long -1,-1,-1,-1
.long -1,-1,-1,-1
.long -1,-1,-1,-1
.long -1,-1,-1,-1
.long -1,-1,-1,-1
.long -1,-1,-1,-1
.long -1,-1,-1,-1
.long -1,-1,-1,-1
.long -1,-1,-1,-1
.long -1,-1,-1,-1
.long -1,-1,-1,-1
.long -1,-1,-1,-1
.long -1,-1,-1,-1
.long -1,-1,-1,-1
.long -1,-1,-1,-1
.long -1,-1,-1,-1
.long -1,-1,-1,-1
.long -1,-1,-1,-1
.long -1,-1,-1,-1
.long -1,-1,-1,-1
.long -1,-1,-1,-1
.long -1,-1,-1,-1
.long -1,-1,-1,-1
.long -1,-1,-1,-1
.long -1,-1,-1,-1
.long -1,-1,-1,-1
.long -1,-1,-1,-1
.long -1,-1,-1,-1
.long 0x180f02,0x445cf4,0x1,0x0
.long 0x190f02,0x445cf4,0x1,0x0
.long 0x1a0f02,0x445cf5,0x1,0x0
.long 0x1b0f02,0x445cf5,0x1,0x0
.long 0x1c0f02,0x445cf6,0x1,0x0
.long 0x1d0f02,0x445cf6,0x1,0x0
.long 0x1e0f02,0x445cf7,0x1,0x0
.long 0x1f0f02,0x445cf7,0x1,0x0
.long 0xc0f07,0x2056117,0x1100008,0xb400000
.long 0xd0f07,0x2056117,0x1100008,0xb400000
.long 0xe0f07,0x2056117,0x1100008,0xb400000
.long 0xf0f07,0x2056117,0x1100008,0xb400000
.long 0xc0f07,0x2056117,0x1101008,0xb480000
.long 0xd0f07,0x2056117,0x1101008,0xb480000
.long 0xe0f07,0x2056117,0x1101008,0xb480000
.long 0xf0f07,0x2056117,0x1101008,0xb480000
.long 0xc0f07,0x2056117,0x1102008,0xb500000
.long 0xd0f07,0x2056117,0x1102008,0xb500000
.long 0xe0f07,0x2056117,0x1102008,0xb500000
.long 0xf0f07,0x2056117,0x1102008,0xb500000
.long 0xc0f07,0x2056117,0x1103008,0xb580000
.long 0xd0f07,0x2056117,0x1103008,0xb580000
.long 0xe0f07,0x2056117,0x1103008,0xb580000
.long 0xf0f07,0x2056117,0x1103008,0xb580000
.long 0x180f04,0x404dd58,0x400,0xb400000
.long 0x190f04,0x404dd58,0x400,0xb400000
.long 0x1a0f04,0x404dd58,0x400,0xb400000
.long 0x1b0f04,0x404dd58,0x400,0xb400000
.long 0x1c0f04,0x404dd58,0x400,0xb400000
.long 0x1d0f04,0x404dd58,0x400,0xb400000
.long 0x1e0f04,0x404dd58,0x400,0xb400000
.long 0x1f0f04,0x404dd58,0x400,0xb400000
.long 0x2a0f07,0x2051d37,0x1100005,0x0
.long 0x2b0f07,0x2051d37,0x1100005,0x0
.long 0x2c0f07,0x2051d37,0x1100005,0x0
.long 0x2d0f07,0x2051d37,0x1100005,0x0
.long 0x2e0f07,0x2051d37,0x1100005,0x0
.long 0x2f0f07,0x2051d37,0x1100005,0x0
.long 0x300f07,0x2051d37,0x1100005,0x0
.long 0x310f07,0x2051d37,0x1100005,0x0
.long 0x320f07,0x2051d37,0x1100005,0x0
.long 0x330f07,0x2051d37,0x1100005,0x0
.long 0x340f07,0x2051d37,0x1100005,0x0
.long 0x350f07,0x2051d37,0x1100005,0x0
.long 0x360f07,0x2051d37,0x1100005,0x0
.long 0x370f07,0x2051d37,0x1100005,0x0
.long 0xc0f07,0x385a147,0x10e000a,0xb600000
.long 0xd0f07,0x385a147,0x10e000a,0xb600000
.long 0xe0f07,0x385a147,0x10e000a,0xb600000
.long 0xf0f07,0x385a147,0x10e000a,0xb600000
.long 0xc0f07,0x385a147,0x10e0e0a,0xb680000
.long 0xd0f07,0x385a147,0x10e0e0a,0xb680000
.long 0xe0f07,0x385a147,0x10e0e0a,0xb680000
.long 0xf0f07,0x385a147,0x10e0e0a,0xb680000
.long 0xc0f07,0x385a147,0x10e1c0a,0xb700000
.long 0xd0f07,0x385a147,0x10e1c0a,0xb700000
.long 0xe0f07,0x385a147,0x10e1c0a,0xb700000
.long 0xf0f07,0x385a147,0x10e1c0a,0xb700000
.long 0xc0f07,0x385a147,0x10e2a0a,0xb780000
.long 0xd0f07,0x385a147,0x10e2a0a,0xb780000
.long 0xe0f07,0x385a147,0x10e2a0a,0xb780000
.long 0xf0f07,0x385a147,0x10e2a0a,0xb780000
.long 0x180f04,0x4052168,0x402,0xb600000
.long 0x190f04,0x4052168,0x402,0xb600000
.long 0x1a0f04,0x4052168,0x402,0xb600000
.long 0x1b0f04,0x4052168,0x402,0xb600000
.long 0x1c0f04,0x4052168,0x402,0xb600000
.long 0x1d0f04,0x4052168,0x402,0xb600000
.long 0x1e0f04,0x4052168,0x402,0xb600000
.long 0x1f0f04,0x4052168,0x402,0xb600000
.long -1,-1,-1,-1
.long -1,-1,-1,-1
.long -1,-1,-1,-1
.long -1,-1,-1,-1
.long -1,-1,-1,-1
.long -1,-1,-1,-1
.long -1,-1,-1,-1
.long -1,-1,-1,-1
.long -1,-1,-1,-1
.long -1,-1,-1,-1
.long -1,-1,-1,-1
.long -1,-1,-1,-1
.long -1,-1,-1,-1
.long -1,-1,-1,-1
.long -1,-1,-1,-1
.long -1,-1,-1,-1
.long -1,-1,-1,-1
.long -1,-1,-1,-1
.long -1,-1,-1,-1
.long -1,-1,-1,-1
.long -1,-1,-1,-1
.long -1,-1,-1,-1
.long -1,-1,-1,-1
.long -1,-1,-1,-1
.long -1,-1,-1,-1
.long -1,-1,-1,-1
.long -1,-1,-1,-1
.long -1,-1,-1,-1
.long -1,-1,-1,-1
.long -1,-1,-1,-1
.long -1,-1,-1,-1
.long -1,-1,-1,-1
.long -1,-1,-1,-1
.long -1,-1,-1,-1
.long -1,-1,-1,-1
.long -1,-1,-1,-1
.long -1,-1,-1,-1
.long -1,-1,-1,-1
.long -1,-1,-1,-1
.long -1,-1,-1,-1
.long -1,-1,-1,-1
.long -1,-1,-1,-1
.long -1,-1,-1,-1
.long -1,-1,-1,-1
.long -1,-1,-1,-1
.long -1,-1,-1,-1
.long -1,-1,-1,-1
.long -1,-1,-1,-1
.long -1,-1,-1,-1
.long -1,-1,-1,-1
.long -1,-1,-1,-1
.long -1,-1,-1,-1
.long -1,-1,-1,-1
.long -1,-1,-1,-1
.long -1,-1,-1,-1
.long -1,-1,-1,-1
.long -1,-1,-1,-1
.long -1,-1,-1,-1
.long -1,-1,-1,-1
.long -1,-1,-1,-1
.long -1,-1,-1,-1
.long -1,-1,-1,-1
.long -1,-1,-1,-1
.long -1,-1,-1,-1
.long -1,-1,-1,-1
.long -1,-1,-1,-1
.long -1,-1,-1,-1
.long -1,-1,-1,-1
.long -1,-1,-1,-1
.long -1,-1,-1,-1
.long -1,-1,-1,-1
.long -1,-1,-1,-1
.long -1,-1,-1,-1
.long -1,-1,-1,-1
.long -1,-1,-1,-1
.long -1,-1,-1,-1
.long -1,-1,-1,-1
.long -1,-1,-1,-1
.long -1,-1,-1,-1
.long -1,-1,-1,-1
.long -1,-1,-1,-1
.long -1,-1,-1,-1
.long -1,-1,-1,-1
.long -1,-1,-1,-1
.long -1,-1,-1,-1
.long -1,-1,-1,-1
.long -1,-1,-1,-1
.long -1,-1,-1,-1
.long -1,-1,-1,-1
.long -1,-1,-1,-1
.long -1,-1,-1,-1
.long -1,-1,-1,-1
.long -1,-1,-1,-1
.long -1,-1,-1,-1
.long -1,-1,-1,-1
.long -1,-1,-1,-1
.long -1,-1,-1,-1
.long -1,-1,-1,-1
.long -1,-1,-1,-1
.long -1,-1,-1,-1
.long -1,-1,-1,-1
.long -1,-1,-1,-1
.long -1,-1,-1,-1
.long -1,-1,-1,-1
.long -1,-1,-1,-1
.long -1,-1,-1,-1
.long -1,-1,-1,-1
.long -1,-1,-1,-1
.long -1,-1,-1,-1
.long -1,-1,-1,-1
.long -1,-1,-1,-1
.long -1,-1,-1,-1
.long -1,-1,-1,-1
.long -1,-1,-1,-1
.long -1,-1,-1,-1
.long -1,-1,-1,-1
.long -1,-1,-1,-1
.long -1,-1,-1,-1
.long -1,-1,-1,-1
.long -1,-1,-1,-1
.long -1,-1,-1,-1
.long -1,-1,-1,-1
.long -1,-1,-1,-1
.long -1,-1,-1,-1
.long -1,-1,-1,-1
.long -1,-1,-1,-1
.long -1,-1,-1,-1
.long -1,-1,-1,-1
.long -1,-1,-1,-1
.long -1,-1,-1,-1
.long -1,-1,-1,-1
.long -1,-1,-1,-1
.long -1,-1,-1,-1
.long -1,-1,-1,-1
.long -1,-1,-1,-1
.long -1,-1,-1,-1
.long -1,-1,-1,-1
.long -1,-1,-1,-1
.long -1,-1,-1,-1
.long -1,-1,-1,-1
.long -1,-1,-1,-1
.long -1,-1,-1,-1
.long -1,-1,-1,-1
.long -1,-1,-1,-1
.long -1,-1,-1,-1
.long -1,-1,-1,-1
.long -1,-1,-1,-1
.long -1,-1,-1,-1
.long -1,-1,-1,-1
.long -1,-1,-1,-1
.long -1,-1,-1,-1
.long -1,-1,-1,-1
.long -1,-1,-1,-1
.long -1,-1,-1,-1
.long -1,-1,-1,-1
.long -1,-1,-1,-1
.long -1,-1,-1,-1
.long -1,-1,-1,-1
.long -1,-1,-1,-1
.long -1,-1,-1,-1
.long -1,-1,-1,-1
.long -1,-1,-1,-1
.long -1,-1,-1,-1
.long -1,-1,-1,-1
.long -1,-1,-1,-1
.long -1,-1,-1,-1
.long -1,-1,-1,-1
.long -1,-1,-1,-1
.long -1,-1,-1,-1
.long -1,-1,-1,-1
.long -1,-1,-1,-1
.long -1,-1,-1,-1
.long -1,-1,-1,-1
.long -1,-1,-1,-1
.long -1,-1,-1,-1
.long -1,-1,-1,-1
.long -1,-1,-1,-1
.long -1,-1,-1,-1
.long -1,-1,-1,-1
.long -1,-1,-1,-1
.long -1,-1,-1,-1
.long -1,-1,-1,-1
.long -1,-1,-1,-1
.long -1,-1,-1,-1
.long -1,-1,-1,-1
.long -1,-1,-1,-1
.long -1,-1,-1,-1
.long -1,-1,-1,-1
.long -1,-1,-1,-1
.long -1,-1,-1,-1
.long -1,-1,-1,-1
.long -1,-1,-1,-1
.long -1,-1,-1,-1
.long -1,-1,-1,-1
.long -1,-1,-1,-1
.long -1,-1,-1,-1
.long -1,-1,-1,-1
.long -1,-1,-1,-1
.long -1,-1,-1,-1
.long -1,-1,-1,-1
.long -1,-1,-1,-1
.long -1,-1,-1,-1
.long -1,-1,-1,-1
.long -1,-1,-1,-1
.long -1,-1,-1,-1
.long -1,-1,-1,-1
.long -1,-1,-1,-1
.long -1,-1,-1,-1
.long -1,-1,-1,-1
.long -1,-1,-1,-1
.long -1,-1,-1,-1
.long -1,-1,-1,-1
.long -1,-1,-1,-1
.long -1,-1,-1,-1
.long -1,-1,-1,-1
.long -1,-1,-1,-1
.long -1,-1,-1,-1
.long -1,-1,-1,-1
.long -1,-1,-1,-1
.long -1,-1,-1,-1
.long -1,-1,-1,-1
.long -1,-1,-1,-1
.long -1,-1,-1,-1
.long -1,-1,-1,-1
.long -1,-1,-1,-1
.long -1,-1,-1,-1
.long -1,-1,-1,-1
.long -1,-1,-1,-1
.long -1,-1,-1,-1
.long -1,-1,-1,-1
.long -1,-1,-1,-1
.long -1,-1,-1,-1
.long -1,-1,-1,-1
.long -1,-1,-1,-1
.long -1,-1,-1,-1
.long -1,-1,-1,-1
.long -1,-1,-1,-1
.long -1,-1,-1,-1
.long -1,-1,-1,-1
.long -1,-1,-1,-1
.long -1,-1,-1,-1
.long -1,-1,-1,-1
.long -1,-1,-1,-1
.long -1,-1,-1,-1
.long -1,-1,-1,-1
.long -1,-1,-1,-1
.long -1,-1,-1,-1
.long -1,-1,-1,-1
.long -1,-1,-1,-1
.long -1,-1,-1,-1
.long -1,-1,-1,-1
.long -1,-1,-1,-1
.long -1,-1,-1,-1
.long -1,-1,-1,-1
.long -1,-1,-1,-1
.long -1,-1,-1,-1
.long -1,-1,-1,-1
.long -1,-1,-1,-1
.long -1,-1,-1,-1
.long -1,-1,-1,-1
.long -1,-1,-1,-1
.long -1,-1,-1,-1
.long -1,-1,-1,-1
.long -1,-1,-1,-1
.long -1,-1,-1,-1
.long -1,-1,-1,-1
.long -1,-1,-1,-1
.long -1,-1,-1,-1
.long -1,-1,-1,-1
.long -1,-1,-1,-1
.long -1,-1,-1,-1
.long -1,-1,-1,-1
.long -1,-1,-1,-1
.long -1,-1,-1,-1
.long -1,-1,-1,-1
.long -1,-1,-1,-1
.long -1,-1,-1,-1
.long -1,-1,-1,-1
.long -1,-1,-1,-1
.long -1,-1,-1,-1
.long -1,-1,-1,-1
.long -1,-1,-1,-1
.long -1,-1,-1,-1
.long -1,-1,-1,-1
.long -1,-1,-1,-1
.long -1,-1,-1,-1
.long -1,-1,-1,-1
.long -1,-1,-1,-1
.long -1,-1,-1,-1
.long -1,-1,-1,-1
.long -1,-1,-1,-1
.long -1,-1,-1,-1
.long -1,-1,-1,-1
.long -1,-1,-1,-1
.long -1,-1,-1,-1
.long -1,-1,-1,-1
.long -1,-1,-1,-1
.long -1,-1,-1,-1
.long -1,-1,-1,-1
.long -1,-1,-1,-1
.long -1,-1,-1,-1
.long -1,-1,-1,-1
.long -1,-1,-1,-1
.long -1,-1,-1,-1
.long -1,-1,-1,-1
.long -1,-1,-1,-1
.long -1,-1,-1,-1
.long -1,-1,-1,-1
.long -1,-1,-1,-1
.long -1,-1,-1,-1
.long -1,-1,-1,-1
.long -1,-1,-1,-1
.long -1,-1,-1,-1
.long -1,-1,-1,-1
.long -1,-1,-1,-1
.long -1,-1,-1,-1
.long -1,-1,-1,-1
.long -1,-1,-1,-1
.long -1,-1,-1,-1
.long -1,-1,-1,-1
.long -1,-1,-1,-1
.long -1,-1,-1,-1
.long -1,-1,-1,-1
.long -1,-1,-1,-1
.long -1,-1,-1,-1
.long -1,-1,-1,-1
.long -1,-1,-1,-1
.long -1,-1,-1,-1
.long -1,-1,-1,-1
.long -1,-1,-1,-1
.long -1,-1,-1,-1
.long -1,-1,-1,-1
.long -1,-1,-1,-1
.long -1,-1,-1,-1
.long -1,-1,-1,-1
.long -1,-1,-1,-1
.long -1,-1,-1,-1
.long -1,-1,-1,-1
.long -1,-1,-1,-1
.long -1,-1,-1,-1
.long -1,-1,-1,-1
.long -1,-1,-1,-1
.long -1,-1,-1,-1
.long -1,-1,-1,-1
.long -1,-1,-1,-1
.long -1,-1,-1,-1
.long -1,-1,-1,-1
.long -1,-1,-1,-1
.long -1,-1,-1,-1
.long -1,-1,-1,-1
.long -1,-1,-1,-1
.long -1,-1,-1,-1
.long -1,-1,-1,-1
.long -1,-1,-1,-1
.long -1,-1,-1,-1
.long -1,-1,-1,-1
.long -1,-1,-1,-1
.long -1,-1,-1,-1
.long -1,-1,-1,-1
.long -1,-1,-1,-1
.long -1,-1,-1,-1
.long -1,-1,-1,-1
.long -1,-1,-1,-1
.long -1,-1,-1,-1
.long -1,-1,-1,-1
.long -1,-1,-1,-1
.long -1,-1,-1,-1
.long -1,-1,-1,-1
.long -1,-1,-1,-1
.long -1,-1,-1,-1
.long -1,-1,-1,-1
.long -1,-1,-1,-1
.long -1,-1,-1,-1
.long -1,-1,-1,-1
.long -1,-1,-1,-1
.long -1,-1,-1,-1
.long -1,-1,-1,-1
.long -1,-1,-1,-1
.long -1,-1,-1,-1
.long -1,-1,-1,-1
mega_code_end:
.section .rodata,"a"
.p2align 6
.amdhsa_kernel mega_kernel
  .amdhsa_next_free_vgpr 512
  .amdhsa_next_free_sgpr 102
  .amdhsa_accum_offset 256
  .amdhsa_group_segment_fixed_size 0
  .amdhsa_kernarg_size 104
  .amdhsa_user_sgpr_count 2
  .amdhsa_user_sgpr_kernarg_segment_ptr 1
  .amdhsa_system_sgpr_workgroup_id_x 1
.end_amdhsa_kernel
```
